```python
import torch

def _softmax(x, axis=-1):
    return torch.softmax(x, dim=axis)

def _gelu(x):
    return torch.nn.functional.gelu(x, approximate='tanh')

def _silu(x):
    return torch.nn.functional.silu(x)

def _sigmoid(x):
    return torch.sigmoid(x)

def _layernorm(x, axis=-1, eps=1e-05):
    m = x.mean(dim=axis, keepdim=True)
    v = x.var(dim=axis, keepdim=True, unbiased=False)
    return (x - m) / torch.sqrt(v + eps)

def _scatter_add(tgt, idx, src, axis=0):
    return tgt.clone().index_add_(axis, idx, src)

def _segment_sum(src, seg, n):
    out = torch.zeros((n,) + src.shape[1:], dtype=src.dtype)
    return out.index_add_(0, seg, src)

def _pad(x, pw):
    flat = tuple((v for pair in reversed(pw) for v in pair))
    return torch.nn.functional.pad(x, flat)
kernel_name = 'parallel_sum__sliding_block__mixer_gmlp__prompt'

def setup_inputs():

    _w = lambda a: (lambda t: t.to(torch.bfloat16) if t.is_floating_point() else t)(torch.as_tensor(a))

    def _A_setup():
        B, S, D = (1, 2048, 576)
        return {'x': _w((lambda *s: torch.randn(*s, dtype=torch.bfloat16) * 0.05)(B, S, D)), 'wqkv': _w((lambda *s: torch.randn(*s, dtype=torch.bfloat16) * 0.1)(D, 3 * D)), 'wo': _w((lambda *s: torch.randn(*s, dtype=torch.bfloat16) * 0.05)(D, D))}
    _A_in = _A_setup()

    def _B_setup():
        B, S, D, F = (1, 2048, 576, 4608)
        Fh = F // 2
        return {'x': _w((lambda *s: torch.randn(*s, dtype=torch.bfloat16) * 0.05)(B, S, D)), 'w_in': _w((lambda *s: torch.randn(*s, dtype=torch.bfloat16) * 0.4)(D, 2 * Fh)), 'w_sp': _w(0.01 * (lambda *s: torch.randn(*s, dtype=torch.bfloat16) * 0.4)(S, S)), 'b_sp': _w(1.0 + 0.01 * (lambda *s: torch.randn(*s, dtype=torch.bfloat16) * 0.05)(S)), 'w_out': _w((lambda *s: torch.randn(*s, dtype=torch.bfloat16) * 0.05)(Fh, D))}
    _B_in = _B_setup()
    return {'A_x': _A_in['x'], 'A_wqkv': _A_in['wqkv'], 'A_wo': _A_in['wo'], 'B_x': _B_in['x'], 'B_w_in': _B_in['w_in'], 'B_w_sp': _B_in['w_sp'], 'B_b_sp': _B_in['b_sp'], 'B_w_out': _B_in['w_out']}

def reference(A_x, A_wqkv, A_wo, B_x, B_w_in, B_w_sp, B_b_sp, B_w_out):

    def _A_ref(x, wqkv, wo):
        B, S, D = x.shape
        H = 32
        Dh = D // H
        W = 256
        qkv = (lambda x, *d: x.permute(*d))((x @ wqkv).reshape(B, S, 3, H, Dh), 2, 0, 3, 1, 4)
        q, k, v = (qkv[0], qkv[1], qkv[2])
        scores = torch.einsum('bhqd,bhkd->bhqk', q, k) * Dh ** (-0.5)
        idx = torch.arange(S)
        mask = (idx[:, None] - idx[None, :] >= 0) & (idx[:, None] - idx[None, :] < W)
        scores = torch.where(mask[None, None], scores, -1000000000.0)
        p = _softmax(scores, axis=-1)
        o = torch.einsum('bhqk,bhkd->bhqd', p, v)
        return (lambda x, *d: x.permute(*d))(o, 0, 2, 1, 3).reshape(B, S, D) @ wo

    def _B_ref(x, w_in, w_sp, b_sp, w_out):
        B, S, D = x.shape
        F = w_in.shape[-1]
        Fh = F // 2
        z = _gelu(torch.einsum('bsd,df->bsf', x, w_in))
        z1 = z[..., :Fh].clone()
        z2 = _layernorm(z[..., Fh:], axis=-1)
        g = torch.einsum('ts,bsf->btf', w_sp, z2) + b_sp[None, :, None]
        return torch.einsum('bsf,fd->bsd', z1 * g, w_out)
    x = A_x
    xn = _layernorm(x, axis=-1)
    return x + _A_ref(xn, A_wqkv, A_wo) + _B_ref(xn, B_w_in, B_w_sp, B_b_sp, B_w_out)
```

```asm
; @launch kernel=g1_kernel grid=(256,1,1) block=(512,1,1) lds=160256
; @launch kernel=g2_kernel grid=(256,1,1) block=(512,1,1) lds=139264
; @launch kernel=g3_kernel grid=(256,1,1) block=(256,1,1) lds=61440
.amdgcn_target "amdgcn-amd-amdhsa--gfx950"
.text
.globl g1_kernel
.p2align 8
.type g1_kernel,@function
g1_kernel:
    s_cmp_ge_u32 s2, 256
    s_cbranch_scc1 g1_end
    s_load_dwordx2 s[8:9], s[0:1], 0
    s_load_dwordx2 s[12:13], s[0:1], 32
    s_load_dwordx2 s[16:17], s[0:1], 8
    s_load_dwordx2 s[20:21], s[0:1], 80
    s_load_dwordx2 s[40:41], s[0:1], 72
    s_load_dwordx2 s[68:69], s[0:1], 56
    s_load_dwordx2 s[60:61], s[0:1], 16
    s_load_dwordx2 s[76:77], s[0:1], 40
    s_memrealtime s[52:53]
    v_lshrrev_b32 v2, 6, v0
    v_and_b32 v1, 63, v0
    s_nop 0
    v_readfirstlane_b32 s3, v2
    s_and_b32 s4, s2, 3
    s_lshl_b32 s4, s4, 2
    s_bfe_u32 s6, s2, 131075
    s_add_u32 s4, s4, s6
    s_bfe_u32 s5, s2, 65538
    s_lshl_b32 s5, s5, 3
    s_lshr_b32 s6, s2, 5
    s_add_u32 s5, s5, s6
    s_and_b32 s44, s3, 3
    v_lshlrev_b32 v2, 4, v1
    v_lshrrev_b32 v0, 4, v1
    v_and_b32 v4, 8, v1
    v_lshl_or_b32 v0, v4, 1, v0
    v_mul_u32_u24 v0, 1152, v0
    v_and_b32 v4, 7, v1
    v_lshl_add_u32 v0, v4, 4, v0
    s_mul_i32 s54, s5, 288
    s_add_u32 s55, s54, 4608
    s_mul_i32 s56, s5, 72
    s_and_b32 s57, s56, 15
    s_and_b32 s56, s56, 0xfffffff0
    s_mov_b32 s47, 0xbdd2d3e8
    s_mov_b32 s50, 0x3f803f80
    s_lshl_b32 s58, s4, 2
    s_add_u32 s58, s58, s44
    s_cmp_ge_u32 s3, 4
    s_cbranch_scc1 g1_pathB
    s_lshl_b32 s6, s4, 4
    s_and_b32 s7, s3, 6
    s_lshl_b32 s7, s7, 1
    s_add_u32 s6, s6, s7
    s_and_b32 s7, s3, 1
    s_add_u32 s6, s6, s7
    s_mul_i32 s6, s6, 9216
    s_add_u32 s7, s6, 4608
    s_waitcnt lgkmcnt(0)
    s_and_b32 s9, s9, 0xffff
    s_mov_b32 s10, 2359296
    s_mov_b32 s11, 0x00020000
    buffer_load_dwordx4 v[16:19], v0, s[8:11], s6 offen offset:0
    buffer_load_dwordx4 v[20:23], v0, s[8:11], s7 offen offset:0
    buffer_load_dwordx4 v[32:35], v0, s[8:11], s6 offen offset:128
    buffer_load_dwordx4 v[36:39], v0, s[8:11], s7 offen offset:128
    buffer_load_dwordx4 v[48:51], v0, s[8:11], s6 offen offset:256
    buffer_load_dwordx4 v[52:55], v0, s[8:11], s7 offen offset:256
    buffer_load_dwordx4 v[64:67], v0, s[8:11], s6 offen offset:384
    buffer_load_dwordx4 v[68:71], v0, s[8:11], s7 offen offset:384
    buffer_load_dwordx4 v[80:83], v0, s[8:11], s6 offen offset:512
    buffer_load_dwordx4 v[84:87], v0, s[8:11], s7 offen offset:512
    buffer_load_dwordx4 v[96:99], v0, s[8:11], s6 offen offset:640
    buffer_load_dwordx4 v[100:103], v0, s[8:11], s7 offen offset:640
    buffer_load_dwordx4 v[112:115], v0, s[8:11], s6 offen offset:768
    buffer_load_dwordx4 v[116:119], v0, s[8:11], s7 offen offset:768
    buffer_load_dwordx4 v[128:131], v0, s[8:11], s6 offen offset:896
    buffer_load_dwordx4 v[132:135], v0, s[8:11], s7 offen offset:896
    buffer_load_dwordx4 v[144:147], v0, s[8:11], s6 offen offset:1024
    buffer_load_dwordx4 v[148:151], v0, s[8:11], s7 offen offset:1024
    s_and_b32 s13, s13, 0xffff
    s_mov_b32 s14, 5308416
    s_mov_b32 s15, 0x00020000
    s_and_b32 s17, s17, 0xffff
    s_mov_b32 s18, 1990656
    s_mov_b32 s19, 0x00020000
    s_and_b32 s41, s41, 0xffff
    s_mov_b32 s42, 256
    s_mov_b32 s43, 0x00020000
    s_mov_b64 s[24:25], s[20:21]
    s_mov_b64 s[28:29], s[20:21]
    s_mov_b64 s[32:33], s[20:21]
    s_mov_b64 s[36:37], s[20:21]
    s_mov_b64 s[72:73], s[20:21]
    s_add_u32 s72, s72, 56623104
    s_addc_u32 s73, s73, 0
    s_and_b32 s73, s73, 0xffff
    s_mov_b32 s74, 3391488
    s_mov_b32 s75, 0x00020000
    s_and_b32 s77, s77, 0xffff
    s_mov_b32 s78, 8388608
    s_mov_b32 s79, 0x00020000
    s_add_u32 s20, s20, 10485760
    s_addc_u32 s21, s21, 0
    s_and_b32 s21, s21, 0xffff
    s_mov_b32 s22, 9437184
    s_mov_b32 s23, 0x00020000
    s_add_u32 s24, s24, 20971520
    s_addc_u32 s25, s25, 0
    s_and_b32 s25, s25, 0xffff
    s_mov_b32 s26, 9437184
    s_mov_b32 s27, 0x00020000
    s_add_u32 s28, s28, 42991616
    s_addc_u32 s29, s29, 0
    s_and_b32 s29, s29, 0xffff
    s_mov_b32 s30, 3145728
    s_mov_b32 s31, 0x00020000
    s_add_u32 s32, s32, 47185920
    s_addc_u32 s33, s33, 0
    s_and_b32 s33, s33, 0xffff
    s_mov_b32 s34, 5505024
    s_mov_b32 s35, 0x00020000
    s_add_u32 s36, s36, 41943040
    s_addc_u32 s37, s37, 0
    s_and_b32 s37, s37, 0xffff
    s_mov_b32 s38, 524288
    s_mov_b32 s39, 0x00020000
    s_lshl_b32 s6, s44, 7
    s_lshl_b32 s46, s6, 4
    s_cmp_eq_u32 s5, 99
    s_cselect_b32 s7, 5, 4
    v_add_u32 v248, s6, v1
    v_add_u32 v248, 0, v248
    v_mul_u32_u24 v249, 3641, v248
    v_lshrrev_b32 v249, 16, v249
    v_mul_u32_u24 v250, 18, v249
    v_sub_u32 v250, v248, v250
    v_and_b32 v251, 0x23, v249
    v_and_b32 v252, 12, v249
    v_lshl_or_b32 v251, v252, 1, v251
    v_and_b32 v252, 16, v249
    v_lshrrev_b32 v252, 2, v252
    v_or_b32 v251, v251, v252
    v_mul_u32_u24 v7, 9216, v251
    v_lshl_add_u32 v7, v250, 4, v7
    v_mul_u32_u24 v10, 3456, v251
    v_mul_u32_u24 v252, 43, v250
    v_lshrrev_b32 v252, 8, v252
    v_mul_u32_u24 v253, 6, v252
    v_sub_u32 v253, v250, v253
    v_min_u32 v253, s7, v253
    v_mul_u32_u24 v252, 1152, v252
    v_lshl_add_u32 v252, v253, 4, v252
    v_add_u32 v10, v10, v252
    v_add_u32 v248, s6, v1
    v_add_u32 v248, 64, v248
    v_mul_u32_u24 v249, 3641, v248
    v_lshrrev_b32 v249, 16, v249
    v_mul_u32_u24 v250, 18, v249
    v_sub_u32 v250, v248, v250
    v_and_b32 v251, 0x23, v249
    v_and_b32 v252, 12, v249
    v_lshl_or_b32 v251, v252, 1, v251
    v_and_b32 v252, 16, v249
    v_lshrrev_b32 v252, 2, v252
    v_or_b32 v251, v251, v252
    v_mul_u32_u24 v8, 9216, v251
    v_lshl_add_u32 v8, v250, 4, v8
    v_mul_u32_u24 v11, 3456, v251
    v_mul_u32_u24 v252, 43, v250
    v_lshrrev_b32 v252, 8, v252
    v_mul_u32_u24 v253, 6, v252
    v_sub_u32 v253, v250, v253
    v_min_u32 v253, s7, v253
    v_mul_u32_u24 v252, 1152, v252
    v_lshl_add_u32 v252, v253, 4, v252
    v_add_u32 v11, v11, v252
    v_subrev_u32 v8, 1024, v8
    v_subrev_u32 v11, 1024, v11
    v_lshrrev_b32 v248, 4, v1
    v_and_b32 v249, 7, v1
    v_and_or_b32 v250, v1, 8, v248
    s_and_b32 s6, s3, 1
    s_lshl_b32 s6, s6, 2
    v_or_b32 v250, s6, v250
    v_xor_b32 v250, v250, v249
    v_lshlrev_b32 v250, 4, v250
    v_lshl_add_u32 v250, v249, 8, v250
    s_lshr_b32 s6, s3, 1
    s_lshl_b32 s6, s6, 12
    s_add_u32 s6, s6, 110592
    v_add_u32 v200, s6, v250
    v_subrev_u32 v201, 36864, v200
    v_lshrrev_b32 v248, 4, v1
    v_and_b32 v249, 15, v1
    v_xor_b32 v249, v249, v248
    v_lshlrev_b32 v249, 4, v249
    v_lshl_add_u32 v249, v248, 8, v249
    s_lshl_b32 s6, s44, 12
    s_add_u32 s6, s6, 110592
    v_add_u32 v202, s6, v249
    v_xor_b32 v203, 64, v202
    v_subrev_u32 v205, 36864, v202
    v_subrev_u32 v207, 36864, v203
    v_lshrrev_b32 v248, 2, v1
    v_mul_u32_u24 v248, 288, v248
    v_and_b32 v249, 3, v1
    v_lshl_add_u32 v3, v249, 3, v248
    v_add_u32 v4, 55296, v3
    s_add_u32 s6, s57, 32
    v_add_u32 v5, s6, v248
    v_and_b32 v249, 1, v1
    v_mul_u32_u24 v249, 96, v249
    v_add_u32 v5, v5, v249
    v_add_u32 v6, 55296, v5
    s_mul_i32 s6, s44, 9216
    s_add_u32 s6, s6, 110592
    v_lshlrev_b32 v13, 2, v1
    v_add_u32 v13, s6, v13
    s_waitcnt vmcnt(16)
    v_dot2_f32_bf16 v244, v16, s50, 0
    v_dot2_f32_bf16 v246, v16, v16, 0
    v_dot2_f32_bf16 v245, v20, s50, 0
    v_dot2_f32_bf16 v247, v20, v20, 0
    v_dot2_f32_bf16 v244, v17, s50, v244
    v_dot2_f32_bf16 v246, v17, v17, v246
    v_dot2_f32_bf16 v245, v21, s50, v245
    v_dot2_f32_bf16 v247, v21, v21, v247
    v_dot2_f32_bf16 v244, v18, s50, v244
    v_dot2_f32_bf16 v246, v18, v18, v246
    v_dot2_f32_bf16 v245, v22, s50, v245
    v_dot2_f32_bf16 v247, v22, v22, v247
    v_dot2_f32_bf16 v244, v19, s50, v244
    v_dot2_f32_bf16 v246, v19, v19, v246
    v_dot2_f32_bf16 v245, v23, s50, v245
    v_dot2_f32_bf16 v247, v23, v23, v247
    s_waitcnt vmcnt(14)
    v_dot2_f32_bf16 v244, v32, s50, v244
    v_dot2_f32_bf16 v246, v32, v32, v246
    v_dot2_f32_bf16 v245, v36, s50, v245
    v_dot2_f32_bf16 v247, v36, v36, v247
    v_dot2_f32_bf16 v244, v33, s50, v244
    v_dot2_f32_bf16 v246, v33, v33, v246
    v_dot2_f32_bf16 v245, v37, s50, v245
    v_dot2_f32_bf16 v247, v37, v37, v247
    v_dot2_f32_bf16 v244, v34, s50, v244
    v_dot2_f32_bf16 v246, v34, v34, v246
    v_dot2_f32_bf16 v245, v38, s50, v245
    v_dot2_f32_bf16 v247, v38, v38, v247
    v_dot2_f32_bf16 v244, v35, s50, v244
    v_dot2_f32_bf16 v246, v35, v35, v246
    v_dot2_f32_bf16 v245, v39, s50, v245
    v_dot2_f32_bf16 v247, v39, v39, v247
    s_waitcnt vmcnt(12)
    v_dot2_f32_bf16 v244, v48, s50, v244
    v_dot2_f32_bf16 v246, v48, v48, v246
    v_dot2_f32_bf16 v245, v52, s50, v245
    v_dot2_f32_bf16 v247, v52, v52, v247
    v_dot2_f32_bf16 v244, v49, s50, v244
    v_dot2_f32_bf16 v246, v49, v49, v246
    v_dot2_f32_bf16 v245, v53, s50, v245
    v_dot2_f32_bf16 v247, v53, v53, v247
    v_dot2_f32_bf16 v244, v50, s50, v244
    v_dot2_f32_bf16 v246, v50, v50, v246
    v_dot2_f32_bf16 v245, v54, s50, v245
    v_dot2_f32_bf16 v247, v54, v54, v247
    v_dot2_f32_bf16 v244, v51, s50, v244
    v_dot2_f32_bf16 v246, v51, v51, v246
    v_dot2_f32_bf16 v245, v55, s50, v245
    v_dot2_f32_bf16 v247, v55, v55, v247
    s_waitcnt vmcnt(10)
    v_dot2_f32_bf16 v244, v64, s50, v244
    v_dot2_f32_bf16 v246, v64, v64, v246
    v_dot2_f32_bf16 v245, v68, s50, v245
    v_dot2_f32_bf16 v247, v68, v68, v247
    v_dot2_f32_bf16 v244, v65, s50, v244
    v_dot2_f32_bf16 v246, v65, v65, v246
    v_dot2_f32_bf16 v245, v69, s50, v245
    v_dot2_f32_bf16 v247, v69, v69, v247
    v_dot2_f32_bf16 v244, v66, s50, v244
    v_dot2_f32_bf16 v246, v66, v66, v246
    v_dot2_f32_bf16 v245, v70, s50, v245
    v_dot2_f32_bf16 v247, v70, v70, v247
    v_dot2_f32_bf16 v244, v67, s50, v244
    v_dot2_f32_bf16 v246, v67, v67, v246
    v_dot2_f32_bf16 v245, v71, s50, v245
    v_dot2_f32_bf16 v247, v71, v71, v247
    s_waitcnt vmcnt(8)
    v_dot2_f32_bf16 v244, v80, s50, v244
    v_dot2_f32_bf16 v246, v80, v80, v246
    v_dot2_f32_bf16 v245, v84, s50, v245
    v_dot2_f32_bf16 v247, v84, v84, v247
    v_dot2_f32_bf16 v244, v81, s50, v244
    v_dot2_f32_bf16 v246, v81, v81, v246
    v_dot2_f32_bf16 v245, v85, s50, v245
    v_dot2_f32_bf16 v247, v85, v85, v247
    v_dot2_f32_bf16 v244, v82, s50, v244
    v_dot2_f32_bf16 v246, v82, v82, v246
    v_dot2_f32_bf16 v245, v86, s50, v245
    v_dot2_f32_bf16 v247, v86, v86, v247
    v_dot2_f32_bf16 v244, v83, s50, v244
    v_dot2_f32_bf16 v246, v83, v83, v246
    v_dot2_f32_bf16 v245, v87, s50, v245
    v_dot2_f32_bf16 v247, v87, v87, v247
    s_waitcnt vmcnt(6)
    v_dot2_f32_bf16 v244, v96, s50, v244
    v_dot2_f32_bf16 v246, v96, v96, v246
    v_dot2_f32_bf16 v245, v100, s50, v245
    v_dot2_f32_bf16 v247, v100, v100, v247
    v_dot2_f32_bf16 v244, v97, s50, v244
    v_dot2_f32_bf16 v246, v97, v97, v246
    v_dot2_f32_bf16 v245, v101, s50, v245
    v_dot2_f32_bf16 v247, v101, v101, v247
    v_dot2_f32_bf16 v244, v98, s50, v244
    v_dot2_f32_bf16 v246, v98, v98, v246
    v_dot2_f32_bf16 v245, v102, s50, v245
    v_dot2_f32_bf16 v247, v102, v102, v247
    v_dot2_f32_bf16 v244, v99, s50, v244
    v_dot2_f32_bf16 v246, v99, v99, v246
    v_dot2_f32_bf16 v245, v103, s50, v245
    v_dot2_f32_bf16 v247, v103, v103, v247
    s_waitcnt vmcnt(4)
    v_dot2_f32_bf16 v244, v112, s50, v244
    v_dot2_f32_bf16 v246, v112, v112, v246
    v_dot2_f32_bf16 v245, v116, s50, v245
    v_dot2_f32_bf16 v247, v116, v116, v247
    v_dot2_f32_bf16 v244, v113, s50, v244
    v_dot2_f32_bf16 v246, v113, v113, v246
    v_dot2_f32_bf16 v245, v117, s50, v245
    v_dot2_f32_bf16 v247, v117, v117, v247
    v_dot2_f32_bf16 v244, v114, s50, v244
    v_dot2_f32_bf16 v246, v114, v114, v246
    v_dot2_f32_bf16 v245, v118, s50, v245
    v_dot2_f32_bf16 v247, v118, v118, v247
    v_dot2_f32_bf16 v244, v115, s50, v244
    v_dot2_f32_bf16 v246, v115, v115, v246
    v_dot2_f32_bf16 v245, v119, s50, v245
    v_dot2_f32_bf16 v247, v119, v119, v247
    s_waitcnt vmcnt(2)
    v_dot2_f32_bf16 v244, v128, s50, v244
    v_dot2_f32_bf16 v246, v128, v128, v246
    v_dot2_f32_bf16 v245, v132, s50, v245
    v_dot2_f32_bf16 v247, v132, v132, v247
    v_dot2_f32_bf16 v244, v129, s50, v244
    v_dot2_f32_bf16 v246, v129, v129, v246
    v_dot2_f32_bf16 v245, v133, s50, v245
    v_dot2_f32_bf16 v247, v133, v133, v247
    v_dot2_f32_bf16 v244, v130, s50, v244
    v_dot2_f32_bf16 v246, v130, v130, v246
    v_dot2_f32_bf16 v245, v134, s50, v245
    v_dot2_f32_bf16 v247, v134, v134, v247
    v_dot2_f32_bf16 v244, v131, s50, v244
    v_dot2_f32_bf16 v246, v131, v131, v246
    v_dot2_f32_bf16 v245, v135, s50, v245
    v_dot2_f32_bf16 v247, v135, v135, v247
    s_waitcnt vmcnt(0)
    v_dot2_f32_bf16 v244, v144, s50, v244
    v_dot2_f32_bf16 v246, v144, v144, v246
    v_dot2_f32_bf16 v245, v148, s50, v245
    v_dot2_f32_bf16 v247, v148, v148, v247
    v_dot2_f32_bf16 v244, v145, s50, v244
    v_dot2_f32_bf16 v246, v145, v145, v246
    v_dot2_f32_bf16 v245, v149, s50, v245
    v_dot2_f32_bf16 v247, v149, v149, v247
    v_dot2_f32_bf16 v244, v146, s50, v244
    v_dot2_f32_bf16 v246, v146, v146, v246
    v_dot2_f32_bf16 v245, v150, s50, v245
    v_dot2_f32_bf16 v247, v150, v150, v247
    v_dot2_f32_bf16 v244, v147, s50, v244
    v_dot2_f32_bf16 v246, v147, v147, v246
    v_dot2_f32_bf16 v245, v151, s50, v245
    v_dot2_f32_bf16 v247, v151, v151, v247
    s_add_u32 s45, s55, 0
    s_add_u32 m0, s46, 0
    s_nop 0
    buffer_load_dwordx4 v7, s[12:15], s45 offen offset:0 lds
    s_nop 0
    buffer_load_dwordx4 v8, s[12:15], s45 offen offset:1024 lds
    s_add_u32 s45, s55, 589824
    s_add_u32 m0, s46, 18432
    s_nop 0
    buffer_load_dwordx4 v7, s[12:15], s45 offen offset:0 lds
    s_nop 0
    buffer_load_dwordx4 v8, s[12:15], s45 offen offset:1024 lds
    s_nop 2
    v_add_f32_dpp v244, v244, v244 quad_perm:[1,0,3,2] row_mask:0xf bank_mask:0xf
    v_add_f32_dpp v245, v245, v245 quad_perm:[1,0,3,2] row_mask:0xf bank_mask:0xf
    v_add_f32_dpp v246, v246, v246 quad_perm:[1,0,3,2] row_mask:0xf bank_mask:0xf
    v_add_f32_dpp v247, v247, v247 quad_perm:[1,0,3,2] row_mask:0xf bank_mask:0xf
    v_add_f32_dpp v244, v244, v244 quad_perm:[2,3,0,1] row_mask:0xf bank_mask:0xf
    v_add_f32_dpp v245, v245, v245 quad_perm:[2,3,0,1] row_mask:0xf bank_mask:0xf
    v_add_f32_dpp v246, v246, v246 quad_perm:[2,3,0,1] row_mask:0xf bank_mask:0xf
    v_add_f32_dpp v247, v247, v247 quad_perm:[2,3,0,1] row_mask:0xf bank_mask:0xf
    v_add_f32_dpp v244, v244, v244 row_half_mirror row_mask:0xf bank_mask:0xf
    v_add_f32_dpp v245, v245, v245 row_half_mirror row_mask:0xf bank_mask:0xf
    v_add_f32_dpp v246, v246, v246 row_half_mirror row_mask:0xf bank_mask:0xf
    v_add_f32_dpp v247, v247, v247 row_half_mirror row_mask:0xf bank_mask:0xf
    v_mul_f32 v244, 0x3ae38e39, v244
    v_mul_f32 v246, 0x3ae38e39, v246
    v_mul_f32 v245, 0x3ae38e39, v245
    v_mul_f32 v247, 0x3ae38e39, v247
    v_fma_f32 v246, -v244, v244, v246
    v_fma_f32 v247, -v245, v245, v247
    v_add_f32 v246, 0x3727c5ac, v246
    v_add_f32 v247, 0x3727c5ac, v247
    v_rsq_f32 v204, v246
    v_rsq_f32 v208, v247
    s_nop 0
    v_mul_f32 v206, v244, v204
    v_mul_f32 v210, v245, v208
    v_lshlrev_b32 v248, 16, v16
    v_and_b32 v249, 0xffff0000, v16
    v_lshlrev_b32 v250, 16, v17
    v_and_b32 v251, 0xffff0000, v17
    v_lshlrev_b32 v252, 16, v18
    v_and_b32 v253, 0xffff0000, v18
    v_lshlrev_b32 v254, 16, v19
    v_and_b32 v255, 0xffff0000, v19
    v_pk_fma_f32 v[248:249], v[248:249], v[204:205], v[206:207] op_sel_hi:[1,0,0] neg_lo:[0,0,1] neg_hi:[0,0,1]
    v_pk_fma_f32 v[250:251], v[250:251], v[204:205], v[206:207] op_sel_hi:[1,0,0] neg_lo:[0,0,1] neg_hi:[0,0,1]
    v_pk_fma_f32 v[252:253], v[252:253], v[204:205], v[206:207] op_sel_hi:[1,0,0] neg_lo:[0,0,1] neg_hi:[0,0,1]
    v_pk_fma_f32 v[254:255], v[254:255], v[204:205], v[206:207] op_sel_hi:[1,0,0] neg_lo:[0,0,1] neg_hi:[0,0,1]
    v_cvt_pk_bf16_f32 v16, v248, v249
    v_cvt_pk_bf16_f32 v17, v250, v251
    v_cvt_pk_bf16_f32 v18, v252, v253
    v_cvt_pk_bf16_f32 v19, v254, v255
    ds_write_b128 v201, v[16:19] offset:0
    v_lshlrev_b32 v248, 16, v20
    v_and_b32 v249, 0xffff0000, v20
    v_lshlrev_b32 v250, 16, v21
    v_and_b32 v251, 0xffff0000, v21
    v_lshlrev_b32 v252, 16, v22
    v_and_b32 v253, 0xffff0000, v22
    v_lshlrev_b32 v254, 16, v23
    v_and_b32 v255, 0xffff0000, v23
    v_pk_fma_f32 v[248:249], v[248:249], v[208:209], v[210:211] op_sel_hi:[1,0,0] neg_lo:[0,0,1] neg_hi:[0,0,1]
    v_pk_fma_f32 v[250:251], v[250:251], v[208:209], v[210:211] op_sel_hi:[1,0,0] neg_lo:[0,0,1] neg_hi:[0,0,1]
    v_pk_fma_f32 v[252:253], v[252:253], v[208:209], v[210:211] op_sel_hi:[1,0,0] neg_lo:[0,0,1] neg_hi:[0,0,1]
    v_pk_fma_f32 v[254:255], v[254:255], v[208:209], v[210:211] op_sel_hi:[1,0,0] neg_lo:[0,0,1] neg_hi:[0,0,1]
    v_cvt_pk_bf16_f32 v20, v248, v249
    v_cvt_pk_bf16_f32 v21, v250, v251
    v_cvt_pk_bf16_f32 v22, v252, v253
    v_cvt_pk_bf16_f32 v23, v254, v255
    ds_write_b128 v201, v[20:23] offset:2048
    s_add_u32 s45, s55, 1179648
    s_add_u32 m0, s46, 36864
    s_nop 0
    buffer_load_dwordx4 v7, s[12:15], s45 offen offset:0 lds
    s_nop 0
    buffer_load_dwordx4 v8, s[12:15], s45 offen offset:1024 lds
    v_lshlrev_b32 v248, 16, v32
    v_and_b32 v249, 0xffff0000, v32
    v_lshlrev_b32 v250, 16, v33
    v_and_b32 v251, 0xffff0000, v33
    v_lshlrev_b32 v252, 16, v34
    v_and_b32 v253, 0xffff0000, v34
    v_lshlrev_b32 v254, 16, v35
    v_and_b32 v255, 0xffff0000, v35
    v_pk_fma_f32 v[248:249], v[248:249], v[204:205], v[206:207] op_sel_hi:[1,0,0] neg_lo:[0,0,1] neg_hi:[0,0,1]
    v_pk_fma_f32 v[250:251], v[250:251], v[204:205], v[206:207] op_sel_hi:[1,0,0] neg_lo:[0,0,1] neg_hi:[0,0,1]
    v_pk_fma_f32 v[252:253], v[252:253], v[204:205], v[206:207] op_sel_hi:[1,0,0] neg_lo:[0,0,1] neg_hi:[0,0,1]
    v_pk_fma_f32 v[254:255], v[254:255], v[204:205], v[206:207] op_sel_hi:[1,0,0] neg_lo:[0,0,1] neg_hi:[0,0,1]
    v_cvt_pk_bf16_f32 v32, v248, v249
    v_cvt_pk_bf16_f32 v33, v250, v251
    v_cvt_pk_bf16_f32 v34, v252, v253
    v_cvt_pk_bf16_f32 v35, v254, v255
    ds_write_b128 v201, v[32:35] offset:18432
    v_lshlrev_b32 v248, 16, v36
    v_and_b32 v249, 0xffff0000, v36
    v_lshlrev_b32 v250, 16, v37
    v_and_b32 v251, 0xffff0000, v37
    v_lshlrev_b32 v252, 16, v38
    v_and_b32 v253, 0xffff0000, v38
    v_lshlrev_b32 v254, 16, v39
    v_and_b32 v255, 0xffff0000, v39
    v_pk_fma_f32 v[248:249], v[248:249], v[208:209], v[210:211] op_sel_hi:[1,0,0] neg_lo:[0,0,1] neg_hi:[0,0,1]
    v_pk_fma_f32 v[250:251], v[250:251], v[208:209], v[210:211] op_sel_hi:[1,0,0] neg_lo:[0,0,1] neg_hi:[0,0,1]
    v_pk_fma_f32 v[252:253], v[252:253], v[208:209], v[210:211] op_sel_hi:[1,0,0] neg_lo:[0,0,1] neg_hi:[0,0,1]
    v_pk_fma_f32 v[254:255], v[254:255], v[208:209], v[210:211] op_sel_hi:[1,0,0] neg_lo:[0,0,1] neg_hi:[0,0,1]
    v_cvt_pk_bf16_f32 v36, v248, v249
    v_cvt_pk_bf16_f32 v37, v250, v251
    v_cvt_pk_bf16_f32 v38, v252, v253
    v_cvt_pk_bf16_f32 v39, v254, v255
    ds_write_b128 v201, v[36:39] offset:20480
    s_add_u32 s45, s55, 1769472
    s_add_u32 m0, s46, 55296
    s_nop 0
    buffer_load_dwordx4 v7, s[12:15], s45 offen offset:0 lds
    s_nop 0
    buffer_load_dwordx4 v8, s[12:15], s45 offen offset:1024 lds
    v_lshlrev_b32 v248, 16, v48
    v_and_b32 v249, 0xffff0000, v48
    v_lshlrev_b32 v250, 16, v49
    v_and_b32 v251, 0xffff0000, v49
    v_lshlrev_b32 v252, 16, v50
    v_and_b32 v253, 0xffff0000, v50
    v_lshlrev_b32 v254, 16, v51
    v_and_b32 v255, 0xffff0000, v51
    v_pk_fma_f32 v[248:249], v[248:249], v[204:205], v[206:207] op_sel_hi:[1,0,0] neg_lo:[0,0,1] neg_hi:[0,0,1]
    v_pk_fma_f32 v[250:251], v[250:251], v[204:205], v[206:207] op_sel_hi:[1,0,0] neg_lo:[0,0,1] neg_hi:[0,0,1]
    v_pk_fma_f32 v[252:253], v[252:253], v[204:205], v[206:207] op_sel_hi:[1,0,0] neg_lo:[0,0,1] neg_hi:[0,0,1]
    v_pk_fma_f32 v[254:255], v[254:255], v[204:205], v[206:207] op_sel_hi:[1,0,0] neg_lo:[0,0,1] neg_hi:[0,0,1]
    v_cvt_pk_bf16_f32 v48, v248, v249
    v_cvt_pk_bf16_f32 v49, v250, v251
    v_cvt_pk_bf16_f32 v50, v252, v253
    v_cvt_pk_bf16_f32 v51, v254, v255
    ds_write_b128 v200, v[48:51] offset:32768
    v_lshlrev_b32 v248, 16, v52
    v_and_b32 v249, 0xffff0000, v52
    v_lshlrev_b32 v250, 16, v53
    v_and_b32 v251, 0xffff0000, v53
    v_lshlrev_b32 v252, 16, v54
    v_and_b32 v253, 0xffff0000, v54
    v_lshlrev_b32 v254, 16, v55
    v_and_b32 v255, 0xffff0000, v55
    v_pk_fma_f32 v[248:249], v[248:249], v[208:209], v[210:211] op_sel_hi:[1,0,0] neg_lo:[0,0,1] neg_hi:[0,0,1]
    v_pk_fma_f32 v[250:251], v[250:251], v[208:209], v[210:211] op_sel_hi:[1,0,0] neg_lo:[0,0,1] neg_hi:[0,0,1]
    v_pk_fma_f32 v[252:253], v[252:253], v[208:209], v[210:211] op_sel_hi:[1,0,0] neg_lo:[0,0,1] neg_hi:[0,0,1]
    v_pk_fma_f32 v[254:255], v[254:255], v[208:209], v[210:211] op_sel_hi:[1,0,0] neg_lo:[0,0,1] neg_hi:[0,0,1]
    v_cvt_pk_bf16_f32 v52, v248, v249
    v_cvt_pk_bf16_f32 v53, v250, v251
    v_cvt_pk_bf16_f32 v54, v252, v253
    v_cvt_pk_bf16_f32 v55, v254, v255
    ds_write_b128 v200, v[52:55] offset:34816
    v_lshlrev_b32 v248, 16, v64
    v_and_b32 v249, 0xffff0000, v64
    v_lshlrev_b32 v250, 16, v65
    v_and_b32 v251, 0xffff0000, v65
    v_lshlrev_b32 v252, 16, v66
    v_and_b32 v253, 0xffff0000, v66
    v_lshlrev_b32 v254, 16, v67
    v_and_b32 v255, 0xffff0000, v67
    v_pk_fma_f32 v[248:249], v[248:249], v[204:205], v[206:207] op_sel_hi:[1,0,0] neg_lo:[0,0,1] neg_hi:[0,0,1]
    v_pk_fma_f32 v[250:251], v[250:251], v[204:205], v[206:207] op_sel_hi:[1,0,0] neg_lo:[0,0,1] neg_hi:[0,0,1]
    v_pk_fma_f32 v[252:253], v[252:253], v[204:205], v[206:207] op_sel_hi:[1,0,0] neg_lo:[0,0,1] neg_hi:[0,0,1]
    v_pk_fma_f32 v[254:255], v[254:255], v[204:205], v[206:207] op_sel_hi:[1,0,0] neg_lo:[0,0,1] neg_hi:[0,0,1]
    v_cvt_pk_bf16_f32 v64, v248, v249
    v_cvt_pk_bf16_f32 v65, v250, v251
    v_cvt_pk_bf16_f32 v66, v252, v253
    v_cvt_pk_bf16_f32 v67, v254, v255
    ds_write_b128 v200, v[64:67] offset:0
    v_lshlrev_b32 v248, 16, v68
    v_and_b32 v249, 0xffff0000, v68
    v_lshlrev_b32 v250, 16, v69
    v_and_b32 v251, 0xffff0000, v69
    v_lshlrev_b32 v252, 16, v70
    v_and_b32 v253, 0xffff0000, v70
    v_lshlrev_b32 v254, 16, v71
    v_and_b32 v255, 0xffff0000, v71
    v_pk_fma_f32 v[248:249], v[248:249], v[208:209], v[210:211] op_sel_hi:[1,0,0] neg_lo:[0,0,1] neg_hi:[0,0,1]
    v_pk_fma_f32 v[250:251], v[250:251], v[208:209], v[210:211] op_sel_hi:[1,0,0] neg_lo:[0,0,1] neg_hi:[0,0,1]
    v_pk_fma_f32 v[252:253], v[252:253], v[208:209], v[210:211] op_sel_hi:[1,0,0] neg_lo:[0,0,1] neg_hi:[0,0,1]
    v_pk_fma_f32 v[254:255], v[254:255], v[208:209], v[210:211] op_sel_hi:[1,0,0] neg_lo:[0,0,1] neg_hi:[0,0,1]
    v_cvt_pk_bf16_f32 v68, v248, v249
    v_cvt_pk_bf16_f32 v69, v250, v251
    v_cvt_pk_bf16_f32 v70, v252, v253
    v_cvt_pk_bf16_f32 v71, v254, v255
    ds_write_b128 v200, v[68:71] offset:2048
    v_lshlrev_b32 v248, 16, v80
    v_and_b32 v249, 0xffff0000, v80
    v_lshlrev_b32 v250, 16, v81
    v_and_b32 v251, 0xffff0000, v81
    v_lshlrev_b32 v252, 16, v82
    v_and_b32 v253, 0xffff0000, v82
    v_lshlrev_b32 v254, 16, v83
    v_and_b32 v255, 0xffff0000, v83
    v_pk_fma_f32 v[248:249], v[248:249], v[204:205], v[206:207] op_sel_hi:[1,0,0] neg_lo:[0,0,1] neg_hi:[0,0,1]
    v_pk_fma_f32 v[250:251], v[250:251], v[204:205], v[206:207] op_sel_hi:[1,0,0] neg_lo:[0,0,1] neg_hi:[0,0,1]
    v_pk_fma_f32 v[252:253], v[252:253], v[204:205], v[206:207] op_sel_hi:[1,0,0] neg_lo:[0,0,1] neg_hi:[0,0,1]
    v_pk_fma_f32 v[254:255], v[254:255], v[204:205], v[206:207] op_sel_hi:[1,0,0] neg_lo:[0,0,1] neg_hi:[0,0,1]
    v_cvt_pk_bf16_f32 v80, v248, v249
    v_cvt_pk_bf16_f32 v81, v250, v251
    v_cvt_pk_bf16_f32 v82, v252, v253
    v_cvt_pk_bf16_f32 v83, v254, v255
    ds_write_b128 v200, v[80:83] offset:16384
    v_lshlrev_b32 v248, 16, v84
    v_and_b32 v249, 0xffff0000, v84
    v_lshlrev_b32 v250, 16, v85
    v_and_b32 v251, 0xffff0000, v85
    v_lshlrev_b32 v252, 16, v86
    v_and_b32 v253, 0xffff0000, v86
    v_lshlrev_b32 v254, 16, v87
    v_and_b32 v255, 0xffff0000, v87
    v_pk_fma_f32 v[248:249], v[248:249], v[208:209], v[210:211] op_sel_hi:[1,0,0] neg_lo:[0,0,1] neg_hi:[0,0,1]
    v_pk_fma_f32 v[250:251], v[250:251], v[208:209], v[210:211] op_sel_hi:[1,0,0] neg_lo:[0,0,1] neg_hi:[0,0,1]
    v_pk_fma_f32 v[252:253], v[252:253], v[208:209], v[210:211] op_sel_hi:[1,0,0] neg_lo:[0,0,1] neg_hi:[0,0,1]
    v_pk_fma_f32 v[254:255], v[254:255], v[208:209], v[210:211] op_sel_hi:[1,0,0] neg_lo:[0,0,1] neg_hi:[0,0,1]
    v_cvt_pk_bf16_f32 v84, v248, v249
    v_cvt_pk_bf16_f32 v85, v250, v251
    v_cvt_pk_bf16_f32 v86, v252, v253
    v_cvt_pk_bf16_f32 v87, v254, v255
    ds_write_b128 v200, v[84:87] offset:18432
    s_waitcnt vmcnt(6)
    s_waitcnt lgkmcnt(6)
    s_barrier
    ds_read_b128 v[16:19], v205 offset:0
    ds_read_b128 v[20:23], v205 offset:2048
    ds_read_b64_tr_b16 v[232:233], v3 offset:0
    ds_read_b64_tr_b16 v[234:235], v3 offset:4608
    ds_read_b64_tr_b16 v[236:237], v3 offset:32
    ds_read_b64_tr_b16 v[238:239], v3 offset:4640
    ds_read_b64_tr_b16 v[240:241], v3 offset:64
    ds_read_b64_tr_b16 v[242:243], v3 offset:4672
    ds_read_b128 v[24:27], v207 offset:1024
    ds_read_b128 v[28:31], v207 offset:3072
    s_cmp_lg_u32 s3, 0
    s_cbranch_scc1 g1_nononce
    s_or_b32 s52, s52, 1
    s_lshl_b32 s6, s4, 4
    v_mov_b32 v14, s52
    v_mov_b32 v15, 0
    s_mov_b64 exec, 1
    buffer_atomic_cmpswap v[14:15], off, s[40:43], s6 sc0 sc1
    s_mov_b64 exec, -1
g1_nononce:
    s_waitcnt lgkmcnt(8)
    s_waitcnt lgkmcnt(6)
    v_mfma_f32_16x16x32_bf16 v[160:163], v[16:19], v[232:235], 0
    v_lshlrev_b32 v248, 16, v96
    v_mfma_f32_16x16x32_bf16 v[164:167], v[20:23], v[232:235], 0
    v_and_b32 v249, 0xffff0000, v96
    v_lshlrev_b32 v250, 16, v97
    ds_read_b64_tr_b16 v[244:245], v3 offset:96
    ds_read_b64_tr_b16 v[246:247], v3 offset:4704
    s_waitcnt lgkmcnt(6)
    v_mfma_f32_16x16x32_bf16 v[168:171], v[16:19], v[236:239], 0
    v_and_b32 v251, 0xffff0000, v97
    v_mfma_f32_16x16x32_bf16 v[172:175], v[20:23], v[236:239], 0
    v_lshlrev_b32 v252, 16, v98
    v_and_b32 v253, 0xffff0000, v98
    ds_read_b128 v[32:35], v205 offset:18432
    ds_read_b64_tr_b16 v[232:233], v3 offset:128
    ds_read_b64_tr_b16 v[234:235], v3 offset:4736
    s_waitcnt lgkmcnt(7)
    v_mfma_f32_16x16x32_bf16 v[176:179], v[16:19], v[240:243], 0
    v_lshlrev_b32 v254, 16, v99
    v_mfma_f32_16x16x32_bf16 v[180:183], v[20:23], v[240:243], 0
    v_and_b32 v255, 0xffff0000, v99
    v_fma_f32 v248, v248, v204, -v206
    ds_read_b128 v[36:39], v205 offset:20480
    ds_read_b64_tr_b16 v[236:237], v3 offset:9216
    ds_read_b64_tr_b16 v[238:239], v3 offset:13824
    s_waitcnt lgkmcnt(6)
    v_mfma_f32_16x16x32_bf16 v[184:187], v[16:19], v[244:247], 0
    v_fma_f32 v249, v249, v204, -v206
    v_mfma_f32_16x16x32_bf16 v[188:191], v[20:23], v[244:247], 0
    v_fma_f32 v250, v250, v204, -v206
    v_fma_f32 v251, v251, v204, -v206
    ds_read_b128 v[40:43], v207 offset:19456
    ds_read_b64_tr_b16 v[240:241], v3 offset:9248
    ds_read_b64_tr_b16 v[242:243], v3 offset:13856
    s_waitcnt lgkmcnt(6)
    v_mfma_f32_16x16x32_bf16 v[192:195], v[16:19], v[232:235], 0
    v_fma_f32 v252, v252, v204, -v206
    v_mfma_f32_16x16x32_bf16 v[196:199], v[20:23], v[232:235], 0
    v_fma_f32 v253, v253, v204, -v206
    v_fma_f32 v254, v254, v204, -v206
    ds_read_b128 v[44:47], v207 offset:21504
    ds_read_b64_tr_b16 v[244:245], v3 offset:9280
    ds_read_b64_tr_b16 v[246:247], v3 offset:13888
    s_waitcnt lgkmcnt(6)
    v_mfma_f32_16x16x32_bf16 v[160:163], v[24:27], v[236:239], v[160:163]
    v_fma_f32 v255, v255, v204, -v206
    v_mfma_f32_16x16x32_bf16 v[164:167], v[28:31], v[236:239], v[164:167]
    v_cvt_pk_bf16_f32 v96, v248, v249
    v_cvt_pk_bf16_f32 v97, v250, v251
    ds_read_b64_tr_b16 v[232:233], v3 offset:9312
    ds_read_b64_tr_b16 v[234:235], v3 offset:13920
    s_waitcnt lgkmcnt(5)
    v_mfma_f32_16x16x32_bf16 v[168:171], v[24:27], v[240:243], v[168:171]
    v_cvt_pk_bf16_f32 v98, v252, v253
    v_mfma_f32_16x16x32_bf16 v[172:175], v[28:31], v[240:243], v[172:175]
    v_cvt_pk_bf16_f32 v99, v254, v255
    ds_read_b64_tr_b16 v[236:237], v3 offset:9344
    ds_read_b64_tr_b16 v[238:239], v3 offset:13952
    s_waitcnt lgkmcnt(4)
    v_mfma_f32_16x16x32_bf16 v[176:179], v[24:27], v[244:247], v[176:179]
    v_mfma_f32_16x16x32_bf16 v[180:183], v[28:31], v[244:247], v[180:183]
    s_waitcnt vmcnt(4)
    s_barrier
    ds_read_b64_tr_b16 v[240:241], v3 offset:18432
    ds_read_b64_tr_b16 v[242:243], v3 offset:23040
    s_waitcnt lgkmcnt(4)
    v_mfma_f32_16x16x32_bf16 v[184:187], v[24:27], v[232:235], v[184:187]
    v_mfma_f32_16x16x32_bf16 v[188:191], v[28:31], v[232:235], v[188:191]
    ds_read_b128 v[48:51], v202 offset:32768
    s_add_u32 s45, s55, 2359296
    s_add_u32 m0, s46, 73728
    s_nop 0
    buffer_load_dwordx4 v7, s[12:15], s45 offen offset:0 lds
    ds_read_b64_tr_b16 v[244:245], v3 offset:18464
    ds_read_b64_tr_b16 v[246:247], v3 offset:23072
    s_waitcnt lgkmcnt(5)
    v_mfma_f32_16x16x32_bf16 v[192:195], v[24:27], v[236:239], v[192:195]
    v_mfma_f32_16x16x32_bf16 v[196:199], v[28:31], v[236:239], v[196:199]
    ds_read_b128 v[52:55], v202 offset:34816
    s_nop 0
    buffer_load_dwordx4 v8, s[12:15], s45 offen offset:1024 lds
    ds_read_b64_tr_b16 v[232:233], v3 offset:18496
    ds_read_b64_tr_b16 v[234:235], v3 offset:23104
    s_waitcnt lgkmcnt(6)
    v_mfma_f32_16x16x32_bf16 v[160:163], v[32:35], v[240:243], v[160:163]
    v_mfma_f32_16x16x32_bf16 v[164:167], v[36:39], v[240:243], v[164:167]
    ds_read_b128 v[56:59], v203 offset:33792
    s_add_u32 s45, s55, 2949120
    s_add_u32 m0, s46, 92160
    s_nop 0
    buffer_load_dwordx4 v7, s[12:15], s45 offen offset:0 lds
    ds_read_b64_tr_b16 v[236:237], v3 offset:18528
    ds_read_b64_tr_b16 v[238:239], v3 offset:23136
    s_waitcnt lgkmcnt(6)
    v_mfma_f32_16x16x32_bf16 v[168:171], v[32:35], v[244:247], v[168:171]
    v_mfma_f32_16x16x32_bf16 v[172:175], v[36:39], v[244:247], v[172:175]
    ds_read_b128 v[60:63], v203 offset:35840
    s_nop 0
    buffer_load_dwordx4 v8, s[12:15], s45 offen offset:1024 lds
    ds_read_b64_tr_b16 v[240:241], v3 offset:18560
    ds_read_b64_tr_b16 v[242:243], v3 offset:23168
    s_waitcnt lgkmcnt(6)
    v_mfma_f32_16x16x32_bf16 v[176:179], v[32:35], v[232:235], v[176:179]
    v_mfma_f32_16x16x32_bf16 v[180:183], v[36:39], v[232:235], v[180:183]
    ds_read_b64_tr_b16 v[244:245], v3 offset:27648
    ds_read_b64_tr_b16 v[246:247], v3 offset:32256
    s_waitcnt lgkmcnt(5)
    v_mfma_f32_16x16x32_bf16 v[184:187], v[32:35], v[236:239], v[184:187]
    v_mfma_f32_16x16x32_bf16 v[188:191], v[36:39], v[236:239], v[188:191]
    ds_read_b64_tr_b16 v[232:233], v3 offset:27680
    ds_read_b64_tr_b16 v[234:235], v3 offset:32288
    s_waitcnt lgkmcnt(4)
    v_mfma_f32_16x16x32_bf16 v[192:195], v[32:35], v[240:243], v[192:195]
    v_mfma_f32_16x16x32_bf16 v[196:199], v[36:39], v[240:243], v[196:199]
    ds_read_b64_tr_b16 v[236:237], v3 offset:27712
    ds_read_b64_tr_b16 v[238:239], v3 offset:32320
    s_waitcnt lgkmcnt(4)
    v_mfma_f32_16x16x32_bf16 v[160:163], v[40:43], v[244:247], v[160:163]
    v_mfma_f32_16x16x32_bf16 v[164:167], v[44:47], v[244:247], v[164:167]
    ds_read_b64_tr_b16 v[240:241], v3 offset:27744
    ds_read_b64_tr_b16 v[242:243], v3 offset:32352
    s_waitcnt lgkmcnt(4)
    v_mfma_f32_16x16x32_bf16 v[168:171], v[40:43], v[232:235], v[168:171]
    v_mfma_f32_16x16x32_bf16 v[172:175], v[44:47], v[232:235], v[172:175]
    ds_read_b64_tr_b16 v[244:245], v3 offset:27776
    ds_read_b64_tr_b16 v[246:247], v3 offset:32384
    s_waitcnt lgkmcnt(4)
    v_mfma_f32_16x16x32_bf16 v[176:179], v[40:43], v[236:239], v[176:179]
    v_mfma_f32_16x16x32_bf16 v[180:183], v[44:47], v[236:239], v[180:183]
    s_waitcnt vmcnt(6)
    s_barrier
    ds_read_b64_tr_b16 v[232:233], v3 offset:36864
    ds_read_b64_tr_b16 v[234:235], v3 offset:41472
    s_waitcnt lgkmcnt(4)
    v_mfma_f32_16x16x32_bf16 v[184:187], v[40:43], v[240:243], v[184:187]
    ds_write_b128 v200, v[96:99] offset:32768
    v_mfma_f32_16x16x32_bf16 v[188:191], v[44:47], v[240:243], v[188:191]
    v_lshlrev_b32 v248, 16, v100
    v_and_b32 v249, 0xffff0000, v100
    ds_read_b128 v[64:67], v202 offset:0
    s_add_u32 s45, s55, 3538944
    s_add_u32 m0, s46, 0
    s_nop 0
    buffer_load_dwordx4 v7, s[12:15], s45 offen offset:0 lds
    ds_read_b64_tr_b16 v[236:237], v3 offset:36896
    ds_read_b64_tr_b16 v[238:239], v3 offset:41504
    s_waitcnt lgkmcnt(6)
    v_mfma_f32_16x16x32_bf16 v[192:195], v[40:43], v[244:247], v[192:195]
    v_lshlrev_b32 v250, 16, v101
    v_mfma_f32_16x16x32_bf16 v[196:199], v[44:47], v[244:247], v[196:199]
    v_and_b32 v251, 0xffff0000, v101
    v_lshlrev_b32 v252, 16, v102
    ds_read_b128 v[68:71], v202 offset:2048
    ds_read_b64_tr_b16 v[240:241], v3 offset:36928
    ds_read_b64_tr_b16 v[242:243], v3 offset:41536
    s_waitcnt lgkmcnt(7)
    v_mfma_f32_16x16x32_bf16 v[160:163], v[48:51], v[232:235], v[160:163]
    v_and_b32 v253, 0xffff0000, v102
    v_mfma_f32_16x16x32_bf16 v[164:167], v[52:55], v[232:235], v[164:167]
    v_lshlrev_b32 v254, 16, v103
    v_and_b32 v255, 0xffff0000, v103
    ds_read_b128 v[72:75], v203 offset:1024
    s_nop 0
    buffer_load_dwordx4 v8, s[12:15], s45 offen offset:1024 lds
    ds_read_b64_tr_b16 v[244:245], v3 offset:36960
    ds_read_b64_tr_b16 v[246:247], v3 offset:41568
    s_waitcnt lgkmcnt(6)
    v_mfma_f32_16x16x32_bf16 v[168:171], v[48:51], v[236:239], v[168:171]
    v_fma_f32 v248, v248, v208, -v210
    v_mfma_f32_16x16x32_bf16 v[172:175], v[52:55], v[236:239], v[172:175]
    v_fma_f32 v249, v249, v208, -v210
    v_fma_f32 v250, v250, v208, -v210
    ds_read_b128 v[76:79], v203 offset:3072
    ds_read_b64_tr_b16 v[232:233], v3 offset:36992
    ds_read_b64_tr_b16 v[234:235], v3 offset:41600
    s_waitcnt lgkmcnt(6)
    v_mfma_f32_16x16x32_bf16 v[176:179], v[48:51], v[240:243], v[176:179]
    v_fma_f32 v251, v251, v208, -v210
    v_mfma_f32_16x16x32_bf16 v[180:183], v[52:55], v[240:243], v[180:183]
    v_fma_f32 v252, v252, v208, -v210
    v_fma_f32 v253, v253, v208, -v210
    ds_read_b64_tr_b16 v[236:237], v3 offset:46080
    ds_read_b64_tr_b16 v[238:239], v3 offset:50688
    s_waitcnt lgkmcnt(5)
    v_mfma_f32_16x16x32_bf16 v[184:187], v[48:51], v[244:247], v[184:187]
    v_fma_f32 v254, v254, v208, -v210
    v_mfma_f32_16x16x32_bf16 v[188:191], v[52:55], v[244:247], v[188:191]
    v_fma_f32 v255, v255, v208, -v210
    v_cvt_pk_bf16_f32 v100, v248, v249
    ds_read_b64_tr_b16 v[240:241], v3 offset:46112
    ds_read_b64_tr_b16 v[242:243], v3 offset:50720
    s_waitcnt lgkmcnt(4)
    v_mfma_f32_16x16x32_bf16 v[192:195], v[48:51], v[232:235], v[192:195]
    v_cvt_pk_bf16_f32 v101, v250, v251
    v_mfma_f32_16x16x32_bf16 v[196:199], v[52:55], v[232:235], v[196:199]
    v_cvt_pk_bf16_f32 v102, v252, v253
    v_cvt_pk_bf16_f32 v103, v254, v255
    ds_read_b64_tr_b16 v[244:245], v3 offset:46144
    ds_read_b64_tr_b16 v[246:247], v3 offset:50752
    s_waitcnt lgkmcnt(4)
    v_mfma_f32_16x16x32_bf16 v[160:163], v[56:59], v[236:239], v[160:163]
    ds_write_b128 v200, v[100:103] offset:34816
    v_mfma_f32_16x16x32_bf16 v[164:167], v[60:63], v[236:239], v[164:167]
    v_lshlrev_b32 v248, 16, v112
    v_and_b32 v249, 0xffff0000, v112
    ds_read_b64_tr_b16 v[232:233], v3 offset:46176
    ds_read_b64_tr_b16 v[234:235], v3 offset:50784
    s_waitcnt lgkmcnt(5)
    v_mfma_f32_16x16x32_bf16 v[168:171], v[56:59], v[240:243], v[168:171]
    v_lshlrev_b32 v250, 16, v113
    v_mfma_f32_16x16x32_bf16 v[172:175], v[60:63], v[240:243], v[172:175]
    v_and_b32 v251, 0xffff0000, v113
    v_lshlrev_b32 v252, 16, v114
    ds_read_b64_tr_b16 v[236:237], v3 offset:46208
    ds_read_b64_tr_b16 v[238:239], v3 offset:50816
    s_waitcnt lgkmcnt(5)
    v_mfma_f32_16x16x32_bf16 v[176:179], v[56:59], v[244:247], v[176:179]
    v_and_b32 v253, 0xffff0000, v114
    v_mfma_f32_16x16x32_bf16 v[180:183], v[60:63], v[244:247], v[180:183]
    v_lshlrev_b32 v254, 16, v115
    v_and_b32 v255, 0xffff0000, v115
    s_waitcnt vmcnt(6)
    s_barrier
    ds_read_b64_tr_b16 v[240:241], v4 offset:0
    ds_read_b64_tr_b16 v[242:243], v4 offset:4608
    s_waitcnt lgkmcnt(4)
    v_mfma_f32_16x16x32_bf16 v[184:187], v[56:59], v[232:235], v[184:187]
    v_fma_f32 v248, v248, v204, -v206
    v_mfma_f32_16x16x32_bf16 v[188:191], v[60:63], v[232:235], v[188:191]
    v_fma_f32 v249, v249, v204, -v206
    v_fma_f32 v250, v250, v204, -v206
    ds_read_b128 v[80:83], v202 offset:16384
    s_add_u32 s45, s55, 4128768
    s_add_u32 m0, s46, 18432
    s_nop 0
    buffer_load_dwordx4 v7, s[12:15], s45 offen offset:0 lds
    ds_read_b64_tr_b16 v[244:245], v4 offset:32
    ds_read_b64_tr_b16 v[246:247], v4 offset:4640
    s_waitcnt lgkmcnt(5)
    v_mfma_f32_16x16x32_bf16 v[192:195], v[56:59], v[236:239], v[192:195]
    v_fma_f32 v251, v251, v204, -v206
    v_mfma_f32_16x16x32_bf16 v[196:199], v[60:63], v[236:239], v[196:199]
    v_fma_f32 v252, v252, v204, -v206
    v_fma_f32 v253, v253, v204, -v206
    ds_read_b128 v[84:87], v202 offset:18432
    ds_read_b64_tr_b16 v[232:233], v4 offset:64
    ds_read_b64_tr_b16 v[234:235], v4 offset:4672
    s_waitcnt lgkmcnt(6)
    v_mfma_f32_16x16x32_bf16 v[160:163], v[64:67], v[240:243], v[160:163]
    v_fma_f32 v254, v254, v204, -v206
    v_mfma_f32_16x16x32_bf16 v[164:167], v[68:71], v[240:243], v[164:167]
    v_fma_f32 v255, v255, v204, -v206
    v_cvt_pk_bf16_f32 v112, v248, v249
    ds_read_b128 v[88:91], v203 offset:17408
    s_nop 0
    buffer_load_dwordx4 v8, s[12:15], s45 offen offset:1024 lds
    ds_read_b64_tr_b16 v[236:237], v4 offset:96
    ds_read_b64_tr_b16 v[238:239], v4 offset:4704
    s_waitcnt lgkmcnt(6)
    v_mfma_f32_16x16x32_bf16 v[168:171], v[64:67], v[244:247], v[168:171]
    v_cvt_pk_bf16_f32 v113, v250, v251
    v_mfma_f32_16x16x32_bf16 v[172:175], v[68:71], v[244:247], v[172:175]
    v_cvt_pk_bf16_f32 v114, v252, v253
    v_cvt_pk_bf16_f32 v115, v254, v255
    ds_read_b128 v[92:95], v203 offset:19456
    ds_read_b64_tr_b16 v[240:241], v4 offset:128
    ds_read_b64_tr_b16 v[242:243], v4 offset:4736
    s_waitcnt lgkmcnt(6)
    v_mfma_f32_16x16x32_bf16 v[176:179], v[64:67], v[232:235], v[176:179]
    ds_write_b128 v200, v[112:115] offset:0
    v_mfma_f32_16x16x32_bf16 v[180:183], v[68:71], v[232:235], v[180:183]
    v_lshlrev_b32 v248, 16, v116
    v_and_b32 v249, 0xffff0000, v116
    ds_read_b64_tr_b16 v[244:245], v4 offset:9216
    ds_read_b64_tr_b16 v[246:247], v4 offset:13824
    s_waitcnt lgkmcnt(6)
    v_mfma_f32_16x16x32_bf16 v[184:187], v[64:67], v[236:239], v[184:187]
    v_lshlrev_b32 v250, 16, v117
    v_mfma_f32_16x16x32_bf16 v[188:191], v[68:71], v[236:239], v[188:191]
    v_and_b32 v251, 0xffff0000, v117
    v_lshlrev_b32 v252, 16, v118
    ds_read_b64_tr_b16 v[232:233], v4 offset:9248
    ds_read_b64_tr_b16 v[234:235], v4 offset:13856
    s_waitcnt lgkmcnt(5)
    v_mfma_f32_16x16x32_bf16 v[192:195], v[64:67], v[240:243], v[192:195]
    v_and_b32 v253, 0xffff0000, v118
    v_mfma_f32_16x16x32_bf16 v[196:199], v[68:71], v[240:243], v[196:199]
    v_lshlrev_b32 v254, 16, v119
    v_and_b32 v255, 0xffff0000, v119
    ds_read_b64_tr_b16 v[236:237], v4 offset:9280
    ds_read_b64_tr_b16 v[238:239], v4 offset:13888
    s_waitcnt lgkmcnt(4)
    v_mfma_f32_16x16x32_bf16 v[160:163], v[72:75], v[244:247], v[160:163]
    v_fma_f32 v248, v248, v208, -v210
    v_mfma_f32_16x16x32_bf16 v[164:167], v[76:79], v[244:247], v[164:167]
    v_fma_f32 v249, v249, v208, -v210
    v_fma_f32 v250, v250, v208, -v210
    ds_read_b64_tr_b16 v[240:241], v4 offset:9312
    ds_read_b64_tr_b16 v[242:243], v4 offset:13920
    s_waitcnt lgkmcnt(4)
    v_mfma_f32_16x16x32_bf16 v[168:171], v[72:75], v[232:235], v[168:171]
    v_fma_f32 v251, v251, v208, -v210
    v_mfma_f32_16x16x32_bf16 v[172:175], v[76:79], v[232:235], v[172:175]
    v_fma_f32 v252, v252, v208, -v210
    v_fma_f32 v253, v253, v208, -v210
    ds_read_b64_tr_b16 v[244:245], v4 offset:9344
    ds_read_b64_tr_b16 v[246:247], v4 offset:13952
    s_waitcnt lgkmcnt(4)
    v_mfma_f32_16x16x32_bf16 v[176:179], v[72:75], v[236:239], v[176:179]
    v_fma_f32 v254, v254, v208, -v210
    v_mfma_f32_16x16x32_bf16 v[180:183], v[76:79], v[236:239], v[180:183]
    v_fma_f32 v255, v255, v208, -v210
    v_cvt_pk_bf16_f32 v116, v248, v249
    s_waitcnt vmcnt(6)
    s_barrier
    ds_read_b64_tr_b16 v[232:233], v4 offset:18432
    ds_read_b64_tr_b16 v[234:235], v4 offset:23040
    s_waitcnt lgkmcnt(4)
    v_mfma_f32_16x16x32_bf16 v[184:187], v[72:75], v[240:243], v[184:187]
    v_cvt_pk_bf16_f32 v117, v250, v251
    v_mfma_f32_16x16x32_bf16 v[188:191], v[76:79], v[240:243], v[188:191]
    v_cvt_pk_bf16_f32 v118, v252, v253
    v_cvt_pk_bf16_f32 v119, v254, v255
    ds_read_b128 v[96:99], v202 offset:32768
    s_add_u32 s45, s55, 4718592
    s_add_u32 m0, s46, 36864
    s_nop 0
    buffer_load_dwordx4 v7, s[12:15], s45 offen offset:0 lds
    ds_read_b64_tr_b16 v[236:237], v4 offset:18464
    ds_read_b64_tr_b16 v[238:239], v4 offset:23072
    s_waitcnt lgkmcnt(5)
    v_mfma_f32_16x16x32_bf16 v[192:195], v[72:75], v[244:247], v[192:195]
    ds_write_b128 v200, v[116:119] offset:2048
    v_mfma_f32_16x16x32_bf16 v[196:199], v[76:79], v[244:247], v[196:199]
    v_lshlrev_b32 v248, 16, v128
    v_and_b32 v249, 0xffff0000, v128
    ds_read_b128 v[100:103], v202 offset:34816
    ds_read_b64_tr_b16 v[240:241], v4 offset:18496
    ds_read_b64_tr_b16 v[242:243], v4 offset:23104
    s_waitcnt lgkmcnt(7)
    v_mfma_f32_16x16x32_bf16 v[160:163], v[80:83], v[232:235], v[160:163]
    v_lshlrev_b32 v250, 16, v129
    v_mfma_f32_16x16x32_bf16 v[164:167], v[84:87], v[232:235], v[164:167]
    v_and_b32 v251, 0xffff0000, v129
    v_lshlrev_b32 v252, 16, v130
    ds_read_b128 v[104:107], v203 offset:33792
    s_nop 0
    buffer_load_dwordx4 v8, s[12:15], s45 offen offset:1024 lds
    ds_read_b64_tr_b16 v[244:245], v4 offset:18528
    ds_read_b64_tr_b16 v[246:247], v4 offset:23136
    s_lshl_b32 s100, s2, 3
    s_add_u32 s100, s100, s3
    s_lshl_b32 s100, s100, 12
    s_mov_b32 exec_lo, 255
    s_mov_b32 exec_hi, 0
    v_lshlrev_b32 v0, 7, v1
    buffer_load_dword v0, v0, s[76:79], s100 offen
    s_mov_b64 exec, -1
    s_waitcnt lgkmcnt(7)
    v_mfma_f32_16x16x32_bf16 v[168:171], v[80:83], v[236:239], v[168:171]
    v_and_b32 v253, 0xffff0000, v130
    v_mfma_f32_16x16x32_bf16 v[172:175], v[84:87], v[236:239], v[172:175]
    v_lshlrev_b32 v254, 16, v131
    v_and_b32 v255, 0xffff0000, v131
    ds_read_b128 v[108:111], v203 offset:35840
    ds_read_b64_tr_b16 v[232:233], v4 offset:18560
    ds_read_b64_tr_b16 v[234:235], v4 offset:23168
    s_waitcnt lgkmcnt(6)
    v_mfma_f32_16x16x32_bf16 v[176:179], v[80:83], v[240:243], v[176:179]
    v_fma_f32 v248, v248, v204, -v206
    v_mfma_f32_16x16x32_bf16 v[180:183], v[84:87], v[240:243], v[180:183]
    v_fma_f32 v249, v249, v204, -v206
    v_fma_f32 v250, v250, v204, -v206
    ds_read_b64_tr_b16 v[236:237], v4 offset:27648
    ds_read_b64_tr_b16 v[238:239], v4 offset:32256
    s_waitcnt lgkmcnt(5)
    v_mfma_f32_16x16x32_bf16 v[184:187], v[80:83], v[244:247], v[184:187]
    v_fma_f32 v251, v251, v204, -v206
    v_mfma_f32_16x16x32_bf16 v[188:191], v[84:87], v[244:247], v[188:191]
    v_fma_f32 v252, v252, v204, -v206
    v_fma_f32 v253, v253, v204, -v206
    ds_read_b64_tr_b16 v[240:241], v4 offset:27680
    ds_read_b64_tr_b16 v[242:243], v4 offset:32288
    s_waitcnt lgkmcnt(4)
    v_mfma_f32_16x16x32_bf16 v[192:195], v[80:83], v[232:235], v[192:195]
    v_fma_f32 v254, v254, v204, -v206
    v_mfma_f32_16x16x32_bf16 v[196:199], v[84:87], v[232:235], v[196:199]
    v_fma_f32 v255, v255, v204, -v206
    v_cvt_pk_bf16_f32 v128, v248, v249
    ds_read_b64_tr_b16 v[244:245], v4 offset:27712
    ds_read_b64_tr_b16 v[246:247], v4 offset:32320
    s_waitcnt lgkmcnt(4)
    v_mfma_f32_16x16x32_bf16 v[160:163], v[88:91], v[236:239], v[160:163]
    v_cvt_pk_bf16_f32 v129, v250, v251
    v_mfma_f32_16x16x32_bf16 v[164:167], v[92:95], v[236:239], v[164:167]
    v_cvt_pk_bf16_f32 v130, v252, v253
    v_cvt_pk_bf16_f32 v131, v254, v255
    ds_read_b64_tr_b16 v[232:233], v4 offset:27744
    ds_read_b64_tr_b16 v[234:235], v4 offset:32352
    s_waitcnt lgkmcnt(4)
    v_mfma_f32_16x16x32_bf16 v[168:171], v[88:91], v[240:243], v[168:171]
    ds_write_b128 v200, v[128:131] offset:16384
    v_mfma_f32_16x16x32_bf16 v[172:175], v[92:95], v[240:243], v[172:175]
    v_lshlrev_b32 v248, 16, v132
    v_and_b32 v249, 0xffff0000, v132
    ds_read_b64_tr_b16 v[236:237], v4 offset:27776
    ds_read_b64_tr_b16 v[238:239], v4 offset:32384
    s_waitcnt lgkmcnt(5)
    v_mfma_f32_16x16x32_bf16 v[176:179], v[88:91], v[244:247], v[176:179]
    v_lshlrev_b32 v250, 16, v133
    v_mfma_f32_16x16x32_bf16 v[180:183], v[92:95], v[244:247], v[180:183]
    v_and_b32 v251, 0xffff0000, v133
    v_lshlrev_b32 v252, 16, v134
    s_waitcnt vmcnt(7)
    s_barrier
    ds_read_b64_tr_b16 v[240:241], v4 offset:36864
    ds_read_b64_tr_b16 v[242:243], v4 offset:41472
    s_waitcnt lgkmcnt(5)
    v_mfma_f32_16x16x32_bf16 v[184:187], v[88:91], v[232:235], v[184:187]
    v_and_b32 v253, 0xffff0000, v134
    v_mfma_f32_16x16x32_bf16 v[188:191], v[92:95], v[232:235], v[188:191]
    v_lshlrev_b32 v254, 16, v135
    v_and_b32 v255, 0xffff0000, v135
    ds_read_b128 v[112:115], v202 offset:0
    s_add_u32 s45, s54, 0
    s_add_u32 m0, s46, 55296
    s_nop 0
    buffer_load_dwordx4 v7, s[12:15], s45 offen offset:0 lds
    ds_read_b64_tr_b16 v[244:245], v4 offset:36896
    ds_read_b64_tr_b16 v[246:247], v4 offset:41504
    s_waitcnt lgkmcnt(5)
    v_mfma_f32_16x16x32_bf16 v[192:195], v[88:91], v[236:239], v[192:195]
    v_fma_f32 v248, v248, v208, -v210
    v_mfma_f32_16x16x32_bf16 v[196:199], v[92:95], v[236:239], v[196:199]
    v_fma_f32 v249, v249, v208, -v210
    v_fma_f32 v250, v250, v208, -v210
    ds_read_b128 v[116:119], v202 offset:2048
    ds_read_b64_tr_b16 v[232:233], v4 offset:36928
    ds_read_b64_tr_b16 v[234:235], v4 offset:41536
    s_cmp_lg_u32 s3, 0
    s_cbranch_scc1 g1_nn2
    v_readfirstlane_b32 s6, v14
    s_cmp_eq_u32 s6, 0
    s_cselect_b32 s6, s52, s6
    v_mov_b32 v14, s6
    v_mov_b32 v15, 159744
    ds_write_b32 v15, v14
    s_waitcnt lgkmcnt(0)
g1_nn2:
    s_waitcnt lgkmcnt(6)
    v_mfma_f32_16x16x32_bf16 v[160:163], v[96:99], v[240:243], v[160:163]
    v_fma_f32 v251, v251, v208, -v210
    v_mfma_f32_16x16x32_bf16 v[164:167], v[100:103], v[240:243], v[164:167]
    v_fma_f32 v252, v252, v208, -v210
    v_fma_f32 v253, v253, v208, -v210
    ds_read_b128 v[120:123], v203 offset:1024
    s_nop 0
    buffer_load_dwordx4 v8, s[12:15], s45 offen offset:1024 lds
    ds_read_b64_tr_b16 v[236:237], v4 offset:36960
    ds_read_b64_tr_b16 v[238:239], v4 offset:41568
    s_waitcnt lgkmcnt(6)
    v_mfma_f32_16x16x32_bf16 v[168:171], v[96:99], v[244:247], v[168:171]
    v_fma_f32 v254, v254, v208, -v210
    v_mfma_f32_16x16x32_bf16 v[172:175], v[100:103], v[244:247], v[172:175]
    v_fma_f32 v255, v255, v208, -v210
    v_cvt_pk_bf16_f32 v132, v248, v249
    ds_read_b128 v[124:127], v203 offset:3072
    ds_read_b64_tr_b16 v[240:241], v4 offset:36992
    ds_read_b64_tr_b16 v[242:243], v4 offset:41600
    s_waitcnt lgkmcnt(6)
    v_mfma_f32_16x16x32_bf16 v[176:179], v[96:99], v[232:235], v[176:179]
    v_cvt_pk_bf16_f32 v133, v250, v251
    v_mfma_f32_16x16x32_bf16 v[180:183], v[100:103], v[232:235], v[180:183]
    v_cvt_pk_bf16_f32 v134, v252, v253
    v_cvt_pk_bf16_f32 v135, v254, v255
    ds_read_b64_tr_b16 v[244:245], v4 offset:46080
    ds_read_b64_tr_b16 v[246:247], v4 offset:50688
    s_waitcnt lgkmcnt(5)
    v_mfma_f32_16x16x32_bf16 v[184:187], v[96:99], v[236:239], v[184:187]
    ds_write_b128 v200, v[132:135] offset:18432
    v_mfma_f32_16x16x32_bf16 v[188:191], v[100:103], v[236:239], v[188:191]
    v_lshlrev_b32 v248, 16, v144
    v_and_b32 v249, 0xffff0000, v144
    ds_read_b64_tr_b16 v[232:233], v4 offset:46112
    ds_read_b64_tr_b16 v[234:235], v4 offset:50720
    s_waitcnt lgkmcnt(5)
    v_mfma_f32_16x16x32_bf16 v[192:195], v[96:99], v[240:243], v[192:195]
    v_lshlrev_b32 v250, 16, v145
    v_mfma_f32_16x16x32_bf16 v[196:199], v[100:103], v[240:243], v[196:199]
    v_and_b32 v251, 0xffff0000, v145
    v_lshlrev_b32 v252, 16, v146
    ds_read_b64_tr_b16 v[236:237], v4 offset:46144
    ds_read_b64_tr_b16 v[238:239], v4 offset:50752
    s_waitcnt lgkmcnt(5)
    v_mfma_f32_16x16x32_bf16 v[160:163], v[104:107], v[244:247], v[160:163]
    v_and_b32 v253, 0xffff0000, v146
    v_mfma_f32_16x16x32_bf16 v[164:167], v[108:111], v[244:247], v[164:167]
    v_lshlrev_b32 v254, 16, v147
    v_and_b32 v255, 0xffff0000, v147
    ds_read_b64_tr_b16 v[240:241], v4 offset:46176
    ds_read_b64_tr_b16 v[242:243], v4 offset:50784
    s_waitcnt lgkmcnt(4)
    v_mfma_f32_16x16x32_bf16 v[168:171], v[104:107], v[232:235], v[168:171]
    v_fma_f32 v248, v248, v204, -v206
    v_mfma_f32_16x16x32_bf16 v[172:175], v[108:111], v[232:235], v[172:175]
    v_fma_f32 v249, v249, v204, -v206
    v_fma_f32 v250, v250, v204, -v206
    ds_read_b64_tr_b16 v[244:245], v4 offset:46208
    ds_read_b64_tr_b16 v[246:247], v4 offset:50816
    s_waitcnt lgkmcnt(4)
    v_mfma_f32_16x16x32_bf16 v[176:179], v[104:107], v[236:239], v[176:179]
    v_fma_f32 v251, v251, v204, -v206
    v_mfma_f32_16x16x32_bf16 v[180:183], v[108:111], v[236:239], v[180:183]
    v_fma_f32 v252, v252, v204, -v206
    v_fma_f32 v253, v253, v204, -v206
    s_waitcnt vmcnt(7)
    s_barrier
    ds_read_b64_tr_b16 v[232:233], v3 offset:0
    ds_read_b64_tr_b16 v[234:235], v3 offset:4608
    s_waitcnt lgkmcnt(4)
    v_mfma_f32_16x16x32_bf16 v[184:187], v[104:107], v[240:243], v[184:187]
    v_fma_f32 v254, v254, v204, -v206
    v_mfma_f32_16x16x32_bf16 v[188:191], v[108:111], v[240:243], v[188:191]
    v_fma_f32 v255, v255, v204, -v206
    v_cvt_pk_bf16_f32 v144, v248, v249
    ds_read_b128 v[128:131], v202 offset:16384
    s_add_u32 s45, s54, 589824
    s_add_u32 m0, s46, 73728
    s_nop 0
    buffer_load_dwordx4 v7, s[12:15], s45 offen offset:0 lds
    ds_read_b64_tr_b16 v[236:237], v3 offset:32
    ds_read_b64_tr_b16 v[238:239], v3 offset:4640
    s_waitcnt lgkmcnt(5)
    v_mfma_f32_16x16x32_bf16 v[192:195], v[104:107], v[244:247], v[192:195]
    v_cvt_pk_bf16_f32 v145, v250, v251
    v_mfma_f32_16x16x32_bf16 v[196:199], v[108:111], v[244:247], v[196:199]
    v_cvt_pk_bf16_f32 v146, v252, v253
    v_cvt_pk_bf16_f32 v147, v254, v255
    ds_read_b128 v[132:135], v202 offset:18432
    ds_read_b64_tr_b16 v[240:241], v3 offset:64
    ds_read_b64_tr_b16 v[242:243], v3 offset:4672
    s_waitcnt lgkmcnt(6)
    v_mfma_f32_16x16x32_bf16 v[160:163], v[112:115], v[232:235], v[160:163]
    ds_write_b128 v200, v[144:147] offset:32768
    v_mfma_f32_16x16x32_bf16 v[164:167], v[116:119], v[232:235], v[164:167]
    v_lshlrev_b32 v248, 16, v148
    v_and_b32 v249, 0xffff0000, v148
    ds_read_b128 v[136:139], v203 offset:17408
    s_nop 0
    buffer_load_dwordx4 v8, s[12:15], s45 offen offset:1024 lds
    ds_read_b64_tr_b16 v[244:245], v3 offset:96
    ds_read_b64_tr_b16 v[246:247], v3 offset:4704
    s_waitcnt lgkmcnt(7)
    v_mfma_f32_16x16x32_bf16 v[168:171], v[112:115], v[236:239], v[168:171]
    v_lshlrev_b32 v250, 16, v149
    v_mfma_f32_16x16x32_bf16 v[172:175], v[116:119], v[236:239], v[172:175]
    v_and_b32 v251, 0xffff0000, v149
    v_lshlrev_b32 v252, 16, v150
    ds_read_b128 v[140:143], v203 offset:19456
    ds_read_b64_tr_b16 v[232:233], v3 offset:128
    ds_read_b64_tr_b16 v[234:235], v3 offset:4736
    s_waitcnt lgkmcnt(7)
    v_mfma_f32_16x16x32_bf16 v[176:179], v[112:115], v[240:243], v[176:179]
    v_and_b32 v253, 0xffff0000, v150
    v_mfma_f32_16x16x32_bf16 v[180:183], v[116:119], v[240:243], v[180:183]
    v_lshlrev_b32 v254, 16, v151
    v_and_b32 v255, 0xffff0000, v151
    ds_read_b64_tr_b16 v[236:237], v3 offset:9216
    ds_read_b64_tr_b16 v[238:239], v3 offset:13824
    s_waitcnt lgkmcnt(5)
    v_mfma_f32_16x16x32_bf16 v[184:187], v[112:115], v[244:247], v[184:187]
    v_fma_f32 v248, v248, v208, -v210
    v_mfma_f32_16x16x32_bf16 v[188:191], v[116:119], v[244:247], v[188:191]
    v_fma_f32 v249, v249, v208, -v210
    v_fma_f32 v250, v250, v208, -v210
    ds_read_b64_tr_b16 v[240:241], v3 offset:9248
    ds_read_b64_tr_b16 v[242:243], v3 offset:13856
    s_waitcnt lgkmcnt(4)
    v_mfma_f32_16x16x32_bf16 v[192:195], v[112:115], v[232:235], v[192:195]
    v_fma_f32 v251, v251, v208, -v210
    v_mfma_f32_16x16x32_bf16 v[196:199], v[116:119], v[232:235], v[196:199]
    v_fma_f32 v252, v252, v208, -v210
    v_fma_f32 v253, v253, v208, -v210
    ds_read_b64_tr_b16 v[244:245], v3 offset:9280
    ds_read_b64_tr_b16 v[246:247], v3 offset:13888
    s_waitcnt lgkmcnt(4)
    v_mfma_f32_16x16x32_bf16 v[160:163], v[120:123], v[236:239], v[160:163]
    v_fma_f32 v254, v254, v208, -v210
    v_mfma_f32_16x16x32_bf16 v[164:167], v[124:127], v[236:239], v[164:167]
    v_fma_f32 v255, v255, v208, -v210
    v_cvt_pk_bf16_f32 v148, v248, v249
    ds_read_b64_tr_b16 v[232:233], v3 offset:9312
    ds_read_b64_tr_b16 v[234:235], v3 offset:13920
    s_waitcnt lgkmcnt(4)
    v_mfma_f32_16x16x32_bf16 v[168:171], v[120:123], v[240:243], v[168:171]
    v_cvt_pk_bf16_f32 v149, v250, v251
    v_mfma_f32_16x16x32_bf16 v[172:175], v[124:127], v[240:243], v[172:175]
    v_cvt_pk_bf16_f32 v150, v252, v253
    v_cvt_pk_bf16_f32 v151, v254, v255
    ds_read_b64_tr_b16 v[236:237], v3 offset:9344
    ds_read_b64_tr_b16 v[238:239], v3 offset:13952
    s_waitcnt lgkmcnt(4)
    v_mfma_f32_16x16x32_bf16 v[176:179], v[120:123], v[244:247], v[176:179]
    ds_write_b128 v200, v[148:151] offset:34816
    v_mfma_f32_16x16x32_bf16 v[180:183], v[124:127], v[244:247], v[180:183]
    s_waitcnt vmcnt(7)
    s_waitcnt lgkmcnt(0)
    s_barrier
    ds_read_b64_tr_b16 v[240:241], v3 offset:18432
    ds_read_b64_tr_b16 v[242:243], v3 offset:23040
    v_mfma_f32_16x16x32_bf16 v[184:187], v[120:123], v[232:235], v[184:187]
    v_mfma_f32_16x16x32_bf16 v[188:191], v[124:127], v[232:235], v[188:191]
    ds_read_b128 v[144:147], v202 offset:32768
    s_add_u32 s45, s54, 1179648
    s_add_u32 m0, s46, 92160
    s_nop 0
    buffer_load_dwordx4 v7, s[12:15], s45 offen offset:0 lds
    ds_read_b64_tr_b16 v[244:245], v3 offset:18464
    ds_read_b64_tr_b16 v[246:247], v3 offset:23072
    v_mfma_f32_16x16x32_bf16 v[192:195], v[120:123], v[236:239], v[192:195]
    v_mfma_f32_16x16x32_bf16 v[196:199], v[124:127], v[236:239], v[196:199]
    ds_read_b128 v[148:151], v202 offset:34816
    ds_read_b64_tr_b16 v[232:233], v3 offset:18496
    ds_read_b64_tr_b16 v[234:235], v3 offset:23104
    v_mov_b32 v15, 159744
    ds_read_b32 v14, v15
    s_waitcnt lgkmcnt(7)
    v_mfma_f32_16x16x32_bf16 v[160:163], v[128:131], v[240:243], v[160:163]
    v_mfma_f32_16x16x32_bf16 v[164:167], v[132:135], v[240:243], v[164:167]
    ds_read_b128 v[152:155], v203 offset:33792
    s_nop 0
    buffer_load_dwordx4 v8, s[12:15], s45 offen offset:1024 lds
    ds_read_b64_tr_b16 v[236:237], v3 offset:18528
    ds_read_b64_tr_b16 v[238:239], v3 offset:23136
    s_lshl_b32 s100, s2, 3
    s_add_u32 s100, s100, s3
    s_lshl_b32 s100, s100, 12
    s_mov_b32 exec_lo, 65280
    s_mov_b32 exec_hi, 0
    v_lshlrev_b32 v0, 7, v1
    buffer_load_dword v0, v0, s[76:79], s100 offen
    s_mov_b64 exec, -1
    s_waitcnt lgkmcnt(7)
    v_mfma_f32_16x16x32_bf16 v[168:171], v[128:131], v[244:247], v[168:171]
    v_mfma_f32_16x16x32_bf16 v[172:175], v[132:135], v[244:247], v[172:175]
    ds_read_b128 v[156:159], v203 offset:35840
    ds_read_b64_tr_b16 v[240:241], v3 offset:18560
    ds_read_b64_tr_b16 v[242:243], v3 offset:23168
    s_waitcnt lgkmcnt(7)
    v_mfma_f32_16x16x32_bf16 v[176:179], v[128:131], v[232:235], v[176:179]
    v_mfma_f32_16x16x32_bf16 v[180:183], v[132:135], v[232:235], v[180:183]
    ds_read_b64_tr_b16 v[244:245], v3 offset:27648
    ds_read_b64_tr_b16 v[246:247], v3 offset:32256
    s_waitcnt lgkmcnt(5)
    v_mfma_f32_16x16x32_bf16 v[184:187], v[128:131], v[236:239], v[184:187]
    v_mfma_f32_16x16x32_bf16 v[188:191], v[132:135], v[236:239], v[188:191]
    ds_read_b64_tr_b16 v[232:233], v3 offset:27680
    ds_read_b64_tr_b16 v[234:235], v3 offset:32288
    s_waitcnt lgkmcnt(4)
    v_mfma_f32_16x16x32_bf16 v[192:195], v[128:131], v[240:243], v[192:195]
    v_mfma_f32_16x16x32_bf16 v[196:199], v[132:135], v[240:243], v[196:199]
    ds_read_b64_tr_b16 v[236:237], v3 offset:27712
    ds_read_b64_tr_b16 v[238:239], v3 offset:32320
    s_waitcnt lgkmcnt(4)
    v_mfma_f32_16x16x32_bf16 v[160:163], v[136:139], v[244:247], v[160:163]
    v_mfma_f32_16x16x32_bf16 v[164:167], v[140:143], v[244:247], v[164:167]
    ds_read_b64_tr_b16 v[240:241], v3 offset:27744
    ds_read_b64_tr_b16 v[242:243], v3 offset:32352
    s_waitcnt lgkmcnt(4)
    v_mfma_f32_16x16x32_bf16 v[168:171], v[136:139], v[232:235], v[168:171]
    v_mfma_f32_16x16x32_bf16 v[172:175], v[140:143], v[232:235], v[172:175]
    ds_read_b64_tr_b16 v[244:245], v3 offset:27776
    ds_read_b64_tr_b16 v[246:247], v3 offset:32384
    s_waitcnt lgkmcnt(4)
    v_mfma_f32_16x16x32_bf16 v[176:179], v[136:139], v[236:239], v[176:179]
    v_mfma_f32_16x16x32_bf16 v[180:183], v[140:143], v[236:239], v[180:183]
    s_waitcnt vmcnt(8)
    s_barrier
    ds_read_b64_tr_b16 v[232:233], v3 offset:36864
    ds_read_b64_tr_b16 v[234:235], v3 offset:41472
    s_waitcnt lgkmcnt(4)
    v_mfma_f32_16x16x32_bf16 v[184:187], v[136:139], v[240:243], v[184:187]
    v_mfma_f32_16x16x32_bf16 v[188:191], v[140:143], v[240:243], v[188:191]
    s_add_u32 s45, s54, 1769472
    s_add_u32 m0, s46, 0
    s_nop 0
    buffer_load_dwordx4 v7, s[12:15], s45 offen offset:0 lds
    ds_read_b64_tr_b16 v[236:237], v3 offset:36896
    ds_read_b64_tr_b16 v[238:239], v3 offset:41504
    s_waitcnt lgkmcnt(4)
    v_mfma_f32_16x16x32_bf16 v[192:195], v[136:139], v[244:247], v[192:195]
    v_mfma_f32_16x16x32_bf16 v[196:199], v[140:143], v[244:247], v[196:199]
    ds_read_b64_tr_b16 v[240:241], v3 offset:36928
    ds_read_b64_tr_b16 v[242:243], v3 offset:41536
    v_readfirstlane_b32 s48, v14
    s_waitcnt lgkmcnt(4)
    v_mfma_f32_16x16x32_bf16 v[160:163], v[144:147], v[232:235], v[160:163]
    v_mfma_f32_16x16x32_bf16 v[164:167], v[148:151], v[232:235], v[164:167]
    s_nop 0
    buffer_load_dwordx4 v8, s[12:15], s45 offen offset:1024 lds
    ds_read_b64_tr_b16 v[244:245], v3 offset:36960
    ds_read_b64_tr_b16 v[246:247], v3 offset:41568
    s_waitcnt lgkmcnt(4)
    v_mfma_f32_16x16x32_bf16 v[168:171], v[144:147], v[236:239], v[168:171]
    v_mfma_f32_16x16x32_bf16 v[172:175], v[148:151], v[236:239], v[172:175]
    ds_read_b64_tr_b16 v[232:233], v3 offset:36992
    ds_read_b64_tr_b16 v[234:235], v3 offset:41600
    s_waitcnt lgkmcnt(4)
    v_mfma_f32_16x16x32_bf16 v[176:179], v[144:147], v[240:243], v[176:179]
    v_mfma_f32_16x16x32_bf16 v[180:183], v[148:151], v[240:243], v[180:183]
    ds_read_b64_tr_b16 v[236:237], v3 offset:46080
    ds_read_b64_tr_b16 v[238:239], v3 offset:50688
    s_waitcnt lgkmcnt(4)
    v_mfma_f32_16x16x32_bf16 v[184:187], v[144:147], v[244:247], v[184:187]
    v_mfma_f32_16x16x32_bf16 v[188:191], v[148:151], v[244:247], v[188:191]
    ds_read_b64_tr_b16 v[240:241], v3 offset:46112
    ds_read_b64_tr_b16 v[242:243], v3 offset:50720
    s_waitcnt lgkmcnt(4)
    v_mfma_f32_16x16x32_bf16 v[192:195], v[144:147], v[232:235], v[192:195]
    v_mfma_f32_16x16x32_bf16 v[196:199], v[148:151], v[232:235], v[196:199]
    ds_read_b64_tr_b16 v[244:245], v3 offset:46144
    ds_read_b64_tr_b16 v[246:247], v3 offset:50752
    s_waitcnt lgkmcnt(4)
    v_mfma_f32_16x16x32_bf16 v[160:163], v[152:155], v[236:239], v[160:163]
    v_mfma_f32_16x16x32_bf16 v[164:167], v[156:159], v[236:239], v[164:167]
    ds_read_b64_tr_b16 v[232:233], v3 offset:46176
    ds_read_b64_tr_b16 v[234:235], v3 offset:50784
    s_waitcnt lgkmcnt(4)
    v_mfma_f32_16x16x32_bf16 v[168:171], v[152:155], v[240:243], v[168:171]
    v_mfma_f32_16x16x32_bf16 v[172:175], v[156:159], v[240:243], v[172:175]
    ds_read_b64_tr_b16 v[236:237], v3 offset:46208
    ds_read_b64_tr_b16 v[238:239], v3 offset:50816
    s_waitcnt lgkmcnt(4)
    v_mfma_f32_16x16x32_bf16 v[176:179], v[152:155], v[244:247], v[176:179]
    v_mfma_f32_16x16x32_bf16 v[180:183], v[156:159], v[244:247], v[180:183]
    s_waitcnt vmcnt(7)
    s_barrier
    ds_read_b64_tr_b16 v[240:241], v4 offset:0
    ds_read_b64_tr_b16 v[242:243], v4 offset:4608
    s_waitcnt lgkmcnt(4)
    v_mfma_f32_16x16x32_bf16 v[184:187], v[152:155], v[232:235], v[184:187]
    v_mfma_f32_16x16x32_bf16 v[188:191], v[156:159], v[232:235], v[188:191]
    s_add_u32 s45, s54, 2359296
    s_add_u32 m0, s46, 18432
    s_nop 0
    buffer_load_dwordx4 v7, s[12:15], s45 offen offset:0 lds
    ds_read_b64_tr_b16 v[244:245], v4 offset:32
    ds_read_b64_tr_b16 v[246:247], v4 offset:4640
    s_waitcnt lgkmcnt(4)
    v_mfma_f32_16x16x32_bf16 v[192:195], v[152:155], v[236:239], v[192:195]
    v_mfma_f32_16x16x32_bf16 v[196:199], v[156:159], v[236:239], v[196:199]
    ds_read_b64_tr_b16 v[232:233], v4 offset:64
    ds_read_b64_tr_b16 v[234:235], v4 offset:4672
    s_waitcnt lgkmcnt(4)
    v_mfma_f32_16x16x32_bf16 v[200:203], v[240:243], v[16:19], 0
    v_mfma_f32_16x16x32_bf16 v[204:207], v[240:243], v[20:23], 0
    s_nop 0
    buffer_load_dwordx4 v8, s[12:15], s45 offen offset:1024 lds
    ds_read_b64_tr_b16 v[236:237], v4 offset:96
    ds_read_b64_tr_b16 v[238:239], v4 offset:4704
    s_and_b32 s100, s4, 3
    s_lshl_b32 s100, s100, 3
    s_add_u32 s100, s100, s3
    s_mul_i32 s100, s100, 62208
    s_add_u32 s100, s100, s56
    v_mul_u32_u24 v15, 1152, v1
    s_mov_b32 exec_lo, 4294967295
    s_mov_b32 exec_hi, 4194303
    buffer_load_dword v0, v15, s[16:19], s100 offen
    buffer_load_dword v15, v15, s[16:19], s100 offen offset:64
    s_mov_b64 exec, -1
    s_waitcnt lgkmcnt(4)
    v_mfma_f32_16x16x32_bf16 v[208:211], v[244:247], v[16:19], 0
    v_mfma_f32_16x16x32_bf16 v[212:215], v[244:247], v[20:23], 0
    ds_read_b64_tr_b16 v[240:241], v4 offset:9216
    ds_read_b64_tr_b16 v[242:243], v4 offset:13824
    s_waitcnt lgkmcnt(4)
    v_mfma_f32_16x16x32_bf16 v[216:219], v[232:235], v[16:19], 0
    v_fmaak_f32 v248, v160, v160, 0x41b2e92f
    v_fmaak_f32 v249, v161, v161, 0x41b2e92f
    v_fmaak_f32 v250, v168, v168, 0x41b2e92f
    v_fmaak_f32 v251, v169, v169, 0x41b2e92f
    v_mfma_f32_16x16x32_bf16 v[220:223], v[232:235], v[20:23], 0
    v_mul_f32 v252, s47, v160
    v_mul_f32 v253, s47, v161
    v_mul_f32 v254, s47, v168
    v_mul_f32 v255, s47, v169
    ds_read_b64_tr_b16 v[244:245], v4 offset:9248
    ds_read_b64_tr_b16 v[246:247], v4 offset:13856
    s_waitcnt lgkmcnt(4)
    v_mfma_f32_16x16x32_bf16 v[224:227], v[236:239], v[16:19], 0
    v_mul_f32 v248, v248, v252
    v_mul_f32 v249, v249, v253
    v_mul_f32 v250, v250, v254
    v_mul_f32 v251, v251, v255
    v_mfma_f32_16x16x32_bf16 v[228:231], v[236:239], v[20:23], 0
    v_exp_f32 v248, v248
    v_exp_f32 v249, v249
    v_exp_f32 v250, v250
    v_exp_f32 v251, v251
    ds_read_b64_tr_b16 v[232:233], v4 offset:9280
    ds_read_b64_tr_b16 v[234:235], v4 offset:13888
    s_waitcnt lgkmcnt(4)
    v_mfma_f32_16x16x32_bf16 v[200:203], v[240:243], v[24:27], v[200:203]
    v_add_f32 v248, 1.0, v248
    v_add_f32 v249, 1.0, v249
    v_add_f32 v250, 1.0, v250
    v_add_f32 v251, 1.0, v251
    v_mfma_f32_16x16x32_bf16 v[204:207], v[240:243], v[28:31], v[204:207]
    v_rcp_f32 v248, v248
    v_rcp_f32 v249, v249
    v_rcp_f32 v250, v250
    v_rcp_f32 v251, v251
    ds_read_b64_tr_b16 v[236:237], v4 offset:9312
    ds_read_b64_tr_b16 v[238:239], v4 offset:13920
    s_waitcnt lgkmcnt(4)
    v_mfma_f32_16x16x32_bf16 v[208:211], v[244:247], v[24:27], v[208:211]
    v_mul_f32 v252, v160, v248
    v_mul_f32 v253, v161, v249
    v_mul_f32 v254, v168, v250
    v_mul_f32 v255, v169, v251
    v_mfma_f32_16x16x32_bf16 v[212:215], v[244:247], v[28:31], v[212:215]
    v_cvt_pk_bf16_f32 v248, v252, v253
    v_cvt_pk_bf16_f32 v250, v254, v255
    v_add_f32 v160, v252, v254
    v_mul_f32 v168, v252, v252
    s_waitcnt vmcnt(9)
    s_barrier
    ds_read_b64_tr_b16 v[240:241], v4 offset:18432
    ds_read_b64_tr_b16 v[242:243], v4 offset:23040
    s_waitcnt lgkmcnt(4)
    v_mfma_f32_16x16x32_bf16 v[216:219], v[232:235], v[24:27], v[216:219]
    v_add_f32 v161, v253, v255
    v_mul_f32 v169, v253, v253
    ds_write_b32 v13, v248 offset:0
    ds_write_b32 v13, v250 offset:1024
    v_mfma_f32_16x16x32_bf16 v[220:223], v[232:235], v[28:31], v[220:223]
    v_fmac_f32 v168, v254, v254
    v_fmac_f32 v169, v255, v255
    v_fmaak_f32 v248, v176, v176, 0x41b2e92f
    v_fmaak_f32 v249, v177, v177, 0x41b2e92f
    s_add_u32 s45, s54, 2949120
    s_add_u32 m0, s46, 36864
    s_nop 0
    buffer_load_dwordx4 v7, s[12:15], s45 offen offset:0 lds
    ds_read_b64_tr_b16 v[244:245], v4 offset:18464
    ds_read_b64_tr_b16 v[246:247], v4 offset:23072
    s_waitcnt lgkmcnt(6)
    v_mfma_f32_16x16x32_bf16 v[224:227], v[236:239], v[24:27], v[224:227]
    v_fmaak_f32 v250, v184, v184, 0x41b2e92f
    v_fmaak_f32 v251, v185, v185, 0x41b2e92f
    v_mul_f32 v252, s47, v176
    v_mul_f32 v253, s47, v177
    v_mfma_f32_16x16x32_bf16 v[228:231], v[236:239], v[28:31], v[228:231]
    v_mul_f32 v254, s47, v184
    v_mul_f32 v255, s47, v185
    v_mul_f32 v248, v248, v252
    v_mul_f32 v249, v249, v253
    ds_read_b64_tr_b16 v[232:233], v4 offset:18496
    ds_read_b64_tr_b16 v[234:235], v4 offset:23104
    s_waitcnt lgkmcnt(6)
    v_mfma_f32_16x16x32_bf16 v[200:203], v[240:243], v[32:35], v[200:203]
    v_mul_f32 v250, v250, v254
    v_mul_f32 v251, v251, v255
    v_exp_f32 v248, v248
    v_exp_f32 v249, v249
    v_mfma_f32_16x16x32_bf16 v[204:207], v[240:243], v[36:39], v[204:207]
    v_exp_f32 v250, v250
    v_exp_f32 v251, v251
    v_add_f32 v248, 1.0, v248
    v_add_f32 v249, 1.0, v249
    s_nop 0
    buffer_load_dwordx4 v8, s[12:15], s45 offen offset:1024 lds
    ds_read_b64_tr_b16 v[236:237], v4 offset:18528
    ds_read_b64_tr_b16 v[238:239], v4 offset:23136
    s_waitcnt lgkmcnt(4)
    v_mfma_f32_16x16x32_bf16 v[208:211], v[244:247], v[32:35], v[208:211]
    v_add_f32 v250, 1.0, v250
    v_add_f32 v251, 1.0, v251
    v_rcp_f32 v248, v248
    v_rcp_f32 v249, v249
    v_mfma_f32_16x16x32_bf16 v[212:215], v[244:247], v[36:39], v[212:215]
    v_rcp_f32 v250, v250
    v_rcp_f32 v251, v251
    v_mul_f32 v252, v176, v248
    v_mul_f32 v253, v177, v249
    ds_read_b64_tr_b16 v[240:241], v4 offset:27648
    ds_read_b64_tr_b16 v[242:243], v4 offset:32256
    s_waitcnt lgkmcnt(4)
    v_mfma_f32_16x16x32_bf16 v[216:219], v[232:235], v[32:35], v[216:219]
    v_mul_f32 v254, v184, v250
    v_mul_f32 v255, v185, v251
    v_cvt_pk_bf16_f32 v248, v252, v253
    v_cvt_pk_bf16_f32 v250, v254, v255
    v_mfma_f32_16x16x32_bf16 v[220:223], v[232:235], v[36:39], v[220:223]
    v_add_f32 v160, v160, v252
    v_fmac_f32 v168, v252, v252
    v_add_f32 v161, v161, v253
    v_fmac_f32 v169, v253, v253
    ds_read_b64_tr_b16 v[244:245], v4 offset:27680
    ds_read_b64_tr_b16 v[246:247], v4 offset:32288
    s_waitcnt lgkmcnt(4)
    v_mfma_f32_16x16x32_bf16 v[224:227], v[236:239], v[32:35], v[224:227]
    ds_write_b32 v13, v248 offset:2048
    ds_write_b32 v13, v250 offset:3072
    v_add_f32 v160, v160, v254
    v_fmac_f32 v168, v254, v254
    v_mfma_f32_16x16x32_bf16 v[228:231], v[236:239], v[36:39], v[228:231]
    v_add_f32 v161, v161, v255
    v_fmac_f32 v169, v255, v255
    v_fmaak_f32 v248, v192, v192, 0x41b2e92f
    v_fmaak_f32 v249, v193, v193, 0x41b2e92f
    ds_read_b64_tr_b16 v[232:233], v4 offset:27712
    ds_read_b64_tr_b16 v[234:235], v4 offset:32320
    s_waitcnt lgkmcnt(6)
    v_mfma_f32_16x16x32_bf16 v[200:203], v[240:243], v[40:43], v[200:203]
    v_mul_f32 v252, s47, v192
    v_mul_f32 v253, s47, v193
    v_mul_f32 v248, v248, v252
    v_mul_f32 v249, v249, v253
    v_mfma_f32_16x16x32_bf16 v[204:207], v[240:243], v[44:47], v[204:207]
    v_exp_f32 v248, v248
    v_exp_f32 v249, v249
    v_add_f32 v248, 1.0, v248
    v_add_f32 v249, 1.0, v249
    ds_read_b64_tr_b16 v[236:237], v4 offset:27744
    ds_read_b64_tr_b16 v[238:239], v4 offset:32352
    s_waitcnt lgkmcnt(6)
    v_mfma_f32_16x16x32_bf16 v[208:211], v[244:247], v[40:43], v[208:211]
    v_rcp_f32 v248, v248
    v_rcp_f32 v249, v249
    v_mul_f32 v252, v192, v248
    v_mul_f32 v253, v193, v249
    v_mfma_f32_16x16x32_bf16 v[212:215], v[244:247], v[44:47], v[212:215]
    v_cvt_pk_bf16_f32 v248, v252, v253
    v_add_f32 v160, v160, v252
    v_fmac_f32 v168, v252, v252
    v_add_f32 v161, v161, v253
    s_waitcnt vmcnt(9)
    s_barrier
    ds_read_b64_tr_b16 v[240:241], v4 offset:36864
    ds_read_b64_tr_b16 v[242:243], v4 offset:41472
    s_waitcnt lgkmcnt(4)
    v_mfma_f32_16x16x32_bf16 v[216:219], v[232:235], v[40:43], v[216:219]
    v_fmac_f32 v169, v253, v253
    ds_write_b32 v13, v248 offset:4096
    v_fmaak_f32 v248, v162, v162, 0x41b2e92f
    v_fmaak_f32 v249, v163, v163, 0x41b2e92f
    v_mfma_f32_16x16x32_bf16 v[220:223], v[232:235], v[44:47], v[220:223]
    v_fmaak_f32 v250, v170, v170, 0x41b2e92f
    v_fmaak_f32 v251, v171, v171, 0x41b2e92f
    v_mul_f32 v252, s47, v162
    v_mul_f32 v253, s47, v163
    s_add_u32 s45, s54, 3538944
    s_add_u32 m0, s46, 55296
    s_nop 0
    buffer_load_dwordx4 v7, s[12:15], s45 offen offset:0 lds
    ds_read_b64_tr_b16 v[244:245], v4 offset:36896
    ds_read_b64_tr_b16 v[246:247], v4 offset:41504
    s_waitcnt lgkmcnt(5)
    v_mfma_f32_16x16x32_bf16 v[224:227], v[236:239], v[40:43], v[224:227]
    v_mul_f32 v254, s47, v170
    v_mul_f32 v255, s47, v171
    v_mul_f32 v248, v248, v252
    v_mul_f32 v249, v249, v253
    v_mfma_f32_16x16x32_bf16 v[228:231], v[236:239], v[44:47], v[228:231]
    v_mul_f32 v250, v250, v254
    v_mul_f32 v251, v251, v255
    v_exp_f32 v248, v248
    v_exp_f32 v249, v249
    ds_read_b64_tr_b16 v[232:233], v4 offset:36928
    ds_read_b64_tr_b16 v[234:235], v4 offset:41536
    s_waitcnt lgkmcnt(5)
    v_mfma_f32_16x16x32_bf16 v[200:203], v[240:243], v[48:51], v[200:203]
    v_exp_f32 v250, v250
    v_exp_f32 v251, v251
    v_add_f32 v248, 1.0, v248
    v_add_f32 v249, 1.0, v249
    v_mfma_f32_16x16x32_bf16 v[204:207], v[240:243], v[52:55], v[204:207]
    v_add_f32 v250, 1.0, v250
    v_add_f32 v251, 1.0, v251
    v_rcp_f32 v248, v248
    v_rcp_f32 v249, v249
    s_nop 0
    buffer_load_dwordx4 v8, s[12:15], s45 offen offset:1024 lds
    ds_read_b64_tr_b16 v[236:237], v4 offset:36960
    ds_read_b64_tr_b16 v[238:239], v4 offset:41568
    s_waitcnt lgkmcnt(4)
    v_mfma_f32_16x16x32_bf16 v[208:211], v[244:247], v[48:51], v[208:211]
    v_rcp_f32 v250, v250
    v_rcp_f32 v251, v251
    v_mul_f32 v252, v162, v248
    v_mul_f32 v253, v163, v249
    v_mfma_f32_16x16x32_bf16 v[212:215], v[244:247], v[52:55], v[212:215]
    v_mul_f32 v254, v170, v250
    v_mul_f32 v255, v171, v251
    v_cvt_pk_bf16_f32 v248, v252, v253
    v_cvt_pk_bf16_f32 v250, v254, v255
    ds_read_b64_tr_b16 v[240:241], v4 offset:46080
    ds_read_b64_tr_b16 v[242:243], v4 offset:50688
    s_waitcnt lgkmcnt(4)
    v_mfma_f32_16x16x32_bf16 v[216:219], v[232:235], v[48:51], v[216:219]
    v_add_f32 v162, v252, v254
    v_mul_f32 v170, v252, v252
    v_add_f32 v163, v253, v255
    v_mul_f32 v171, v253, v253
    v_mfma_f32_16x16x32_bf16 v[220:223], v[232:235], v[52:55], v[220:223]
    ds_write_b32 v13, v248 offset:256
    ds_write_b32 v13, v250 offset:1280
    v_fmac_f32 v170, v254, v254
    v_fmac_f32 v171, v255, v255
    ds_read_b64_tr_b16 v[244:245], v4 offset:46112
    ds_read_b64_tr_b16 v[246:247], v4 offset:50720
    s_waitcnt lgkmcnt(6)
    v_mfma_f32_16x16x32_bf16 v[224:227], v[236:239], v[48:51], v[224:227]
    v_fmaak_f32 v248, v178, v178, 0x41b2e92f
    v_fmaak_f32 v249, v179, v179, 0x41b2e92f
    v_fmaak_f32 v250, v186, v186, 0x41b2e92f
    v_fmaak_f32 v251, v187, v187, 0x41b2e92f
    v_mfma_f32_16x16x32_bf16 v[228:231], v[236:239], v[52:55], v[228:231]
    v_mul_f32 v252, s47, v178
    v_mul_f32 v253, s47, v179
    v_mul_f32 v254, s47, v186
    v_mul_f32 v255, s47, v187
    ds_read_b64_tr_b16 v[232:233], v4 offset:46144
    ds_read_b64_tr_b16 v[234:235], v4 offset:50752
    s_waitcnt lgkmcnt(6)
    v_mfma_f32_16x16x32_bf16 v[200:203], v[240:243], v[56:59], v[200:203]
    v_mul_f32 v248, v248, v252
    v_mul_f32 v249, v249, v253
    v_mul_f32 v250, v250, v254
    v_mul_f32 v251, v251, v255
    v_mfma_f32_16x16x32_bf16 v[204:207], v[240:243], v[60:63], v[204:207]
    v_exp_f32 v248, v248
    v_exp_f32 v249, v249
    v_exp_f32 v250, v250
    v_exp_f32 v251, v251
    ds_read_b64_tr_b16 v[236:237], v4 offset:46176
    ds_read_b64_tr_b16 v[238:239], v4 offset:50784
    s_waitcnt lgkmcnt(4)
    v_mfma_f32_16x16x32_bf16 v[208:211], v[244:247], v[56:59], v[208:211]
    v_add_f32 v248, 1.0, v248
    v_add_f32 v249, 1.0, v249
    v_add_f32 v250, 1.0, v250
    v_add_f32 v251, 1.0, v251
    v_mfma_f32_16x16x32_bf16 v[212:215], v[244:247], v[60:63], v[212:215]
    v_rcp_f32 v248, v248
    v_rcp_f32 v249, v249
    v_rcp_f32 v250, v250
    v_rcp_f32 v251, v251
    s_waitcnt vmcnt(8)
    s_barrier
    ds_read_b64_tr_b16 v[240:241], v3 offset:0
    ds_read_b64_tr_b16 v[242:243], v3 offset:4608
    s_waitcnt lgkmcnt(4)
    v_mfma_f32_16x16x32_bf16 v[216:219], v[232:235], v[56:59], v[216:219]
    v_mul_f32 v252, v178, v248
    v_mul_f32 v253, v179, v249
    v_mul_f32 v254, v186, v250
    v_mul_f32 v255, v187, v251
    v_mfma_f32_16x16x32_bf16 v[220:223], v[232:235], v[60:63], v[220:223]
    v_cvt_pk_bf16_f32 v248, v252, v253
    v_cvt_pk_bf16_f32 v250, v254, v255
    v_add_f32 v162, v162, v252
    v_fmac_f32 v170, v252, v252
    s_add_u32 s45, s54, 4128768
    s_add_u32 m0, s46, 73728
    s_nop 0
    buffer_load_dwordx4 v7, s[12:15], s45 offen offset:0 lds
    ds_read_b64_tr_b16 v[244:245], v3 offset:32
    ds_read_b64_tr_b16 v[246:247], v3 offset:4640
    s_waitcnt lgkmcnt(4)
    v_mfma_f32_16x16x32_bf16 v[224:227], v[236:239], v[56:59], v[224:227]
    v_add_f32 v163, v163, v253
    v_fmac_f32 v171, v253, v253
    ds_write_b32 v13, v248 offset:2304
    ds_write_b32 v13, v250 offset:3328
    v_mfma_f32_16x16x32_bf16 v[228:231], v[236:239], v[60:63], v[228:231]
    v_add_f32 v162, v162, v254
    v_fmac_f32 v170, v254, v254
    v_add_f32 v163, v163, v255
    v_fmac_f32 v171, v255, v255
    ds_read_b64_tr_b16 v[232:233], v3 offset:64
    ds_read_b64_tr_b16 v[234:235], v3 offset:4672
    s_waitcnt lgkmcnt(6)
    v_mfma_f32_16x16x32_bf16 v[200:203], v[240:243], v[64:67], v[200:203]
    v_fmaak_f32 v248, v194, v194, 0x41b2e92f
    v_fmaak_f32 v249, v195, v195, 0x41b2e92f
    v_mul_f32 v252, s47, v194
    v_mul_f32 v253, s47, v195
    v_mfma_f32_16x16x32_bf16 v[204:207], v[240:243], v[68:71], v[204:207]
    v_mul_f32 v248, v248, v252
    v_mul_f32 v249, v249, v253
    v_exp_f32 v248, v248
    v_exp_f32 v249, v249
    s_nop 0
    buffer_load_dwordx4 v8, s[12:15], s45 offen offset:1024 lds
    ds_read_b64_tr_b16 v[236:237], v3 offset:96
    ds_read_b64_tr_b16 v[238:239], v3 offset:4704
    s_waitcnt lgkmcnt(6)
    v_mfma_f32_16x16x32_bf16 v[208:211], v[244:247], v[64:67], v[208:211]
    v_add_f32 v248, 1.0, v248
    v_add_f32 v249, 1.0, v249
    v_rcp_f32 v248, v248
    v_rcp_f32 v249, v249
    v_mfma_f32_16x16x32_bf16 v[212:215], v[244:247], v[68:71], v[212:215]
    v_mul_f32 v252, v194, v248
    v_mul_f32 v253, v195, v249
    v_cvt_pk_bf16_f32 v248, v252, v253
    v_add_f32 v162, v162, v252
    ds_read_b64_tr_b16 v[240:241], v3 offset:9216
    ds_read_b64_tr_b16 v[242:243], v3 offset:13824
    s_waitcnt lgkmcnt(4)
    v_mfma_f32_16x16x32_bf16 v[216:219], v[232:235], v[64:67], v[216:219]
    v_fmac_f32 v170, v252, v252
    v_add_f32 v163, v163, v253
    v_fmac_f32 v171, v253, v253
    ds_write_b32 v13, v248 offset:4352
    v_mfma_f32_16x16x32_bf16 v[220:223], v[232:235], v[68:71], v[220:223]
    v_fmaak_f32 v248, v164, v164, 0x41b2e92f
    v_fmaak_f32 v249, v165, v165, 0x41b2e92f
    v_fmaak_f32 v250, v172, v172, 0x41b2e92f
    v_fmaak_f32 v251, v173, v173, 0x41b2e92f
    ds_read_b64_tr_b16 v[244:245], v3 offset:9248
    ds_read_b64_tr_b16 v[246:247], v3 offset:13856
    s_waitcnt lgkmcnt(5)
    v_mfma_f32_16x16x32_bf16 v[224:227], v[236:239], v[64:67], v[224:227]
    v_mul_f32 v252, s47, v164
    v_mul_f32 v253, s47, v165
    v_mul_f32 v254, s47, v172
    v_mul_f32 v255, s47, v173
    v_mfma_f32_16x16x32_bf16 v[228:231], v[236:239], v[68:71], v[228:231]
    v_mul_f32 v248, v248, v252
    v_mul_f32 v249, v249, v253
    v_mul_f32 v250, v250, v254
    v_mul_f32 v251, v251, v255
    ds_read_b64_tr_b16 v[232:233], v3 offset:9280
    ds_read_b64_tr_b16 v[234:235], v3 offset:13888
    s_waitcnt lgkmcnt(5)
    v_mfma_f32_16x16x32_bf16 v[200:203], v[240:243], v[72:75], v[200:203]
    v_exp_f32 v248, v248
    v_exp_f32 v249, v249
    v_exp_f32 v250, v250
    v_exp_f32 v251, v251
    v_mfma_f32_16x16x32_bf16 v[204:207], v[240:243], v[76:79], v[204:207]
    v_add_f32 v248, 1.0, v248
    v_add_f32 v249, 1.0, v249
    v_add_f32 v250, 1.0, v250
    v_add_f32 v251, 1.0, v251
    ds_read_b64_tr_b16 v[236:237], v3 offset:9312
    ds_read_b64_tr_b16 v[238:239], v3 offset:13920
    s_waitcnt lgkmcnt(4)
    v_mfma_f32_16x16x32_bf16 v[208:211], v[244:247], v[72:75], v[208:211]
    v_rcp_f32 v248, v248
    v_rcp_f32 v249, v249
    v_rcp_f32 v250, v250
    v_rcp_f32 v251, v251
    v_mfma_f32_16x16x32_bf16 v[212:215], v[244:247], v[76:79], v[212:215]
    v_mul_f32 v252, v164, v248
    v_mul_f32 v253, v165, v249
    v_mul_f32 v254, v172, v250
    v_mul_f32 v255, v173, v251
    s_waitcnt vmcnt(8)
    s_barrier
    ds_read_b64_tr_b16 v[240:241], v3 offset:18432
    ds_read_b64_tr_b16 v[242:243], v3 offset:23040
    s_waitcnt lgkmcnt(4)
    v_mfma_f32_16x16x32_bf16 v[216:219], v[232:235], v[72:75], v[216:219]
    v_cvt_pk_bf16_f32 v248, v252, v253
    v_cvt_pk_bf16_f32 v250, v254, v255
    v_add_f32 v164, v252, v254
    v_mul_f32 v172, v252, v252
    v_mfma_f32_16x16x32_bf16 v[220:223], v[232:235], v[76:79], v[220:223]
    v_add_f32 v165, v253, v255
    v_mul_f32 v173, v253, v253
    ds_write_b32 v13, v248 offset:512
    ds_write_b32 v13, v250 offset:1536
    s_add_u32 s45, s54, 4718592
    s_add_u32 m0, s46, 92160
    s_nop 0
    buffer_load_dwordx4 v7, s[12:15], s45 offen offset:0 lds
    ds_read_b64_tr_b16 v[244:245], v3 offset:18464
    ds_read_b64_tr_b16 v[246:247], v3 offset:23072
    s_waitcnt lgkmcnt(6)
    v_mfma_f32_16x16x32_bf16 v[224:227], v[236:239], v[72:75], v[224:227]
    v_fmac_f32 v172, v254, v254
    v_fmac_f32 v173, v255, v255
    v_fmaak_f32 v248, v180, v180, 0x41b2e92f
    v_fmaak_f32 v249, v181, v181, 0x41b2e92f
    v_mfma_f32_16x16x32_bf16 v[228:231], v[236:239], v[76:79], v[228:231]
    v_fmaak_f32 v250, v188, v188, 0x41b2e92f
    v_fmaak_f32 v251, v189, v189, 0x41b2e92f
    v_mul_f32 v252, s47, v180
    v_mul_f32 v253, s47, v181
    ds_read_b64_tr_b16 v[232:233], v3 offset:18496
    ds_read_b64_tr_b16 v[234:235], v3 offset:23104
    s_waitcnt lgkmcnt(6)
    v_mfma_f32_16x16x32_bf16 v[200:203], v[240:243], v[80:83], v[200:203]
    v_mul_f32 v254, s47, v188
    v_mul_f32 v255, s47, v189
    v_mul_f32 v248, v248, v252
    v_mul_f32 v249, v249, v253
    v_mfma_f32_16x16x32_bf16 v[204:207], v[240:243], v[84:87], v[204:207]
    v_mul_f32 v250, v250, v254
    v_mul_f32 v251, v251, v255
    v_exp_f32 v248, v248
    v_exp_f32 v249, v249
    s_nop 0
    buffer_load_dwordx4 v8, s[12:15], s45 offen offset:1024 lds
    ds_read_b64_tr_b16 v[236:237], v3 offset:18528
    ds_read_b64_tr_b16 v[238:239], v3 offset:23136
    s_waitcnt vmcnt(8)
    s_lshl_b32 s100, s2, 3
    s_add_u32 s100, s100, s3
    s_lshl_b32 s100, s100, 12
    s_mov_b32 exec_lo, 16711680
    s_mov_b32 exec_hi, 0
    v_lshlrev_b32 v0, 7, v1
    buffer_load_dword v0, v0, s[76:79], s100 offen
    s_mov_b64 exec, -1
    s_waitcnt lgkmcnt(4)
    v_mfma_f32_16x16x32_bf16 v[208:211], v[244:247], v[80:83], v[208:211]
    v_exp_f32 v250, v250
    v_exp_f32 v251, v251
    v_add_f32 v248, 1.0, v248
    v_add_f32 v249, 1.0, v249
    v_mfma_f32_16x16x32_bf16 v[212:215], v[244:247], v[84:87], v[212:215]
    v_add_f32 v250, 1.0, v250
    v_add_f32 v251, 1.0, v251
    v_rcp_f32 v248, v248
    v_rcp_f32 v249, v249
    ds_read_b64_tr_b16 v[240:241], v3 offset:27648
    ds_read_b64_tr_b16 v[242:243], v3 offset:32256
    s_waitcnt lgkmcnt(4)
    v_mfma_f32_16x16x32_bf16 v[216:219], v[232:235], v[80:83], v[216:219]
    v_rcp_f32 v250, v250
    v_rcp_f32 v251, v251
    v_mul_f32 v252, v180, v248
    v_mul_f32 v253, v181, v249
    v_mfma_f32_16x16x32_bf16 v[220:223], v[232:235], v[84:87], v[220:223]
    v_mul_f32 v254, v188, v250
    v_mul_f32 v255, v189, v251
    v_cvt_pk_bf16_f32 v248, v252, v253
    v_cvt_pk_bf16_f32 v250, v254, v255
    ds_read_b64_tr_b16 v[244:245], v3 offset:27680
    ds_read_b64_tr_b16 v[246:247], v3 offset:32288
    s_waitcnt lgkmcnt(4)
    v_mfma_f32_16x16x32_bf16 v[224:227], v[236:239], v[80:83], v[224:227]
    v_add_f32 v164, v164, v252
    v_fmac_f32 v172, v252, v252
    v_add_f32 v165, v165, v253
    v_fmac_f32 v173, v253, v253
    v_mfma_f32_16x16x32_bf16 v[228:231], v[236:239], v[84:87], v[228:231]
    ds_write_b32 v13, v248 offset:2560
    ds_write_b32 v13, v250 offset:3584
    v_add_f32 v164, v164, v254
    v_fmac_f32 v172, v254, v254
    ds_read_b64_tr_b16 v[232:233], v3 offset:27712
    ds_read_b64_tr_b16 v[234:235], v3 offset:32320
    s_waitcnt lgkmcnt(6)
    v_mfma_f32_16x16x32_bf16 v[200:203], v[240:243], v[88:91], v[200:203]
    v_add_f32 v165, v165, v255
    v_fmac_f32 v173, v255, v255
    v_fmaak_f32 v248, v196, v196, 0x41b2e92f
    v_fmaak_f32 v249, v197, v197, 0x41b2e92f
    v_mfma_f32_16x16x32_bf16 v[204:207], v[240:243], v[92:95], v[204:207]
    v_mul_f32 v252, s47, v196
    v_mul_f32 v253, s47, v197
    v_mul_f32 v248, v248, v252
    v_mul_f32 v249, v249, v253
    ds_read_b64_tr_b16 v[236:237], v3 offset:27744
    ds_read_b64_tr_b16 v[238:239], v3 offset:32352
    s_waitcnt lgkmcnt(6)
    v_mfma_f32_16x16x32_bf16 v[208:211], v[244:247], v[88:91], v[208:211]
    v_exp_f32 v248, v248
    v_exp_f32 v249, v249
    v_add_f32 v248, 1.0, v248
    v_add_f32 v249, 1.0, v249
    v_mfma_f32_16x16x32_bf16 v[212:215], v[244:247], v[92:95], v[212:215]
    v_rcp_f32 v248, v248
    v_rcp_f32 v249, v249
    v_mul_f32 v252, v196, v248
    v_mul_f32 v253, v197, v249
    s_waitcnt vmcnt(7)
    s_barrier
    ds_read_b64_tr_b16 v[240:241], v3 offset:36864
    ds_read_b64_tr_b16 v[242:243], v3 offset:41472
    s_waitcnt lgkmcnt(4)
    v_mfma_f32_16x16x32_bf16 v[216:219], v[232:235], v[88:91], v[216:219]
    v_cvt_pk_bf16_f32 v248, v252, v253
    v_add_f32 v164, v164, v252
    v_fmac_f32 v172, v252, v252
    v_add_f32 v165, v165, v253
    v_mfma_f32_16x16x32_bf16 v[220:223], v[232:235], v[92:95], v[220:223]
    v_fmac_f32 v173, v253, v253
    ds_write_b32 v13, v248 offset:4608
    v_fmaak_f32 v248, v166, v166, 0x41b2e92f
    v_fmaak_f32 v249, v167, v167, 0x41b2e92f
    s_add_u32 s45, s56, 0
    s_add_u32 m0, s46, 0
    s_nop 0
    buffer_load_dwordx4 v10, s[16:19], s45 offen offset:0 lds
    ds_read_b64_tr_b16 v[244:245], v3 offset:36896
    ds_read_b64_tr_b16 v[246:247], v3 offset:41504
    s_waitcnt lgkmcnt(5)
    v_mfma_f32_16x16x32_bf16 v[224:227], v[236:239], v[88:91], v[224:227]
    v_fmaak_f32 v250, v174, v174, 0x41b2e92f
    v_fmaak_f32 v251, v175, v175, 0x41b2e92f
    v_mul_f32 v252, s47, v166
    v_mul_f32 v253, s47, v167
    v_mfma_f32_16x16x32_bf16 v[228:231], v[236:239], v[92:95], v[228:231]
    v_mul_f32 v254, s47, v174
    v_mul_f32 v255, s47, v175
    v_mul_f32 v248, v248, v252
    v_mul_f32 v249, v249, v253
    ds_read_b64_tr_b16 v[232:233], v3 offset:36928
    ds_read_b64_tr_b16 v[234:235], v3 offset:41536
    s_waitcnt lgkmcnt(5)
    v_mfma_f32_16x16x32_bf16 v[200:203], v[240:243], v[96:99], v[200:203]
    v_mul_f32 v250, v250, v254
    v_mul_f32 v251, v251, v255
    v_exp_f32 v248, v248
    v_exp_f32 v249, v249
    v_mfma_f32_16x16x32_bf16 v[204:207], v[240:243], v[100:103], v[204:207]
    v_exp_f32 v250, v250
    v_exp_f32 v251, v251
    v_add_f32 v248, 1.0, v248
    v_add_f32 v249, 1.0, v249
    s_nop 0
    buffer_load_dwordx4 v11, s[16:19], s45 offen offset:1024 lds
    ds_read_b64_tr_b16 v[236:237], v3 offset:36960
    ds_read_b64_tr_b16 v[238:239], v3 offset:41568
    s_waitcnt lgkmcnt(4)
    v_mfma_f32_16x16x32_bf16 v[208:211], v[244:247], v[96:99], v[208:211]
    v_add_f32 v250, 1.0, v250
    v_add_f32 v251, 1.0, v251
    v_rcp_f32 v248, v248
    v_rcp_f32 v249, v249
    v_mfma_f32_16x16x32_bf16 v[212:215], v[244:247], v[100:103], v[212:215]
    v_rcp_f32 v250, v250
    v_rcp_f32 v251, v251
    v_mul_f32 v252, v166, v248
    v_mul_f32 v253, v167, v249
    ds_read_b64_tr_b16 v[240:241], v3 offset:46080
    ds_read_b64_tr_b16 v[242:243], v3 offset:50688
    s_waitcnt lgkmcnt(4)
    v_mfma_f32_16x16x32_bf16 v[216:219], v[232:235], v[96:99], v[216:219]
    v_mul_f32 v254, v174, v250
    v_mul_f32 v255, v175, v251
    v_cvt_pk_bf16_f32 v248, v252, v253
    v_cvt_pk_bf16_f32 v250, v254, v255
    v_mfma_f32_16x16x32_bf16 v[220:223], v[232:235], v[100:103], v[220:223]
    v_add_f32 v166, v252, v254
    v_mul_f32 v174, v252, v252
    v_add_f32 v167, v253, v255
    v_mul_f32 v175, v253, v253
    ds_read_b64_tr_b16 v[244:245], v3 offset:46112
    ds_read_b64_tr_b16 v[246:247], v3 offset:50720
    s_waitcnt lgkmcnt(4)
    v_mfma_f32_16x16x32_bf16 v[224:227], v[236:239], v[96:99], v[224:227]
    ds_write_b32 v13, v248 offset:768
    ds_write_b32 v13, v250 offset:1792
    v_fmac_f32 v174, v254, v254
    v_fmac_f32 v175, v255, v255
    v_mfma_f32_16x16x32_bf16 v[228:231], v[236:239], v[100:103], v[228:231]
    v_fmaak_f32 v248, v182, v182, 0x41b2e92f
    v_fmaak_f32 v249, v183, v183, 0x41b2e92f
    v_fmaak_f32 v250, v190, v190, 0x41b2e92f
    v_fmaak_f32 v251, v191, v191, 0x41b2e92f
    ds_read_b64_tr_b16 v[232:233], v3 offset:46144
    ds_read_b64_tr_b16 v[234:235], v3 offset:50752
    s_waitcnt lgkmcnt(6)
    v_mfma_f32_16x16x32_bf16 v[200:203], v[240:243], v[104:107], v[200:203]
    v_mul_f32 v252, s47, v182
    v_mul_f32 v253, s47, v183
    v_mul_f32 v254, s47, v190
    v_mul_f32 v255, s47, v191
    v_mfma_f32_16x16x32_bf16 v[204:207], v[240:243], v[108:111], v[204:207]
    v_mul_f32 v248, v248, v252
    v_mul_f32 v249, v249, v253
    v_mul_f32 v250, v250, v254
    v_mul_f32 v251, v251, v255
    ds_read_b64_tr_b16 v[236:237], v3 offset:46176
    ds_read_b64_tr_b16 v[238:239], v3 offset:50784
    s_waitcnt lgkmcnt(6)
    v_mfma_f32_16x16x32_bf16 v[208:211], v[244:247], v[104:107], v[208:211]
    v_exp_f32 v248, v248
    v_exp_f32 v249, v249
    v_exp_f32 v250, v250
    v_exp_f32 v251, v251
    v_mfma_f32_16x16x32_bf16 v[212:215], v[244:247], v[108:111], v[212:215]
    v_add_f32 v248, 1.0, v248
    v_add_f32 v249, 1.0, v249
    v_add_f32 v250, 1.0, v250
    v_add_f32 v251, 1.0, v251
    s_waitcnt vmcnt(7)
    s_barrier
    ds_read_b64_tr_b16 v[240:241], v4 offset:0
    ds_read_b64_tr_b16 v[242:243], v4 offset:4608
    s_waitcnt lgkmcnt(4)
    v_mfma_f32_16x16x32_bf16 v[216:219], v[232:235], v[104:107], v[216:219]
    v_rcp_f32 v248, v248
    v_rcp_f32 v249, v249
    v_rcp_f32 v250, v250
    v_rcp_f32 v251, v251
    v_mfma_f32_16x16x32_bf16 v[220:223], v[232:235], v[108:111], v[220:223]
    v_mul_f32 v252, v182, v248
    v_mul_f32 v253, v183, v249
    v_mul_f32 v254, v190, v250
    v_mul_f32 v255, v191, v251
    s_add_u32 s45, s56, 221184
    s_add_u32 m0, s46, 18432
    s_nop 0
    buffer_load_dwordx4 v10, s[16:19], s45 offen offset:0 lds
    ds_read_b64_tr_b16 v[244:245], v4 offset:32
    ds_read_b64_tr_b16 v[246:247], v4 offset:4640
    s_waitcnt lgkmcnt(4)
    v_mfma_f32_16x16x32_bf16 v[224:227], v[236:239], v[104:107], v[224:227]
    v_cvt_pk_bf16_f32 v248, v252, v253
    v_cvt_pk_bf16_f32 v250, v254, v255
    v_add_f32 v166, v166, v252
    v_fmac_f32 v174, v252, v252
    v_mfma_f32_16x16x32_bf16 v[228:231], v[236:239], v[108:111], v[228:231]
    v_add_f32 v167, v167, v253
    v_fmac_f32 v175, v253, v253
    ds_write_b32 v13, v248 offset:2816
    ds_write_b32 v13, v250 offset:3840
    ds_read_b64_tr_b16 v[232:233], v4 offset:64
    ds_read_b64_tr_b16 v[234:235], v4 offset:4672
    s_waitcnt lgkmcnt(6)
    v_mfma_f32_16x16x32_bf16 v[200:203], v[240:243], v[112:115], v[200:203]
    v_add_f32 v166, v166, v254
    v_fmac_f32 v174, v254, v254
    v_add_f32 v167, v167, v255
    v_fmac_f32 v175, v255, v255
    v_mfma_f32_16x16x32_bf16 v[204:207], v[240:243], v[116:119], v[204:207]
    v_fmaak_f32 v248, v198, v198, 0x41b2e92f
    v_fmaak_f32 v249, v199, v199, 0x41b2e92f
    v_mul_f32 v252, s47, v198
    v_mul_f32 v253, s47, v199
    s_nop 0
    buffer_load_dwordx4 v11, s[16:19], s45 offen offset:1024 lds
    ds_read_b64_tr_b16 v[236:237], v4 offset:96
    ds_read_b64_tr_b16 v[238:239], v4 offset:4704
    s_waitcnt lgkmcnt(6)
    v_mfma_f32_16x16x32_bf16 v[208:211], v[244:247], v[112:115], v[208:211]
    v_mul_f32 v248, v248, v252
    v_mul_f32 v249, v249, v253
    v_exp_f32 v248, v248
    v_exp_f32 v249, v249
    v_mfma_f32_16x16x32_bf16 v[212:215], v[244:247], v[116:119], v[212:215]
    v_add_f32 v248, 1.0, v248
    v_add_f32 v249, 1.0, v249
    v_rcp_f32 v248, v248
    v_rcp_f32 v249, v249
    ds_read_b64_tr_b16 v[240:241], v4 offset:9216
    ds_read_b64_tr_b16 v[242:243], v4 offset:13824
    s_waitcnt lgkmcnt(4)
    v_mfma_f32_16x16x32_bf16 v[216:219], v[232:235], v[112:115], v[216:219]
    v_mul_f32 v252, v198, v248
    v_mul_f32 v253, v199, v249
    v_cvt_pk_bf16_f32 v248, v252, v253
    v_add_f32 v166, v166, v252
    v_mfma_f32_16x16x32_bf16 v[220:223], v[232:235], v[116:119], v[220:223]
    v_fmac_f32 v174, v252, v252
    v_add_f32 v167, v167, v253
    v_fmac_f32 v175, v253, v253
    ds_write_b32 v13, v248 offset:4864
    ds_read_b64_tr_b16 v[244:245], v4 offset:9248
    ds_read_b64_tr_b16 v[246:247], v4 offset:13856
    s_waitcnt lgkmcnt(5)
    v_mfma_f32_16x16x32_bf16 v[224:227], v[236:239], v[112:115], v[224:227]
    s_nop 1
    v_add_f32_dpp v160, v160, v160 row_mirror row_mask:0xf bank_mask:0x3
    v_add_f32_dpp v161, v161, v161 row_mirror row_mask:0xf bank_mask:0x3
    v_add_f32_dpp v162, v162, v162 row_mirror row_mask:0xf bank_mask:0x3
    v_mfma_f32_16x16x32_bf16 v[228:231], v[236:239], v[116:119], v[228:231]
    v_add_f32_dpp v163, v163, v163 row_mirror row_mask:0xf bank_mask:0x3
    v_add_f32_dpp v168, v168, v168 row_mirror row_mask:0xf bank_mask:0x3
    v_add_f32_dpp v169, v169, v169 row_mirror row_mask:0xf bank_mask:0x3
    v_add_f32_dpp v170, v170, v170 row_mirror row_mask:0xf bank_mask:0x3
    ds_read_b64_tr_b16 v[232:233], v4 offset:9280
    ds_read_b64_tr_b16 v[234:235], v4 offset:13888
    s_waitcnt lgkmcnt(5)
    v_mfma_f32_16x16x32_bf16 v[200:203], v[240:243], v[120:123], v[200:203]
    v_add_f32_dpp v171, v171, v171 row_mirror row_mask:0xf bank_mask:0x3
    v_add_f32_dpp v160, v164, v164 row_mirror row_mask:0xf bank_mask:0xc
    v_add_f32_dpp v161, v165, v165 row_mirror row_mask:0xf bank_mask:0xc
    v_add_f32_dpp v162, v166, v166 row_mirror row_mask:0xf bank_mask:0xc
    v_mfma_f32_16x16x32_bf16 v[204:207], v[240:243], v[124:127], v[204:207]
    v_add_f32_dpp v163, v167, v167 row_mirror row_mask:0xf bank_mask:0xc
    v_add_f32_dpp v168, v172, v172 row_mirror row_mask:0xf bank_mask:0xc
    v_add_f32_dpp v169, v173, v173 row_mirror row_mask:0xf bank_mask:0xc
    v_add_f32_dpp v170, v174, v174 row_mirror row_mask:0xf bank_mask:0xc
    ds_read_b64_tr_b16 v[236:237], v4 offset:9312
    ds_read_b64_tr_b16 v[238:239], v4 offset:13920
    s_waitcnt lgkmcnt(4)
    v_mfma_f32_16x16x32_bf16 v[208:211], v[244:247], v[120:123], v[208:211]
    v_add_f32_dpp v171, v175, v175 row_mirror row_mask:0xf bank_mask:0xc
    v_add_f32_dpp v160, v160, v160 row_half_mirror row_mask:0xf bank_mask:0x5
    v_add_f32_dpp v161, v161, v161 row_half_mirror row_mask:0xf bank_mask:0x5
    v_add_f32_dpp v168, v168, v168 row_half_mirror row_mask:0xf bank_mask:0x5
    v_mfma_f32_16x16x32_bf16 v[212:215], v[244:247], v[124:127], v[212:215]
    v_add_f32_dpp v169, v169, v169 row_half_mirror row_mask:0xf bank_mask:0x5
    v_add_f32_dpp v160, v162, v162 row_half_mirror row_mask:0xf bank_mask:0xa
    v_add_f32_dpp v161, v163, v163 row_half_mirror row_mask:0xf bank_mask:0xa
    v_add_f32_dpp v168, v170, v170 row_half_mirror row_mask:0xf bank_mask:0xa
    s_waitcnt vmcnt(7)
    s_barrier
    ds_read_b64_tr_b16 v[240:241], v4 offset:18432
    ds_read_b64_tr_b16 v[242:243], v4 offset:23040
    s_waitcnt lgkmcnt(4)
    v_mfma_f32_16x16x32_bf16 v[216:219], v[232:235], v[120:123], v[216:219]
    v_add_f32_dpp v169, v171, v171 row_half_mirror row_mask:0xf bank_mask:0xa
    v_add_f32_dpp v160, v160, v160 quad_perm:[1,0,3,2] row_mask:0xf bank_mask:0xf
    v_add_f32_dpp v161, v161, v161 quad_perm:[1,0,3,2] row_mask:0xf bank_mask:0xf
    v_add_f32_dpp v168, v168, v168 quad_perm:[1,0,3,2] row_mask:0xf bank_mask:0xf
    v_mfma_f32_16x16x32_bf16 v[220:223], v[232:235], v[124:127], v[220:223]
    v_add_f32_dpp v169, v169, v169 quad_perm:[1,0,3,2] row_mask:0xf bank_mask:0xf
    v_add_f32_dpp v160, v160, v160 quad_perm:[2,3,0,1] row_mask:0xf bank_mask:0xf
    v_add_f32_dpp v161, v161, v161 quad_perm:[2,3,0,1] row_mask:0xf bank_mask:0xf
    v_add_f32_dpp v168, v168, v168 quad_perm:[2,3,0,1] row_mask:0xf bank_mask:0xf
    s_add_u32 s45, s56, 442368
    s_add_u32 m0, s46, 36864
    s_nop 0
    buffer_load_dwordx4 v10, s[16:19], s45 offen offset:0 lds
    ds_read_b64_tr_b16 v[244:245], v4 offset:18464
    ds_read_b64_tr_b16 v[246:247], v4 offset:23072
    s_waitcnt lgkmcnt(4)
    v_mfma_f32_16x16x32_bf16 v[224:227], v[236:239], v[120:123], v[224:227]
    v_add_f32_dpp v169, v169, v169 quad_perm:[2,3,0,1] row_mask:0xf bank_mask:0xf
    s_mov_b32 s60, 0xaaaaaaaa
    s_mov_b32 s61, 0xaaaaaaaa
    s_lshl_b32 s6, s44, 9
    s_add_u32 s6, s6, 155904
    v_lshlrev_b32 v255, 3, v1
    v_mfma_f32_16x16x32_bf16 v[228:231], v[236:239], v[124:127], v[228:231]
    v_add_u32 v255, s6, v255
    v_cndmask_b32 v248, v160, v161, s[60:61]
    v_cndmask_b32 v250, v168, v169, s[60:61]
    ds_read_b64 v[252:253], v255
    ds_read_b64_tr_b16 v[232:233], v4 offset:18496
    ds_read_b64_tr_b16 v[234:235], v4 offset:23104
    s_waitcnt lgkmcnt(5)
    v_mfma_f32_16x16x32_bf16 v[200:203], v[240:243], v[128:131], v[200:203]
    v_lshrrev_b32 v254, 2, v1
    v_and_b32 v255, 1, v1
    v_lshl_or_b32 v254, v254, 1, v255
    v_lshlrev_b32 v254, 4, v254
    v_mfma_f32_16x16x32_bf16 v[204:207], v[240:243], v[132:135], v[204:207]
    v_mov_b32 v249, s48
    v_mov_b32 v251, s48
    s_lshl_b32 s6, s58, 4
    s_add_u32 s6, s6, s5
    s_lshl_b32 s6, s6, 9
    s_nop 0
    buffer_load_dwordx4 v11, s[16:19], s45 offen offset:1024 lds
    ds_read_b64_tr_b16 v[236:237], v4 offset:18528
    ds_read_b64_tr_b16 v[238:239], v4 offset:23136
    s_lshl_b32 s100, s2, 3
    s_add_u32 s100, s100, s3
    s_lshl_b32 s100, s100, 12
    s_mov_b32 exec_lo, 4278190080
    s_mov_b32 exec_hi, 0
    v_lshlrev_b32 v0, 7, v1
    buffer_load_dword v0, v0, s[76:79], s100 offen
    s_mov_b64 exec, -1
    s_waitcnt lgkmcnt(5)
    v_mfma_f32_16x16x32_bf16 v[208:211], v[244:247], v[128:131], v[208:211]
    v_mfma_f32_16x16x32_bf16 v[212:215], v[244:247], v[132:135], v[212:215]
    ds_read_b64_tr_b16 v[240:241], v4 offset:27648
    ds_read_b64_tr_b16 v[242:243], v4 offset:32256
    s_waitcnt lgkmcnt(4)
    v_mfma_f32_16x16x32_bf16 v[216:219], v[232:235], v[128:131], v[216:219]
    v_mfma_f32_16x16x32_bf16 v[220:223], v[232:235], v[132:135], v[220:223]
    v_add_f32 v248, v248, v252
    v_add_f32 v250, v250, v253
    s_mov_b32 exec_lo, 0x33333333
    s_mov_b32 exec_hi, 0x33333333
    buffer_store_dwordx4 v[248:251], v254, s[36:39], s6 offen sc1
    s_mov_b64 exec, -1
    s_nop 0
    ds_read_b64_tr_b16 v[244:245], v4 offset:27680
    ds_read_b64_tr_b16 v[246:247], v4 offset:32288
    s_waitcnt lgkmcnt(4)
    v_mfma_f32_16x16x32_bf16 v[224:227], v[236:239], v[128:131], v[224:227]
    v_mfma_f32_16x16x32_bf16 v[228:231], v[236:239], v[132:135], v[228:231]
    ds_read_b64_tr_b16 v[232:233], v4 offset:27712
    ds_read_b64_tr_b16 v[234:235], v4 offset:32320
    s_waitcnt lgkmcnt(4)
    v_mfma_f32_16x16x32_bf16 v[200:203], v[240:243], v[136:139], v[200:203]
    v_mfma_f32_16x16x32_bf16 v[204:207], v[240:243], v[140:143], v[204:207]
    ds_read_b64_tr_b16 v[236:237], v4 offset:27744
    ds_read_b64_tr_b16 v[238:239], v4 offset:32352
    s_waitcnt lgkmcnt(4)
    v_mfma_f32_16x16x32_bf16 v[208:211], v[244:247], v[136:139], v[208:211]
    v_mfma_f32_16x16x32_bf16 v[212:215], v[244:247], v[140:143], v[212:215]
    s_waitcnt vmcnt(9)
    s_barrier
    ds_read_b64_tr_b16 v[240:241], v4 offset:36864
    ds_read_b64_tr_b16 v[242:243], v4 offset:41472
    s_waitcnt lgkmcnt(4)
    v_mfma_f32_16x16x32_bf16 v[216:219], v[232:235], v[136:139], v[216:219]
    v_mfma_f32_16x16x32_bf16 v[220:223], v[232:235], v[140:143], v[220:223]
    s_add_u32 s45, s56, 663552
    s_add_u32 m0, s46, 55296
    s_nop 0
    buffer_load_dwordx4 v10, s[16:19], s45 offen offset:0 lds
    ds_read_b64_tr_b16 v[244:245], v4 offset:36896
    ds_read_b64_tr_b16 v[246:247], v4 offset:41504
    s_waitcnt lgkmcnt(4)
    v_mfma_f32_16x16x32_bf16 v[224:227], v[236:239], v[136:139], v[224:227]
    v_mfma_f32_16x16x32_bf16 v[228:231], v[236:239], v[140:143], v[228:231]
    ds_read_b64_tr_b16 v[232:233], v4 offset:36928
    ds_read_b64_tr_b16 v[234:235], v4 offset:41536
    s_waitcnt lgkmcnt(4)
    v_mfma_f32_16x16x32_bf16 v[200:203], v[240:243], v[144:147], v[200:203]
    v_mfma_f32_16x16x32_bf16 v[204:207], v[240:243], v[148:151], v[204:207]
    s_nop 0
    buffer_load_dwordx4 v11, s[16:19], s45 offen offset:1024 lds
    ds_read_b64_tr_b16 v[236:237], v4 offset:36960
    ds_read_b64_tr_b16 v[238:239], v4 offset:41568
    s_waitcnt lgkmcnt(4)
    v_mfma_f32_16x16x32_bf16 v[208:211], v[244:247], v[144:147], v[208:211]
    v_mfma_f32_16x16x32_bf16 v[212:215], v[244:247], v[148:151], v[212:215]
    ds_read_b64_tr_b16 v[240:241], v4 offset:46080
    ds_read_b64_tr_b16 v[242:243], v4 offset:50688
    s_waitcnt lgkmcnt(4)
    v_mfma_f32_16x16x32_bf16 v[216:219], v[232:235], v[144:147], v[216:219]
    v_mfma_f32_16x16x32_bf16 v[220:223], v[232:235], v[148:151], v[220:223]
    ds_read_b64_tr_b16 v[244:245], v4 offset:46112
    ds_read_b64_tr_b16 v[246:247], v4 offset:50720
    s_waitcnt lgkmcnt(4)
    v_mfma_f32_16x16x32_bf16 v[224:227], v[236:239], v[144:147], v[224:227]
    v_mfma_f32_16x16x32_bf16 v[228:231], v[236:239], v[148:151], v[228:231]
    ds_read_b64_tr_b16 v[232:233], v4 offset:46144
    ds_read_b64_tr_b16 v[234:235], v4 offset:50752
    s_waitcnt lgkmcnt(4)
    v_mfma_f32_16x16x32_bf16 v[200:203], v[240:243], v[152:155], v[200:203]
    v_mfma_f32_16x16x32_bf16 v[204:207], v[240:243], v[156:159], v[204:207]
    ds_read_b64_tr_b16 v[236:237], v4 offset:46176
    ds_read_b64_tr_b16 v[238:239], v4 offset:50784
    s_waitcnt lgkmcnt(4)
    v_mfma_f32_16x16x32_bf16 v[208:211], v[244:247], v[152:155], v[208:211]
    v_mfma_f32_16x16x32_bf16 v[212:215], v[244:247], v[156:159], v[212:215]
    s_waitcnt vmcnt(8)
    s_barrier
    v_add_u32 v3, s57, v3
    v_add_u32 v4, s57, v4
    ds_read_b64_tr_b16 v[240:241], v3 offset:0
    ds_read_b64_tr_b16 v[242:243], v3 offset:4608
    s_waitcnt lgkmcnt(4)
    v_mfma_f32_16x16x32_bf16 v[216:219], v[232:235], v[152:155], v[216:219]
    v_mfma_f32_16x16x32_bf16 v[220:223], v[232:235], v[156:159], v[220:223]
    s_add_u32 s45, s56, 884736
    s_add_u32 m0, s46, 73728
    s_nop 0
    buffer_load_dwordx4 v10, s[16:19], s45 offen offset:0 lds
    ds_read_b64_tr_b16 v[244:245], v3 offset:40
    ds_read_b64_tr_b16 v[246:247], v3 offset:4648
    s_waitcnt lgkmcnt(4)
    v_mfma_f32_16x16x32_bf16 v[224:227], v[236:239], v[152:155], v[224:227]
    v_mfma_f32_16x16x32_bf16 v[228:231], v[236:239], v[156:159], v[228:231]
    ds_read_b64_tr_b16 v[232:233], v3 offset:96
    ds_read_b64_tr_b16 v[234:235], v3 offset:4704
    s_waitcnt lgkmcnt(4)
    v_mfma_f32_16x16x32_bf16 v[160:163], v[240:243], v[16:19], 0
    v_mfma_f32_16x16x32_bf16 v[164:167], v[240:243], v[20:23], 0
    s_nop 0
    buffer_load_dwordx4 v11, s[16:19], s45 offen offset:1024 lds
    ds_read_b64_tr_b16 v[236:237], v3 offset:136
    ds_read_b64_tr_b16 v[238:239], v3 offset:4744
    s_waitcnt lgkmcnt(4)
    v_mfma_f32_16x16x32_bf16 v[168:171], v[244:247], v[16:19], 0
    v_mfma_f32_16x16x32_bf16 v[172:175], v[244:247], v[20:23], 0
    ds_read_b64_tr_b16 v[240:241], v5 offset:0
    ds_read_b64_tr_b16 v[242:243], v5 offset:4608
    s_waitcnt lgkmcnt(4)
    v_mfma_f32_16x16x32_bf16 v[176:179], v[232:235], v[16:19], 0
    s_lshl_b32 s6, s4, 4
    s_add_u32 s6, s6, s5
    s_lshl_b32 s6, s6, 2
    s_add_u32 s6, s6, s44
    s_mul_i32 s6, s6, 9216
    s_add_u32 s62, s6, 0
    s_add_u32 s63, s62, 4096
    v_fmaak_f32 v248, v200, v200, 0x41b2e92f
    v_fmaak_f32 v249, v201, v201, 0x41b2e92f
    v_mfma_f32_16x16x32_bf16 v[180:183], v[232:235], v[20:23], 0
    v_fmaak_f32 v250, v202, v202, 0x41b2e92f
    v_fmaak_f32 v251, v203, v203, 0x41b2e92f
    v_mul_f32 v252, s47, v200
    ds_read_b64_tr_b16 v[244:245], v3 offset:9216
    ds_read_b64_tr_b16 v[246:247], v3 offset:13824
    s_waitcnt lgkmcnt(4)
    v_mfma_f32_16x16x32_bf16 v[184:187], v[236:239], v[16:19], 0
    v_mul_f32 v253, s47, v201
    v_mul_f32 v254, s47, v202
    v_mul_f32 v255, s47, v203
    v_mfma_f32_16x16x32_bf16 v[188:191], v[236:239], v[20:23], 0
    v_mul_f32 v248, v248, v252
    v_mul_f32 v249, v249, v253
    v_mul_f32 v250, v250, v254
    ds_read_b64_tr_b16 v[232:233], v3 offset:9256
    ds_read_b64_tr_b16 v[234:235], v3 offset:13864
    s_waitcnt lgkmcnt(4)
    v_mfma_f32_16x16x32_bf16 v[192:195], v[240:243], v[16:19], 0
    v_mul_f32 v251, v251, v255
    v_exp_f32 v248, v248
    v_exp_f32 v249, v249
    v_mfma_f32_16x16x32_bf16 v[196:199], v[240:243], v[20:23], 0
    v_exp_f32 v250, v250
    v_exp_f32 v251, v251
    v_add_f32 v248, 1.0, v248
    ds_read_b64_tr_b16 v[236:237], v3 offset:9312
    ds_read_b64_tr_b16 v[238:239], v3 offset:13920
    s_waitcnt lgkmcnt(4)
    v_mfma_f32_16x16x32_bf16 v[160:163], v[244:247], v[24:27], v[160:163]
    v_add_f32 v249, 1.0, v249
    v_add_f32 v250, 1.0, v250
    v_add_f32 v251, 1.0, v251
    v_mfma_f32_16x16x32_bf16 v[164:167], v[244:247], v[28:31], v[164:167]
    v_rcp_f32 v248, v248
    v_rcp_f32 v249, v249
    v_rcp_f32 v250, v250
    ds_read_b64_tr_b16 v[240:241], v3 offset:9352
    ds_read_b64_tr_b16 v[242:243], v3 offset:13960
    s_waitcnt lgkmcnt(4)
    v_mfma_f32_16x16x32_bf16 v[168:171], v[232:235], v[24:27], v[168:171]
    v_rcp_f32 v251, v251
    v_mul_f32 v252, v200, v248
    v_mul_f32 v253, v201, v249
    v_mfma_f32_16x16x32_bf16 v[172:175], v[232:235], v[28:31], v[172:175]
    v_mul_f32 v254, v202, v250
    v_mul_f32 v255, v203, v251
    v_cvt_pk_bf16_f32 v200, v252, v253
    ds_read_b64_tr_b16 v[244:245], v5 offset:9216
    ds_read_b64_tr_b16 v[246:247], v5 offset:13824
    s_waitcnt lgkmcnt(4)
    v_mfma_f32_16x16x32_bf16 v[176:179], v[236:239], v[24:27], v[176:179]
    v_cvt_pk_bf16_f32 v201, v254, v255
    v_fmaak_f32 v248, v204, v204, 0x41b2e92f
    v_fmaak_f32 v249, v205, v205, 0x41b2e92f
    v_mfma_f32_16x16x32_bf16 v[180:183], v[236:239], v[28:31], v[180:183]
    v_fmaak_f32 v250, v206, v206, 0x41b2e92f
    v_fmaak_f32 v251, v207, v207, 0x41b2e92f
    v_mul_f32 v252, s47, v204
    s_waitcnt vmcnt(8)
    s_barrier
    ds_read_b64_tr_b16 v[232:233], v3 offset:18432
    ds_read_b64_tr_b16 v[234:235], v3 offset:23040
    s_waitcnt lgkmcnt(4)
    v_mfma_f32_16x16x32_bf16 v[184:187], v[240:243], v[24:27], v[184:187]
    v_mul_f32 v253, s47, v205
    v_mul_f32 v254, s47, v206
    v_mul_f32 v255, s47, v207
    v_mfma_f32_16x16x32_bf16 v[188:191], v[240:243], v[28:31], v[188:191]
    v_mul_f32 v248, v248, v252
    v_mul_f32 v249, v249, v253
    v_mul_f32 v250, v250, v254
    s_add_u32 s45, s56, 1105920
    s_add_u32 m0, s46, 92160
    s_nop 0
    buffer_load_dwordx4 v10, s[16:19], s45 offen offset:0 lds
    ds_read_b64_tr_b16 v[236:237], v3 offset:18472
    ds_read_b64_tr_b16 v[238:239], v3 offset:23080
    s_waitcnt lgkmcnt(4)
    v_mfma_f32_16x16x32_bf16 v[192:195], v[244:247], v[24:27], v[192:195]
    v_mul_f32 v251, v251, v255
    v_exp_f32 v248, v248
    v_exp_f32 v249, v249
    v_mfma_f32_16x16x32_bf16 v[196:199], v[244:247], v[28:31], v[196:199]
    v_exp_f32 v250, v250
    v_exp_f32 v251, v251
    v_add_f32 v248, 1.0, v248
    ds_read_b64_tr_b16 v[240:241], v3 offset:18528
    ds_read_b64_tr_b16 v[242:243], v3 offset:23136
    s_waitcnt lgkmcnt(4)
    v_mfma_f32_16x16x32_bf16 v[160:163], v[232:235], v[32:35], v[160:163]
    v_add_f32 v249, 1.0, v249
    v_add_f32 v250, 1.0, v250
    v_add_f32 v251, 1.0, v251
    v_mfma_f32_16x16x32_bf16 v[164:167], v[232:235], v[36:39], v[164:167]
    v_rcp_f32 v248, v248
    v_rcp_f32 v249, v249
    v_rcp_f32 v250, v250
    s_nop 0
    buffer_load_dwordx4 v11, s[16:19], s45 offen offset:1024 lds
    ds_read_b64_tr_b16 v[244:245], v3 offset:18568
    ds_read_b64_tr_b16 v[246:247], v3 offset:23176
    s_waitcnt lgkmcnt(4)
    v_mfma_f32_16x16x32_bf16 v[168:171], v[236:239], v[32:35], v[168:171]
    v_rcp_f32 v251, v251
    v_mul_f32 v252, v204, v248
    v_mul_f32 v253, v205, v249
    v_mfma_f32_16x16x32_bf16 v[172:175], v[236:239], v[36:39], v[172:175]
    v_mul_f32 v254, v206, v250
    v_mul_f32 v255, v207, v251
    v_cvt_pk_bf16_f32 v202, v252, v253
    ds_read_b64_tr_b16 v[232:233], v5 offset:18432
    ds_read_b64_tr_b16 v[234:235], v5 offset:23040
    s_waitcnt lgkmcnt(4)
    v_mfma_f32_16x16x32_bf16 v[176:179], v[240:243], v[32:35], v[176:179]
    v_cvt_pk_bf16_f32 v203, v254, v255
    buffer_store_dwordx4 v[200:203], v2, s[24:27], s62 offen offset:0
    v_fmaak_f32 v248, v208, v208, 0x41b2e92f
    v_mfma_f32_16x16x32_bf16 v[180:183], v[240:243], v[36:39], v[180:183]
    v_fmaak_f32 v249, v209, v209, 0x41b2e92f
    v_fmaak_f32 v250, v210, v210, 0x41b2e92f
    v_fmaak_f32 v251, v211, v211, 0x41b2e92f
    ds_read_b64_tr_b16 v[236:237], v3 offset:27648
    ds_read_b64_tr_b16 v[238:239], v3 offset:32256
    s_waitcnt lgkmcnt(4)
    v_mfma_f32_16x16x32_bf16 v[184:187], v[244:247], v[32:35], v[184:187]
    v_mul_f32 v252, s47, v208
    v_mul_f32 v253, s47, v209
    v_mul_f32 v254, s47, v210
    v_mfma_f32_16x16x32_bf16 v[188:191], v[244:247], v[36:39], v[188:191]
    v_mul_f32 v255, s47, v211
    v_mul_f32 v248, v248, v252
    v_mul_f32 v249, v249, v253
    ds_read_b64_tr_b16 v[240:241], v3 offset:27688
    ds_read_b64_tr_b16 v[242:243], v3 offset:32296
    s_waitcnt lgkmcnt(4)
    v_mfma_f32_16x16x32_bf16 v[192:195], v[232:235], v[32:35], v[192:195]
    v_mul_f32 v250, v250, v254
    v_mul_f32 v251, v251, v255
    v_exp_f32 v248, v248
    v_mfma_f32_16x16x32_bf16 v[196:199], v[232:235], v[36:39], v[196:199]
    v_exp_f32 v249, v249
    v_exp_f32 v250, v250
    v_exp_f32 v251, v251
    ds_read_b64_tr_b16 v[244:245], v3 offset:27744
    ds_read_b64_tr_b16 v[246:247], v3 offset:32352
    s_waitcnt lgkmcnt(4)
    v_mfma_f32_16x16x32_bf16 v[160:163], v[236:239], v[40:43], v[160:163]
    v_add_f32 v248, 1.0, v248
    v_add_f32 v249, 1.0, v249
    v_add_f32 v250, 1.0, v250
    v_mfma_f32_16x16x32_bf16 v[164:167], v[236:239], v[44:47], v[164:167]
    v_add_f32 v251, 1.0, v251
    v_rcp_f32 v248, v248
    v_rcp_f32 v249, v249
    ds_read_b64_tr_b16 v[232:233], v3 offset:27784
    ds_read_b64_tr_b16 v[234:235], v3 offset:32392
    s_waitcnt lgkmcnt(4)
    v_mfma_f32_16x16x32_bf16 v[168:171], v[240:243], v[40:43], v[168:171]
    v_rcp_f32 v250, v250
    v_rcp_f32 v251, v251
    v_mul_f32 v252, v208, v248
    v_mfma_f32_16x16x32_bf16 v[172:175], v[240:243], v[44:47], v[172:175]
    v_mul_f32 v253, v209, v249
    v_mul_f32 v254, v210, v250
    v_mul_f32 v255, v211, v251
    ds_read_b64_tr_b16 v[236:237], v5 offset:27648
    ds_read_b64_tr_b16 v[238:239], v5 offset:32256
    s_waitcnt lgkmcnt(4)
    v_mfma_f32_16x16x32_bf16 v[176:179], v[244:247], v[40:43], v[176:179]
    v_cvt_pk_bf16_f32 v208, v252, v253
    v_cvt_pk_bf16_f32 v209, v254, v255
    v_fmaak_f32 v248, v212, v212, 0x41b2e92f
    v_mfma_f32_16x16x32_bf16 v[180:183], v[244:247], v[44:47], v[180:183]
    v_fmaak_f32 v249, v213, v213, 0x41b2e92f
    v_fmaak_f32 v250, v214, v214, 0x41b2e92f
    v_fmaak_f32 v251, v215, v215, 0x41b2e92f
    s_waitcnt vmcnt(9)
    s_barrier
    ds_read_b64_tr_b16 v[240:241], v3 offset:36864
    ds_read_b64_tr_b16 v[242:243], v3 offset:41472
    s_waitcnt lgkmcnt(4)
    v_mfma_f32_16x16x32_bf16 v[184:187], v[232:235], v[40:43], v[184:187]
    v_mul_f32 v252, s47, v212
    v_mul_f32 v253, s47, v213
    v_mul_f32 v254, s47, v214
    v_mfma_f32_16x16x32_bf16 v[188:191], v[232:235], v[44:47], v[188:191]
    v_mul_f32 v255, s47, v215
    v_mul_f32 v248, v248, v252
    v_mul_f32 v249, v249, v253
    s_add_u32 s45, s56, 1327104
    s_add_u32 m0, s46, 0
    s_nop 0
    buffer_load_dwordx4 v10, s[16:19], s45 offen offset:0 lds
    ds_read_b64_tr_b16 v[244:245], v3 offset:36904
    ds_read_b64_tr_b16 v[246:247], v3 offset:41512
    s_waitcnt lgkmcnt(4)
    v_mfma_f32_16x16x32_bf16 v[192:195], v[236:239], v[40:43], v[192:195]
    v_mul_f32 v250, v250, v254
    v_mul_f32 v251, v251, v255
    v_exp_f32 v248, v248
    v_mfma_f32_16x16x32_bf16 v[196:199], v[236:239], v[44:47], v[196:199]
    v_exp_f32 v249, v249
    v_exp_f32 v250, v250
    v_exp_f32 v251, v251
    ds_read_b64_tr_b16 v[232:233], v3 offset:36960
    ds_read_b64_tr_b16 v[234:235], v3 offset:41568
    s_waitcnt lgkmcnt(4)
    v_mfma_f32_16x16x32_bf16 v[160:163], v[240:243], v[48:51], v[160:163]
    v_add_f32 v248, 1.0, v248
    v_add_f32 v249, 1.0, v249
    v_add_f32 v250, 1.0, v250
    v_mfma_f32_16x16x32_bf16 v[164:167], v[240:243], v[52:55], v[164:167]
    v_add_f32 v251, 1.0, v251
    v_rcp_f32 v248, v248
    v_rcp_f32 v249, v249
    s_nop 0
    buffer_load_dwordx4 v11, s[16:19], s45 offen offset:1024 lds
    ds_read_b64_tr_b16 v[236:237], v3 offset:37000
    ds_read_b64_tr_b16 v[238:239], v3 offset:41608
    s_waitcnt lgkmcnt(4)
    v_mfma_f32_16x16x32_bf16 v[168:171], v[244:247], v[48:51], v[168:171]
    v_rcp_f32 v250, v250
    v_rcp_f32 v251, v251
    v_mul_f32 v252, v212, v248
    v_mfma_f32_16x16x32_bf16 v[172:175], v[244:247], v[52:55], v[172:175]
    v_mul_f32 v253, v213, v249
    v_mul_f32 v254, v214, v250
    v_mul_f32 v255, v215, v251
    ds_read_b64_tr_b16 v[240:241], v5 offset:36864
    ds_read_b64_tr_b16 v[242:243], v5 offset:41472
    s_waitcnt lgkmcnt(4)
    v_mfma_f32_16x16x32_bf16 v[176:179], v[232:235], v[48:51], v[176:179]
    v_cvt_pk_bf16_f32 v210, v252, v253
    v_cvt_pk_bf16_f32 v211, v254, v255
    buffer_store_dwordx4 v[208:211], v2, s[24:27], s62 offen offset:1024
    v_mfma_f32_16x16x32_bf16 v[180:183], v[232:235], v[52:55], v[180:183]
    v_fmaak_f32 v248, v216, v216, 0x41b2e92f
    v_fmaak_f32 v249, v217, v217, 0x41b2e92f
    v_fmaak_f32 v250, v218, v218, 0x41b2e92f
    ds_read_b64_tr_b16 v[244:245], v3 offset:46080
    ds_read_b64_tr_b16 v[246:247], v3 offset:50688
    s_waitcnt lgkmcnt(4)
    v_mfma_f32_16x16x32_bf16 v[184:187], v[236:239], v[48:51], v[184:187]
    v_fmaak_f32 v251, v219, v219, 0x41b2e92f
    v_mul_f32 v252, s47, v216
    v_mul_f32 v253, s47, v217
    v_mfma_f32_16x16x32_bf16 v[188:191], v[236:239], v[52:55], v[188:191]
    v_mul_f32 v254, s47, v218
    v_mul_f32 v255, s47, v219
    v_mul_f32 v248, v248, v252
    ds_read_b64_tr_b16 v[232:233], v3 offset:46120
    ds_read_b64_tr_b16 v[234:235], v3 offset:50728
    s_waitcnt lgkmcnt(4)
    v_mfma_f32_16x16x32_bf16 v[192:195], v[240:243], v[48:51], v[192:195]
    v_mul_f32 v249, v249, v253
    v_mul_f32 v250, v250, v254
    v_mul_f32 v251, v251, v255
    v_mfma_f32_16x16x32_bf16 v[196:199], v[240:243], v[52:55], v[196:199]
    v_exp_f32 v248, v248
    v_exp_f32 v249, v249
    v_exp_f32 v250, v250
    ds_read_b64_tr_b16 v[236:237], v3 offset:46176
    ds_read_b64_tr_b16 v[238:239], v3 offset:50784
    s_waitcnt lgkmcnt(4)
    v_mfma_f32_16x16x32_bf16 v[160:163], v[244:247], v[56:59], v[160:163]
    v_exp_f32 v251, v251
    v_add_f32 v248, 1.0, v248
    v_add_f32 v249, 1.0, v249
    v_mfma_f32_16x16x32_bf16 v[164:167], v[244:247], v[60:63], v[164:167]
    v_add_f32 v250, 1.0, v250
    v_add_f32 v251, 1.0, v251
    v_rcp_f32 v248, v248
    ds_read_b64_tr_b16 v[240:241], v3 offset:46216
    ds_read_b64_tr_b16 v[242:243], v3 offset:50824
    s_waitcnt lgkmcnt(4)
    v_mfma_f32_16x16x32_bf16 v[168:171], v[232:235], v[56:59], v[168:171]
    v_rcp_f32 v249, v249
    v_rcp_f32 v250, v250
    v_rcp_f32 v251, v251
    v_mfma_f32_16x16x32_bf16 v[172:175], v[232:235], v[60:63], v[172:175]
    v_mul_f32 v252, v216, v248
    v_mul_f32 v253, v217, v249
    v_mul_f32 v254, v218, v250
    ds_read_b64_tr_b16 v[244:245], v5 offset:46080
    ds_read_b64_tr_b16 v[246:247], v5 offset:50688
    s_waitcnt lgkmcnt(4)
    v_mfma_f32_16x16x32_bf16 v[176:179], v[236:239], v[56:59], v[176:179]
    v_mul_f32 v255, v219, v251
    v_cvt_pk_bf16_f32 v216, v252, v253
    v_cvt_pk_bf16_f32 v217, v254, v255
    v_mfma_f32_16x16x32_bf16 v[180:183], v[236:239], v[60:63], v[180:183]
    v_fmaak_f32 v248, v220, v220, 0x41b2e92f
    v_fmaak_f32 v249, v221, v221, 0x41b2e92f
    v_fmaak_f32 v250, v222, v222, 0x41b2e92f
    s_waitcnt vmcnt(8)
    s_barrier
    ds_read_b64_tr_b16 v[232:233], v4 offset:0
    ds_read_b64_tr_b16 v[234:235], v4 offset:4608
    s_waitcnt lgkmcnt(4)
    v_mfma_f32_16x16x32_bf16 v[184:187], v[240:243], v[56:59], v[184:187]
    v_fmaak_f32 v251, v223, v223, 0x41b2e92f
    v_mul_f32 v252, s47, v220
    v_mul_f32 v253, s47, v221
    v_mfma_f32_16x16x32_bf16 v[188:191], v[240:243], v[60:63], v[188:191]
    v_mul_f32 v254, s47, v222
    v_mul_f32 v255, s47, v223
    v_mul_f32 v248, v248, v252
    s_add_u32 s45, s56, 1548288
    s_add_u32 m0, s46, 18432
    s_nop 0
    buffer_load_dwordx4 v10, s[16:19], s45 offen offset:0 lds
    ds_read_b64_tr_b16 v[236:237], v4 offset:40
    ds_read_b64_tr_b16 v[238:239], v4 offset:4648
    s_waitcnt lgkmcnt(4)
    v_mfma_f32_16x16x32_bf16 v[192:195], v[244:247], v[56:59], v[192:195]
    v_mul_f32 v249, v249, v253
    v_mul_f32 v250, v250, v254
    v_mul_f32 v251, v251, v255
    v_mfma_f32_16x16x32_bf16 v[196:199], v[244:247], v[60:63], v[196:199]
    v_exp_f32 v248, v248
    v_exp_f32 v249, v249
    v_exp_f32 v250, v250
    ds_read_b64_tr_b16 v[240:241], v4 offset:96
    ds_read_b64_tr_b16 v[242:243], v4 offset:4704
    s_lshl_b32 s6, s58, 13
    s_add_u32 s7, s6, 4096
    buffer_load_dwordx4 v[16:19], v2, s[36:39], s6 offen offset:0 sc1
    buffer_load_dwordx4 v[20:23], v2, s[36:39], s6 offen offset:1024 sc1
    buffer_load_dwordx4 v[24:27], v2, s[36:39], s6 offen offset:2048 sc1
    buffer_load_dwordx4 v[28:31], v2, s[36:39], s6 offen offset:3072 sc1
    buffer_load_dwordx4 v[32:35], v2, s[36:39], s7 offen offset:0 sc1
    buffer_load_dwordx4 v[36:39], v2, s[36:39], s7 offen offset:1024 sc1
    buffer_load_dwordx4 v[40:43], v2, s[36:39], s7 offen offset:2048 sc1
    buffer_load_dwordx4 v[44:47], v2, s[36:39], s7 offen offset:3072 sc1
    s_waitcnt lgkmcnt(4)
    v_mfma_f32_16x16x32_bf16 v[160:163], v[232:235], v[64:67], v[160:163]
    v_exp_f32 v251, v251
    v_add_f32 v248, 1.0, v248
    v_add_f32 v249, 1.0, v249
    v_mfma_f32_16x16x32_bf16 v[164:167], v[232:235], v[68:71], v[164:167]
    v_add_f32 v250, 1.0, v250
    v_add_f32 v251, 1.0, v251
    v_rcp_f32 v248, v248
    s_nop 0
    buffer_load_dwordx4 v11, s[16:19], s45 offen offset:1024 lds
    ds_read_b64_tr_b16 v[244:245], v4 offset:136
    ds_read_b64_tr_b16 v[246:247], v4 offset:4744
    s_waitcnt lgkmcnt(4)
    v_mfma_f32_16x16x32_bf16 v[168:171], v[236:239], v[64:67], v[168:171]
    v_rcp_f32 v249, v249
    v_rcp_f32 v250, v250
    v_rcp_f32 v251, v251
    v_mfma_f32_16x16x32_bf16 v[172:175], v[236:239], v[68:71], v[172:175]
    v_mul_f32 v252, v220, v248
    v_mul_f32 v253, v221, v249
    v_mul_f32 v254, v222, v250
    ds_read_b64_tr_b16 v[232:233], v6 offset:0
    ds_read_b64_tr_b16 v[234:235], v6 offset:4608
    s_waitcnt lgkmcnt(4)
    v_mfma_f32_16x16x32_bf16 v[176:179], v[240:243], v[64:67], v[176:179]
    v_mul_f32 v255, v223, v251
    v_cvt_pk_bf16_f32 v218, v252, v253
    v_cvt_pk_bf16_f32 v219, v254, v255
    v_mfma_f32_16x16x32_bf16 v[180:183], v[240:243], v[68:71], v[180:183]
    buffer_store_dwordx4 v[216:219], v2, s[24:27], s62 offen offset:2048
    v_fmaak_f32 v248, v224, v224, 0x41b2e92f
    v_fmaak_f32 v249, v225, v225, 0x41b2e92f
    ds_read_b64_tr_b16 v[236:237], v4 offset:9216
    ds_read_b64_tr_b16 v[238:239], v4 offset:13824
    s_waitcnt lgkmcnt(4)
    v_mfma_f32_16x16x32_bf16 v[184:187], v[244:247], v[64:67], v[184:187]
    v_fmaak_f32 v250, v226, v226, 0x41b2e92f
    v_fmaak_f32 v251, v227, v227, 0x41b2e92f
    v_mul_f32 v252, s47, v224
    v_mfma_f32_16x16x32_bf16 v[188:191], v[244:247], v[68:71], v[188:191]
    v_mul_f32 v253, s47, v225
    v_mul_f32 v254, s47, v226
    v_mul_f32 v255, s47, v227
    ds_read_b64_tr_b16 v[240:241], v4 offset:9256
    ds_read_b64_tr_b16 v[242:243], v4 offset:13864
    s_waitcnt lgkmcnt(4)
    v_mfma_f32_16x16x32_bf16 v[192:195], v[232:235], v[64:67], v[192:195]
    v_mul_f32 v248, v248, v252
    v_mul_f32 v249, v249, v253
    v_mul_f32 v250, v250, v254
    v_mfma_f32_16x16x32_bf16 v[196:199], v[232:235], v[68:71], v[196:199]
    v_mul_f32 v251, v251, v255
    v_exp_f32 v248, v248
    v_exp_f32 v249, v249
    ds_read_b64_tr_b16 v[244:245], v4 offset:9312
    ds_read_b64_tr_b16 v[246:247], v4 offset:13920
    s_waitcnt lgkmcnt(4)
    v_mfma_f32_16x16x32_bf16 v[160:163], v[236:239], v[72:75], v[160:163]
    v_exp_f32 v250, v250
    v_exp_f32 v251, v251
    v_add_f32 v248, 1.0, v248
    v_mfma_f32_16x16x32_bf16 v[164:167], v[236:239], v[76:79], v[164:167]
    v_add_f32 v249, 1.0, v249
    v_add_f32 v250, 1.0, v250
    v_add_f32 v251, 1.0, v251
    ds_read_b64_tr_b16 v[232:233], v4 offset:9352
    ds_read_b64_tr_b16 v[234:235], v4 offset:13960
    s_waitcnt lgkmcnt(4)
    v_mfma_f32_16x16x32_bf16 v[168:171], v[240:243], v[72:75], v[168:171]
    v_rcp_f32 v248, v248
    v_rcp_f32 v249, v249
    v_rcp_f32 v250, v250
    v_mfma_f32_16x16x32_bf16 v[172:175], v[240:243], v[76:79], v[172:175]
    v_rcp_f32 v251, v251
    v_mul_f32 v252, v224, v248
    v_mul_f32 v253, v225, v249
    ds_read_b64_tr_b16 v[236:237], v6 offset:9216
    ds_read_b64_tr_b16 v[238:239], v6 offset:13824
    s_waitcnt lgkmcnt(4)
    v_mfma_f32_16x16x32_bf16 v[176:179], v[244:247], v[72:75], v[176:179]
    v_mul_f32 v254, v226, v250
    v_mul_f32 v255, v227, v251
    v_cvt_pk_bf16_f32 v224, v252, v253
    v_mfma_f32_16x16x32_bf16 v[180:183], v[244:247], v[76:79], v[180:183]
    v_cvt_pk_bf16_f32 v225, v254, v255
    v_fmaak_f32 v248, v228, v228, 0x41b2e92f
    v_fmaak_f32 v249, v229, v229, 0x41b2e92f
    s_waitcnt vmcnt(17)
    s_barrier
    ds_read_b64_tr_b16 v[240:241], v4 offset:18432
    ds_read_b64_tr_b16 v[242:243], v4 offset:23040
    s_waitcnt lgkmcnt(4)
    v_mfma_f32_16x16x32_bf16 v[184:187], v[232:235], v[72:75], v[184:187]
    v_fmaak_f32 v250, v230, v230, 0x41b2e92f
    v_fmaak_f32 v251, v231, v231, 0x41b2e92f
    v_mul_f32 v252, s47, v228
    v_mfma_f32_16x16x32_bf16 v[188:191], v[232:235], v[76:79], v[188:191]
    v_mul_f32 v253, s47, v229
    v_mul_f32 v254, s47, v230
    v_mul_f32 v255, s47, v231
    s_add_u32 s45, s56, 1769472
    s_add_u32 m0, s46, 36864
    s_nop 0
    buffer_load_dwordx4 v10, s[16:19], s45 offen offset:0 lds
    ds_read_b64_tr_b16 v[244:245], v4 offset:18472
    ds_read_b64_tr_b16 v[246:247], v4 offset:23080
    s_waitcnt lgkmcnt(4)
    v_mfma_f32_16x16x32_bf16 v[192:195], v[236:239], v[72:75], v[192:195]
    v_mul_f32 v248, v248, v252
    v_mul_f32 v249, v249, v253
    v_mul_f32 v250, v250, v254
    v_mfma_f32_16x16x32_bf16 v[196:199], v[236:239], v[76:79], v[196:199]
    v_mul_f32 v251, v251, v255
    v_exp_f32 v248, v248
    v_exp_f32 v249, v249
    ds_read_b64_tr_b16 v[232:233], v4 offset:18528
    ds_read_b64_tr_b16 v[234:235], v4 offset:23136
    s_waitcnt lgkmcnt(4)
    v_mfma_f32_16x16x32_bf16 v[160:163], v[240:243], v[80:83], v[160:163]
    v_exp_f32 v250, v250
    v_exp_f32 v251, v251
    v_add_f32 v248, 1.0, v248
    v_mfma_f32_16x16x32_bf16 v[164:167], v[240:243], v[84:87], v[164:167]
    v_add_f32 v249, 1.0, v249
    v_add_f32 v250, 1.0, v250
    v_add_f32 v251, 1.0, v251
    s_nop 0
    buffer_load_dwordx4 v11, s[16:19], s45 offen offset:1024 lds
    ds_read_b64_tr_b16 v[236:237], v4 offset:18568
    ds_read_b64_tr_b16 v[238:239], v4 offset:23176
    s_waitcnt lgkmcnt(4)
    v_mfma_f32_16x16x32_bf16 v[168:171], v[244:247], v[80:83], v[168:171]
    v_rcp_f32 v248, v248
    v_rcp_f32 v249, v249
    v_rcp_f32 v250, v250
    v_mfma_f32_16x16x32_bf16 v[172:175], v[244:247], v[84:87], v[172:175]
    v_rcp_f32 v251, v251
    v_mul_f32 v252, v228, v248
    v_mul_f32 v253, v229, v249
    ds_read_b64_tr_b16 v[240:241], v6 offset:18432
    ds_read_b64_tr_b16 v[242:243], v6 offset:23040
    s_waitcnt lgkmcnt(4)
    v_mfma_f32_16x16x32_bf16 v[176:179], v[232:235], v[80:83], v[176:179]
    v_mul_f32 v254, v230, v250
    v_mul_f32 v255, v231, v251
    v_cvt_pk_bf16_f32 v226, v252, v253
    v_mfma_f32_16x16x32_bf16 v[180:183], v[232:235], v[84:87], v[180:183]
    v_cvt_pk_bf16_f32 v227, v254, v255
    buffer_store_dwordx4 v[224:227], v2, s[24:27], s62 offen offset:3072
    ds_read_b64_tr_b16 v[244:245], v4 offset:27648
    ds_read_b64_tr_b16 v[246:247], v4 offset:32256
    s_waitcnt lgkmcnt(4)
    v_mfma_f32_16x16x32_bf16 v[184:187], v[236:239], v[80:83], v[184:187]
    v_mfma_f32_16x16x32_bf16 v[188:191], v[236:239], v[84:87], v[188:191]
    ds_read_b64_tr_b16 v[232:233], v4 offset:27688
    ds_read_b64_tr_b16 v[234:235], v4 offset:32296
    s_waitcnt lgkmcnt(4)
    v_mfma_f32_16x16x32_bf16 v[192:195], v[240:243], v[80:83], v[192:195]
    v_mfma_f32_16x16x32_bf16 v[196:199], v[240:243], v[84:87], v[196:199]
    ds_read_b64_tr_b16 v[236:237], v4 offset:27744
    ds_read_b64_tr_b16 v[238:239], v4 offset:32352
    s_waitcnt lgkmcnt(4)
    v_mfma_f32_16x16x32_bf16 v[160:163], v[244:247], v[88:91], v[160:163]
    v_mfma_f32_16x16x32_bf16 v[164:167], v[244:247], v[92:95], v[164:167]
    ds_read_b64_tr_b16 v[240:241], v4 offset:27784
    ds_read_b64_tr_b16 v[242:243], v4 offset:32392
    s_waitcnt lgkmcnt(4)
    v_mfma_f32_16x16x32_bf16 v[168:171], v[232:235], v[88:91], v[168:171]
    v_mfma_f32_16x16x32_bf16 v[172:175], v[232:235], v[92:95], v[172:175]
    ds_read_b64_tr_b16 v[244:245], v6 offset:27648
    ds_read_b64_tr_b16 v[246:247], v6 offset:32256
    s_waitcnt lgkmcnt(4)
    v_mfma_f32_16x16x32_bf16 v[176:179], v[236:239], v[88:91], v[176:179]
    v_mfma_f32_16x16x32_bf16 v[180:183], v[236:239], v[92:95], v[180:183]
    s_waitcnt vmcnt(18)
    s_barrier
    ds_read_b64_tr_b16 v[232:233], v4 offset:36864
    ds_read_b64_tr_b16 v[234:235], v4 offset:41472
    s_waitcnt lgkmcnt(4)
    v_mfma_f32_16x16x32_bf16 v[184:187], v[240:243], v[88:91], v[184:187]
    ds_read2st64_b32 v[48:49], v13 offset0:0 offset1:1
    ds_read2st64_b32 v[50:51], v13 offset0:2 offset1:3
    ds_read2st64_b32 v[52:53], v13 offset0:4 offset1:5
    v_mfma_f32_16x16x32_bf16 v[188:191], v[240:243], v[92:95], v[188:191]
    ds_read2st64_b32 v[54:55], v13 offset0:6 offset1:7
    ds_read2st64_b32 v[56:57], v13 offset0:8 offset1:9
    ds_read2st64_b32 v[58:59], v13 offset0:10 offset1:11
    ds_read_b64_tr_b16 v[236:237], v4 offset:36904
    ds_read_b64_tr_b16 v[238:239], v4 offset:41512
    s_waitcnt lgkmcnt(10)
    v_mfma_f32_16x16x32_bf16 v[192:195], v[244:247], v[88:91], v[192:195]
    ds_read2st64_b32 v[60:61], v13 offset0:12 offset1:13
    ds_read2st64_b32 v[62:63], v13 offset0:14 offset1:15
    ds_read2st64_b32 v[64:65], v13 offset0:16 offset1:17
    v_mfma_f32_16x16x32_bf16 v[196:199], v[244:247], v[92:95], v[196:199]
    ds_read2st64_b32 v[66:67], v13 offset0:18 offset1:19
    s_waitcnt vmcnt(5)
    s_mov_b32 s66, 4096
g1_chk0:
    v_min3_u32 v248, v17, v19, v21
    v_min3_u32 v248, v248, v23, v25
    v_min3_u32 v248, v248, v27, v29
    v_min3_u32 v248, v248, v31, v33
    v_min3_u32 v248, v248, v35, v37
    v_min3_u32 v248, v248, v39, v41
    v_min3_u32 v248, v248, v43, v45
    v_min_u32 v248, v248, v47
    v_max3_u32 v249, v17, v19, v21
    v_max3_u32 v249, v249, v23, v25
    v_max3_u32 v249, v249, v27, v29
    v_max3_u32 v249, v249, v31, v33
    v_max3_u32 v249, v249, v35, v37
    v_max3_u32 v249, v249, v39, v41
    v_max3_u32 v249, v249, v43, v45
    v_max_u32 v249, v249, v47
    v_cmp_ne_u32 vcc, s48, v248
    v_cmp_ne_u32 s[60:61], s48, v249
    s_or_b64 vcc, vcc, s[60:61]
    s_cbranch_vccz g1_ok0
    s_sub_u32 s66, s66, 1
    s_cmp_eq_u32 s66, 0
    s_cbranch_scc1 g1_ok0
    s_lshl_b32 s6, s58, 13
    s_add_u32 s7, s6, 4096
    buffer_load_dwordx4 v[16:19], v2, s[36:39], s6 offen offset:0 sc1
    buffer_load_dwordx4 v[20:23], v2, s[36:39], s6 offen offset:1024 sc1
    buffer_load_dwordx4 v[24:27], v2, s[36:39], s6 offen offset:2048 sc1
    buffer_load_dwordx4 v[28:31], v2, s[36:39], s6 offen offset:3072 sc1
    buffer_load_dwordx4 v[32:35], v2, s[36:39], s7 offen offset:0 sc1
    buffer_load_dwordx4 v[36:39], v2, s[36:39], s7 offen offset:1024 sc1
    buffer_load_dwordx4 v[40:43], v2, s[36:39], s7 offen offset:2048 sc1
    buffer_load_dwordx4 v[44:47], v2, s[36:39], s7 offen offset:3072 sc1
    s_waitcnt vmcnt(0)
    s_branch g1_chk0
g1_ok0:
    v_add_f32 v16, v16, v32
    ds_read_b64_tr_b16 v[240:241], v4 offset:36960
    ds_read_b64_tr_b16 v[242:243], v4 offset:41568
    s_waitcnt lgkmcnt(14)
    v_mfma_f32_16x16x32_bf16 v[160:163], v[232:235], v[96:99], v[160:163]
    v_add_f32 v18, v18, v34
    v_add_f32 v20, v20, v36
    v_add_f32 v22, v22, v38
    v_mfma_f32_16x16x32_bf16 v[164:167], v[232:235], v[100:103], v[164:167]
    v_add_f32 v24, v24, v40
    v_add_f32 v26, v26, v42
    v_add_f32 v28, v28, v44
    ds_read_b64_tr_b16 v[244:245], v4 offset:37000
    ds_read_b64_tr_b16 v[246:247], v4 offset:41608
    s_waitcnt lgkmcnt(8)
    v_mfma_f32_16x16x32_bf16 v[168:171], v[236:239], v[96:99], v[168:171]
    v_add_f32 v30, v30, v46
    v_add_f32 v16, v16, v24
    v_add_f32 v18, v18, v26
    v_mfma_f32_16x16x32_bf16 v[172:175], v[236:239], v[100:103], v[172:175]
    v_add_f32 v20, v20, v28
    v_add_f32 v22, v22, v30
    v_add_f32 v16, v16, v20
    ds_read_b64_tr_b16 v[232:233], v6 offset:36864
    ds_read_b64_tr_b16 v[234:235], v6 offset:41472
    s_waitcnt lgkmcnt(4)
    v_mfma_f32_16x16x32_bf16 v[176:179], v[240:243], v[96:99], v[176:179]
    v_add_f32 v18, v18, v22
    v_mov_b32 v17, v16
    v_mov_b32 v19, v18
    v_mfma_f32_16x16x32_bf16 v[180:183], v[240:243], v[100:103], v[180:183]
    v_and_b32 v250, 31, v1
    v_lshlrev_b32 v250, 3, v250
    v_permlane32_swap_b32 v16, v17
    ds_read_b64_tr_b16 v[236:237], v4 offset:46080
    ds_read_b64_tr_b16 v[238:239], v4 offset:50688
    s_waitcnt lgkmcnt(4)
    v_mfma_f32_16x16x32_bf16 v[184:187], v[244:247], v[96:99], v[184:187]
    v_permlane32_swap_b32 v18, v19
    s_lshl_b32 s60, s3, 8
    s_add_u32 s60, s60, 157952
    v_mfma_f32_16x16x32_bf16 v[188:191], v[244:247], v[100:103], v[188:191]
    v_add_f32 v16, v16, v17
    v_add_f32 v18, v18, v19
    v_mul_f32 v16, 0x39e38e39, v16
    ds_read_b64_tr_b16 v[240:241], v4 offset:46120
    ds_read_b64_tr_b16 v[242:243], v4 offset:50728
    s_waitcnt lgkmcnt(4)
    v_mfma_f32_16x16x32_bf16 v[192:195], v[232:235], v[96:99], v[192:195]
    v_mul_f32 v18, 0x39e38e39, v18
    v_fma_f32 v18, -v16, v16, v18
    v_add_f32 v18, 0x3727c5ac, v18
    v_mfma_f32_16x16x32_bf16 v[196:199], v[232:235], v[100:103], v[196:199]
    v_rsq_f32 v18, v18
    v_add_u32 v250, s60, v250
    v_mul_f32 v19, v16, v18
    ds_read_b64_tr_b16 v[244:245], v4 offset:46176
    ds_read_b64_tr_b16 v[246:247], v4 offset:50784
    s_waitcnt lgkmcnt(4)
    v_mfma_f32_16x16x32_bf16 v[160:163], v[236:239], v[104:107], v[160:163]
    v_lshrrev_b32 v251, 4, v1
    v_lshlrev_b32 v251, 6, v251
    v_add_u32 v251, s60, v251
    v_mfma_f32_16x16x32_bf16 v[164:167], v[236:239], v[108:111], v[164:167]
    ds_write_b64 v250, v[18:19]
    ds_read_b128 v[24:27], v251 offset:0
    ds_read_b128 v[28:31], v251 offset:16
    ds_read_b64_tr_b16 v[232:233], v4 offset:46216
    ds_read_b64_tr_b16 v[234:235], v4 offset:50824
    s_waitcnt lgkmcnt(7)
    v_mfma_f32_16x16x32_bf16 v[168:171], v[240:243], v[104:107], v[168:171]
    ds_read_b128 v[32:35], v251 offset:32
    ds_read_b128 v[36:39], v251 offset:48
    s_lshl_b32 s60, s5, 6
    s_add_u32 s60, s60, s58
    s_mul_i32 s60, s60, 9216
    s_add_u32 s62, s60, 0
    s_add_u32 s63, s62, 4096
    v_mfma_f32_16x16x32_bf16 v[172:175], v[240:243], v[108:111], v[172:175]
    ds_read_b64_tr_b16 v[236:237], v6 offset:46080
    ds_read_b64_tr_b16 v[238:239], v6 offset:50688
    s_waitcnt lgkmcnt(9)
    v_mfma_f32_16x16x32_bf16 v[176:179], v[244:247], v[104:107], v[176:179]
    v_mfma_f32_16x16x32_bf16 v[180:183], v[244:247], v[108:111], v[180:183]
    s_barrier
    ds_read_b64_tr_b16 v[240:241], v3 offset:0
    ds_read_b64_tr_b16 v[242:243], v3 offset:4608
    s_waitcnt lgkmcnt(6)
    v_mfma_f32_16x16x32_bf16 v[184:187], v[232:235], v[104:107], v[184:187]
    s_waitcnt lgkmcnt(4)
    v_lshlrev_b32 v248, 16, v48
    v_and_b32 v249, 0xffff0000, v48
    v_mfma_f32_16x16x32_bf16 v[188:191], v[232:235], v[108:111], v[188:191]
    v_lshlrev_b32 v250, 16, v49
    v_and_b32 v251, 0xffff0000, v49
    v_lshlrev_b32 v252, 16, v50
    ds_read_b64_tr_b16 v[244:245], v3 offset:40
    ds_read_b64_tr_b16 v[246:247], v3 offset:4648
    s_waitcnt lgkmcnt(4)
    v_mfma_f32_16x16x32_bf16 v[192:195], v[236:239], v[104:107], v[192:195]
    v_and_b32 v253, 0xffff0000, v50
    v_lshlrev_b32 v254, 16, v51
    v_and_b32 v255, 0xffff0000, v51
    v_mfma_f32_16x16x32_bf16 v[196:199], v[236:239], v[108:111], v[196:199]
    v_fma_f32 v248, v248, v24, -v25
    v_fma_f32 v249, v249, v26, -v27
    v_fma_f32 v250, v250, v28, -v29
    ds_read_b64_tr_b16 v[232:233], v3 offset:96
    ds_read_b64_tr_b16 v[234:235], v3 offset:4704
    s_waitcnt lgkmcnt(4)
    v_mfma_f32_16x16x32_bf16 v[160:163], v[240:243], v[112:115], v[160:163]
    v_fma_f32 v251, v251, v30, -v31
    v_fma_f32 v252, v252, v32, -v33
    v_fma_f32 v253, v253, v34, -v35
    v_mfma_f32_16x16x32_bf16 v[164:167], v[240:243], v[116:119], v[164:167]
    v_fma_f32 v254, v254, v36, -v37
    v_fma_f32 v255, v255, v38, -v39
    v_cvt_pk_bf16_f32 v48, v248, v249
    ds_read_b64_tr_b16 v[236:237], v3 offset:136
    ds_read_b64_tr_b16 v[238:239], v3 offset:4744
    s_waitcnt lgkmcnt(4)
    v_mfma_f32_16x16x32_bf16 v[168:171], v[244:247], v[112:115], v[168:171]
    v_cvt_pk_bf16_f32 v49, v250, v251
    v_cvt_pk_bf16_f32 v50, v252, v253
    v_cvt_pk_bf16_f32 v51, v254, v255
    v_mfma_f32_16x16x32_bf16 v[172:175], v[244:247], v[116:119], v[172:175]
    buffer_store_dwordx4 v[48:51], v2, s[20:23], s62 offen offset:0
    v_lshlrev_b32 v248, 16, v52
    v_and_b32 v249, 0xffff0000, v52
    ds_read_b64_tr_b16 v[240:241], v5 offset:0
    ds_read_b64_tr_b16 v[242:243], v5 offset:4608
    s_waitcnt lgkmcnt(4)
    v_mfma_f32_16x16x32_bf16 v[176:179], v[232:235], v[112:115], v[176:179]
    v_lshlrev_b32 v250, 16, v53
    v_and_b32 v251, 0xffff0000, v53
    v_lshlrev_b32 v252, 16, v54
    v_mfma_f32_16x16x32_bf16 v[180:183], v[232:235], v[116:119], v[180:183]
    v_and_b32 v253, 0xffff0000, v54
    v_lshlrev_b32 v254, 16, v55
    v_and_b32 v255, 0xffff0000, v55
    ds_read_b64_tr_b16 v[244:245], v3 offset:9216
    ds_read_b64_tr_b16 v[246:247], v3 offset:13824
    s_waitcnt lgkmcnt(4)
    v_mfma_f32_16x16x32_bf16 v[184:187], v[236:239], v[112:115], v[184:187]
    v_fma_f32 v248, v248, v24, -v25
    v_fma_f32 v249, v249, v26, -v27
    v_fma_f32 v250, v250, v28, -v29
    v_mfma_f32_16x16x32_bf16 v[188:191], v[236:239], v[116:119], v[188:191]
    v_fma_f32 v251, v251, v30, -v31
    v_fma_f32 v252, v252, v32, -v33
    v_fma_f32 v253, v253, v34, -v35
    ds_read_b64_tr_b16 v[232:233], v3 offset:9256
    ds_read_b64_tr_b16 v[234:235], v3 offset:13864
    s_waitcnt lgkmcnt(4)
    v_mfma_f32_16x16x32_bf16 v[192:195], v[240:243], v[112:115], v[192:195]
    v_fma_f32 v254, v254, v36, -v37
    v_fma_f32 v255, v255, v38, -v39
    v_cvt_pk_bf16_f32 v52, v248, v249
    v_mfma_f32_16x16x32_bf16 v[196:199], v[240:243], v[116:119], v[196:199]
    v_cvt_pk_bf16_f32 v53, v250, v251
    v_cvt_pk_bf16_f32 v54, v252, v253
    v_cvt_pk_bf16_f32 v55, v254, v255
    ds_read_b64_tr_b16 v[236:237], v3 offset:9312
    ds_read_b64_tr_b16 v[238:239], v3 offset:13920
    s_waitcnt lgkmcnt(4)
    v_mfma_f32_16x16x32_bf16 v[160:163], v[244:247], v[120:123], v[160:163]
    buffer_store_dwordx4 v[52:55], v2, s[20:23], s62 offen offset:1024
    v_lshlrev_b32 v248, 16, v56
    v_and_b32 v249, 0xffff0000, v56
    v_mfma_f32_16x16x32_bf16 v[164:167], v[244:247], v[124:127], v[164:167]
    v_lshlrev_b32 v250, 16, v57
    v_and_b32 v251, 0xffff0000, v57
    v_lshlrev_b32 v252, 16, v58
    ds_read_b64_tr_b16 v[240:241], v3 offset:9352
    ds_read_b64_tr_b16 v[242:243], v3 offset:13960
    s_waitcnt lgkmcnt(4)
    v_mfma_f32_16x16x32_bf16 v[168:171], v[232:235], v[120:123], v[168:171]
    v_and_b32 v253, 0xffff0000, v58
    v_lshlrev_b32 v254, 16, v59
    v_and_b32 v255, 0xffff0000, v59
    v_mfma_f32_16x16x32_bf16 v[172:175], v[232:235], v[124:127], v[172:175]
    v_fma_f32 v248, v248, v24, -v25
    v_fma_f32 v249, v249, v26, -v27
    v_fma_f32 v250, v250, v28, -v29
    ds_read_b64_tr_b16 v[244:245], v5 offset:9216
    ds_read_b64_tr_b16 v[246:247], v5 offset:13824
    s_waitcnt lgkmcnt(4)
    v_mfma_f32_16x16x32_bf16 v[176:179], v[236:239], v[120:123], v[176:179]
    v_fma_f32 v251, v251, v30, -v31
    v_fma_f32 v252, v252, v32, -v33
    v_fma_f32 v253, v253, v34, -v35
    v_mfma_f32_16x16x32_bf16 v[180:183], v[236:239], v[124:127], v[180:183]
    v_fma_f32 v254, v254, v36, -v37
    v_fma_f32 v255, v255, v38, -v39
    v_cvt_pk_bf16_f32 v56, v248, v249
    s_waitcnt vmcnt(6)
    s_barrier
    ds_read_b64_tr_b16 v[232:233], v3 offset:18432
    ds_read_b64_tr_b16 v[234:235], v3 offset:23040
    s_waitcnt lgkmcnt(4)
    v_mfma_f32_16x16x32_bf16 v[184:187], v[240:243], v[120:123], v[184:187]
    v_cvt_pk_bf16_f32 v57, v250, v251
    v_cvt_pk_bf16_f32 v58, v252, v253
    v_cvt_pk_bf16_f32 v59, v254, v255
    v_mfma_f32_16x16x32_bf16 v[188:191], v[240:243], v[124:127], v[188:191]
    buffer_store_dwordx4 v[56:59], v2, s[20:23], s62 offen offset:2048
    v_lshlrev_b32 v248, 16, v60
    v_and_b32 v249, 0xffff0000, v60
    ds_read_b64_tr_b16 v[236:237], v3 offset:18472
    ds_read_b64_tr_b16 v[238:239], v3 offset:23080
    s_waitcnt lgkmcnt(4)
    v_mfma_f32_16x16x32_bf16 v[192:195], v[244:247], v[120:123], v[192:195]
    v_lshlrev_b32 v250, 16, v61
    v_and_b32 v251, 0xffff0000, v61
    v_lshlrev_b32 v252, 16, v62
    v_mfma_f32_16x16x32_bf16 v[196:199], v[244:247], v[124:127], v[196:199]
    v_and_b32 v253, 0xffff0000, v62
    v_lshlrev_b32 v254, 16, v63
    v_and_b32 v255, 0xffff0000, v63
    ds_read_b64_tr_b16 v[240:241], v3 offset:18528
    ds_read_b64_tr_b16 v[242:243], v3 offset:23136
    s_waitcnt lgkmcnt(4)
    v_mfma_f32_16x16x32_bf16 v[160:163], v[232:235], v[128:131], v[160:163]
    v_fma_f32 v248, v248, v24, -v25
    v_fma_f32 v249, v249, v26, -v27
    v_fma_f32 v250, v250, v28, -v29
    v_mfma_f32_16x16x32_bf16 v[164:167], v[232:235], v[132:135], v[164:167]
    v_fma_f32 v251, v251, v30, -v31
    v_fma_f32 v252, v252, v32, -v33
    v_fma_f32 v253, v253, v34, -v35
    ds_read_b64_tr_b16 v[244:245], v3 offset:18568
    ds_read_b64_tr_b16 v[246:247], v3 offset:23176
    s_waitcnt lgkmcnt(4)
    v_mfma_f32_16x16x32_bf16 v[168:171], v[236:239], v[128:131], v[168:171]
    v_fma_f32 v254, v254, v36, -v37
    v_fma_f32 v255, v255, v38, -v39
    v_cvt_pk_bf16_f32 v60, v248, v249
    v_mfma_f32_16x16x32_bf16 v[172:175], v[236:239], v[132:135], v[172:175]
    v_cvt_pk_bf16_f32 v61, v250, v251
    v_cvt_pk_bf16_f32 v62, v252, v253
    v_cvt_pk_bf16_f32 v63, v254, v255
    ds_read_b64_tr_b16 v[232:233], v5 offset:18432
    ds_read_b64_tr_b16 v[234:235], v5 offset:23040
    s_waitcnt lgkmcnt(4)
    v_mfma_f32_16x16x32_bf16 v[176:179], v[240:243], v[128:131], v[176:179]
    buffer_store_dwordx4 v[60:63], v2, s[20:23], s62 offen offset:3072
    v_lshlrev_b32 v248, 16, v64
    v_and_b32 v249, 0xffff0000, v64
    v_mfma_f32_16x16x32_bf16 v[180:183], v[240:243], v[132:135], v[180:183]
    v_lshlrev_b32 v250, 16, v65
    v_and_b32 v251, 0xffff0000, v65
    v_lshlrev_b32 v252, 16, v66
    ds_read_b64_tr_b16 v[236:237], v3 offset:27648
    ds_read_b64_tr_b16 v[238:239], v3 offset:32256
    s_waitcnt lgkmcnt(4)
    v_mfma_f32_16x16x32_bf16 v[184:187], v[244:247], v[128:131], v[184:187]
    v_and_b32 v253, 0xffff0000, v66
    v_lshlrev_b32 v254, 16, v67
    v_and_b32 v255, 0xffff0000, v67
    v_mfma_f32_16x16x32_bf16 v[188:191], v[244:247], v[132:135], v[188:191]
    v_fma_f32 v248, v248, v24, -v25
    v_fma_f32 v249, v249, v26, -v27
    v_fma_f32 v250, v250, v28, -v29
    ds_read_b64_tr_b16 v[240:241], v3 offset:27688
    ds_read_b64_tr_b16 v[242:243], v3 offset:32296
    s_waitcnt lgkmcnt(4)
    v_mfma_f32_16x16x32_bf16 v[192:195], v[232:235], v[128:131], v[192:195]
    v_fma_f32 v251, v251, v30, -v31
    v_fma_f32 v252, v252, v32, -v33
    v_fma_f32 v253, v253, v34, -v35
    v_mfma_f32_16x16x32_bf16 v[196:199], v[232:235], v[132:135], v[196:199]
    v_fma_f32 v254, v254, v36, -v37
    v_fma_f32 v255, v255, v38, -v39
    v_cvt_pk_bf16_f32 v64, v248, v249
    ds_read_b64_tr_b16 v[244:245], v3 offset:27744
    ds_read_b64_tr_b16 v[246:247], v3 offset:32352
    s_waitcnt lgkmcnt(4)
    v_mfma_f32_16x16x32_bf16 v[160:163], v[236:239], v[136:139], v[160:163]
    v_cvt_pk_bf16_f32 v65, v250, v251
    v_cvt_pk_bf16_f32 v66, v252, v253
    v_cvt_pk_bf16_f32 v67, v254, v255
    v_mfma_f32_16x16x32_bf16 v[164:167], v[236:239], v[140:143], v[164:167]
    buffer_store_dwordx4 v[64:67], v2, s[20:23], s63 offen offset:0
    ds_read_b64_tr_b16 v[232:233], v3 offset:27784
    ds_read_b64_tr_b16 v[234:235], v3 offset:32392
    s_waitcnt lgkmcnt(4)
    v_mfma_f32_16x16x32_bf16 v[168:171], v[240:243], v[136:139], v[168:171]
    v_mfma_f32_16x16x32_bf16 v[172:175], v[240:243], v[140:143], v[172:175]
    ds_read_b64_tr_b16 v[236:237], v5 offset:27648
    ds_read_b64_tr_b16 v[238:239], v5 offset:32256
    s_waitcnt lgkmcnt(4)
    v_mfma_f32_16x16x32_bf16 v[176:179], v[244:247], v[136:139], v[176:179]
    v_mfma_f32_16x16x32_bf16 v[180:183], v[244:247], v[140:143], v[180:183]
    s_waitcnt vmcnt(6)
    s_barrier
    ds_read_b64_tr_b16 v[240:241], v3 offset:36864
    ds_read_b64_tr_b16 v[242:243], v3 offset:41472
    s_waitcnt lgkmcnt(4)
    v_mfma_f32_16x16x32_bf16 v[184:187], v[232:235], v[136:139], v[184:187]
    v_mfma_f32_16x16x32_bf16 v[188:191], v[232:235], v[140:143], v[188:191]
    ds_read_b64_tr_b16 v[244:245], v3 offset:36904
    ds_read_b64_tr_b16 v[246:247], v3 offset:41512
    s_waitcnt lgkmcnt(4)
    v_mfma_f32_16x16x32_bf16 v[192:195], v[236:239], v[136:139], v[192:195]
    v_mfma_f32_16x16x32_bf16 v[196:199], v[236:239], v[140:143], v[196:199]
    ds_read_b64_tr_b16 v[232:233], v3 offset:36960
    ds_read_b64_tr_b16 v[234:235], v3 offset:41568
    s_waitcnt lgkmcnt(4)
    v_mfma_f32_16x16x32_bf16 v[160:163], v[240:243], v[144:147], v[160:163]
    v_mfma_f32_16x16x32_bf16 v[164:167], v[240:243], v[148:151], v[164:167]
    ds_read_b64_tr_b16 v[236:237], v3 offset:37000
    ds_read_b64_tr_b16 v[238:239], v3 offset:41608
    s_waitcnt lgkmcnt(4)
    v_mfma_f32_16x16x32_bf16 v[168:171], v[244:247], v[144:147], v[168:171]
    v_mfma_f32_16x16x32_bf16 v[172:175], v[244:247], v[148:151], v[172:175]
    ds_read_b64_tr_b16 v[240:241], v5 offset:36864
    ds_read_b64_tr_b16 v[242:243], v5 offset:41472
    s_waitcnt lgkmcnt(4)
    v_mfma_f32_16x16x32_bf16 v[176:179], v[232:235], v[144:147], v[176:179]
    v_mfma_f32_16x16x32_bf16 v[180:183], v[232:235], v[148:151], v[180:183]
    ds_read_b64_tr_b16 v[244:245], v3 offset:46080
    ds_read_b64_tr_b16 v[246:247], v3 offset:50688
    s_waitcnt lgkmcnt(4)
    v_mfma_f32_16x16x32_bf16 v[184:187], v[236:239], v[144:147], v[184:187]
    v_mfma_f32_16x16x32_bf16 v[188:191], v[236:239], v[148:151], v[188:191]
    ds_read_b64_tr_b16 v[232:233], v3 offset:46120
    ds_read_b64_tr_b16 v[234:235], v3 offset:50728
    s_waitcnt lgkmcnt(4)
    v_mfma_f32_16x16x32_bf16 v[192:195], v[240:243], v[144:147], v[192:195]
    v_mfma_f32_16x16x32_bf16 v[196:199], v[240:243], v[148:151], v[196:199]
    ds_read_b64_tr_b16 v[236:237], v3 offset:46176
    ds_read_b64_tr_b16 v[238:239], v3 offset:50784
    s_waitcnt lgkmcnt(4)
    v_mfma_f32_16x16x32_bf16 v[160:163], v[244:247], v[152:155], v[160:163]
    v_mfma_f32_16x16x32_bf16 v[164:167], v[244:247], v[156:159], v[164:167]
    ds_read_b64_tr_b16 v[240:241], v3 offset:46216
    ds_read_b64_tr_b16 v[242:243], v3 offset:50824
    s_waitcnt lgkmcnt(4)
    v_mfma_f32_16x16x32_bf16 v[168:171], v[232:235], v[152:155], v[168:171]
    v_mfma_f32_16x16x32_bf16 v[172:175], v[232:235], v[156:159], v[172:175]
    ds_read_b64_tr_b16 v[244:245], v5 offset:46080
    ds_read_b64_tr_b16 v[246:247], v5 offset:50688
    s_waitcnt lgkmcnt(4)
    v_mfma_f32_16x16x32_bf16 v[176:179], v[236:239], v[152:155], v[176:179]
    v_mfma_f32_16x16x32_bf16 v[180:183], v[236:239], v[156:159], v[180:183]
    s_waitcnt lgkmcnt(2)
    v_mfma_f32_16x16x32_bf16 v[184:187], v[240:243], v[152:155], v[184:187]
    v_mfma_f32_16x16x32_bf16 v[188:191], v[240:243], v[156:159], v[188:191]
    s_waitcnt lgkmcnt(0)
    v_mfma_f32_16x16x32_bf16 v[192:195], v[244:247], v[152:155], v[192:195]
    v_mfma_f32_16x16x32_bf16 v[196:199], v[244:247], v[156:159], v[196:199]
    s_nop 4
    v_mul_u32_u24 v255, 12, v1
    s_lshl_b32 s6, s5, 7
    s_add_u32 s6, s6, s58
    s_mul_i32 s62, s6, 1536
    s_add_u32 s63, s62, 98304
    s_mul_i32 s64, s6, 2688
    s_add_u32 s65, s64, 172032
    s_mov_b32 s60, -1
    s_mov_b32 s61, 0
    v_cvt_pk_bf16_f32 v248, v192, v193
    v_cvt_pk_bf16_f32 v249, v194, v195
    v_cvt_pk_bf16_f32 v250, v196, v197
    v_cvt_pk_bf16_f32 v251, v198, v199
    v_cvt_pk_bf16_f32 v160, v160, v161
    v_cvt_pk_bf16_f32 v161, v162, v163
    v_mov_b32 v162, 0
    v_cndmask_b32 v163, 0, v248, s[60:61]
    v_cvt_pk_bf16_f32 v164, v164, v165
    v_cvt_pk_bf16_f32 v165, v166, v167
    v_mov_b32 v166, 0
    v_cndmask_b32 v167, 0, v250, s[60:61]
    v_cvt_pk_bf16_f32 v168, v168, v169
    v_cvt_pk_bf16_f32 v169, v170, v171
    v_mov_b32 v170, 0
    v_cndmask_b32 v171, 0, v249, s[60:61]
    v_cvt_pk_bf16_f32 v172, v172, v173
    v_cvt_pk_bf16_f32 v173, v174, v175
    v_mov_b32 v174, 0
    v_cndmask_b32 v175, 0, v251, s[60:61]
    v_cvt_pk_bf16_f32 v176, v176, v177
    v_cvt_pk_bf16_f32 v177, v178, v179
    v_mov_b32 v178, v248
    v_cvt_pk_bf16_f32 v180, v180, v181
    v_cvt_pk_bf16_f32 v181, v182, v183
    v_mov_b32 v182, v250
    v_cvt_pk_bf16_f32 v184, v184, v185
    v_cvt_pk_bf16_f32 v185, v186, v187
    v_mov_b32 v186, v249
    v_cvt_pk_bf16_f32 v188, v188, v189
    v_cvt_pk_bf16_f32 v189, v190, v191
    v_mov_b32 v190, v251
    v_permlane16_swap_b32 v162, v163
    v_permlane16_swap_b32 v170, v171
    v_permlane16_swap_b32 v166, v167
    v_permlane16_swap_b32 v174, v175
    buffer_store_dwordx3 v[176:178], v255, s[32:35], s64 offen offset:0
    buffer_store_dwordx3 v[180:182], v255, s[32:35], s64 offen offset:768
    buffer_store_dwordx3 v[184:186], v255, s[32:35], s65 offen offset:0
    buffer_store_dwordx3 v[188:190], v255, s[32:35], s65 offen offset:768
    buffer_store_dwordx3 v[160:162], v255, s[28:31], s62 offen offset:0
    buffer_store_dwordx3 v[164:166], v255, s[28:31], s62 offen offset:768
    buffer_store_dwordx3 v[168:170], v255, s[28:31], s63 offen offset:0
    buffer_store_dwordx3 v[172:174], v255, s[28:31], s63 offen offset:768
    s_endpgm
g1_pathB:
    s_lshl_b32 s6, s4, 4
    s_and_b32 s7, s3, 6
    s_lshl_b32 s7, s7, 1
    s_add_u32 s6, s6, s7
    s_and_b32 s7, s3, 1
    s_add_u32 s6, s6, s7
    s_mul_i32 s6, s6, 9216
    s_add_u32 s7, s6, 4608
    s_waitcnt lgkmcnt(0)
    s_and_b32 s9, s9, 0xffff
    s_mov_b32 s10, 2359296
    s_mov_b32 s11, 0x00020000
    buffer_load_dwordx4 v[16:19], v0, s[8:11], s6 offen offset:0
    buffer_load_dwordx4 v[20:23], v0, s[8:11], s7 offen offset:0
    buffer_load_dwordx4 v[32:35], v0, s[8:11], s6 offen offset:128
    buffer_load_dwordx4 v[36:39], v0, s[8:11], s7 offen offset:128
    buffer_load_dwordx4 v[48:51], v0, s[8:11], s6 offen offset:256
    buffer_load_dwordx4 v[52:55], v0, s[8:11], s7 offen offset:256
    buffer_load_dwordx4 v[64:67], v0, s[8:11], s6 offen offset:384
    buffer_load_dwordx4 v[68:71], v0, s[8:11], s7 offen offset:384
    buffer_load_dwordx4 v[80:83], v0, s[8:11], s6 offen offset:512
    buffer_load_dwordx4 v[84:87], v0, s[8:11], s7 offen offset:512
    buffer_load_dwordx4 v[96:99], v0, s[8:11], s6 offen offset:640
    buffer_load_dwordx4 v[100:103], v0, s[8:11], s7 offen offset:640
    buffer_load_dwordx4 v[112:115], v0, s[8:11], s6 offen offset:768
    buffer_load_dwordx4 v[116:119], v0, s[8:11], s7 offen offset:768
    buffer_load_dwordx4 v[128:131], v0, s[8:11], s6 offen offset:896
    buffer_load_dwordx4 v[132:135], v0, s[8:11], s7 offen offset:896
    buffer_load_dwordx4 v[144:147], v0, s[8:11], s6 offen offset:1024
    buffer_load_dwordx4 v[148:151], v0, s[8:11], s7 offen offset:1024
    s_lshl_b32 s67, s2, 2
    s_add_u32 s67, s67, s44
    s_sub_u32 s64, s67, 512
    s_cmp_ge_u32 s67, 736
    s_cselect_b32 s64, s64, s67
    s_mul_i32 s62, s64, 2850
    s_lshr_b32 s62, s62, 16
    s_mul_i32 s63, s62, 23
    s_sub_u32 s63, s64, s63
    s_lshr_b32 s64, s62, 2
    s_and_b32 s62, s62, 3
    s_sub_u32 s49, s63, 1
    s_lshr_b32 s65, s49, 2
    s_mul_i32 s65, s65, 144
    s_and_b32 s49, s49, 3
    s_lshl_b32 s49, s49, 5
    s_add_u32 s49, s49, s65
    s_mul_i32 s65, s62, 576
    s_add_u32 s49, s49, s65
    s_mov_b32 s51, 16
    s_mov_b32 s59, 4
    s_sub_u32 s66, s63, 17
    s_mul_i32 s66, s66, 288
    s_add_u32 s66, s66, s65
    s_add_u32 s66, s66, 128
    s_cmp_ge_u32 s63, 17
    s_cselect_b32 s49, s66, s49
    s_cselect_b32 s51, 144, s51
    s_sub_u32 s66, s63, 19
    s_mul_i32 s66, s66, 36
    s_mul_i32 s65, s62, 144
    s_add_u32 s66, s66, s65
    s_cmp_ge_u32 s63, 19
    s_cselect_b32 s49, s66, s49
    s_cselect_b32 s51, 20, s51
    s_cselect_b32 s65, 1, 0
    s_and_b32 s66, s62, 1
    s_mul_i32 s66, s66, 288
    s_add_u32 s66, s66, 16
    s_cmp_eq_u32 s63, 0
    s_cselect_b32 s49, s66, s49
    s_cselect_b32 s51, 36, s51
    s_cselect_b32 s59, 72, s59
    s_cselect_b32 s65, 1, s65
    s_mov_b32 s100, s65
    s_mul_i32 s49, s49, 1152
    s_mul_i32 s66, s64, 144
    s_add_u32 s49, s49, s66
    s_mul_i32 s51, s51, 1152
    s_mul_i32 s59, s59, 1152
    s_and_b32 s13, s13, 0xffff
    s_mov_b32 s14, 5308416
    s_mov_b32 s15, 0x00020000
    s_and_b32 s17, s17, 0xffff
    s_mov_b32 s18, 1990656
    s_mov_b32 s19, 0x00020000
    s_and_b32 s41, s41, 0xffff
    s_mov_b32 s42, 256
    s_mov_b32 s43, 0x00020000
    s_mov_b64 s[24:25], s[20:21]
    s_mov_b64 s[28:29], s[20:21]
    s_mov_b64 s[32:33], s[20:21]
    s_mov_b64 s[36:37], s[20:21]
    s_mov_b64 s[72:73], s[20:21]
    s_add_u32 s72, s72, 56623104
    s_addc_u32 s73, s73, 0
    s_and_b32 s73, s73, 0xffff
    s_mov_b32 s74, 3391488
    s_mov_b32 s75, 0x00020000
    s_and_b32 s77, s77, 0xffff
    s_mov_b32 s78, 8388608
    s_mov_b32 s79, 0x00020000
    s_cmp_eq_u32 s100, 1
    s_cselect_b32 s68, s60, s68
    s_cselect_b32 s69, s61, s69
    s_mov_b32 s70, 2654208
    s_cselect_b32 s70, 663552, s70
    s_and_b32 s69, s69, 0xffff
    s_mov_b32 s71, 0x00020000
    s_add_u32 s20, s20, 10485760
    s_addc_u32 s21, s21, 0
    s_and_b32 s21, s21, 0xffff
    s_mov_b32 s22, 9437184
    s_mov_b32 s23, 0x00020000
    s_add_u32 s24, s24, 20971520
    s_addc_u32 s25, s25, 0
    s_and_b32 s25, s25, 0xffff
    s_mov_b32 s26, 9437184
    s_mov_b32 s27, 0x00020000
    s_add_u32 s28, s28, 42991616
    s_addc_u32 s29, s29, 0
    s_and_b32 s29, s29, 0xffff
    s_mov_b32 s30, 3145728
    s_mov_b32 s31, 0x00020000
    s_add_u32 s32, s32, 47185920
    s_addc_u32 s33, s33, 0
    s_and_b32 s33, s33, 0xffff
    s_mov_b32 s34, 5505024
    s_mov_b32 s35, 0x00020000
    s_add_u32 s36, s36, 41943040
    s_addc_u32 s37, s37, 0
    s_and_b32 s37, s37, 0xffff
    s_mov_b32 s38, 524288
    s_mov_b32 s39, 0x00020000
    s_mul_i32 s6, s44, 160
    s_add_u32 s6, s6, 512
    s_lshl_b32 s46, s6, 4
    s_cmp_eq_u32 s5, 99
    s_cselect_b32 s7, 5, 4
    v_add_u32 v248, s6, v1
    v_add_u32 v248, 0, v248
    v_mul_u32_u24 v249, 3641, v248
    v_lshrrev_b32 v249, 16, v249
    v_mul_u32_u24 v250, 18, v249
    v_sub_u32 v250, v248, v250
    v_and_b32 v251, 0x23, v249
    v_and_b32 v252, 12, v249
    v_lshl_or_b32 v251, v252, 1, v251
    v_and_b32 v252, 16, v249
    v_lshrrev_b32 v252, 2, v252
    v_or_b32 v251, v251, v252
    v_mul_u32_u24 v7, 9216, v251
    v_lshl_add_u32 v7, v250, 4, v7
    v_mul_u32_u24 v10, 3456, v251
    v_mul_u32_u24 v252, 43, v250
    v_lshrrev_b32 v252, 8, v252
    v_mul_u32_u24 v253, 6, v252
    v_sub_u32 v253, v250, v253
    v_min_u32 v253, s7, v253
    v_mul_u32_u24 v252, 1152, v252
    v_lshl_add_u32 v252, v253, 4, v252
    v_add_u32 v10, v10, v252
    v_add_u32 v248, s6, v1
    v_add_u32 v248, 64, v248
    v_mul_u32_u24 v249, 3641, v248
    v_lshrrev_b32 v249, 16, v249
    v_mul_u32_u24 v250, 18, v249
    v_sub_u32 v250, v248, v250
    v_and_b32 v251, 0x23, v249
    v_and_b32 v252, 12, v249
    v_lshl_or_b32 v251, v252, 1, v251
    v_and_b32 v252, 16, v249
    v_lshrrev_b32 v252, 2, v252
    v_or_b32 v251, v251, v252
    v_mul_u32_u24 v8, 9216, v251
    v_lshl_add_u32 v8, v250, 4, v8
    v_mul_u32_u24 v11, 3456, v251
    v_mul_u32_u24 v252, 43, v250
    v_lshrrev_b32 v252, 8, v252
    v_mul_u32_u24 v253, 6, v252
    v_sub_u32 v253, v250, v253
    v_min_u32 v253, s7, v253
    v_mul_u32_u24 v252, 1152, v252
    v_lshl_add_u32 v252, v253, 4, v252
    v_add_u32 v11, v11, v252
    v_subrev_u32 v8, 1024, v8
    v_subrev_u32 v11, 1024, v11
    v_add_u32 v248, s6, v1
    v_add_u32 v248, 128, v248
    v_mul_u32_u24 v249, 3641, v248
    v_lshrrev_b32 v249, 16, v249
    v_mul_u32_u24 v250, 18, v249
    v_sub_u32 v250, v248, v250
    v_and_b32 v251, 0x23, v249
    v_and_b32 v252, 12, v249
    v_lshl_or_b32 v251, v252, 1, v251
    v_and_b32 v252, 16, v249
    v_lshrrev_b32 v252, 2, v252
    v_or_b32 v251, v251, v252
    v_mul_u32_u24 v9, 9216, v251
    v_lshl_add_u32 v9, v250, 4, v9
    v_mul_u32_u24 v12, 3456, v251
    v_mul_u32_u24 v252, 43, v250
    v_lshrrev_b32 v252, 8, v252
    v_mul_u32_u24 v253, 6, v252
    v_sub_u32 v253, v250, v253
    v_min_u32 v253, s7, v253
    v_mul_u32_u24 v252, 1152, v252
    v_lshl_add_u32 v252, v253, 4, v252
    v_add_u32 v12, v12, v252
    v_subrev_u32 v9, 2048, v9
    v_subrev_u32 v12, 2048, v12
    v_add_u32 v232, 0, v1
    v_mul_u32_u24 v233, 7282, v232
    v_lshrrev_b32 v233, 16, v233
    v_mul_u32_u24 v234, 9, v233
    v_sub_u32 v234, v232, v234
    v_lshlrev_b32 v234, 4, v234
    v_and_b32 v232, 3, v233
    v_mul_u32_u24 v232, 1152, v232
    v_add_u32 v234, v234, v232
    v_bfe_u32 v232, v233, 2, 2
    v_mul_u32_u24 v232, s59, v232
    v_add_u32 v234, v234, v232
    v_bfe_u32 v232, v233, 4, 1
    v_mul_u32_u24 v232, s51, v232
    v_add_u32 v172, v234, v232
    v_add_u32 v232, 64, v1
    v_mul_u32_u24 v233, 7282, v232
    v_lshrrev_b32 v233, 16, v233
    v_mul_u32_u24 v234, 9, v233
    v_sub_u32 v234, v232, v234
    v_lshlrev_b32 v234, 4, v234
    v_and_b32 v232, 3, v233
    v_mul_u32_u24 v232, 1152, v232
    v_add_u32 v234, v234, v232
    v_bfe_u32 v232, v233, 2, 2
    v_mul_u32_u24 v232, s59, v232
    v_add_u32 v234, v234, v232
    v_bfe_u32 v232, v233, 4, 1
    v_mul_u32_u24 v232, s51, v232
    v_add_u32 v176, v234, v232
    v_add_u32 v232, 128, v1
    v_mul_u32_u24 v233, 7282, v232
    v_lshrrev_b32 v233, 16, v233
    v_mul_u32_u24 v234, 9, v233
    v_sub_u32 v234, v232, v234
    v_lshlrev_b32 v234, 4, v234
    v_and_b32 v232, 3, v233
    v_mul_u32_u24 v232, 1152, v232
    v_add_u32 v234, v234, v232
    v_bfe_u32 v232, v233, 2, 2
    v_mul_u32_u24 v232, s59, v232
    v_add_u32 v234, v234, v232
    v_bfe_u32 v232, v233, 4, 1
    v_mul_u32_u24 v232, s51, v232
    v_add_u32 v180, v234, v232
    v_add_u32 v232, 192, v1
    v_mul_u32_u24 v233, 7282, v232
    v_lshrrev_b32 v233, 16, v233
    v_mul_u32_u24 v234, 9, v233
    v_sub_u32 v234, v232, v234
    v_lshlrev_b32 v234, 4, v234
    v_and_b32 v232, 3, v233
    v_mul_u32_u24 v232, 1152, v232
    v_add_u32 v234, v234, v232
    v_bfe_u32 v232, v233, 2, 2
    v_mul_u32_u24 v232, s59, v232
    v_add_u32 v234, v234, v232
    v_bfe_u32 v232, v233, 4, 1
    v_mul_u32_u24 v232, s51, v232
    v_add_u32 v184, v234, v232
    v_add_u32 v232, 256, v1
    v_mul_u32_u24 v233, 7282, v232
    v_lshrrev_b32 v233, 16, v233
    v_mul_u32_u24 v234, 9, v233
    v_sub_u32 v234, v232, v234
    v_lshlrev_b32 v234, 4, v234
    v_and_b32 v232, 3, v233
    v_mul_u32_u24 v232, 1152, v232
    v_add_u32 v234, v234, v232
    v_bfe_u32 v232, v233, 2, 2
    v_mul_u32_u24 v232, s59, v232
    v_add_u32 v234, v234, v232
    v_bfe_u32 v232, v233, 4, 1
    v_mul_u32_u24 v232, s51, v232
    v_add_u32 v188, v234, v232
    v_lshrrev_b32 v248, 4, v1
    v_and_b32 v249, 7, v1
    v_and_or_b32 v250, v1, 8, v248
    s_and_b32 s6, s3, 1
    s_lshl_b32 s6, s6, 2
    v_or_b32 v250, s6, v250
    v_xor_b32 v250, v250, v249
    v_lshlrev_b32 v250, 4, v250
    v_lshl_add_u32 v250, v249, 8, v250
    s_lshr_b32 s6, s3, 1
    s_lshl_b32 s6, s6, 12
    s_add_u32 s6, s6, 110592
    v_add_u32 v160, s6, v250
    v_subrev_u32 v161, 36864, v160
    v_lshrrev_b32 v248, 4, v1
    v_and_b32 v249, 15, v1
    v_xor_b32 v249, v249, v248
    v_lshlrev_b32 v249, 4, v249
    v_lshl_add_u32 v249, v248, 8, v249
    s_lshl_b32 s6, s44, 12
    s_add_u32 s6, s6, 110592
    v_add_u32 v162, s6, v249
    v_xor_b32 v163, 64, v162
    v_subrev_u32 v165, 36864, v162
    v_subrev_u32 v167, 36864, v163
    v_lshrrev_b32 v248, 2, v1
    v_mul_u32_u24 v248, 288, v248
    v_and_b32 v249, 3, v1
    v_lshl_add_u32 v3, v249, 3, v248
    v_add_u32 v4, 55296, v3
    s_add_u32 s6, s57, 224
    v_add_u32 v5, s6, v248
    v_add_u32 v6, 55296, v5
    s_mul_i32 s6, s44, 9216
    s_add_u32 s6, s6, 115712
    v_lshlrev_b32 v13, 2, v1
    v_add_u32 v13, s6, v13
    v_lshrrev_b32 v192, 2, v1
    v_mul_u32_u24 v192, 144, v192
    s_mul_i32 s6, s44, 4608
    s_add_u32 s6, s6, 110592
    v_add_u32 v192, s6, v192
    v_and_b32 v193, 1, v1
    v_lshl_add_u32 v193, v193, 3, v192
    v_and_b32 v194, 3, v1
    v_lshl_add_u32 v192, v194, 4, v192
    v_lshrrev_b32 v194, 4, v1
    v_lshlrev_b32 v194, 3, v194
    v_and_b32 v195, 7, v1
    v_add_u32 v194, v194, v195
    v_lshlrev_b32 v194, 4, v194
    s_waitcnt vmcnt(16)
    v_dot2_f32_bf16 v244, v16, s50, 0
    v_dot2_f32_bf16 v246, v16, v16, 0
    v_dot2_f32_bf16 v245, v20, s50, 0
    v_dot2_f32_bf16 v247, v20, v20, 0
    v_dot2_f32_bf16 v244, v17, s50, v244
    v_dot2_f32_bf16 v246, v17, v17, v246
    v_dot2_f32_bf16 v245, v21, s50, v245
    v_dot2_f32_bf16 v247, v21, v21, v247
    v_dot2_f32_bf16 v244, v18, s50, v244
    v_dot2_f32_bf16 v246, v18, v18, v246
    v_dot2_f32_bf16 v245, v22, s50, v245
    v_dot2_f32_bf16 v247, v22, v22, v247
    v_dot2_f32_bf16 v244, v19, s50, v244
    v_dot2_f32_bf16 v246, v19, v19, v246
    v_dot2_f32_bf16 v245, v23, s50, v245
    v_dot2_f32_bf16 v247, v23, v23, v247
    s_waitcnt vmcnt(14)
    v_dot2_f32_bf16 v244, v32, s50, v244
    v_dot2_f32_bf16 v246, v32, v32, v246
    v_dot2_f32_bf16 v245, v36, s50, v245
    v_dot2_f32_bf16 v247, v36, v36, v247
    v_dot2_f32_bf16 v244, v33, s50, v244
    v_dot2_f32_bf16 v246, v33, v33, v246
    v_dot2_f32_bf16 v245, v37, s50, v245
    v_dot2_f32_bf16 v247, v37, v37, v247
    v_dot2_f32_bf16 v244, v34, s50, v244
    v_dot2_f32_bf16 v246, v34, v34, v246
    v_dot2_f32_bf16 v245, v38, s50, v245
    v_dot2_f32_bf16 v247, v38, v38, v247
    v_dot2_f32_bf16 v244, v35, s50, v244
    v_dot2_f32_bf16 v246, v35, v35, v246
    v_dot2_f32_bf16 v245, v39, s50, v245
    v_dot2_f32_bf16 v247, v39, v39, v247
    s_waitcnt vmcnt(12)
    v_dot2_f32_bf16 v244, v48, s50, v244
    v_dot2_f32_bf16 v246, v48, v48, v246
    v_dot2_f32_bf16 v245, v52, s50, v245
    v_dot2_f32_bf16 v247, v52, v52, v247
    v_dot2_f32_bf16 v244, v49, s50, v244
    v_dot2_f32_bf16 v246, v49, v49, v246
    v_dot2_f32_bf16 v245, v53, s50, v245
    v_dot2_f32_bf16 v247, v53, v53, v247
    v_dot2_f32_bf16 v244, v50, s50, v244
    v_dot2_f32_bf16 v246, v50, v50, v246
    v_dot2_f32_bf16 v245, v54, s50, v245
    v_dot2_f32_bf16 v247, v54, v54, v247
    v_dot2_f32_bf16 v244, v51, s50, v244
    v_dot2_f32_bf16 v246, v51, v51, v246
    v_dot2_f32_bf16 v245, v55, s50, v245
    v_dot2_f32_bf16 v247, v55, v55, v247
    s_waitcnt vmcnt(10)
    v_dot2_f32_bf16 v244, v64, s50, v244
    v_dot2_f32_bf16 v246, v64, v64, v246
    v_dot2_f32_bf16 v245, v68, s50, v245
    v_dot2_f32_bf16 v247, v68, v68, v247
    v_dot2_f32_bf16 v244, v65, s50, v244
    v_dot2_f32_bf16 v246, v65, v65, v246
    v_dot2_f32_bf16 v245, v69, s50, v245
    v_dot2_f32_bf16 v247, v69, v69, v247
    v_dot2_f32_bf16 v244, v66, s50, v244
    v_dot2_f32_bf16 v246, v66, v66, v246
    v_dot2_f32_bf16 v245, v70, s50, v245
    v_dot2_f32_bf16 v247, v70, v70, v247
    v_dot2_f32_bf16 v244, v67, s50, v244
    v_dot2_f32_bf16 v246, v67, v67, v246
    v_dot2_f32_bf16 v245, v71, s50, v245
    v_dot2_f32_bf16 v247, v71, v71, v247
    s_waitcnt vmcnt(8)
    v_dot2_f32_bf16 v244, v80, s50, v244
    v_dot2_f32_bf16 v246, v80, v80, v246
    v_dot2_f32_bf16 v245, v84, s50, v245
    v_dot2_f32_bf16 v247, v84, v84, v247
    v_dot2_f32_bf16 v244, v81, s50, v244
    v_dot2_f32_bf16 v246, v81, v81, v246
    v_dot2_f32_bf16 v245, v85, s50, v245
    v_dot2_f32_bf16 v247, v85, v85, v247
    v_dot2_f32_bf16 v244, v82, s50, v244
    v_dot2_f32_bf16 v246, v82, v82, v246
    v_dot2_f32_bf16 v245, v86, s50, v245
    v_dot2_f32_bf16 v247, v86, v86, v247
    v_dot2_f32_bf16 v244, v83, s50, v244
    v_dot2_f32_bf16 v246, v83, v83, v246
    v_dot2_f32_bf16 v245, v87, s50, v245
    v_dot2_f32_bf16 v247, v87, v87, v247
    s_waitcnt vmcnt(6)
    v_dot2_f32_bf16 v244, v96, s50, v244
    v_dot2_f32_bf16 v246, v96, v96, v246
    v_dot2_f32_bf16 v245, v100, s50, v245
    v_dot2_f32_bf16 v247, v100, v100, v247
    v_dot2_f32_bf16 v244, v97, s50, v244
    v_dot2_f32_bf16 v246, v97, v97, v246
    v_dot2_f32_bf16 v245, v101, s50, v245
    v_dot2_f32_bf16 v247, v101, v101, v247
    v_dot2_f32_bf16 v244, v98, s50, v244
    v_dot2_f32_bf16 v246, v98, v98, v246
    v_dot2_f32_bf16 v245, v102, s50, v245
    v_dot2_f32_bf16 v247, v102, v102, v247
    v_dot2_f32_bf16 v244, v99, s50, v244
    v_dot2_f32_bf16 v246, v99, v99, v246
    v_dot2_f32_bf16 v245, v103, s50, v245
    v_dot2_f32_bf16 v247, v103, v103, v247
    s_waitcnt vmcnt(4)
    v_dot2_f32_bf16 v244, v112, s50, v244
    v_dot2_f32_bf16 v246, v112, v112, v246
    v_dot2_f32_bf16 v245, v116, s50, v245
    v_dot2_f32_bf16 v247, v116, v116, v247
    v_dot2_f32_bf16 v244, v113, s50, v244
    v_dot2_f32_bf16 v246, v113, v113, v246
    v_dot2_f32_bf16 v245, v117, s50, v245
    v_dot2_f32_bf16 v247, v117, v117, v247
    v_dot2_f32_bf16 v244, v114, s50, v244
    v_dot2_f32_bf16 v246, v114, v114, v246
    v_dot2_f32_bf16 v245, v118, s50, v245
    v_dot2_f32_bf16 v247, v118, v118, v247
    v_dot2_f32_bf16 v244, v115, s50, v244
    v_dot2_f32_bf16 v246, v115, v115, v246
    v_dot2_f32_bf16 v245, v119, s50, v245
    v_dot2_f32_bf16 v247, v119, v119, v247
    s_waitcnt vmcnt(2)
    v_dot2_f32_bf16 v244, v128, s50, v244
    v_dot2_f32_bf16 v246, v128, v128, v246
    v_dot2_f32_bf16 v245, v132, s50, v245
    v_dot2_f32_bf16 v247, v132, v132, v247
    v_dot2_f32_bf16 v244, v129, s50, v244
    v_dot2_f32_bf16 v246, v129, v129, v246
    v_dot2_f32_bf16 v245, v133, s50, v245
    v_dot2_f32_bf16 v247, v133, v133, v247
    v_dot2_f32_bf16 v244, v130, s50, v244
    v_dot2_f32_bf16 v246, v130, v130, v246
    v_dot2_f32_bf16 v245, v134, s50, v245
    v_dot2_f32_bf16 v247, v134, v134, v247
    v_dot2_f32_bf16 v244, v131, s50, v244
    v_dot2_f32_bf16 v246, v131, v131, v246
    v_dot2_f32_bf16 v245, v135, s50, v245
    v_dot2_f32_bf16 v247, v135, v135, v247
    s_waitcnt vmcnt(0)
    v_dot2_f32_bf16 v244, v144, s50, v244
    v_dot2_f32_bf16 v246, v144, v144, v246
    v_dot2_f32_bf16 v245, v148, s50, v245
    v_dot2_f32_bf16 v247, v148, v148, v247
    v_dot2_f32_bf16 v244, v145, s50, v244
    v_dot2_f32_bf16 v246, v145, v145, v246
    v_dot2_f32_bf16 v245, v149, s50, v245
    v_dot2_f32_bf16 v247, v149, v149, v247
    v_dot2_f32_bf16 v244, v146, s50, v244
    v_dot2_f32_bf16 v246, v146, v146, v246
    v_dot2_f32_bf16 v245, v150, s50, v245
    v_dot2_f32_bf16 v247, v150, v150, v247
    v_dot2_f32_bf16 v244, v147, s50, v244
    v_dot2_f32_bf16 v246, v147, v147, v246
    v_dot2_f32_bf16 v245, v151, s50, v245
    v_dot2_f32_bf16 v247, v151, v151, v247
    s_add_u32 s45, s55, 0
    s_add_u32 m0, s46, 0
    s_nop 0
    buffer_load_dwordx4 v7, s[12:15], s45 offen offset:0 lds
    s_nop 0
    buffer_load_dwordx4 v8, s[12:15], s45 offen offset:1024 lds
    s_mov_b32 exec_hi, 0
    buffer_load_dwordx4 v9, s[12:15], s45 offen offset:2048 lds
    s_mov_b32 exec_hi, -1
    s_nop 2
    v_add_f32_dpp v244, v244, v244 quad_perm:[1,0,3,2] row_mask:0xf bank_mask:0xf
    v_add_f32_dpp v245, v245, v245 quad_perm:[1,0,3,2] row_mask:0xf bank_mask:0xf
    v_add_f32_dpp v246, v246, v246 quad_perm:[1,0,3,2] row_mask:0xf bank_mask:0xf
    v_add_f32_dpp v247, v247, v247 quad_perm:[1,0,3,2] row_mask:0xf bank_mask:0xf
    v_add_f32_dpp v244, v244, v244 quad_perm:[2,3,0,1] row_mask:0xf bank_mask:0xf
    v_add_f32_dpp v245, v245, v245 quad_perm:[2,3,0,1] row_mask:0xf bank_mask:0xf
    v_add_f32_dpp v246, v246, v246 quad_perm:[2,3,0,1] row_mask:0xf bank_mask:0xf
    v_add_f32_dpp v247, v247, v247 quad_perm:[2,3,0,1] row_mask:0xf bank_mask:0xf
    v_add_f32_dpp v244, v244, v244 row_half_mirror row_mask:0xf bank_mask:0xf
    v_add_f32_dpp v245, v245, v245 row_half_mirror row_mask:0xf bank_mask:0xf
    v_add_f32_dpp v246, v246, v246 row_half_mirror row_mask:0xf bank_mask:0xf
    v_add_f32_dpp v247, v247, v247 row_half_mirror row_mask:0xf bank_mask:0xf
    v_mul_f32 v244, 0x3ae38e39, v244
    v_mul_f32 v246, 0x3ae38e39, v246
    v_mul_f32 v245, 0x3ae38e39, v245
    v_mul_f32 v247, 0x3ae38e39, v247
    v_fma_f32 v246, -v244, v244, v246
    v_fma_f32 v247, -v245, v245, v247
    v_add_f32 v246, 0x3727c5ac, v246
    v_add_f32 v247, 0x3727c5ac, v247
    v_rsq_f32 v164, v246
    v_rsq_f32 v168, v247
    s_nop 0
    v_mul_f32 v166, v244, v164
    v_mul_f32 v170, v245, v168
    v_lshlrev_b32 v248, 16, v16
    v_and_b32 v249, 0xffff0000, v16
    v_lshlrev_b32 v250, 16, v17
    v_and_b32 v251, 0xffff0000, v17
    v_lshlrev_b32 v252, 16, v18
    v_and_b32 v253, 0xffff0000, v18
    v_lshlrev_b32 v254, 16, v19
    v_and_b32 v255, 0xffff0000, v19
    v_pk_fma_f32 v[248:249], v[248:249], v[164:165], v[166:167] op_sel_hi:[1,0,0] neg_lo:[0,0,1] neg_hi:[0,0,1]
    v_pk_fma_f32 v[250:251], v[250:251], v[164:165], v[166:167] op_sel_hi:[1,0,0] neg_lo:[0,0,1] neg_hi:[0,0,1]
    v_pk_fma_f32 v[252:253], v[252:253], v[164:165], v[166:167] op_sel_hi:[1,0,0] neg_lo:[0,0,1] neg_hi:[0,0,1]
    v_pk_fma_f32 v[254:255], v[254:255], v[164:165], v[166:167] op_sel_hi:[1,0,0] neg_lo:[0,0,1] neg_hi:[0,0,1]
    v_cvt_pk_bf16_f32 v16, v248, v249
    v_cvt_pk_bf16_f32 v17, v250, v251
    v_cvt_pk_bf16_f32 v18, v252, v253
    v_cvt_pk_bf16_f32 v19, v254, v255
    ds_write_b128 v161, v[16:19] offset:0
    v_lshlrev_b32 v248, 16, v20
    v_and_b32 v249, 0xffff0000, v20
    v_lshlrev_b32 v250, 16, v21
    v_and_b32 v251, 0xffff0000, v21
    v_lshlrev_b32 v252, 16, v22
    v_and_b32 v253, 0xffff0000, v22
    v_lshlrev_b32 v254, 16, v23
    v_and_b32 v255, 0xffff0000, v23
    v_pk_fma_f32 v[248:249], v[248:249], v[168:169], v[170:171] op_sel_hi:[1,0,0] neg_lo:[0,0,1] neg_hi:[0,0,1]
    v_pk_fma_f32 v[250:251], v[250:251], v[168:169], v[170:171] op_sel_hi:[1,0,0] neg_lo:[0,0,1] neg_hi:[0,0,1]
    v_pk_fma_f32 v[252:253], v[252:253], v[168:169], v[170:171] op_sel_hi:[1,0,0] neg_lo:[0,0,1] neg_hi:[0,0,1]
    v_pk_fma_f32 v[254:255], v[254:255], v[168:169], v[170:171] op_sel_hi:[1,0,0] neg_lo:[0,0,1] neg_hi:[0,0,1]
    v_cvt_pk_bf16_f32 v20, v248, v249
    v_cvt_pk_bf16_f32 v21, v250, v251
    v_cvt_pk_bf16_f32 v22, v252, v253
    v_cvt_pk_bf16_f32 v23, v254, v255
    ds_write_b128 v161, v[20:23] offset:2048
    s_add_u32 s45, s55, 589824
    s_add_u32 m0, s46, 18432
    s_nop 0
    buffer_load_dwordx4 v7, s[12:15], s45 offen offset:0 lds
    s_nop 0
    buffer_load_dwordx4 v8, s[12:15], s45 offen offset:1024 lds
    s_mov_b32 exec_hi, 0
    buffer_load_dwordx4 v9, s[12:15], s45 offen offset:2048 lds
    s_mov_b32 exec_hi, -1
    v_lshlrev_b32 v248, 16, v32
    v_and_b32 v249, 0xffff0000, v32
    v_lshlrev_b32 v250, 16, v33
    v_and_b32 v251, 0xffff0000, v33
    v_lshlrev_b32 v252, 16, v34
    v_and_b32 v253, 0xffff0000, v34
    v_lshlrev_b32 v254, 16, v35
    v_and_b32 v255, 0xffff0000, v35
    v_pk_fma_f32 v[248:249], v[248:249], v[164:165], v[166:167] op_sel_hi:[1,0,0] neg_lo:[0,0,1] neg_hi:[0,0,1]
    v_pk_fma_f32 v[250:251], v[250:251], v[164:165], v[166:167] op_sel_hi:[1,0,0] neg_lo:[0,0,1] neg_hi:[0,0,1]
    v_pk_fma_f32 v[252:253], v[252:253], v[164:165], v[166:167] op_sel_hi:[1,0,0] neg_lo:[0,0,1] neg_hi:[0,0,1]
    v_pk_fma_f32 v[254:255], v[254:255], v[164:165], v[166:167] op_sel_hi:[1,0,0] neg_lo:[0,0,1] neg_hi:[0,0,1]
    v_cvt_pk_bf16_f32 v32, v248, v249
    v_cvt_pk_bf16_f32 v33, v250, v251
    v_cvt_pk_bf16_f32 v34, v252, v253
    v_cvt_pk_bf16_f32 v35, v254, v255
    ds_write_b128 v161, v[32:35] offset:18432
    v_lshlrev_b32 v248, 16, v36
    v_and_b32 v249, 0xffff0000, v36
    v_lshlrev_b32 v250, 16, v37
    v_and_b32 v251, 0xffff0000, v37
    v_lshlrev_b32 v252, 16, v38
    v_and_b32 v253, 0xffff0000, v38
    v_lshlrev_b32 v254, 16, v39
    v_and_b32 v255, 0xffff0000, v39
    v_pk_fma_f32 v[248:249], v[248:249], v[168:169], v[170:171] op_sel_hi:[1,0,0] neg_lo:[0,0,1] neg_hi:[0,0,1]
    v_pk_fma_f32 v[250:251], v[250:251], v[168:169], v[170:171] op_sel_hi:[1,0,0] neg_lo:[0,0,1] neg_hi:[0,0,1]
    v_pk_fma_f32 v[252:253], v[252:253], v[168:169], v[170:171] op_sel_hi:[1,0,0] neg_lo:[0,0,1] neg_hi:[0,0,1]
    v_pk_fma_f32 v[254:255], v[254:255], v[168:169], v[170:171] op_sel_hi:[1,0,0] neg_lo:[0,0,1] neg_hi:[0,0,1]
    v_cvt_pk_bf16_f32 v36, v248, v249
    v_cvt_pk_bf16_f32 v37, v250, v251
    v_cvt_pk_bf16_f32 v38, v252, v253
    v_cvt_pk_bf16_f32 v39, v254, v255
    ds_write_b128 v161, v[36:39] offset:20480
    s_add_u32 s45, s55, 1179648
    s_add_u32 m0, s46, 36864
    s_nop 0
    buffer_load_dwordx4 v7, s[12:15], s45 offen offset:0 lds
    s_nop 0
    buffer_load_dwordx4 v8, s[12:15], s45 offen offset:1024 lds
    s_mov_b32 exec_hi, 0
    buffer_load_dwordx4 v9, s[12:15], s45 offen offset:2048 lds
    s_mov_b32 exec_hi, -1
    v_lshlrev_b32 v248, 16, v48
    v_and_b32 v249, 0xffff0000, v48
    v_lshlrev_b32 v250, 16, v49
    v_and_b32 v251, 0xffff0000, v49
    v_lshlrev_b32 v252, 16, v50
    v_and_b32 v253, 0xffff0000, v50
    v_lshlrev_b32 v254, 16, v51
    v_and_b32 v255, 0xffff0000, v51
    v_pk_fma_f32 v[248:249], v[248:249], v[164:165], v[166:167] op_sel_hi:[1,0,0] neg_lo:[0,0,1] neg_hi:[0,0,1]
    v_pk_fma_f32 v[250:251], v[250:251], v[164:165], v[166:167] op_sel_hi:[1,0,0] neg_lo:[0,0,1] neg_hi:[0,0,1]
    v_pk_fma_f32 v[252:253], v[252:253], v[164:165], v[166:167] op_sel_hi:[1,0,0] neg_lo:[0,0,1] neg_hi:[0,0,1]
    v_pk_fma_f32 v[254:255], v[254:255], v[164:165], v[166:167] op_sel_hi:[1,0,0] neg_lo:[0,0,1] neg_hi:[0,0,1]
    v_cvt_pk_bf16_f32 v48, v248, v249
    v_cvt_pk_bf16_f32 v49, v250, v251
    v_cvt_pk_bf16_f32 v50, v252, v253
    v_cvt_pk_bf16_f32 v51, v254, v255
    ds_write_b128 v160, v[48:51] offset:32768
    v_lshlrev_b32 v248, 16, v52
    v_and_b32 v249, 0xffff0000, v52
    v_lshlrev_b32 v250, 16, v53
    v_and_b32 v251, 0xffff0000, v53
    v_lshlrev_b32 v252, 16, v54
    v_and_b32 v253, 0xffff0000, v54
    v_lshlrev_b32 v254, 16, v55
    v_and_b32 v255, 0xffff0000, v55
    v_pk_fma_f32 v[248:249], v[248:249], v[168:169], v[170:171] op_sel_hi:[1,0,0] neg_lo:[0,0,1] neg_hi:[0,0,1]
    v_pk_fma_f32 v[250:251], v[250:251], v[168:169], v[170:171] op_sel_hi:[1,0,0] neg_lo:[0,0,1] neg_hi:[0,0,1]
    v_pk_fma_f32 v[252:253], v[252:253], v[168:169], v[170:171] op_sel_hi:[1,0,0] neg_lo:[0,0,1] neg_hi:[0,0,1]
    v_pk_fma_f32 v[254:255], v[254:255], v[168:169], v[170:171] op_sel_hi:[1,0,0] neg_lo:[0,0,1] neg_hi:[0,0,1]
    v_cvt_pk_bf16_f32 v52, v248, v249
    v_cvt_pk_bf16_f32 v53, v250, v251
    v_cvt_pk_bf16_f32 v54, v252, v253
    v_cvt_pk_bf16_f32 v55, v254, v255
    ds_write_b128 v160, v[52:55] offset:34816
    s_add_u32 s45, s55, 1769472
    s_add_u32 m0, s46, 55296
    s_nop 0
    buffer_load_dwordx4 v7, s[12:15], s45 offen offset:0 lds
    s_nop 0
    buffer_load_dwordx4 v8, s[12:15], s45 offen offset:1024 lds
    s_mov_b32 exec_hi, 0
    buffer_load_dwordx4 v9, s[12:15], s45 offen offset:2048 lds
    s_mov_b32 exec_hi, -1
    v_lshlrev_b32 v248, 16, v64
    v_and_b32 v249, 0xffff0000, v64
    v_lshlrev_b32 v250, 16, v65
    v_and_b32 v251, 0xffff0000, v65
    v_lshlrev_b32 v252, 16, v66
    v_and_b32 v253, 0xffff0000, v66
    v_lshlrev_b32 v254, 16, v67
    v_and_b32 v255, 0xffff0000, v67
    v_pk_fma_f32 v[248:249], v[248:249], v[164:165], v[166:167] op_sel_hi:[1,0,0] neg_lo:[0,0,1] neg_hi:[0,0,1]
    v_pk_fma_f32 v[250:251], v[250:251], v[164:165], v[166:167] op_sel_hi:[1,0,0] neg_lo:[0,0,1] neg_hi:[0,0,1]
    v_pk_fma_f32 v[252:253], v[252:253], v[164:165], v[166:167] op_sel_hi:[1,0,0] neg_lo:[0,0,1] neg_hi:[0,0,1]
    v_pk_fma_f32 v[254:255], v[254:255], v[164:165], v[166:167] op_sel_hi:[1,0,0] neg_lo:[0,0,1] neg_hi:[0,0,1]
    v_cvt_pk_bf16_f32 v64, v248, v249
    v_cvt_pk_bf16_f32 v65, v250, v251
    v_cvt_pk_bf16_f32 v66, v252, v253
    v_cvt_pk_bf16_f32 v67, v254, v255
    ds_write_b128 v160, v[64:67] offset:0
    v_lshlrev_b32 v248, 16, v68
    v_and_b32 v249, 0xffff0000, v68
    v_lshlrev_b32 v250, 16, v69
    v_and_b32 v251, 0xffff0000, v69
    v_lshlrev_b32 v252, 16, v70
    v_and_b32 v253, 0xffff0000, v70
    v_lshlrev_b32 v254, 16, v71
    v_and_b32 v255, 0xffff0000, v71
    v_pk_fma_f32 v[248:249], v[248:249], v[168:169], v[170:171] op_sel_hi:[1,0,0] neg_lo:[0,0,1] neg_hi:[0,0,1]
    v_pk_fma_f32 v[250:251], v[250:251], v[168:169], v[170:171] op_sel_hi:[1,0,0] neg_lo:[0,0,1] neg_hi:[0,0,1]
    v_pk_fma_f32 v[252:253], v[252:253], v[168:169], v[170:171] op_sel_hi:[1,0,0] neg_lo:[0,0,1] neg_hi:[0,0,1]
    v_pk_fma_f32 v[254:255], v[254:255], v[168:169], v[170:171] op_sel_hi:[1,0,0] neg_lo:[0,0,1] neg_hi:[0,0,1]
    v_cvt_pk_bf16_f32 v68, v248, v249
    v_cvt_pk_bf16_f32 v69, v250, v251
    v_cvt_pk_bf16_f32 v70, v252, v253
    v_cvt_pk_bf16_f32 v71, v254, v255
    ds_write_b128 v160, v[68:71] offset:2048
    v_lshlrev_b32 v248, 16, v80
    v_and_b32 v249, 0xffff0000, v80
    v_lshlrev_b32 v250, 16, v81
    v_and_b32 v251, 0xffff0000, v81
    v_lshlrev_b32 v252, 16, v82
    v_and_b32 v253, 0xffff0000, v82
    v_lshlrev_b32 v254, 16, v83
    v_and_b32 v255, 0xffff0000, v83
    v_pk_fma_f32 v[248:249], v[248:249], v[164:165], v[166:167] op_sel_hi:[1,0,0] neg_lo:[0,0,1] neg_hi:[0,0,1]
    v_pk_fma_f32 v[250:251], v[250:251], v[164:165], v[166:167] op_sel_hi:[1,0,0] neg_lo:[0,0,1] neg_hi:[0,0,1]
    v_pk_fma_f32 v[252:253], v[252:253], v[164:165], v[166:167] op_sel_hi:[1,0,0] neg_lo:[0,0,1] neg_hi:[0,0,1]
    v_pk_fma_f32 v[254:255], v[254:255], v[164:165], v[166:167] op_sel_hi:[1,0,0] neg_lo:[0,0,1] neg_hi:[0,0,1]
    v_cvt_pk_bf16_f32 v80, v248, v249
    v_cvt_pk_bf16_f32 v81, v250, v251
    v_cvt_pk_bf16_f32 v82, v252, v253
    v_cvt_pk_bf16_f32 v83, v254, v255
    ds_write_b128 v160, v[80:83] offset:16384
    v_lshlrev_b32 v248, 16, v84
    v_and_b32 v249, 0xffff0000, v84
    v_lshlrev_b32 v250, 16, v85
    v_and_b32 v251, 0xffff0000, v85
    v_lshlrev_b32 v252, 16, v86
    v_and_b32 v253, 0xffff0000, v86
    v_lshlrev_b32 v254, 16, v87
    v_and_b32 v255, 0xffff0000, v87
    v_pk_fma_f32 v[248:249], v[248:249], v[168:169], v[170:171] op_sel_hi:[1,0,0] neg_lo:[0,0,1] neg_hi:[0,0,1]
    v_pk_fma_f32 v[250:251], v[250:251], v[168:169], v[170:171] op_sel_hi:[1,0,0] neg_lo:[0,0,1] neg_hi:[0,0,1]
    v_pk_fma_f32 v[252:253], v[252:253], v[168:169], v[170:171] op_sel_hi:[1,0,0] neg_lo:[0,0,1] neg_hi:[0,0,1]
    v_pk_fma_f32 v[254:255], v[254:255], v[168:169], v[170:171] op_sel_hi:[1,0,0] neg_lo:[0,0,1] neg_hi:[0,0,1]
    v_cvt_pk_bf16_f32 v84, v248, v249
    v_cvt_pk_bf16_f32 v85, v250, v251
    v_cvt_pk_bf16_f32 v86, v252, v253
    v_cvt_pk_bf16_f32 v87, v254, v255
    ds_write_b128 v160, v[84:87] offset:18432
    s_waitcnt vmcnt(9)
    s_waitcnt lgkmcnt(6)
    s_barrier
    ds_read_b128 v[16:19], v165 offset:0
    ds_read_b128 v[20:23], v165 offset:2048
    ds_read_b64_tr_b16 v[232:233], v3 offset:160
    ds_read_b64_tr_b16 v[234:235], v3 offset:4768
    ds_read_b64_tr_b16 v[236:237], v3 offset:192
    ds_read_b64_tr_b16 v[238:239], v3 offset:4800
    ds_read_b64_tr_b16 v[240:241], v3 offset:224
    ds_read_b64_tr_b16 v[242:243], v3 offset:4832
    ds_read_b128 v[24:27], v167 offset:1024
    ds_read_b128 v[28:31], v167 offset:3072
    buffer_load_dwordx4 v[172:175], v172, s[68:71], s49 offen
    buffer_load_dwordx4 v[176:179], v176, s[68:71], s49 offen
    buffer_load_dwordx4 v[180:183], v180, s[68:71], s49 offen
    buffer_load_dwordx4 v[184:187], v184, s[68:71], s49 offen
    s_mov_b32 exec_hi, 0
    buffer_load_dwordx4 v[188:191], v188, s[68:71], s49 offen
    s_mov_b32 exec_hi, -1
    s_waitcnt lgkmcnt(8)
    s_waitcnt lgkmcnt(6)
    v_mfma_f32_16x16x32_bf16 v[200:203], v[16:19], v[232:235], 0
    v_lshlrev_b32 v248, 16, v96
    v_and_b32 v249, 0xffff0000, v96
    v_mfma_f32_16x16x32_bf16 v[204:207], v[20:23], v[232:235], 0
    v_lshlrev_b32 v250, 16, v97
    v_and_b32 v251, 0xffff0000, v97
    ds_read_b64_tr_b16 v[244:245], v3 offset:256
    ds_read_b64_tr_b16 v[246:247], v3 offset:4864
    s_waitcnt lgkmcnt(6)
    v_mfma_f32_16x16x32_bf16 v[208:211], v[16:19], v[236:239], 0
    v_lshlrev_b32 v252, 16, v98
    v_and_b32 v253, 0xffff0000, v98
    v_mfma_f32_16x16x32_bf16 v[212:215], v[20:23], v[236:239], 0
    v_lshlrev_b32 v254, 16, v99
    v_and_b32 v255, 0xffff0000, v99
    ds_read_b128 v[32:35], v165 offset:18432
    ds_read_b64_tr_b16 v[232:233], v3 offset:9376
    ds_read_b64_tr_b16 v[234:235], v3 offset:13984
    s_waitcnt lgkmcnt(7)
    v_mfma_f32_16x16x32_bf16 v[216:219], v[16:19], v[240:243], 0
    v_fma_f32 v248, v248, v164, -v166
    v_fma_f32 v249, v249, v164, -v166
    v_mfma_f32_16x16x32_bf16 v[220:223], v[20:23], v[240:243], 0
    v_fma_f32 v250, v250, v164, -v166
    v_fma_f32 v251, v251, v164, -v166
    ds_read_b128 v[36:39], v165 offset:20480
    ds_read_b64_tr_b16 v[236:237], v3 offset:9408
    ds_read_b64_tr_b16 v[238:239], v3 offset:14016
    s_waitcnt lgkmcnt(6)
    v_mfma_f32_16x16x32_bf16 v[224:227], v[16:19], v[244:247], 0
    v_fma_f32 v252, v252, v164, -v166
    v_fma_f32 v253, v253, v164, -v166
    v_mfma_f32_16x16x32_bf16 v[228:231], v[20:23], v[244:247], 0
    v_fma_f32 v254, v254, v164, -v166
    v_fma_f32 v255, v255, v164, -v166
    ds_read_b128 v[40:43], v167 offset:19456
    ds_read_b64_tr_b16 v[240:241], v3 offset:9440
    ds_read_b64_tr_b16 v[242:243], v3 offset:14048
    s_waitcnt lgkmcnt(6)
    v_mfma_f32_16x16x32_bf16 v[200:203], v[24:27], v[232:235], v[200:203]
    v_cvt_pk_bf16_f32 v96, v248, v249
    v_cvt_pk_bf16_f32 v97, v250, v251
    v_mfma_f32_16x16x32_bf16 v[204:207], v[28:31], v[232:235], v[204:207]
    v_cvt_pk_bf16_f32 v98, v252, v253
    v_cvt_pk_bf16_f32 v99, v254, v255
    ds_read_b128 v[44:47], v167 offset:21504
    ds_read_b64_tr_b16 v[244:245], v3 offset:9472
    ds_read_b64_tr_b16 v[246:247], v3 offset:14080
    s_waitcnt lgkmcnt(6)
    v_mfma_f32_16x16x32_bf16 v[208:211], v[24:27], v[236:239], v[208:211]
    v_mfma_f32_16x16x32_bf16 v[212:215], v[28:31], v[236:239], v[212:215]
    s_waitcnt vmcnt(11)
    s_waitcnt lgkmcnt(2)
    s_barrier
    ds_read_b64_tr_b16 v[232:233], v3 offset:18592
    ds_read_b64_tr_b16 v[234:235], v3 offset:23200
    v_mfma_f32_16x16x32_bf16 v[216:219], v[24:27], v[240:243], v[216:219]
    v_mfma_f32_16x16x32_bf16 v[220:223], v[28:31], v[240:243], v[220:223]
    ds_read_b128 v[48:51], v162 offset:32768
    s_add_u32 s45, s55, 2359296
    s_add_u32 m0, s46, 73728
    s_nop 0
    buffer_load_dwordx4 v7, s[12:15], s45 offen offset:0 lds
    ds_read_b64_tr_b16 v[236:237], v3 offset:18624
    ds_read_b64_tr_b16 v[238:239], v3 offset:23232
    s_waitcnt lgkmcnt(5)
    v_mfma_f32_16x16x32_bf16 v[224:227], v[24:27], v[244:247], v[224:227]
    v_mfma_f32_16x16x32_bf16 v[228:231], v[28:31], v[244:247], v[228:231]
    ds_read_b128 v[52:55], v162 offset:34816
    s_nop 0
    buffer_load_dwordx4 v8, s[12:15], s45 offen offset:1024 lds
    ds_read_b64_tr_b16 v[240:241], v3 offset:18656
    ds_read_b64_tr_b16 v[242:243], v3 offset:23264
    s_waitcnt lgkmcnt(6)
    v_mfma_f32_16x16x32_bf16 v[200:203], v[32:35], v[232:235], v[200:203]
    v_mfma_f32_16x16x32_bf16 v[204:207], v[36:39], v[232:235], v[204:207]
    ds_read_b128 v[56:59], v163 offset:33792
    s_mov_b32 exec_hi, 0
    buffer_load_dwordx4 v9, s[12:15], s45 offen offset:2048 lds
    s_mov_b32 exec_hi, -1
    ds_read_b64_tr_b16 v[244:245], v3 offset:18688
    ds_read_b64_tr_b16 v[246:247], v3 offset:23296
    s_waitcnt lgkmcnt(6)
    v_mfma_f32_16x16x32_bf16 v[208:211], v[32:35], v[236:239], v[208:211]
    v_mfma_f32_16x16x32_bf16 v[212:215], v[36:39], v[236:239], v[212:215]
    ds_read_b128 v[60:63], v163 offset:35840
    s_add_u32 s45, s55, 2949120
    s_add_u32 m0, s46, 92160
    s_nop 0
    buffer_load_dwordx4 v7, s[12:15], s45 offen offset:0 lds
    ds_read_b64_tr_b16 v[232:233], v3 offset:27808
    ds_read_b64_tr_b16 v[234:235], v3 offset:32416
    s_waitcnt lgkmcnt(6)
    v_mfma_f32_16x16x32_bf16 v[216:219], v[32:35], v[240:243], v[216:219]
    v_mfma_f32_16x16x32_bf16 v[220:223], v[36:39], v[240:243], v[220:223]
    s_nop 0
    buffer_load_dwordx4 v8, s[12:15], s45 offen offset:1024 lds
    ds_read_b64_tr_b16 v[236:237], v3 offset:27840
    ds_read_b64_tr_b16 v[238:239], v3 offset:32448
    s_waitcnt lgkmcnt(5)
    v_mfma_f32_16x16x32_bf16 v[224:227], v[32:35], v[244:247], v[224:227]
    v_mfma_f32_16x16x32_bf16 v[228:231], v[36:39], v[244:247], v[228:231]
    s_mov_b32 exec_hi, 0
    buffer_load_dwordx4 v9, s[12:15], s45 offen offset:2048 lds
    s_mov_b32 exec_hi, -1
    ds_read_b64_tr_b16 v[240:241], v3 offset:27872
    ds_read_b64_tr_b16 v[242:243], v3 offset:32480
    s_waitcnt lgkmcnt(4)
    v_mfma_f32_16x16x32_bf16 v[200:203], v[40:43], v[232:235], v[200:203]
    v_mfma_f32_16x16x32_bf16 v[204:207], v[44:47], v[232:235], v[204:207]
    ds_read_b64_tr_b16 v[244:245], v3 offset:27904
    ds_read_b64_tr_b16 v[246:247], v3 offset:32512
    s_waitcnt lgkmcnt(4)
    v_mfma_f32_16x16x32_bf16 v[208:211], v[40:43], v[236:239], v[208:211]
    v_mfma_f32_16x16x32_bf16 v[212:215], v[44:47], v[236:239], v[212:215]
    s_waitcnt vmcnt(14)
    s_barrier
    ds_read_b64_tr_b16 v[232:233], v3 offset:37024
    ds_read_b64_tr_b16 v[234:235], v3 offset:41632
    s_waitcnt lgkmcnt(4)
    v_mfma_f32_16x16x32_bf16 v[216:219], v[40:43], v[240:243], v[216:219]
    ds_write_b128 v160, v[96:99] offset:32768
    v_lshlrev_b32 v248, 16, v100
    v_mfma_f32_16x16x32_bf16 v[220:223], v[44:47], v[240:243], v[220:223]
    v_and_b32 v249, 0xffff0000, v100
    v_lshlrev_b32 v250, 16, v101
    ds_read_b128 v[64:67], v162 offset:0
    s_add_u32 s45, s55, 3538944
    s_add_u32 m0, s46, 0
    s_nop 0
    buffer_load_dwordx4 v7, s[12:15], s45 offen offset:0 lds
    ds_read_b64_tr_b16 v[236:237], v3 offset:37056
    ds_read_b64_tr_b16 v[238:239], v3 offset:41664
    s_waitcnt lgkmcnt(6)
    v_mfma_f32_16x16x32_bf16 v[224:227], v[40:43], v[244:247], v[224:227]
    v_and_b32 v251, 0xffff0000, v101
    v_lshlrev_b32 v252, 16, v102
    v_mfma_f32_16x16x32_bf16 v[228:231], v[44:47], v[244:247], v[228:231]
    v_and_b32 v253, 0xffff0000, v102
    v_lshlrev_b32 v254, 16, v103
    ds_read_b128 v[68:71], v162 offset:2048
    ds_read_b64_tr_b16 v[240:241], v3 offset:37088
    ds_read_b64_tr_b16 v[242:243], v3 offset:41696
    s_waitcnt lgkmcnt(7)
    v_mfma_f32_16x16x32_bf16 v[200:203], v[48:51], v[232:235], v[200:203]
    v_and_b32 v255, 0xffff0000, v103
    v_fma_f32 v248, v248, v168, -v170
    v_mfma_f32_16x16x32_bf16 v[204:207], v[52:55], v[232:235], v[204:207]
    v_fma_f32 v249, v249, v168, -v170
    v_fma_f32 v250, v250, v168, -v170
    ds_read_b128 v[72:75], v163 offset:1024
    s_nop 0
    buffer_load_dwordx4 v8, s[12:15], s45 offen offset:1024 lds
    ds_read_b64_tr_b16 v[244:245], v3 offset:37120
    ds_read_b64_tr_b16 v[246:247], v3 offset:41728
    s_waitcnt lgkmcnt(6)
    v_mfma_f32_16x16x32_bf16 v[208:211], v[48:51], v[236:239], v[208:211]
    v_fma_f32 v251, v251, v168, -v170
    v_fma_f32 v252, v252, v168, -v170
    v_mfma_f32_16x16x32_bf16 v[212:215], v[52:55], v[236:239], v[212:215]
    v_fma_f32 v253, v253, v168, -v170
    v_fma_f32 v254, v254, v168, -v170
    ds_read_b128 v[76:79], v163 offset:3072
    ds_read_b64_tr_b16 v[232:233], v3 offset:46240
    ds_read_b64_tr_b16 v[234:235], v3 offset:50848
    s_waitcnt lgkmcnt(6)
    v_mfma_f32_16x16x32_bf16 v[216:219], v[48:51], v[240:243], v[216:219]
    v_fma_f32 v255, v255, v168, -v170
    v_cvt_pk_bf16_f32 v100, v248, v249
    v_mfma_f32_16x16x32_bf16 v[220:223], v[52:55], v[240:243], v[220:223]
    v_cvt_pk_bf16_f32 v101, v250, v251
    v_cvt_pk_bf16_f32 v102, v252, v253
    s_mov_b32 exec_hi, 0
    buffer_load_dwordx4 v9, s[12:15], s45 offen offset:2048 lds
    s_mov_b32 exec_hi, -1
    ds_read_b64_tr_b16 v[236:237], v3 offset:46272
    ds_read_b64_tr_b16 v[238:239], v3 offset:50880
    s_waitcnt lgkmcnt(5)
    v_mfma_f32_16x16x32_bf16 v[224:227], v[48:51], v[244:247], v[224:227]
    v_cvt_pk_bf16_f32 v103, v254, v255
    ds_write_b128 v160, v[100:103] offset:34816
    v_mfma_f32_16x16x32_bf16 v[228:231], v[52:55], v[244:247], v[228:231]
    v_lshlrev_b32 v248, 16, v112
    v_and_b32 v249, 0xffff0000, v112
    ds_read_b64_tr_b16 v[240:241], v3 offset:46304
    ds_read_b64_tr_b16 v[242:243], v3 offset:50912
    s_waitcnt lgkmcnt(5)
    v_mfma_f32_16x16x32_bf16 v[200:203], v[56:59], v[232:235], v[200:203]
    v_lshlrev_b32 v250, 16, v113
    v_and_b32 v251, 0xffff0000, v113
    v_mfma_f32_16x16x32_bf16 v[204:207], v[60:63], v[232:235], v[204:207]
    v_lshlrev_b32 v252, 16, v114
    v_and_b32 v253, 0xffff0000, v114
    ds_read_b64_tr_b16 v[244:245], v3 offset:46336
    ds_read_b64_tr_b16 v[246:247], v3 offset:50944
    s_waitcnt lgkmcnt(5)
    v_mfma_f32_16x16x32_bf16 v[208:211], v[56:59], v[236:239], v[208:211]
    v_lshlrev_b32 v254, 16, v115
    v_and_b32 v255, 0xffff0000, v115
    v_mfma_f32_16x16x32_bf16 v[212:215], v[60:63], v[236:239], v[212:215]
    v_fma_f32 v248, v248, v164, -v166
    v_fma_f32 v249, v249, v164, -v166
    s_waitcnt vmcnt(14)
    s_barrier
    ds_read_b64_tr_b16 v[232:233], v4 offset:160
    ds_read_b64_tr_b16 v[234:235], v4 offset:4768
    s_waitcnt lgkmcnt(4)
    v_mfma_f32_16x16x32_bf16 v[216:219], v[56:59], v[240:243], v[216:219]
    v_fma_f32 v250, v250, v164, -v166
    v_fma_f32 v251, v251, v164, -v166
    v_mfma_f32_16x16x32_bf16 v[220:223], v[60:63], v[240:243], v[220:223]
    v_fma_f32 v252, v252, v164, -v166
    v_fma_f32 v253, v253, v164, -v166
    ds_read_b128 v[80:83], v162 offset:16384
    s_add_u32 s45, s55, 4128768
    s_add_u32 m0, s46, 18432
    s_nop 0
    buffer_load_dwordx4 v7, s[12:15], s45 offen offset:0 lds
    ds_read_b64_tr_b16 v[236:237], v4 offset:192
    ds_read_b64_tr_b16 v[238:239], v4 offset:4800
    s_waitcnt lgkmcnt(5)
    v_mfma_f32_16x16x32_bf16 v[224:227], v[56:59], v[244:247], v[224:227]
    v_fma_f32 v254, v254, v164, -v166
    v_fma_f32 v255, v255, v164, -v166
    v_mfma_f32_16x16x32_bf16 v[228:231], v[60:63], v[244:247], v[228:231]
    v_cvt_pk_bf16_f32 v112, v248, v249
    v_cvt_pk_bf16_f32 v113, v250, v251
    ds_read_b128 v[84:87], v162 offset:18432
    ds_read_b64_tr_b16 v[240:241], v4 offset:224
    ds_read_b64_tr_b16 v[242:243], v4 offset:4832
    s_waitcnt lgkmcnt(6)
    v_mfma_f32_16x16x32_bf16 v[200:203], v[64:67], v[232:235], v[200:203]
    v_cvt_pk_bf16_f32 v114, v252, v253
    v_cvt_pk_bf16_f32 v115, v254, v255
    v_mfma_f32_16x16x32_bf16 v[204:207], v[68:71], v[232:235], v[204:207]
    ds_write_b128 v160, v[112:115] offset:0
    v_lshlrev_b32 v248, 16, v116
    ds_read_b128 v[88:91], v163 offset:17408
    s_nop 0
    buffer_load_dwordx4 v8, s[12:15], s45 offen offset:1024 lds
    ds_read_b64_tr_b16 v[244:245], v4 offset:256
    ds_read_b64_tr_b16 v[246:247], v4 offset:4864
    s_waitcnt lgkmcnt(7)
    v_mfma_f32_16x16x32_bf16 v[208:211], v[64:67], v[236:239], v[208:211]
    v_and_b32 v249, 0xffff0000, v116
    v_lshlrev_b32 v250, 16, v117
    v_mfma_f32_16x16x32_bf16 v[212:215], v[68:71], v[236:239], v[212:215]
    v_and_b32 v251, 0xffff0000, v117
    v_lshlrev_b32 v252, 16, v118
    ds_read_b128 v[92:95], v163 offset:19456
    ds_read_b64_tr_b16 v[232:233], v4 offset:9376
    ds_read_b64_tr_b16 v[234:235], v4 offset:13984
    s_waitcnt lgkmcnt(7)
    v_mfma_f32_16x16x32_bf16 v[216:219], v[64:67], v[240:243], v[216:219]
    v_and_b32 v253, 0xffff0000, v118
    v_lshlrev_b32 v254, 16, v119
    v_mfma_f32_16x16x32_bf16 v[220:223], v[68:71], v[240:243], v[220:223]
    v_and_b32 v255, 0xffff0000, v119
    v_fma_f32 v248, v248, v168, -v170
    s_mov_b32 exec_hi, 0
    buffer_load_dwordx4 v9, s[12:15], s45 offen offset:2048 lds
    s_mov_b32 exec_hi, -1
    ds_read_b64_tr_b16 v[236:237], v4 offset:9408
    ds_read_b64_tr_b16 v[238:239], v4 offset:14016
    s_waitcnt lgkmcnt(5)
    v_mfma_f32_16x16x32_bf16 v[224:227], v[64:67], v[244:247], v[224:227]
    v_fma_f32 v249, v249, v168, -v170
    v_fma_f32 v250, v250, v168, -v170
    v_mfma_f32_16x16x32_bf16 v[228:231], v[68:71], v[244:247], v[228:231]
    v_fma_f32 v251, v251, v168, -v170
    v_fma_f32 v252, v252, v168, -v170
    ds_read_b64_tr_b16 v[240:241], v4 offset:9440
    ds_read_b64_tr_b16 v[242:243], v4 offset:14048
    s_waitcnt lgkmcnt(4)
    v_mfma_f32_16x16x32_bf16 v[200:203], v[72:75], v[232:235], v[200:203]
    v_fma_f32 v253, v253, v168, -v170
    v_fma_f32 v254, v254, v168, -v170
    v_mfma_f32_16x16x32_bf16 v[204:207], v[76:79], v[232:235], v[204:207]
    v_fma_f32 v255, v255, v168, -v170
    v_cvt_pk_bf16_f32 v116, v248, v249
    ds_read_b64_tr_b16 v[244:245], v4 offset:9472
    ds_read_b64_tr_b16 v[246:247], v4 offset:14080
    s_waitcnt lgkmcnt(4)
    v_mfma_f32_16x16x32_bf16 v[208:211], v[72:75], v[236:239], v[208:211]
    v_cvt_pk_bf16_f32 v117, v250, v251
    v_cvt_pk_bf16_f32 v118, v252, v253
    v_mfma_f32_16x16x32_bf16 v[212:215], v[76:79], v[236:239], v[212:215]
    v_cvt_pk_bf16_f32 v119, v254, v255
    ds_write_b128 v160, v[116:119] offset:2048
    s_waitcnt vmcnt(9)
    s_barrier
    ds_read_b64_tr_b16 v[232:233], v4 offset:18592
    ds_read_b64_tr_b16 v[234:235], v4 offset:23200
    s_waitcnt lgkmcnt(5)
    v_mfma_f32_16x16x32_bf16 v[216:219], v[72:75], v[240:243], v[216:219]
    v_lshlrev_b32 v248, 16, v128
    v_and_b32 v249, 0xffff0000, v128
    v_mfma_f32_16x16x32_bf16 v[220:223], v[76:79], v[240:243], v[220:223]
    v_lshlrev_b32 v250, 16, v129
    v_and_b32 v251, 0xffff0000, v129
    ds_read_b128 v[96:99], v162 offset:32768
    s_add_u32 s45, s55, 4718592
    s_add_u32 m0, s46, 36864
    s_nop 0
    buffer_load_dwordx4 v7, s[12:15], s45 offen offset:0 lds
    ds_read_b64_tr_b16 v[236:237], v4 offset:18624
    ds_read_b64_tr_b16 v[238:239], v4 offset:23232
    s_waitcnt lgkmcnt(6)
    v_mfma_f32_16x16x32_bf16 v[224:227], v[72:75], v[244:247], v[224:227]
    v_lshlrev_b32 v252, 16, v130
    v_and_b32 v253, 0xffff0000, v130
    v_mfma_f32_16x16x32_bf16 v[228:231], v[76:79], v[244:247], v[228:231]
    v_lshlrev_b32 v254, 16, v131
    v_and_b32 v255, 0xffff0000, v131
    ds_read_b128 v[100:103], v162 offset:34816
    ds_read_b64_tr_b16 v[240:241], v4 offset:18656
    ds_read_b64_tr_b16 v[242:243], v4 offset:23264
    s_waitcnt lgkmcnt(6)
    v_mfma_f32_16x16x32_bf16 v[200:203], v[80:83], v[232:235], v[200:203]
    v_fma_f32 v248, v248, v164, -v166
    v_fma_f32 v249, v249, v164, -v166
    v_mfma_f32_16x16x32_bf16 v[204:207], v[84:87], v[232:235], v[204:207]
    v_fma_f32 v250, v250, v164, -v166
    v_fma_f32 v251, v251, v164, -v166
    ds_read_b128 v[104:107], v163 offset:33792
    s_nop 0
    buffer_load_dwordx4 v8, s[12:15], s45 offen offset:1024 lds
    ds_read_b64_tr_b16 v[244:245], v4 offset:18688
    ds_read_b64_tr_b16 v[246:247], v4 offset:23296
    s_waitcnt lgkmcnt(6)
    v_mfma_f32_16x16x32_bf16 v[208:211], v[80:83], v[236:239], v[208:211]
    v_fma_f32 v252, v252, v164, -v166
    v_fma_f32 v253, v253, v164, -v166
    v_mfma_f32_16x16x32_bf16 v[212:215], v[84:87], v[236:239], v[212:215]
    v_fma_f32 v254, v254, v164, -v166
    v_fma_f32 v255, v255, v164, -v166
    ds_read_b128 v[108:111], v163 offset:35840
    ds_read_b64_tr_b16 v[232:233], v4 offset:27808
    ds_read_b64_tr_b16 v[234:235], v4 offset:32416
    s_waitcnt lgkmcnt(6)
    v_mfma_f32_16x16x32_bf16 v[216:219], v[80:83], v[240:243], v[216:219]
    v_cvt_pk_bf16_f32 v128, v248, v249
    v_cvt_pk_bf16_f32 v129, v250, v251
    v_mfma_f32_16x16x32_bf16 v[220:223], v[84:87], v[240:243], v[220:223]
    v_cvt_pk_bf16_f32 v130, v252, v253
    v_cvt_pk_bf16_f32 v131, v254, v255
    s_mov_b32 exec_hi, 0
    buffer_load_dwordx4 v9, s[12:15], s45 offen offset:2048 lds
    s_mov_b32 exec_hi, -1
    ds_read_b64_tr_b16 v[236:237], v4 offset:27840
    ds_read_b64_tr_b16 v[238:239], v4 offset:32448
    s_waitcnt lgkmcnt(5)
    v_mfma_f32_16x16x32_bf16 v[224:227], v[80:83], v[244:247], v[224:227]
    ds_write_b128 v160, v[128:131] offset:16384
    v_lshlrev_b32 v248, 16, v132
    v_mfma_f32_16x16x32_bf16 v[228:231], v[84:87], v[244:247], v[228:231]
    v_and_b32 v249, 0xffff0000, v132
    v_lshlrev_b32 v250, 16, v133
    ds_read_b64_tr_b16 v[240:241], v4 offset:27872
    ds_read_b64_tr_b16 v[242:243], v4 offset:32480
    s_waitcnt lgkmcnt(5)
    v_mfma_f32_16x16x32_bf16 v[200:203], v[88:91], v[232:235], v[200:203]
    v_and_b32 v251, 0xffff0000, v133
    v_lshlrev_b32 v252, 16, v134
    v_mfma_f32_16x16x32_bf16 v[204:207], v[92:95], v[232:235], v[204:207]
    v_and_b32 v253, 0xffff0000, v134
    v_lshlrev_b32 v254, 16, v135
    ds_read_b64_tr_b16 v[244:245], v4 offset:27904
    ds_read_b64_tr_b16 v[246:247], v4 offset:32512
    s_waitcnt lgkmcnt(5)
    v_mfma_f32_16x16x32_bf16 v[208:211], v[88:91], v[236:239], v[208:211]
    v_and_b32 v255, 0xffff0000, v135
    v_fma_f32 v248, v248, v168, -v170
    v_mfma_f32_16x16x32_bf16 v[212:215], v[92:95], v[236:239], v[212:215]
    v_fma_f32 v249, v249, v168, -v170
    v_fma_f32 v250, v250, v168, -v170
    s_waitcnt vmcnt(9)
    s_barrier
    ds_read_b64_tr_b16 v[232:233], v4 offset:37024
    ds_read_b64_tr_b16 v[234:235], v4 offset:41632
    s_waitcnt lgkmcnt(4)
    v_mfma_f32_16x16x32_bf16 v[216:219], v[88:91], v[240:243], v[216:219]
    v_fma_f32 v251, v251, v168, -v170
    v_fma_f32 v252, v252, v168, -v170
    v_mfma_f32_16x16x32_bf16 v[220:223], v[92:95], v[240:243], v[220:223]
    v_fma_f32 v253, v253, v168, -v170
    v_fma_f32 v254, v254, v168, -v170
    ds_read_b128 v[112:115], v162 offset:0
    s_add_u32 s45, s54, 0
    s_add_u32 m0, s46, 55296
    s_nop 0
    buffer_load_dwordx4 v7, s[12:15], s45 offen offset:0 lds
    ds_read_b64_tr_b16 v[236:237], v4 offset:37056
    ds_read_b64_tr_b16 v[238:239], v4 offset:41664
    s_waitcnt lgkmcnt(5)
    v_mfma_f32_16x16x32_bf16 v[224:227], v[88:91], v[244:247], v[224:227]
    v_fma_f32 v255, v255, v168, -v170
    v_cvt_pk_bf16_f32 v132, v248, v249
    v_mfma_f32_16x16x32_bf16 v[228:231], v[92:95], v[244:247], v[228:231]
    v_cvt_pk_bf16_f32 v133, v250, v251
    v_cvt_pk_bf16_f32 v134, v252, v253
    ds_read_b128 v[116:119], v162 offset:2048
    ds_read_b64_tr_b16 v[240:241], v4 offset:37088
    ds_read_b64_tr_b16 v[242:243], v4 offset:41696
    s_waitcnt lgkmcnt(6)
    v_mfma_f32_16x16x32_bf16 v[200:203], v[96:99], v[232:235], v[200:203]
    v_cvt_pk_bf16_f32 v135, v254, v255
    ds_write_b128 v160, v[132:135] offset:18432
    v_mfma_f32_16x16x32_bf16 v[204:207], v[100:103], v[232:235], v[204:207]
    v_lshlrev_b32 v248, 16, v144
    v_and_b32 v249, 0xffff0000, v144
    ds_read_b128 v[120:123], v163 offset:1024
    s_nop 0
    buffer_load_dwordx4 v8, s[12:15], s45 offen offset:1024 lds
    ds_read_b64_tr_b16 v[244:245], v4 offset:37120
    ds_read_b64_tr_b16 v[246:247], v4 offset:41728
    s_lshl_b32 s100, s2, 3
    s_add_u32 s100, s100, s3
    s_lshl_b32 s100, s100, 12
    s_mov_b32 exec_lo, 255
    s_mov_b32 exec_hi, 0
    v_lshlrev_b32 v0, 7, v1
    buffer_load_dword v0, v0, s[76:79], s100 offen
    s_mov_b64 exec, -1
    s_waitcnt lgkmcnt(7)
    v_mfma_f32_16x16x32_bf16 v[208:211], v[96:99], v[236:239], v[208:211]
    v_lshlrev_b32 v250, 16, v145
    v_and_b32 v251, 0xffff0000, v145
    v_mfma_f32_16x16x32_bf16 v[212:215], v[100:103], v[236:239], v[212:215]
    v_lshlrev_b32 v252, 16, v146
    v_and_b32 v253, 0xffff0000, v146
    ds_read_b128 v[124:127], v163 offset:3072
    ds_read_b64_tr_b16 v[232:233], v4 offset:46240
    ds_read_b64_tr_b16 v[234:235], v4 offset:50848
    s_waitcnt lgkmcnt(7)
    v_mfma_f32_16x16x32_bf16 v[216:219], v[96:99], v[240:243], v[216:219]
    v_lshlrev_b32 v254, 16, v147
    v_and_b32 v255, 0xffff0000, v147
    v_mfma_f32_16x16x32_bf16 v[220:223], v[100:103], v[240:243], v[220:223]
    v_fma_f32 v248, v248, v164, -v166
    v_fma_f32 v249, v249, v164, -v166
    s_mov_b32 exec_hi, 0
    buffer_load_dwordx4 v9, s[12:15], s45 offen offset:2048 lds
    s_mov_b32 exec_hi, -1
    ds_read_b64_tr_b16 v[236:237], v4 offset:46272
    ds_read_b64_tr_b16 v[238:239], v4 offset:50880
    s_waitcnt lgkmcnt(5)
    v_mfma_f32_16x16x32_bf16 v[224:227], v[96:99], v[244:247], v[224:227]
    v_fma_f32 v250, v250, v164, -v166
    v_fma_f32 v251, v251, v164, -v166
    v_mfma_f32_16x16x32_bf16 v[228:231], v[100:103], v[244:247], v[228:231]
    v_fma_f32 v252, v252, v164, -v166
    v_fma_f32 v253, v253, v164, -v166
    ds_read_b64_tr_b16 v[240:241], v4 offset:46304
    ds_read_b64_tr_b16 v[242:243], v4 offset:50912
    s_waitcnt lgkmcnt(4)
    v_mfma_f32_16x16x32_bf16 v[200:203], v[104:107], v[232:235], v[200:203]
    v_fma_f32 v254, v254, v164, -v166
    v_fma_f32 v255, v255, v164, -v166
    v_mfma_f32_16x16x32_bf16 v[204:207], v[108:111], v[232:235], v[204:207]
    v_cvt_pk_bf16_f32 v144, v248, v249
    v_cvt_pk_bf16_f32 v145, v250, v251
    ds_read_b64_tr_b16 v[244:245], v4 offset:46336
    ds_read_b64_tr_b16 v[246:247], v4 offset:50944
    s_waitcnt lgkmcnt(4)
    v_mfma_f32_16x16x32_bf16 v[208:211], v[104:107], v[236:239], v[208:211]
    v_cvt_pk_bf16_f32 v146, v252, v253
    v_cvt_pk_bf16_f32 v147, v254, v255
    v_mfma_f32_16x16x32_bf16 v[212:215], v[108:111], v[236:239], v[212:215]
    ds_write_b128 v160, v[144:147] offset:32768
    v_lshlrev_b32 v248, 16, v148
    s_waitcnt vmcnt(10)
    s_barrier
    ds_read_b64_tr_b16 v[232:233], v3 offset:160
    ds_read_b64_tr_b16 v[234:235], v3 offset:4768
    s_waitcnt lgkmcnt(5)
    v_mfma_f32_16x16x32_bf16 v[216:219], v[104:107], v[240:243], v[216:219]
    v_and_b32 v249, 0xffff0000, v148
    v_lshlrev_b32 v250, 16, v149
    v_mfma_f32_16x16x32_bf16 v[220:223], v[108:111], v[240:243], v[220:223]
    v_and_b32 v251, 0xffff0000, v149
    v_lshlrev_b32 v252, 16, v150
    ds_read_b128 v[128:131], v162 offset:16384
    s_add_u32 s45, s54, 589824
    s_add_u32 m0, s46, 73728
    s_nop 0
    buffer_load_dwordx4 v7, s[12:15], s45 offen offset:0 lds
    ds_read_b64_tr_b16 v[236:237], v3 offset:192
    ds_read_b64_tr_b16 v[238:239], v3 offset:4800
    s_waitcnt lgkmcnt(6)
    v_mfma_f32_16x16x32_bf16 v[224:227], v[104:107], v[244:247], v[224:227]
    v_and_b32 v253, 0xffff0000, v150
    v_lshlrev_b32 v254, 16, v151
    v_mfma_f32_16x16x32_bf16 v[228:231], v[108:111], v[244:247], v[228:231]
    v_and_b32 v255, 0xffff0000, v151
    v_fma_f32 v248, v248, v168, -v170
    ds_read_b128 v[132:135], v162 offset:18432
    ds_read_b64_tr_b16 v[240:241], v3 offset:224
    ds_read_b64_tr_b16 v[242:243], v3 offset:4832
    s_waitcnt lgkmcnt(6)
    v_mfma_f32_16x16x32_bf16 v[200:203], v[112:115], v[232:235], v[200:203]
    v_fma_f32 v249, v249, v168, -v170
    v_fma_f32 v250, v250, v168, -v170
    v_mfma_f32_16x16x32_bf16 v[204:207], v[116:119], v[232:235], v[204:207]
    v_fma_f32 v251, v251, v168, -v170
    v_fma_f32 v252, v252, v168, -v170
    ds_read_b128 v[136:139], v163 offset:17408
    s_nop 0
    buffer_load_dwordx4 v8, s[12:15], s45 offen offset:1024 lds
    ds_read_b64_tr_b16 v[244:245], v3 offset:256
    ds_read_b64_tr_b16 v[246:247], v3 offset:4864
    s_waitcnt lgkmcnt(6)
    v_mfma_f32_16x16x32_bf16 v[208:211], v[112:115], v[236:239], v[208:211]
    v_fma_f32 v253, v253, v168, -v170
    v_fma_f32 v254, v254, v168, -v170
    v_mfma_f32_16x16x32_bf16 v[212:215], v[116:119], v[236:239], v[212:215]
    v_fma_f32 v255, v255, v168, -v170
    v_cvt_pk_bf16_f32 v148, v248, v249
    ds_read_b128 v[140:143], v163 offset:19456
    ds_read_b64_tr_b16 v[232:233], v3 offset:9376
    ds_read_b64_tr_b16 v[234:235], v3 offset:13984
    s_waitcnt lgkmcnt(6)
    v_mfma_f32_16x16x32_bf16 v[216:219], v[112:115], v[240:243], v[216:219]
    v_cvt_pk_bf16_f32 v149, v250, v251
    v_cvt_pk_bf16_f32 v150, v252, v253
    v_mfma_f32_16x16x32_bf16 v[220:223], v[116:119], v[240:243], v[220:223]
    v_cvt_pk_bf16_f32 v151, v254, v255
    ds_write_b128 v160, v[148:151] offset:34816
    s_mov_b32 exec_hi, 0
    buffer_load_dwordx4 v9, s[12:15], s45 offen offset:2048 lds
    s_mov_b32 exec_hi, -1
    ds_read_b64_tr_b16 v[236:237], v3 offset:9408
    ds_read_b64_tr_b16 v[238:239], v3 offset:14016
    s_waitcnt lgkmcnt(6)
    v_mfma_f32_16x16x32_bf16 v[224:227], v[112:115], v[244:247], v[224:227]
    v_mfma_f32_16x16x32_bf16 v[228:231], v[116:119], v[244:247], v[228:231]
    ds_read_b64_tr_b16 v[240:241], v3 offset:9440
    ds_read_b64_tr_b16 v[242:243], v3 offset:14048
    s_waitcnt lgkmcnt(5)
    v_mfma_f32_16x16x32_bf16 v[200:203], v[120:123], v[232:235], v[200:203]
    v_mfma_f32_16x16x32_bf16 v[204:207], v[124:127], v[232:235], v[204:207]
    ds_read_b64_tr_b16 v[244:245], v3 offset:9472
    ds_read_b64_tr_b16 v[246:247], v3 offset:14080
    s_waitcnt lgkmcnt(4)
    v_mfma_f32_16x16x32_bf16 v[208:211], v[120:123], v[236:239], v[208:211]
    v_mfma_f32_16x16x32_bf16 v[212:215], v[124:127], v[236:239], v[212:215]
    s_waitcnt vmcnt(10)
    s_barrier
    ds_read_b64_tr_b16 v[232:233], v3 offset:18592
    ds_read_b64_tr_b16 v[234:235], v3 offset:23200
    s_waitcnt lgkmcnt(4)
    v_mfma_f32_16x16x32_bf16 v[216:219], v[120:123], v[240:243], v[216:219]
    v_mfma_f32_16x16x32_bf16 v[220:223], v[124:127], v[240:243], v[220:223]
    ds_read_b128 v[144:147], v162 offset:32768
    s_add_u32 s45, s54, 1179648
    s_add_u32 m0, s46, 92160
    s_nop 0
    buffer_load_dwordx4 v7, s[12:15], s45 offen offset:0 lds
    ds_read_b64_tr_b16 v[236:237], v3 offset:18624
    ds_read_b64_tr_b16 v[238:239], v3 offset:23232
    s_waitcnt lgkmcnt(5)
    v_mfma_f32_16x16x32_bf16 v[224:227], v[120:123], v[244:247], v[224:227]
    v_mfma_f32_16x16x32_bf16 v[228:231], v[124:127], v[244:247], v[228:231]
    ds_read_b128 v[148:151], v162 offset:34816
    ds_read_b64_tr_b16 v[240:241], v3 offset:18656
    ds_read_b64_tr_b16 v[242:243], v3 offset:23264
    v_mov_b32 v15, 159744
    ds_read_b32 v14, v15
    s_waitcnt lgkmcnt(7)
    v_mfma_f32_16x16x32_bf16 v[200:203], v[128:131], v[232:235], v[200:203]
    v_mfma_f32_16x16x32_bf16 v[204:207], v[132:135], v[232:235], v[204:207]
    ds_read_b128 v[152:155], v163 offset:33792
    s_nop 0
    buffer_load_dwordx4 v8, s[12:15], s45 offen offset:1024 lds
    ds_read_b64_tr_b16 v[244:245], v3 offset:18688
    ds_read_b64_tr_b16 v[246:247], v3 offset:23296
    s_mul_i32 s6, s44, 4608
    s_add_u32 s6, s6, 110592
    v_add_u32 v195, s6, v2
    ds_write_b128 v195, v[172:175] offset:0
    s_waitcnt lgkmcnt(8)
    v_mfma_f32_16x16x32_bf16 v[208:211], v[128:131], v[236:239], v[208:211]
    v_mfma_f32_16x16x32_bf16 v[212:215], v[132:135], v[236:239], v[212:215]
    ds_read_b128 v[156:159], v163 offset:35840
    ds_read_b64_tr_b16 v[232:233], v3 offset:27808
    ds_read_b64_tr_b16 v[234:235], v3 offset:32416
    ds_write_b128 v195, v[176:179] offset:1024
    s_waitcnt lgkmcnt(9)
    v_mfma_f32_16x16x32_bf16 v[216:219], v[128:131], v[240:243], v[216:219]
    v_mfma_f32_16x16x32_bf16 v[220:223], v[132:135], v[240:243], v[220:223]
    s_mov_b32 exec_hi, 0
    buffer_load_dwordx4 v9, s[12:15], s45 offen offset:2048 lds
    s_mov_b32 exec_hi, -1
    ds_read_b64_tr_b16 v[236:237], v3 offset:27840
    ds_read_b64_tr_b16 v[238:239], v3 offset:32448
    ds_write_b128 v195, v[180:183] offset:2048
    s_waitcnt lgkmcnt(8)
    v_mfma_f32_16x16x32_bf16 v[224:227], v[128:131], v[244:247], v[224:227]
    v_mfma_f32_16x16x32_bf16 v[228:231], v[132:135], v[244:247], v[228:231]
    ds_read_b64_tr_b16 v[240:241], v3 offset:27872
    ds_read_b64_tr_b16 v[242:243], v3 offset:32480
    ds_write_b128 v195, v[184:187] offset:3072
    s_waitcnt lgkmcnt(7)
    v_mfma_f32_16x16x32_bf16 v[200:203], v[136:139], v[232:235], v[200:203]
    v_mfma_f32_16x16x32_bf16 v[204:207], v[140:143], v[232:235], v[204:207]
    ds_read_b64_tr_b16 v[244:245], v3 offset:27904
    ds_read_b64_tr_b16 v[246:247], v3 offset:32512
    s_mov_b32 exec_hi, 0
    ds_write_b128 v195, v[188:191] offset:4096
    s_mov_b32 exec_hi, -1
    s_waitcnt lgkmcnt(7)
    v_mfma_f32_16x16x32_bf16 v[208:211], v[136:139], v[236:239], v[208:211]
    v_mfma_f32_16x16x32_bf16 v[212:215], v[140:143], v[236:239], v[212:215]
    s_waitcnt vmcnt(10)
    s_barrier
    ds_read_b64_tr_b16 v[232:233], v3 offset:37024
    ds_read_b64_tr_b16 v[234:235], v3 offset:41632
    s_waitcnt lgkmcnt(6)
    v_mfma_f32_16x16x32_bf16 v[216:219], v[136:139], v[240:243], v[216:219]
    v_mfma_f32_16x16x32_bf16 v[220:223], v[140:143], v[240:243], v[220:223]
    s_add_u32 s45, s54, 1769472
    s_add_u32 m0, s46, 0
    s_nop 0
    buffer_load_dwordx4 v7, s[12:15], s45 offen offset:0 lds
    ds_read_b64_tr_b16 v[236:237], v3 offset:37056
    ds_read_b64_tr_b16 v[238:239], v3 offset:41664
    s_waitcnt lgkmcnt(5)
    v_mfma_f32_16x16x32_bf16 v[224:227], v[136:139], v[244:247], v[224:227]
    v_mfma_f32_16x16x32_bf16 v[228:231], v[140:143], v[244:247], v[228:231]
    ds_read_b64_tr_b16 v[240:241], v3 offset:37088
    ds_read_b64_tr_b16 v[242:243], v3 offset:41696
    v_readfirstlane_b32 s48, v14
    ds_read_b64_tr_b16 v[172:173], v192 offset:0
    ds_read_b64_tr_b16 v[174:175], v192 offset:2304
    ds_read_b64_tr_b16 v[176:177], v192 offset:8
    ds_read_b64_tr_b16 v[178:179], v192 offset:2312
    ds_read_b64_tr_b16 v[180:181], v192 offset:64
    ds_read_b64_tr_b16 v[182:183], v192 offset:2368
    ds_read_b64_tr_b16 v[184:185], v192 offset:72
    ds_read_b64_tr_b16 v[186:187], v192 offset:2376
    ds_read_b64_tr_b16 v[188:189], v193 offset:128
    ds_read_b64_tr_b16 v[190:191], v193 offset:2432
    s_waitcnt lgkmcnt(14)
    v_mfma_f32_16x16x32_bf16 v[200:203], v[144:147], v[232:235], v[200:203]
    v_mfma_f32_16x16x32_bf16 v[204:207], v[148:151], v[232:235], v[204:207]
    s_nop 0
    buffer_load_dwordx4 v8, s[12:15], s45 offen offset:1024 lds
    ds_read_b64_tr_b16 v[244:245], v3 offset:37120
    ds_read_b64_tr_b16 v[246:247], v3 offset:41728
    s_lshl_b32 s100, s2, 3
    s_add_u32 s100, s100, s3
    s_lshl_b32 s100, s100, 12
    s_mov_b32 exec_lo, 65280
    s_mov_b32 exec_hi, 0
    v_lshlrev_b32 v0, 7, v1
    buffer_load_dword v0, v0, s[76:79], s100 offen
    s_mov_b64 exec, -1
    s_waitcnt lgkmcnt(14)
    v_mfma_f32_16x16x32_bf16 v[208:211], v[144:147], v[236:239], v[208:211]
    v_mfma_f32_16x16x32_bf16 v[212:215], v[148:151], v[236:239], v[212:215]
    ds_read_b64_tr_b16 v[232:233], v3 offset:46240
    ds_read_b64_tr_b16 v[234:235], v3 offset:50848
    s_waitcnt lgkmcnt(14)
    v_mfma_f32_16x16x32_bf16 v[216:219], v[144:147], v[240:243], v[216:219]
    v_mfma_f32_16x16x32_bf16 v[220:223], v[148:151], v[240:243], v[220:223]
    s_mov_b32 exec_hi, 0
    buffer_load_dwordx4 v9, s[12:15], s45 offen offset:2048 lds
    s_mov_b32 exec_hi, -1
    ds_read_b64_tr_b16 v[236:237], v3 offset:46272
    ds_read_b64_tr_b16 v[238:239], v3 offset:50880
    s_waitcnt lgkmcnt(4)
    v_mfma_f32_16x16x32_bf16 v[224:227], v[144:147], v[244:247], v[224:227]
    v_mfma_f32_16x16x32_bf16 v[228:231], v[148:151], v[244:247], v[228:231]
    ds_read_b64_tr_b16 v[240:241], v3 offset:46304
    ds_read_b64_tr_b16 v[242:243], v3 offset:50912
    s_cmp_ge_u32 s67, 736
    s_cbranch_scc1 g1_now3
    s_mul_i32 s6, s67, 4608
    s_add_u32 s7, s6, 4096
    buffer_store_dwordx4 v[172:175], v2, s[72:75], s6 offen offset:0
    buffer_store_dwordx4 v[176:179], v2, s[72:75], s6 offen offset:1024
    buffer_store_dwordx4 v[180:183], v2, s[72:75], s6 offen offset:2048
    buffer_store_dwordx4 v[184:187], v2, s[72:75], s6 offen offset:3072
    s_mov_b32 exec_lo, 0x00ff00ff
    s_mov_b32 exec_hi, 0x00ff00ff
    buffer_store_dwordx4 v[188:191], v194, s[72:75], s7 offen
    s_mov_b64 exec, -1
g1_now3:
    s_waitcnt lgkmcnt(4)
    v_mfma_f32_16x16x32_bf16 v[200:203], v[152:155], v[232:235], v[200:203]
    v_mfma_f32_16x16x32_bf16 v[204:207], v[156:159], v[232:235], v[204:207]
    ds_read_b64_tr_b16 v[244:245], v3 offset:46336
    ds_read_b64_tr_b16 v[246:247], v3 offset:50944
    s_waitcnt lgkmcnt(4)
    v_mfma_f32_16x16x32_bf16 v[208:211], v[152:155], v[236:239], v[208:211]
    v_mfma_f32_16x16x32_bf16 v[212:215], v[156:159], v[236:239], v[212:215]
    s_waitcnt vmcnt(10)
    s_barrier
    ds_read_b64_tr_b16 v[232:233], v4 offset:128
    ds_read_b64_tr_b16 v[234:235], v4 offset:4736
    s_waitcnt lgkmcnt(4)
    v_mfma_f32_16x16x32_bf16 v[216:219], v[152:155], v[240:243], v[216:219]
    v_mfma_f32_16x16x32_bf16 v[220:223], v[156:159], v[240:243], v[220:223]
    s_add_u32 s45, s54, 2359296
    s_add_u32 m0, s46, 18432
    s_nop 0
    buffer_load_dwordx4 v7, s[12:15], s45 offen offset:0 lds
    ds_read_b64_tr_b16 v[236:237], v4 offset:160
    ds_read_b64_tr_b16 v[238:239], v4 offset:4768
    s_waitcnt lgkmcnt(4)
    v_mfma_f32_16x16x32_bf16 v[224:227], v[152:155], v[244:247], v[224:227]
    v_mfma_f32_16x16x32_bf16 v[228:231], v[156:159], v[244:247], v[228:231]
    ds_read_b64_tr_b16 v[240:241], v4 offset:192
    ds_read_b64_tr_b16 v[242:243], v4 offset:4800
    s_waitcnt lgkmcnt(4)
    v_mfma_f32_16x16x32_bf16 v[160:163], v[232:235], v[16:19], 0
    v_mfma_f32_16x16x32_bf16 v[164:167], v[232:235], v[20:23], 0
    s_nop 0
    buffer_load_dwordx4 v8, s[12:15], s45 offen offset:1024 lds
    ds_read_b64_tr_b16 v[244:245], v4 offset:224
    ds_read_b64_tr_b16 v[246:247], v4 offset:4832
    s_and_b32 s100, s4, 3
    s_lshl_b32 s100, s100, 3
    s_add_u32 s100, s100, s3
    s_mul_i32 s100, s100, 62208
    s_add_u32 s100, s100, s56
    v_mul_u32_u24 v15, 1152, v1
    s_mov_b32 exec_lo, 4294967295
    s_mov_b32 exec_hi, 4194303
    buffer_load_dword v0, v15, s[16:19], s100 offen
    buffer_load_dword v15, v15, s[16:19], s100 offen offset:64
    s_mov_b64 exec, -1
    s_waitcnt lgkmcnt(4)
    v_mfma_f32_16x16x32_bf16 v[168:171], v[236:239], v[16:19], 0
    v_mfma_f32_16x16x32_bf16 v[172:175], v[236:239], v[20:23], 0
    ds_read_b64_tr_b16 v[232:233], v4 offset:256
    ds_read_b64_tr_b16 v[234:235], v4 offset:4864
    s_waitcnt lgkmcnt(4)
    v_mfma_f32_16x16x32_bf16 v[176:179], v[240:243], v[16:19], 0
    v_fmaak_f32 v248, v200, v200, 0x41b2e92f
    v_fmaak_f32 v249, v201, v201, 0x41b2e92f
    v_fmaak_f32 v250, v208, v208, 0x41b2e92f
    v_mfma_f32_16x16x32_bf16 v[180:183], v[240:243], v[20:23], 0
    v_fmaak_f32 v251, v209, v209, 0x41b2e92f
    v_mul_f32 v252, s47, v200
    v_mul_f32 v253, s47, v201
    s_mov_b32 exec_hi, 0
    buffer_load_dwordx4 v9, s[12:15], s45 offen offset:2048 lds
    s_mov_b32 exec_hi, -1
    ds_read_b64_tr_b16 v[236:237], v4 offset:9344
    ds_read_b64_tr_b16 v[238:239], v4 offset:13952
    s_waitcnt lgkmcnt(4)
    v_mfma_f32_16x16x32_bf16 v[184:187], v[244:247], v[16:19], 0
    v_mul_f32 v254, s47, v208
    v_mul_f32 v255, s47, v209
    v_mul_f32 v248, v248, v252
    v_mfma_f32_16x16x32_bf16 v[188:191], v[244:247], v[20:23], 0
    v_mul_f32 v249, v249, v253
    v_mul_f32 v250, v250, v254
    v_mul_f32 v251, v251, v255
    ds_read_b64_tr_b16 v[240:241], v4 offset:9376
    ds_read_b64_tr_b16 v[242:243], v4 offset:13984
    s_waitcnt lgkmcnt(4)
    v_mfma_f32_16x16x32_bf16 v[192:195], v[232:235], v[16:19], 0
    v_exp_f32 v248, v248
    v_exp_f32 v249, v249
    v_exp_f32 v250, v250
    v_mfma_f32_16x16x32_bf16 v[196:199], v[232:235], v[20:23], 0
    v_exp_f32 v251, v251
    v_add_f32 v248, 1.0, v248
    v_add_f32 v249, 1.0, v249
    ds_read_b64_tr_b16 v[244:245], v4 offset:9408
    ds_read_b64_tr_b16 v[246:247], v4 offset:14016
    s_waitcnt lgkmcnt(4)
    v_mfma_f32_16x16x32_bf16 v[160:163], v[236:239], v[24:27], v[160:163]
    v_add_f32 v250, 1.0, v250
    v_add_f32 v251, 1.0, v251
    v_rcp_f32 v248, v248
    v_mfma_f32_16x16x32_bf16 v[164:167], v[236:239], v[28:31], v[164:167]
    v_rcp_f32 v249, v249
    v_rcp_f32 v250, v250
    v_rcp_f32 v251, v251
    ds_read_b64_tr_b16 v[232:233], v4 offset:9440
    ds_read_b64_tr_b16 v[234:235], v4 offset:14048
    s_waitcnt lgkmcnt(4)
    v_mfma_f32_16x16x32_bf16 v[168:171], v[240:243], v[24:27], v[168:171]
    v_mul_f32 v252, v200, v248
    v_mul_f32 v253, v201, v249
    v_mul_f32 v254, v208, v250
    v_mfma_f32_16x16x32_bf16 v[172:175], v[240:243], v[28:31], v[172:175]
    v_mul_f32 v255, v209, v251
    v_cvt_pk_bf16_f32 v248, v252, v253
    v_cvt_pk_bf16_f32 v250, v254, v255
    ds_read_b64_tr_b16 v[236:237], v4 offset:9472
    ds_read_b64_tr_b16 v[238:239], v4 offset:14080
    s_waitcnt lgkmcnt(4)
    v_mfma_f32_16x16x32_bf16 v[176:179], v[244:247], v[24:27], v[176:179]
    v_add_f32 v200, v252, v254
    v_mul_f32 v208, v252, v252
    v_add_f32 v201, v253, v255
    v_mfma_f32_16x16x32_bf16 v[180:183], v[244:247], v[28:31], v[180:183]
    v_mul_f32 v209, v253, v253
    ds_write_b32 v13, v248 offset:0
    ds_write_b32 v13, v250 offset:1024
    s_waitcnt vmcnt(12)
    s_barrier
    ds_read_b64_tr_b16 v[240:241], v4 offset:18560
    ds_read_b64_tr_b16 v[242:243], v4 offset:23168
    s_waitcnt lgkmcnt(6)
    v_mfma_f32_16x16x32_bf16 v[184:187], v[232:235], v[24:27], v[184:187]
    v_fmac_f32 v208, v254, v254
    v_fmac_f32 v209, v255, v255
    v_fmaak_f32 v248, v216, v216, 0x41b2e92f
    v_mfma_f32_16x16x32_bf16 v[188:191], v[232:235], v[28:31], v[188:191]
    v_fmaak_f32 v249, v217, v217, 0x41b2e92f
    v_fmaak_f32 v250, v224, v224, 0x41b2e92f
    v_fmaak_f32 v251, v225, v225, 0x41b2e92f
    s_add_u32 s45, s54, 2949120
    s_add_u32 m0, s46, 36864
    s_nop 0
    buffer_load_dwordx4 v7, s[12:15], s45 offen offset:0 lds
    ds_read_b64_tr_b16 v[244:245], v4 offset:18592
    ds_read_b64_tr_b16 v[246:247], v4 offset:23200
    s_waitcnt lgkmcnt(6)
    v_mfma_f32_16x16x32_bf16 v[192:195], v[236:239], v[24:27], v[192:195]
    v_mul_f32 v252, s47, v216
    v_mul_f32 v253, s47, v217
    v_mul_f32 v254, s47, v224
    v_mfma_f32_16x16x32_bf16 v[196:199], v[236:239], v[28:31], v[196:199]
    v_mul_f32 v255, s47, v225
    v_mul_f32 v248, v248, v252
    v_mul_f32 v249, v249, v253
    ds_read_b64_tr_b16 v[232:233], v4 offset:18624
    ds_read_b64_tr_b16 v[234:235], v4 offset:23232
    s_waitcnt lgkmcnt(4)
    v_mfma_f32_16x16x32_bf16 v[160:163], v[240:243], v[32:35], v[160:163]
    v_mul_f32 v250, v250, v254
    v_mul_f32 v251, v251, v255
    v_exp_f32 v248, v248
    v_mfma_f32_16x16x32_bf16 v[164:167], v[240:243], v[36:39], v[164:167]
    v_exp_f32 v249, v249
    v_exp_f32 v250, v250
    v_exp_f32 v251, v251
    s_nop 0
    buffer_load_dwordx4 v8, s[12:15], s45 offen offset:1024 lds
    ds_read_b64_tr_b16 v[236:237], v4 offset:18656
    ds_read_b64_tr_b16 v[238:239], v4 offset:23264
    s_waitcnt lgkmcnt(4)
    v_mfma_f32_16x16x32_bf16 v[168:171], v[244:247], v[32:35], v[168:171]
    v_add_f32 v248, 1.0, v248
    v_add_f32 v249, 1.0, v249
    v_add_f32 v250, 1.0, v250
    v_mfma_f32_16x16x32_bf16 v[172:175], v[244:247], v[36:39], v[172:175]
    v_add_f32 v251, 1.0, v251
    v_rcp_f32 v248, v248
    v_rcp_f32 v249, v249
    ds_read_b64_tr_b16 v[240:241], v4 offset:18688
    ds_read_b64_tr_b16 v[242:243], v4 offset:23296
    s_waitcnt lgkmcnt(4)
    v_mfma_f32_16x16x32_bf16 v[176:179], v[232:235], v[32:35], v[176:179]
    v_rcp_f32 v250, v250
    v_rcp_f32 v251, v251
    v_mul_f32 v252, v216, v248
    v_mfma_f32_16x16x32_bf16 v[180:183], v[232:235], v[36:39], v[180:183]
    v_mul_f32 v253, v217, v249
    v_mul_f32 v254, v224, v250
    v_mul_f32 v255, v225, v251
    s_mov_b32 exec_hi, 0
    buffer_load_dwordx4 v9, s[12:15], s45 offen offset:2048 lds
    s_mov_b32 exec_hi, -1
    ds_read_b64_tr_b16 v[244:245], v4 offset:27776
    ds_read_b64_tr_b16 v[246:247], v4 offset:32384
    s_waitcnt lgkmcnt(4)
    v_mfma_f32_16x16x32_bf16 v[184:187], v[236:239], v[32:35], v[184:187]
    v_cvt_pk_bf16_f32 v248, v252, v253
    v_cvt_pk_bf16_f32 v250, v254, v255
    v_add_f32 v200, v200, v252
    v_mfma_f32_16x16x32_bf16 v[188:191], v[236:239], v[36:39], v[188:191]
    v_fmac_f32 v208, v252, v252
    v_add_f32 v201, v201, v253
    v_fmac_f32 v209, v253, v253
    ds_read_b64_tr_b16 v[232:233], v4 offset:27808
    ds_read_b64_tr_b16 v[234:235], v4 offset:32416
    s_waitcnt lgkmcnt(4)
    v_mfma_f32_16x16x32_bf16 v[192:195], v[240:243], v[32:35], v[192:195]
    ds_write_b32 v13, v248 offset:2048
    ds_write_b32 v13, v250 offset:3072
    v_add_f32 v200, v200, v254
    v_mfma_f32_16x16x32_bf16 v[196:199], v[240:243], v[36:39], v[196:199]
    v_fmac_f32 v208, v254, v254
    v_add_f32 v201, v201, v255
    v_fmac_f32 v209, v255, v255
    ds_read_b64_tr_b16 v[236:237], v4 offset:27840
    ds_read_b64_tr_b16 v[238:239], v4 offset:32448
    s_waitcnt lgkmcnt(6)
    v_mfma_f32_16x16x32_bf16 v[160:163], v[244:247], v[40:43], v[160:163]
    v_fmaak_f32 v248, v202, v202, 0x41b2e92f
    v_fmaak_f32 v249, v203, v203, 0x41b2e92f
    v_fmaak_f32 v250, v210, v210, 0x41b2e92f
    v_mfma_f32_16x16x32_bf16 v[164:167], v[244:247], v[44:47], v[164:167]
    v_fmaak_f32 v251, v211, v211, 0x41b2e92f
    v_mul_f32 v252, s47, v202
    v_mul_f32 v253, s47, v203
    ds_read_b64_tr_b16 v[240:241], v4 offset:27872
    ds_read_b64_tr_b16 v[242:243], v4 offset:32480
    s_waitcnt lgkmcnt(6)
    v_mfma_f32_16x16x32_bf16 v[168:171], v[232:235], v[40:43], v[168:171]
    v_mul_f32 v254, s47, v210
    v_mul_f32 v255, s47, v211
    v_mul_f32 v248, v248, v252
    v_mfma_f32_16x16x32_bf16 v[172:175], v[232:235], v[44:47], v[172:175]
    v_mul_f32 v249, v249, v253
    v_mul_f32 v250, v250, v254
    v_mul_f32 v251, v251, v255
    ds_read_b64_tr_b16 v[244:245], v4 offset:27904
    ds_read_b64_tr_b16 v[246:247], v4 offset:32512
    s_waitcnt lgkmcnt(4)
    v_mfma_f32_16x16x32_bf16 v[176:179], v[236:239], v[40:43], v[176:179]
    v_exp_f32 v248, v248
    v_exp_f32 v249, v249
    v_exp_f32 v250, v250
    v_mfma_f32_16x16x32_bf16 v[180:183], v[236:239], v[44:47], v[180:183]
    v_exp_f32 v251, v251
    v_add_f32 v248, 1.0, v248
    v_add_f32 v249, 1.0, v249
    s_waitcnt vmcnt(12)
    s_barrier
    ds_read_b64_tr_b16 v[232:233], v4 offset:36992
    ds_read_b64_tr_b16 v[234:235], v4 offset:41600
    s_waitcnt lgkmcnt(4)
    v_mfma_f32_16x16x32_bf16 v[184:187], v[240:243], v[40:43], v[184:187]
    v_add_f32 v250, 1.0, v250
    v_add_f32 v251, 1.0, v251
    v_rcp_f32 v248, v248
    v_mfma_f32_16x16x32_bf16 v[188:191], v[240:243], v[44:47], v[188:191]
    v_rcp_f32 v249, v249
    v_rcp_f32 v250, v250
    v_rcp_f32 v251, v251
    s_add_u32 s45, s54, 3538944
    s_add_u32 m0, s46, 55296
    s_nop 0
    buffer_load_dwordx4 v7, s[12:15], s45 offen offset:0 lds
    ds_read_b64_tr_b16 v[236:237], v4 offset:37024
    ds_read_b64_tr_b16 v[238:239], v4 offset:41632
    s_waitcnt lgkmcnt(4)
    v_mfma_f32_16x16x32_bf16 v[192:195], v[244:247], v[40:43], v[192:195]
    v_mul_f32 v252, v202, v248
    v_mul_f32 v253, v203, v249
    v_mul_f32 v254, v210, v250
    v_mfma_f32_16x16x32_bf16 v[196:199], v[244:247], v[44:47], v[196:199]
    v_mul_f32 v255, v211, v251
    v_cvt_pk_bf16_f32 v248, v252, v253
    v_cvt_pk_bf16_f32 v250, v254, v255
    ds_read_b64_tr_b16 v[240:241], v4 offset:37056
    ds_read_b64_tr_b16 v[242:243], v4 offset:41664
    s_waitcnt lgkmcnt(4)
    v_mfma_f32_16x16x32_bf16 v[160:163], v[232:235], v[48:51], v[160:163]
    v_add_f32 v202, v252, v254
    v_mul_f32 v210, v252, v252
    v_add_f32 v203, v253, v255
    v_mfma_f32_16x16x32_bf16 v[164:167], v[232:235], v[52:55], v[164:167]
    v_mul_f32 v211, v253, v253
    ds_write_b32 v13, v248 offset:256
    ds_write_b32 v13, v250 offset:1280
    s_nop 0
    buffer_load_dwordx4 v8, s[12:15], s45 offen offset:1024 lds
    ds_read_b64_tr_b16 v[244:245], v4 offset:37088
    ds_read_b64_tr_b16 v[246:247], v4 offset:41696
    s_waitcnt lgkmcnt(6)
    v_mfma_f32_16x16x32_bf16 v[168:171], v[236:239], v[48:51], v[168:171]
    v_fmac_f32 v210, v254, v254
    v_fmac_f32 v211, v255, v255
    v_fmaak_f32 v248, v218, v218, 0x41b2e92f
    v_mfma_f32_16x16x32_bf16 v[172:175], v[236:239], v[52:55], v[172:175]
    v_fmaak_f32 v249, v219, v219, 0x41b2e92f
    v_fmaak_f32 v250, v226, v226, 0x41b2e92f
    v_fmaak_f32 v251, v227, v227, 0x41b2e92f
    ds_read_b64_tr_b16 v[232:233], v4 offset:37120
    ds_read_b64_tr_b16 v[234:235], v4 offset:41728
    s_waitcnt lgkmcnt(6)
    v_mfma_f32_16x16x32_bf16 v[176:179], v[240:243], v[48:51], v[176:179]
    v_mul_f32 v252, s47, v218
    v_mul_f32 v253, s47, v219
    v_mul_f32 v254, s47, v226
    v_mfma_f32_16x16x32_bf16 v[180:183], v[240:243], v[52:55], v[180:183]
    v_mul_f32 v255, s47, v227
    v_mul_f32 v248, v248, v252
    v_mul_f32 v249, v249, v253
    s_mov_b32 exec_hi, 0
    buffer_load_dwordx4 v9, s[12:15], s45 offen offset:2048 lds
    s_mov_b32 exec_hi, -1
    ds_read_b64_tr_b16 v[236:237], v4 offset:46208
    ds_read_b64_tr_b16 v[238:239], v4 offset:50816
    s_waitcnt lgkmcnt(4)
    v_mfma_f32_16x16x32_bf16 v[184:187], v[244:247], v[48:51], v[184:187]
    v_mul_f32 v250, v250, v254
    v_mul_f32 v251, v251, v255
    v_exp_f32 v248, v248
    v_mfma_f32_16x16x32_bf16 v[188:191], v[244:247], v[52:55], v[188:191]
    v_exp_f32 v249, v249
    v_exp_f32 v250, v250
    v_exp_f32 v251, v251
    ds_read_b64_tr_b16 v[240:241], v4 offset:46240
    ds_read_b64_tr_b16 v[242:243], v4 offset:50848
    s_waitcnt lgkmcnt(4)
    v_mfma_f32_16x16x32_bf16 v[192:195], v[232:235], v[48:51], v[192:195]
    v_add_f32 v248, 1.0, v248
    v_add_f32 v249, 1.0, v249
    v_add_f32 v250, 1.0, v250
    v_mfma_f32_16x16x32_bf16 v[196:199], v[232:235], v[52:55], v[196:199]
    v_add_f32 v251, 1.0, v251
    v_rcp_f32 v248, v248
    v_rcp_f32 v249, v249
    ds_read_b64_tr_b16 v[244:245], v4 offset:46272
    ds_read_b64_tr_b16 v[246:247], v4 offset:50880
    s_waitcnt lgkmcnt(4)
    v_mfma_f32_16x16x32_bf16 v[160:163], v[236:239], v[56:59], v[160:163]
    v_rcp_f32 v250, v250
    v_rcp_f32 v251, v251
    v_mul_f32 v252, v218, v248
    v_mfma_f32_16x16x32_bf16 v[164:167], v[236:239], v[60:63], v[164:167]
    v_mul_f32 v253, v219, v249
    v_mul_f32 v254, v226, v250
    v_mul_f32 v255, v227, v251
    ds_read_b64_tr_b16 v[232:233], v4 offset:46304
    ds_read_b64_tr_b16 v[234:235], v4 offset:50912
    s_waitcnt lgkmcnt(4)
    v_mfma_f32_16x16x32_bf16 v[168:171], v[240:243], v[56:59], v[168:171]
    v_cvt_pk_bf16_f32 v248, v252, v253
    v_cvt_pk_bf16_f32 v250, v254, v255
    v_add_f32 v202, v202, v252
    v_mfma_f32_16x16x32_bf16 v[172:175], v[240:243], v[60:63], v[172:175]
    v_fmac_f32 v210, v252, v252
    v_add_f32 v203, v203, v253
    v_fmac_f32 v211, v253, v253
    ds_read_b64_tr_b16 v[236:237], v4 offset:46336
    ds_read_b64_tr_b16 v[238:239], v4 offset:50944
    s_waitcnt lgkmcnt(4)
    v_mfma_f32_16x16x32_bf16 v[176:179], v[244:247], v[56:59], v[176:179]
    ds_write_b32 v13, v248 offset:2304
    ds_write_b32 v13, v250 offset:3328
    v_add_f32 v202, v202, v254
    v_mfma_f32_16x16x32_bf16 v[180:183], v[244:247], v[60:63], v[180:183]
    v_fmac_f32 v210, v254, v254
    v_add_f32 v203, v203, v255
    v_fmac_f32 v211, v255, v255
    s_waitcnt vmcnt(11)
    s_barrier
    ds_read_b64_tr_b16 v[240:241], v3 offset:128
    ds_read_b64_tr_b16 v[242:243], v3 offset:4736
    s_waitcnt lgkmcnt(6)
    v_mfma_f32_16x16x32_bf16 v[184:187], v[232:235], v[56:59], v[184:187]
    v_fmaak_f32 v248, v204, v204, 0x41b2e92f
    v_fmaak_f32 v249, v205, v205, 0x41b2e92f
    v_fmaak_f32 v250, v212, v212, 0x41b2e92f
    v_mfma_f32_16x16x32_bf16 v[188:191], v[232:235], v[60:63], v[188:191]
    v_fmaak_f32 v251, v213, v213, 0x41b2e92f
    v_mul_f32 v252, s47, v204
    v_mul_f32 v253, s47, v205
    s_add_u32 s45, s54, 4128768
    s_add_u32 m0, s46, 73728
    s_nop 0
    buffer_load_dwordx4 v7, s[12:15], s45 offen offset:0 lds
    ds_read_b64_tr_b16 v[244:245], v3 offset:160
    ds_read_b64_tr_b16 v[246:247], v3 offset:4768
    s_waitcnt lgkmcnt(6)
    v_mfma_f32_16x16x32_bf16 v[192:195], v[236:239], v[56:59], v[192:195]
    v_mul_f32 v254, s47, v212
    v_mul_f32 v255, s47, v213
    v_mul_f32 v248, v248, v252
    v_mfma_f32_16x16x32_bf16 v[196:199], v[236:239], v[60:63], v[196:199]
    v_mul_f32 v249, v249, v253
    v_mul_f32 v250, v250, v254
    v_mul_f32 v251, v251, v255
    ds_read_b64_tr_b16 v[232:233], v3 offset:192
    ds_read_b64_tr_b16 v[234:235], v3 offset:4800
    s_waitcnt lgkmcnt(4)
    v_mfma_f32_16x16x32_bf16 v[160:163], v[240:243], v[64:67], v[160:163]
    v_exp_f32 v248, v248
    v_exp_f32 v249, v249
    v_exp_f32 v250, v250
    v_mfma_f32_16x16x32_bf16 v[164:167], v[240:243], v[68:71], v[164:167]
    v_exp_f32 v251, v251
    v_add_f32 v248, 1.0, v248
    v_add_f32 v249, 1.0, v249
    s_nop 0
    buffer_load_dwordx4 v8, s[12:15], s45 offen offset:1024 lds
    ds_read_b64_tr_b16 v[236:237], v3 offset:224
    ds_read_b64_tr_b16 v[238:239], v3 offset:4832
    s_waitcnt lgkmcnt(4)
    v_mfma_f32_16x16x32_bf16 v[168:171], v[244:247], v[64:67], v[168:171]
    v_add_f32 v250, 1.0, v250
    v_add_f32 v251, 1.0, v251
    v_rcp_f32 v248, v248
    v_mfma_f32_16x16x32_bf16 v[172:175], v[244:247], v[68:71], v[172:175]
    v_rcp_f32 v249, v249
    v_rcp_f32 v250, v250
    v_rcp_f32 v251, v251
    ds_read_b64_tr_b16 v[240:241], v3 offset:256
    ds_read_b64_tr_b16 v[242:243], v3 offset:4864
    s_waitcnt lgkmcnt(4)
    v_mfma_f32_16x16x32_bf16 v[176:179], v[232:235], v[64:67], v[176:179]
    v_mul_f32 v252, v204, v248
    v_mul_f32 v253, v205, v249
    v_mul_f32 v254, v212, v250
    v_mfma_f32_16x16x32_bf16 v[180:183], v[232:235], v[68:71], v[180:183]
    v_mul_f32 v255, v213, v251
    v_cvt_pk_bf16_f32 v248, v252, v253
    v_cvt_pk_bf16_f32 v250, v254, v255
    s_mov_b32 exec_hi, 0
    buffer_load_dwordx4 v9, s[12:15], s45 offen offset:2048 lds
    s_mov_b32 exec_hi, -1
    ds_read_b64_tr_b16 v[244:245], v3 offset:9344
    ds_read_b64_tr_b16 v[246:247], v3 offset:13952
    s_waitcnt lgkmcnt(4)
    v_mfma_f32_16x16x32_bf16 v[184:187], v[236:239], v[64:67], v[184:187]
    v_add_f32 v204, v252, v254
    v_mul_f32 v212, v252, v252
    v_add_f32 v205, v253, v255
    v_mfma_f32_16x16x32_bf16 v[188:191], v[236:239], v[68:71], v[188:191]
    v_mul_f32 v213, v253, v253
    ds_write_b32 v13, v248 offset:512
    ds_write_b32 v13, v250 offset:1536
    ds_read_b64_tr_b16 v[232:233], v3 offset:9376
    ds_read_b64_tr_b16 v[234:235], v3 offset:13984
    s_waitcnt lgkmcnt(6)
    v_mfma_f32_16x16x32_bf16 v[192:195], v[240:243], v[64:67], v[192:195]
    v_fmac_f32 v212, v254, v254
    v_fmac_f32 v213, v255, v255
    v_fmaak_f32 v248, v220, v220, 0x41b2e92f
    v_mfma_f32_16x16x32_bf16 v[196:199], v[240:243], v[68:71], v[196:199]
    v_fmaak_f32 v249, v221, v221, 0x41b2e92f
    v_fmaak_f32 v250, v228, v228, 0x41b2e92f
    v_fmaak_f32 v251, v229, v229, 0x41b2e92f
    ds_read_b64_tr_b16 v[236:237], v3 offset:9408
    ds_read_b64_tr_b16 v[238:239], v3 offset:14016
    s_waitcnt lgkmcnt(6)
    v_mfma_f32_16x16x32_bf16 v[160:163], v[244:247], v[72:75], v[160:163]
    v_mul_f32 v252, s47, v220
    v_mul_f32 v253, s47, v221
    v_mul_f32 v254, s47, v228
    v_mfma_f32_16x16x32_bf16 v[164:167], v[244:247], v[76:79], v[164:167]
    v_mul_f32 v255, s47, v229
    v_mul_f32 v248, v248, v252
    v_mul_f32 v249, v249, v253
    ds_read_b64_tr_b16 v[240:241], v3 offset:9440
    ds_read_b64_tr_b16 v[242:243], v3 offset:14048
    s_waitcnt lgkmcnt(4)
    v_mfma_f32_16x16x32_bf16 v[168:171], v[232:235], v[72:75], v[168:171]
    v_mul_f32 v250, v250, v254
    v_mul_f32 v251, v251, v255
    v_exp_f32 v248, v248
    v_mfma_f32_16x16x32_bf16 v[172:175], v[232:235], v[76:79], v[172:175]
    v_exp_f32 v249, v249
    v_exp_f32 v250, v250
    v_exp_f32 v251, v251
    ds_read_b64_tr_b16 v[244:245], v3 offset:9472
    ds_read_b64_tr_b16 v[246:247], v3 offset:14080
    s_waitcnt lgkmcnt(4)
    v_mfma_f32_16x16x32_bf16 v[176:179], v[236:239], v[72:75], v[176:179]
    v_add_f32 v248, 1.0, v248
    v_add_f32 v249, 1.0, v249
    v_add_f32 v250, 1.0, v250
    v_mfma_f32_16x16x32_bf16 v[180:183], v[236:239], v[76:79], v[180:183]
    v_add_f32 v251, 1.0, v251
    v_rcp_f32 v248, v248
    v_rcp_f32 v249, v249
    s_waitcnt vmcnt(9)
    s_barrier
    ds_read_b64_tr_b16 v[232:233], v3 offset:18560
    ds_read_b64_tr_b16 v[234:235], v3 offset:23168
    s_waitcnt lgkmcnt(4)
    v_mfma_f32_16x16x32_bf16 v[184:187], v[240:243], v[72:75], v[184:187]
    v_rcp_f32 v250, v250
    v_rcp_f32 v251, v251
    v_mul_f32 v252, v220, v248
    v_mfma_f32_16x16x32_bf16 v[188:191], v[240:243], v[76:79], v[188:191]
    v_mul_f32 v253, v221, v249
    v_mul_f32 v254, v228, v250
    v_mul_f32 v255, v229, v251
    s_add_u32 s45, s54, 4718592
    s_add_u32 m0, s46, 92160
    s_nop 0
    buffer_load_dwordx4 v7, s[12:15], s45 offen offset:0 lds
    ds_read_b64_tr_b16 v[236:237], v3 offset:18592
    ds_read_b64_tr_b16 v[238:239], v3 offset:23200
    s_waitcnt lgkmcnt(4)
    v_mfma_f32_16x16x32_bf16 v[192:195], v[244:247], v[72:75], v[192:195]
    v_cvt_pk_bf16_f32 v248, v252, v253
    v_cvt_pk_bf16_f32 v250, v254, v255
    v_add_f32 v204, v204, v252
    v_mfma_f32_16x16x32_bf16 v[196:199], v[244:247], v[76:79], v[196:199]
    v_fmac_f32 v212, v252, v252
    v_add_f32 v205, v205, v253
    v_fmac_f32 v213, v253, v253
    ds_read_b64_tr_b16 v[240:241], v3 offset:18624
    ds_read_b64_tr_b16 v[242:243], v3 offset:23232
    s_waitcnt lgkmcnt(4)
    v_mfma_f32_16x16x32_bf16 v[160:163], v[232:235], v[80:83], v[160:163]
    ds_write_b32 v13, v248 offset:2560
    ds_write_b32 v13, v250 offset:3584
    v_add_f32 v204, v204, v254
    v_mfma_f32_16x16x32_bf16 v[164:167], v[232:235], v[84:87], v[164:167]
    v_fmac_f32 v212, v254, v254
    v_add_f32 v205, v205, v255
    v_fmac_f32 v213, v255, v255
    s_nop 0
    buffer_load_dwordx4 v8, s[12:15], s45 offen offset:1024 lds
    ds_read_b64_tr_b16 v[244:245], v3 offset:18656
    ds_read_b64_tr_b16 v[246:247], v3 offset:23264
    s_waitcnt lgkmcnt(6)
    v_mfma_f32_16x16x32_bf16 v[168:171], v[236:239], v[80:83], v[168:171]
    v_fmaak_f32 v248, v206, v206, 0x41b2e92f
    v_fmaak_f32 v249, v207, v207, 0x41b2e92f
    v_fmaak_f32 v250, v214, v214, 0x41b2e92f
    v_mfma_f32_16x16x32_bf16 v[172:175], v[236:239], v[84:87], v[172:175]
    v_fmaak_f32 v251, v215, v215, 0x41b2e92f
    v_mul_f32 v252, s47, v206
    v_mul_f32 v253, s47, v207
    ds_read_b64_tr_b16 v[232:233], v3 offset:18688
    ds_read_b64_tr_b16 v[234:235], v3 offset:23296
    s_waitcnt lgkmcnt(6)
    v_mfma_f32_16x16x32_bf16 v[176:179], v[240:243], v[80:83], v[176:179]
    v_mul_f32 v254, s47, v214
    v_mul_f32 v255, s47, v215
    v_mul_f32 v248, v248, v252
    v_mfma_f32_16x16x32_bf16 v[180:183], v[240:243], v[84:87], v[180:183]
    v_mul_f32 v249, v249, v253
    v_mul_f32 v250, v250, v254
    v_mul_f32 v251, v251, v255
    s_mov_b32 exec_hi, 0
    buffer_load_dwordx4 v9, s[12:15], s45 offen offset:2048 lds
    s_mov_b32 exec_hi, -1
    ds_read_b64_tr_b16 v[236:237], v3 offset:27776
    ds_read_b64_tr_b16 v[238:239], v3 offset:32384
    s_waitcnt lgkmcnt(4)
    v_mfma_f32_16x16x32_bf16 v[184:187], v[244:247], v[80:83], v[184:187]
    v_exp_f32 v248, v248
    v_exp_f32 v249, v249
    v_exp_f32 v250, v250
    v_mfma_f32_16x16x32_bf16 v[188:191], v[244:247], v[84:87], v[188:191]
    v_exp_f32 v251, v251
    v_add_f32 v248, 1.0, v248
    v_add_f32 v249, 1.0, v249
    ds_read_b64_tr_b16 v[240:241], v3 offset:27808
    ds_read_b64_tr_b16 v[242:243], v3 offset:32416
    s_waitcnt lgkmcnt(4)
    v_mfma_f32_16x16x32_bf16 v[192:195], v[232:235], v[80:83], v[192:195]
    v_add_f32 v250, 1.0, v250
    v_add_f32 v251, 1.0, v251
    v_rcp_f32 v248, v248
    v_mfma_f32_16x16x32_bf16 v[196:199], v[232:235], v[84:87], v[196:199]
    v_rcp_f32 v249, v249
    v_rcp_f32 v250, v250
    v_rcp_f32 v251, v251
    ds_read_b64_tr_b16 v[244:245], v3 offset:27840
    ds_read_b64_tr_b16 v[246:247], v3 offset:32448
    s_waitcnt lgkmcnt(4)
    v_mfma_f32_16x16x32_bf16 v[160:163], v[236:239], v[88:91], v[160:163]
    v_mul_f32 v252, v206, v248
    v_mul_f32 v253, v207, v249
    v_mul_f32 v254, v214, v250
    v_mfma_f32_16x16x32_bf16 v[164:167], v[236:239], v[92:95], v[164:167]
    v_mul_f32 v255, v215, v251
    v_cvt_pk_bf16_f32 v248, v252, v253
    v_cvt_pk_bf16_f32 v250, v254, v255
    ds_read_b64_tr_b16 v[232:233], v3 offset:27872
    ds_read_b64_tr_b16 v[234:235], v3 offset:32480
    s_waitcnt lgkmcnt(4)
    v_mfma_f32_16x16x32_bf16 v[168:171], v[240:243], v[88:91], v[168:171]
    v_add_f32 v206, v252, v254
    v_mul_f32 v214, v252, v252
    v_add_f32 v207, v253, v255
    v_mfma_f32_16x16x32_bf16 v[172:175], v[240:243], v[92:95], v[172:175]
    v_mul_f32 v215, v253, v253
    ds_write_b32 v13, v248 offset:768
    ds_write_b32 v13, v250 offset:1792
    ds_read_b64_tr_b16 v[236:237], v3 offset:27904
    ds_read_b64_tr_b16 v[238:239], v3 offset:32512
    s_waitcnt lgkmcnt(6)
    v_mfma_f32_16x16x32_bf16 v[176:179], v[244:247], v[88:91], v[176:179]
    v_fmac_f32 v214, v254, v254
    v_fmac_f32 v215, v255, v255
    v_fmaak_f32 v248, v222, v222, 0x41b2e92f
    v_mfma_f32_16x16x32_bf16 v[180:183], v[244:247], v[92:95], v[180:183]
    v_fmaak_f32 v249, v223, v223, 0x41b2e92f
    v_fmaak_f32 v250, v230, v230, 0x41b2e92f
    v_fmaak_f32 v251, v231, v231, 0x41b2e92f
    s_waitcnt vmcnt(9)
    s_barrier
    ds_read_b64_tr_b16 v[240:241], v3 offset:36992
    ds_read_b64_tr_b16 v[242:243], v3 offset:41600
    s_waitcnt lgkmcnt(6)
    v_mfma_f32_16x16x32_bf16 v[184:187], v[232:235], v[88:91], v[184:187]
    v_mul_f32 v252, s47, v222
    v_mul_f32 v253, s47, v223
    v_mul_f32 v254, s47, v230
    v_mfma_f32_16x16x32_bf16 v[188:191], v[232:235], v[92:95], v[188:191]
    v_mul_f32 v255, s47, v231
    v_mul_f32 v248, v248, v252
    v_mul_f32 v249, v249, v253
    s_add_u32 s45, s56, 0
    s_add_u32 m0, s46, 0
    s_nop 0
    buffer_load_dwordx4 v10, s[16:19], s45 offen offset:0 lds
    ds_read_b64_tr_b16 v[244:245], v3 offset:37024
    ds_read_b64_tr_b16 v[246:247], v3 offset:41632
    s_waitcnt lgkmcnt(4)
    v_mfma_f32_16x16x32_bf16 v[192:195], v[236:239], v[88:91], v[192:195]
    v_mul_f32 v250, v250, v254
    v_mul_f32 v251, v251, v255
    v_exp_f32 v248, v248
    v_mfma_f32_16x16x32_bf16 v[196:199], v[236:239], v[92:95], v[196:199]
    v_exp_f32 v249, v249
    v_exp_f32 v250, v250
    v_exp_f32 v251, v251
    ds_read_b64_tr_b16 v[232:233], v3 offset:37056
    ds_read_b64_tr_b16 v[234:235], v3 offset:41664
    s_waitcnt lgkmcnt(4)
    v_mfma_f32_16x16x32_bf16 v[160:163], v[240:243], v[96:99], v[160:163]
    v_add_f32 v248, 1.0, v248
    v_add_f32 v249, 1.0, v249
    v_add_f32 v250, 1.0, v250
    v_mfma_f32_16x16x32_bf16 v[164:167], v[240:243], v[100:103], v[164:167]
    v_add_f32 v251, 1.0, v251
    v_rcp_f32 v248, v248
    v_rcp_f32 v249, v249
    s_nop 0
    buffer_load_dwordx4 v11, s[16:19], s45 offen offset:1024 lds
    ds_read_b64_tr_b16 v[236:237], v3 offset:37088
    ds_read_b64_tr_b16 v[238:239], v3 offset:41696
    s_lshl_b32 s100, s2, 3
    s_add_u32 s100, s100, s3
    s_lshl_b32 s100, s100, 12
    s_mov_b32 exec_lo, 16711680
    s_mov_b32 exec_hi, 0
    v_lshlrev_b32 v0, 7, v1
    buffer_load_dword v0, v0, s[76:79], s100 offen
    s_mov_b64 exec, -1
    s_waitcnt lgkmcnt(4)
    v_mfma_f32_16x16x32_bf16 v[168:171], v[244:247], v[96:99], v[168:171]
    v_rcp_f32 v250, v250
    v_rcp_f32 v251, v251
    v_mul_f32 v252, v222, v248
    v_mfma_f32_16x16x32_bf16 v[172:175], v[244:247], v[100:103], v[172:175]
    v_mul_f32 v253, v223, v249
    v_mul_f32 v254, v230, v250
    v_mul_f32 v255, v231, v251
    ds_read_b64_tr_b16 v[240:241], v3 offset:37120
    ds_read_b64_tr_b16 v[242:243], v3 offset:41728
    s_waitcnt lgkmcnt(4)
    v_mfma_f32_16x16x32_bf16 v[176:179], v[232:235], v[96:99], v[176:179]
    v_cvt_pk_bf16_f32 v248, v252, v253
    v_cvt_pk_bf16_f32 v250, v254, v255
    v_add_f32 v206, v206, v252
    v_mfma_f32_16x16x32_bf16 v[180:183], v[232:235], v[100:103], v[180:183]
    v_fmac_f32 v214, v252, v252
    v_add_f32 v207, v207, v253
    v_fmac_f32 v215, v253, v253
    s_mov_b32 exec_hi, 0
    buffer_load_dwordx4 v12, s[16:19], s45 offen offset:2048 lds
    s_mov_b32 exec_hi, -1
    ds_read_b64_tr_b16 v[244:245], v3 offset:46208
    ds_read_b64_tr_b16 v[246:247], v3 offset:50816
    s_waitcnt lgkmcnt(4)
    v_mfma_f32_16x16x32_bf16 v[184:187], v[236:239], v[96:99], v[184:187]
    ds_write_b32 v13, v248 offset:2816
    ds_write_b32 v13, v250 offset:3840
    v_add_f32 v206, v206, v254
    v_mfma_f32_16x16x32_bf16 v[188:191], v[236:239], v[100:103], v[188:191]
    v_fmac_f32 v214, v254, v254
    v_add_f32 v207, v207, v255
    v_fmac_f32 v215, v255, v255
    ds_read_b64_tr_b16 v[232:233], v3 offset:46240
    ds_read_b64_tr_b16 v[234:235], v3 offset:50848
    s_waitcnt lgkmcnt(6)
    v_mfma_f32_16x16x32_bf16 v[192:195], v[240:243], v[96:99], v[192:195]
    s_nop 1
    v_add_f32_dpp v200, v200, v200 row_mirror row_mask:0xf bank_mask:0x3
    v_add_f32_dpp v201, v201, v201 row_mirror row_mask:0xf bank_mask:0x3
    v_mfma_f32_16x16x32_bf16 v[196:199], v[240:243], v[100:103], v[196:199]
    v_add_f32_dpp v202, v202, v202 row_mirror row_mask:0xf bank_mask:0x3
    v_add_f32_dpp v203, v203, v203 row_mirror row_mask:0xf bank_mask:0x3
    v_add_f32_dpp v208, v208, v208 row_mirror row_mask:0xf bank_mask:0x3
    ds_read_b64_tr_b16 v[236:237], v3 offset:46272
    ds_read_b64_tr_b16 v[238:239], v3 offset:50880
    s_waitcnt lgkmcnt(6)
    v_mfma_f32_16x16x32_bf16 v[160:163], v[244:247], v[104:107], v[160:163]
    v_add_f32_dpp v209, v209, v209 row_mirror row_mask:0xf bank_mask:0x3
    v_add_f32_dpp v210, v210, v210 row_mirror row_mask:0xf bank_mask:0x3
    v_add_f32_dpp v211, v211, v211 row_mirror row_mask:0xf bank_mask:0x3
    v_mfma_f32_16x16x32_bf16 v[164:167], v[244:247], v[108:111], v[164:167]
    v_add_f32_dpp v200, v204, v204 row_mirror row_mask:0xf bank_mask:0xc
    v_add_f32_dpp v201, v205, v205 row_mirror row_mask:0xf bank_mask:0xc
    v_add_f32_dpp v202, v206, v206 row_mirror row_mask:0xf bank_mask:0xc
    ds_read_b64_tr_b16 v[240:241], v3 offset:46304
    ds_read_b64_tr_b16 v[242:243], v3 offset:50912
    s_waitcnt lgkmcnt(4)
    v_mfma_f32_16x16x32_bf16 v[168:171], v[232:235], v[104:107], v[168:171]
    v_add_f32_dpp v203, v207, v207 row_mirror row_mask:0xf bank_mask:0xc
    v_add_f32_dpp v208, v212, v212 row_mirror row_mask:0xf bank_mask:0xc
    v_add_f32_dpp v209, v213, v213 row_mirror row_mask:0xf bank_mask:0xc
    v_mfma_f32_16x16x32_bf16 v[172:175], v[232:235], v[108:111], v[172:175]
    v_add_f32_dpp v210, v214, v214 row_mirror row_mask:0xf bank_mask:0xc
    v_add_f32_dpp v211, v215, v215 row_mirror row_mask:0xf bank_mask:0xc
    v_add_f32_dpp v200, v200, v200 row_half_mirror row_mask:0xf bank_mask:0x5
    ds_read_b64_tr_b16 v[244:245], v3 offset:46336
    ds_read_b64_tr_b16 v[246:247], v3 offset:50944
    s_waitcnt lgkmcnt(4)
    v_mfma_f32_16x16x32_bf16 v[176:179], v[236:239], v[104:107], v[176:179]
    v_add_f32_dpp v201, v201, v201 row_half_mirror row_mask:0xf bank_mask:0x5
    v_add_f32_dpp v208, v208, v208 row_half_mirror row_mask:0xf bank_mask:0x5
    v_add_f32_dpp v209, v209, v209 row_half_mirror row_mask:0xf bank_mask:0x5
    v_mfma_f32_16x16x32_bf16 v[180:183], v[236:239], v[108:111], v[180:183]
    v_add_f32_dpp v200, v202, v202 row_half_mirror row_mask:0xf bank_mask:0xa
    v_add_f32_dpp v201, v203, v203 row_half_mirror row_mask:0xf bank_mask:0xa
    v_add_f32_dpp v208, v210, v210 row_half_mirror row_mask:0xf bank_mask:0xa
    s_waitcnt vmcnt(10)
    s_barrier
    ds_read_b64_tr_b16 v[232:233], v4 offset:128
    ds_read_b64_tr_b16 v[234:235], v4 offset:4736
    s_waitcnt lgkmcnt(4)
    v_mfma_f32_16x16x32_bf16 v[184:187], v[240:243], v[104:107], v[184:187]
    v_add_f32_dpp v209, v211, v211 row_half_mirror row_mask:0xf bank_mask:0xa
    v_add_f32_dpp v200, v200, v200 quad_perm:[1,0,3,2] row_mask:0xf bank_mask:0xf
    v_add_f32_dpp v201, v201, v201 quad_perm:[1,0,3,2] row_mask:0xf bank_mask:0xf
    v_mfma_f32_16x16x32_bf16 v[188:191], v[240:243], v[108:111], v[188:191]
    v_add_f32_dpp v208, v208, v208 quad_perm:[1,0,3,2] row_mask:0xf bank_mask:0xf
    v_add_f32_dpp v209, v209, v209 quad_perm:[1,0,3,2] row_mask:0xf bank_mask:0xf
    v_add_f32_dpp v200, v200, v200 quad_perm:[2,3,0,1] row_mask:0xf bank_mask:0xf
    s_add_u32 s45, s56, 221184
    s_add_u32 m0, s46, 18432
    s_nop 0
    buffer_load_dwordx4 v10, s[16:19], s45 offen offset:0 lds
    ds_read_b64_tr_b16 v[236:237], v4 offset:160
    ds_read_b64_tr_b16 v[238:239], v4 offset:4768
    s_waitcnt lgkmcnt(4)
    v_mfma_f32_16x16x32_bf16 v[192:195], v[244:247], v[104:107], v[192:195]
    v_add_f32_dpp v201, v201, v201 quad_perm:[2,3,0,1] row_mask:0xf bank_mask:0xf
    v_add_f32_dpp v208, v208, v208 quad_perm:[2,3,0,1] row_mask:0xf bank_mask:0xf
    v_add_f32_dpp v209, v209, v209 quad_perm:[2,3,0,1] row_mask:0xf bank_mask:0xf
    v_mfma_f32_16x16x32_bf16 v[196:199], v[244:247], v[108:111], v[196:199]
    s_mov_b32 s60, 0xaaaaaaaa
    s_mov_b32 s61, 0xaaaaaaaa
    s_lshl_b32 s6, s44, 9
    s_add_u32 s6, s6, 155904
    v_lshlrev_b32 v255, 3, v1
    ds_read_b64_tr_b16 v[240:241], v4 offset:192
    ds_read_b64_tr_b16 v[242:243], v4 offset:4800
    s_waitcnt lgkmcnt(4)
    v_mfma_f32_16x16x32_bf16 v[160:163], v[232:235], v[112:115], v[160:163]
    v_add_u32 v255, s6, v255
    v_cndmask_b32 v248, v200, v201, s[60:61]
    v_cndmask_b32 v249, v208, v209, s[60:61]
    v_mfma_f32_16x16x32_bf16 v[164:167], v[232:235], v[116:119], v[164:167]
    ds_write_b64 v255, v[248:249]
    s_nop 0
    buffer_load_dwordx4 v11, s[16:19], s45 offen offset:1024 lds
    ds_read_b64_tr_b16 v[244:245], v4 offset:224
    ds_read_b64_tr_b16 v[246:247], v4 offset:4832
    s_waitcnt lgkmcnt(5)
    v_mfma_f32_16x16x32_bf16 v[168:171], v[236:239], v[112:115], v[168:171]
    v_mfma_f32_16x16x32_bf16 v[172:175], v[236:239], v[116:119], v[172:175]
    ds_read_b64_tr_b16 v[232:233], v4 offset:256
    ds_read_b64_tr_b16 v[234:235], v4 offset:4864
    s_waitcnt lgkmcnt(5)
    v_mfma_f32_16x16x32_bf16 v[176:179], v[240:243], v[112:115], v[176:179]
    v_mfma_f32_16x16x32_bf16 v[180:183], v[240:243], v[116:119], v[180:183]
    s_mov_b32 exec_hi, 0
    buffer_load_dwordx4 v12, s[16:19], s45 offen offset:2048 lds
    s_mov_b32 exec_hi, -1
    ds_read_b64_tr_b16 v[236:237], v4 offset:9344
    ds_read_b64_tr_b16 v[238:239], v4 offset:13952
    s_waitcnt lgkmcnt(4)
    v_mfma_f32_16x16x32_bf16 v[184:187], v[244:247], v[112:115], v[184:187]
    v_mfma_f32_16x16x32_bf16 v[188:191], v[244:247], v[116:119], v[188:191]
    ds_read_b64_tr_b16 v[240:241], v4 offset:9376
    ds_read_b64_tr_b16 v[242:243], v4 offset:13984
    s_waitcnt lgkmcnt(4)
    v_mfma_f32_16x16x32_bf16 v[192:195], v[232:235], v[112:115], v[192:195]
    v_mfma_f32_16x16x32_bf16 v[196:199], v[232:235], v[116:119], v[196:199]
    ds_read_b64_tr_b16 v[244:245], v4 offset:9408
    ds_read_b64_tr_b16 v[246:247], v4 offset:14016
    s_waitcnt lgkmcnt(4)
    v_mfma_f32_16x16x32_bf16 v[160:163], v[236:239], v[120:123], v[160:163]
    v_mfma_f32_16x16x32_bf16 v[164:167], v[236:239], v[124:127], v[164:167]
    ds_read_b64_tr_b16 v[232:233], v4 offset:9440
    ds_read_b64_tr_b16 v[234:235], v4 offset:14048
    s_waitcnt lgkmcnt(4)
    v_mfma_f32_16x16x32_bf16 v[168:171], v[240:243], v[120:123], v[168:171]
    v_mfma_f32_16x16x32_bf16 v[172:175], v[240:243], v[124:127], v[172:175]
    ds_read_b64_tr_b16 v[236:237], v4 offset:9472
    ds_read_b64_tr_b16 v[238:239], v4 offset:14080
    s_waitcnt lgkmcnt(4)
    v_mfma_f32_16x16x32_bf16 v[176:179], v[244:247], v[120:123], v[176:179]
    v_mfma_f32_16x16x32_bf16 v[180:183], v[244:247], v[124:127], v[180:183]
    s_waitcnt vmcnt(10)
    s_barrier
    ds_read_b64_tr_b16 v[240:241], v4 offset:18560
    ds_read_b64_tr_b16 v[242:243], v4 offset:23168
    s_waitcnt lgkmcnt(4)
    v_mfma_f32_16x16x32_bf16 v[184:187], v[232:235], v[120:123], v[184:187]
    v_mfma_f32_16x16x32_bf16 v[188:191], v[232:235], v[124:127], v[188:191]
    s_add_u32 s45, s56, 442368
    s_add_u32 m0, s46, 36864
    s_nop 0
    buffer_load_dwordx4 v10, s[16:19], s45 offen offset:0 lds
    ds_read_b64_tr_b16 v[244:245], v4 offset:18592
    ds_read_b64_tr_b16 v[246:247], v4 offset:23200
    s_waitcnt lgkmcnt(4)
    v_mfma_f32_16x16x32_bf16 v[192:195], v[236:239], v[120:123], v[192:195]
    v_mfma_f32_16x16x32_bf16 v[196:199], v[236:239], v[124:127], v[196:199]
    ds_read_b64_tr_b16 v[232:233], v4 offset:18624
    ds_read_b64_tr_b16 v[234:235], v4 offset:23232
    s_waitcnt lgkmcnt(4)
    v_mfma_f32_16x16x32_bf16 v[160:163], v[240:243], v[128:131], v[160:163]
    v_mfma_f32_16x16x32_bf16 v[164:167], v[240:243], v[132:135], v[164:167]
    s_nop 0
    buffer_load_dwordx4 v11, s[16:19], s45 offen offset:1024 lds
    ds_read_b64_tr_b16 v[236:237], v4 offset:18656
    ds_read_b64_tr_b16 v[238:239], v4 offset:23264
    s_waitcnt lgkmcnt(4)
    v_mfma_f32_16x16x32_bf16 v[168:171], v[244:247], v[128:131], v[168:171]
    v_mfma_f32_16x16x32_bf16 v[172:175], v[244:247], v[132:135], v[172:175]
    ds_read_b64_tr_b16 v[240:241], v4 offset:18688
    ds_read_b64_tr_b16 v[242:243], v4 offset:23296
    s_waitcnt lgkmcnt(4)
    v_mfma_f32_16x16x32_bf16 v[176:179], v[232:235], v[128:131], v[176:179]
    v_mfma_f32_16x16x32_bf16 v[180:183], v[232:235], v[132:135], v[180:183]
    s_mov_b32 exec_hi, 0
    buffer_load_dwordx4 v12, s[16:19], s45 offen offset:2048 lds
    s_mov_b32 exec_hi, -1
    ds_read_b64_tr_b16 v[244:245], v4 offset:27776
    ds_read_b64_tr_b16 v[246:247], v4 offset:32384
    s_waitcnt lgkmcnt(4)
    v_mfma_f32_16x16x32_bf16 v[184:187], v[236:239], v[128:131], v[184:187]
    v_mfma_f32_16x16x32_bf16 v[188:191], v[236:239], v[132:135], v[188:191]
    ds_read_b64_tr_b16 v[232:233], v4 offset:27808
    ds_read_b64_tr_b16 v[234:235], v4 offset:32416
    s_waitcnt lgkmcnt(4)
    v_mfma_f32_16x16x32_bf16 v[192:195], v[240:243], v[128:131], v[192:195]
    v_mfma_f32_16x16x32_bf16 v[196:199], v[240:243], v[132:135], v[196:199]
    ds_read_b64_tr_b16 v[236:237], v4 offset:27840
    ds_read_b64_tr_b16 v[238:239], v4 offset:32448
    s_waitcnt lgkmcnt(4)
    v_mfma_f32_16x16x32_bf16 v[160:163], v[244:247], v[136:139], v[160:163]
    v_mfma_f32_16x16x32_bf16 v[164:167], v[244:247], v[140:143], v[164:167]
    ds_read_b64_tr_b16 v[240:241], v4 offset:27872
    ds_read_b64_tr_b16 v[242:243], v4 offset:32480
    s_waitcnt lgkmcnt(4)
    v_mfma_f32_16x16x32_bf16 v[168:171], v[232:235], v[136:139], v[168:171]
    v_mfma_f32_16x16x32_bf16 v[172:175], v[232:235], v[140:143], v[172:175]
    ds_read_b64_tr_b16 v[244:245], v4 offset:27904
    ds_read_b64_tr_b16 v[246:247], v4 offset:32512
    s_waitcnt lgkmcnt(4)
    v_mfma_f32_16x16x32_bf16 v[176:179], v[236:239], v[136:139], v[176:179]
    v_mfma_f32_16x16x32_bf16 v[180:183], v[236:239], v[140:143], v[180:183]
    s_waitcnt vmcnt(10)
    s_barrier
    ds_read_b64_tr_b16 v[232:233], v4 offset:36992
    ds_read_b64_tr_b16 v[234:235], v4 offset:41600
    s_waitcnt lgkmcnt(4)
    v_mfma_f32_16x16x32_bf16 v[184:187], v[240:243], v[136:139], v[184:187]
    v_mfma_f32_16x16x32_bf16 v[188:191], v[240:243], v[140:143], v[188:191]
    s_add_u32 s45, s56, 663552
    s_add_u32 m0, s46, 55296
    s_nop 0
    buffer_load_dwordx4 v10, s[16:19], s45 offen offset:0 lds
    ds_read_b64_tr_b16 v[236:237], v4 offset:37024
    ds_read_b64_tr_b16 v[238:239], v4 offset:41632
    s_waitcnt lgkmcnt(4)
    v_mfma_f32_16x16x32_bf16 v[192:195], v[244:247], v[136:139], v[192:195]
    v_mfma_f32_16x16x32_bf16 v[196:199], v[244:247], v[140:143], v[196:199]
    ds_read_b64_tr_b16 v[240:241], v4 offset:37056
    ds_read_b64_tr_b16 v[242:243], v4 offset:41664
    s_waitcnt lgkmcnt(4)
    v_mfma_f32_16x16x32_bf16 v[160:163], v[232:235], v[144:147], v[160:163]
    v_mfma_f32_16x16x32_bf16 v[164:167], v[232:235], v[148:151], v[164:167]
    s_nop 0
    buffer_load_dwordx4 v11, s[16:19], s45 offen offset:1024 lds
    ds_read_b64_tr_b16 v[244:245], v4 offset:37088
    ds_read_b64_tr_b16 v[246:247], v4 offset:41696
    s_lshl_b32 s100, s2, 3
    s_add_u32 s100, s100, s3
    s_lshl_b32 s100, s100, 12
    s_mov_b32 exec_lo, 4278190080
    s_mov_b32 exec_hi, 0
    v_lshlrev_b32 v0, 7, v1
    buffer_load_dword v0, v0, s[76:79], s100 offen
    s_mov_b64 exec, -1
    s_waitcnt lgkmcnt(4)
    v_mfma_f32_16x16x32_bf16 v[168:171], v[236:239], v[144:147], v[168:171]
    v_mfma_f32_16x16x32_bf16 v[172:175], v[236:239], v[148:151], v[172:175]
    ds_read_b64_tr_b16 v[232:233], v4 offset:37120
    ds_read_b64_tr_b16 v[234:235], v4 offset:41728
    s_waitcnt lgkmcnt(4)
    v_mfma_f32_16x16x32_bf16 v[176:179], v[240:243], v[144:147], v[176:179]
    v_mfma_f32_16x16x32_bf16 v[180:183], v[240:243], v[148:151], v[180:183]
    s_mov_b32 exec_hi, 0
    buffer_load_dwordx4 v12, s[16:19], s45 offen offset:2048 lds
    s_mov_b32 exec_hi, -1
    ds_read_b64_tr_b16 v[236:237], v4 offset:46208
    ds_read_b64_tr_b16 v[238:239], v4 offset:50816
    s_waitcnt lgkmcnt(4)
    v_mfma_f32_16x16x32_bf16 v[184:187], v[244:247], v[144:147], v[184:187]
    v_mfma_f32_16x16x32_bf16 v[188:191], v[244:247], v[148:151], v[188:191]
    ds_read_b64_tr_b16 v[240:241], v4 offset:46240
    ds_read_b64_tr_b16 v[242:243], v4 offset:50848
    s_waitcnt lgkmcnt(4)
    v_mfma_f32_16x16x32_bf16 v[192:195], v[232:235], v[144:147], v[192:195]
    v_mfma_f32_16x16x32_bf16 v[196:199], v[232:235], v[148:151], v[196:199]
    ds_read_b64_tr_b16 v[244:245], v4 offset:46272
    ds_read_b64_tr_b16 v[246:247], v4 offset:50880
    s_waitcnt lgkmcnt(4)
    v_mfma_f32_16x16x32_bf16 v[160:163], v[236:239], v[152:155], v[160:163]
    v_mfma_f32_16x16x32_bf16 v[164:167], v[236:239], v[156:159], v[164:167]
    ds_read_b64_tr_b16 v[232:233], v4 offset:46304
    ds_read_b64_tr_b16 v[234:235], v4 offset:50912
    s_waitcnt lgkmcnt(4)
    v_mfma_f32_16x16x32_bf16 v[168:171], v[240:243], v[152:155], v[168:171]
    v_mfma_f32_16x16x32_bf16 v[172:175], v[240:243], v[156:159], v[172:175]
    ds_read_b64_tr_b16 v[236:237], v4 offset:46336
    ds_read_b64_tr_b16 v[238:239], v4 offset:50944
    s_waitcnt lgkmcnt(4)
    v_mfma_f32_16x16x32_bf16 v[176:179], v[244:247], v[152:155], v[176:179]
    v_mfma_f32_16x16x32_bf16 v[180:183], v[244:247], v[156:159], v[180:183]
    s_waitcnt vmcnt(10)
    s_barrier
    v_add_u32 v3, s57, v3
    v_add_u32 v4, s57, v4
    ds_read_b64_tr_b16 v[240:241], v3 offset:192
    ds_read_b64_tr_b16 v[242:243], v3 offset:4800
    s_waitcnt lgkmcnt(4)
    v_mfma_f32_16x16x32_bf16 v[184:187], v[232:235], v[152:155], v[184:187]
    v_mfma_f32_16x16x32_bf16 v[188:191], v[232:235], v[156:159], v[188:191]
    s_add_u32 s45, s56, 884736
    s_add_u32 m0, s46, 73728
    s_nop 0
    buffer_load_dwordx4 v10, s[16:19], s45 offen offset:0 lds
    ds_read_b64_tr_b16 v[244:245], v3 offset:232
    ds_read_b64_tr_b16 v[246:247], v3 offset:4840
    s_waitcnt lgkmcnt(4)
    v_mfma_f32_16x16x32_bf16 v[192:195], v[236:239], v[152:155], v[192:195]
    v_mfma_f32_16x16x32_bf16 v[196:199], v[236:239], v[156:159], v[196:199]
    ds_read_b64_tr_b16 v[232:233], v5 offset:0
    ds_read_b64_tr_b16 v[234:235], v5 offset:4608
    s_waitcnt lgkmcnt(4)
    v_mfma_f32_16x16x32_bf16 v[200:203], v[16:19], v[240:243], 0
    v_mfma_f32_16x16x32_bf16 v[204:207], v[20:23], v[240:243], 0
    s_nop 0
    buffer_load_dwordx4 v11, s[16:19], s45 offen offset:1024 lds
    ds_read_b64_tr_b16 v[236:237], v3 offset:9408
    ds_read_b64_tr_b16 v[238:239], v3 offset:14016
    s_waitcnt lgkmcnt(4)
    v_mfma_f32_16x16x32_bf16 v[208:211], v[16:19], v[244:247], 0
    v_mfma_f32_16x16x32_bf16 v[212:215], v[20:23], v[244:247], 0
    ds_read_b64_tr_b16 v[240:241], v3 offset:9448
    ds_read_b64_tr_b16 v[242:243], v3 offset:14056
    s_waitcnt lgkmcnt(4)
    v_mfma_f32_16x16x32_bf16 v[216:219], v[16:19], v[232:235], 0
    s_lshl_b32 s6, s4, 4
    s_add_u32 s6, s6, s5
    s_lshl_b32 s6, s6, 2
    s_add_u32 s6, s6, s44
    s_mul_i32 s6, s6, 9216
    s_add_u32 s62, s6, 4096
    s_add_u32 s63, s62, 4096
    v_fmaak_f32 v248, v160, v160, 0x41b2e92f
    v_fmaak_f32 v249, v161, v161, 0x41b2e92f
    v_fmaak_f32 v250, v162, v162, 0x41b2e92f
    v_mfma_f32_16x16x32_bf16 v[220:223], v[20:23], v[232:235], 0
    v_fmaak_f32 v251, v163, v163, 0x41b2e92f
    v_mul_f32 v252, s47, v160
    v_mul_f32 v253, s47, v161
    v_mul_f32 v254, s47, v162
    s_mov_b32 exec_hi, 0
    buffer_load_dwordx4 v12, s[16:19], s45 offen offset:2048 lds
    s_mov_b32 exec_hi, -1
    ds_read_b64_tr_b16 v[244:245], v5 offset:9216
    ds_read_b64_tr_b16 v[246:247], v5 offset:13824
    s_waitcnt lgkmcnt(4)
    v_mfma_f32_16x16x32_bf16 v[200:203], v[24:27], v[236:239], v[200:203]
    v_mul_f32 v255, s47, v163
    v_mul_f32 v248, v248, v252
    v_mul_f32 v249, v249, v253
    v_mul_f32 v250, v250, v254
    v_mfma_f32_16x16x32_bf16 v[204:207], v[28:31], v[236:239], v[204:207]
    v_mul_f32 v251, v251, v255
    v_exp_f32 v248, v248
    v_exp_f32 v249, v249
    v_exp_f32 v250, v250
    s_waitcnt vmcnt(10)
    s_barrier
    ds_read_b64_tr_b16 v[232:233], v3 offset:18624
    ds_read_b64_tr_b16 v[234:235], v3 offset:23232
    s_waitcnt lgkmcnt(4)
    v_mfma_f32_16x16x32_bf16 v[208:211], v[24:27], v[240:243], v[208:211]
    v_exp_f32 v251, v251
    v_add_f32 v248, 1.0, v248
    v_add_f32 v249, 1.0, v249
    v_add_f32 v250, 1.0, v250
    v_mfma_f32_16x16x32_bf16 v[212:215], v[28:31], v[240:243], v[212:215]
    v_add_f32 v251, 1.0, v251
    v_rcp_f32 v248, v248
    v_rcp_f32 v249, v249
    v_rcp_f32 v250, v250
    s_add_u32 s45, s56, 1105920
    s_add_u32 m0, s46, 92160
    s_nop 0
    buffer_load_dwordx4 v10, s[16:19], s45 offen offset:0 lds
    ds_read_b64_tr_b16 v[236:237], v3 offset:18664
    ds_read_b64_tr_b16 v[238:239], v3 offset:23272
    s_waitcnt lgkmcnt(4)
    v_mfma_f32_16x16x32_bf16 v[216:219], v[24:27], v[244:247], v[216:219]
    v_rcp_f32 v251, v251
    v_mul_f32 v252, v160, v248
    v_mul_f32 v253, v161, v249
    v_mul_f32 v254, v162, v250
    v_mfma_f32_16x16x32_bf16 v[220:223], v[28:31], v[244:247], v[220:223]
    v_mul_f32 v255, v163, v251
    v_cvt_pk_bf16_f32 v160, v252, v253
    v_cvt_pk_bf16_f32 v161, v254, v255
    v_fmaak_f32 v248, v164, v164, 0x41b2e92f
    ds_read_b64_tr_b16 v[240:241], v5 offset:18432
    ds_read_b64_tr_b16 v[242:243], v5 offset:23040
    s_waitcnt lgkmcnt(4)
    v_mfma_f32_16x16x32_bf16 v[200:203], v[32:35], v[232:235], v[200:203]
    v_fmaak_f32 v249, v165, v165, 0x41b2e92f
    v_fmaak_f32 v250, v166, v166, 0x41b2e92f
    v_fmaak_f32 v251, v167, v167, 0x41b2e92f
    v_mul_f32 v252, s47, v164
    v_mfma_f32_16x16x32_bf16 v[204:207], v[36:39], v[232:235], v[204:207]
    v_mul_f32 v253, s47, v165
    v_mul_f32 v254, s47, v166
    v_mul_f32 v255, s47, v167
    v_mul_f32 v248, v248, v252
    s_nop 0
    buffer_load_dwordx4 v11, s[16:19], s45 offen offset:1024 lds
    ds_read_b64_tr_b16 v[244:245], v3 offset:27840
    ds_read_b64_tr_b16 v[246:247], v3 offset:32448
    s_waitcnt lgkmcnt(4)
    v_mfma_f32_16x16x32_bf16 v[208:211], v[32:35], v[236:239], v[208:211]
    v_mul_f32 v249, v249, v253
    v_mul_f32 v250, v250, v254
    v_mul_f32 v251, v251, v255
    v_exp_f32 v248, v248
    v_mfma_f32_16x16x32_bf16 v[212:215], v[36:39], v[236:239], v[212:215]
    v_exp_f32 v249, v249
    v_exp_f32 v250, v250
    v_exp_f32 v251, v251
    v_add_f32 v248, 1.0, v248
    ds_read_b64_tr_b16 v[232:233], v3 offset:27880
    ds_read_b64_tr_b16 v[234:235], v3 offset:32488
    s_waitcnt lgkmcnt(4)
    v_mfma_f32_16x16x32_bf16 v[216:219], v[32:35], v[240:243], v[216:219]
    v_add_f32 v249, 1.0, v249
    v_add_f32 v250, 1.0, v250
    v_add_f32 v251, 1.0, v251
    v_rcp_f32 v248, v248
    v_mfma_f32_16x16x32_bf16 v[220:223], v[36:39], v[240:243], v[220:223]
    v_rcp_f32 v249, v249
    v_rcp_f32 v250, v250
    v_rcp_f32 v251, v251
    v_mul_f32 v252, v164, v248
    s_mov_b32 exec_hi, 0
    buffer_load_dwordx4 v12, s[16:19], s45 offen offset:2048 lds
    s_mov_b32 exec_hi, -1
    ds_read_b64_tr_b16 v[236:237], v5 offset:27648
    ds_read_b64_tr_b16 v[238:239], v5 offset:32256
    s_waitcnt lgkmcnt(4)
    v_mfma_f32_16x16x32_bf16 v[200:203], v[40:43], v[244:247], v[200:203]
    v_mul_f32 v253, v165, v249
    v_mul_f32 v254, v166, v250
    v_mul_f32 v255, v167, v251
    v_cvt_pk_bf16_f32 v162, v252, v253
    v_mfma_f32_16x16x32_bf16 v[204:207], v[44:47], v[244:247], v[204:207]
    v_cvt_pk_bf16_f32 v163, v254, v255
    buffer_store_dwordx4 v[160:163], v2, s[24:27], s62 offen offset:0
    v_fmaak_f32 v248, v168, v168, 0x41b2e92f
    v_fmaak_f32 v249, v169, v169, 0x41b2e92f
    s_waitcnt vmcnt(11)
    s_barrier
    ds_read_b64_tr_b16 v[240:241], v3 offset:37056
    ds_read_b64_tr_b16 v[242:243], v3 offset:41664
    s_waitcnt lgkmcnt(4)
    v_mfma_f32_16x16x32_bf16 v[208:211], v[40:43], v[232:235], v[208:211]
    v_fmaak_f32 v250, v170, v170, 0x41b2e92f
    v_fmaak_f32 v251, v171, v171, 0x41b2e92f
    v_mul_f32 v252, s47, v168
    v_mul_f32 v253, s47, v169
    v_mfma_f32_16x16x32_bf16 v[212:215], v[44:47], v[232:235], v[212:215]
    v_mul_f32 v254, s47, v170
    v_mul_f32 v255, s47, v171
    v_mul_f32 v248, v248, v252
    v_mul_f32 v249, v249, v253
    s_add_u32 s45, s56, 1327104
    s_add_u32 m0, s46, 0
    s_nop 0
    buffer_load_dwordx4 v10, s[16:19], s45 offen offset:0 lds
    ds_read_b64_tr_b16 v[244:245], v3 offset:37096
    ds_read_b64_tr_b16 v[246:247], v3 offset:41704
    s_waitcnt lgkmcnt(4)
    v_mfma_f32_16x16x32_bf16 v[216:219], v[40:43], v[236:239], v[216:219]
    v_mul_f32 v250, v250, v254
    v_mul_f32 v251, v251, v255
    v_exp_f32 v248, v248
    v_exp_f32 v249, v249
    v_mfma_f32_16x16x32_bf16 v[220:223], v[44:47], v[236:239], v[220:223]
    v_exp_f32 v250, v250
    v_exp_f32 v251, v251
    v_add_f32 v248, 1.0, v248
    v_add_f32 v249, 1.0, v249
    ds_read_b64_tr_b16 v[232:233], v5 offset:36864
    ds_read_b64_tr_b16 v[234:235], v5 offset:41472
    s_waitcnt lgkmcnt(4)
    v_mfma_f32_16x16x32_bf16 v[200:203], v[48:51], v[240:243], v[200:203]
    v_add_f32 v250, 1.0, v250
    v_add_f32 v251, 1.0, v251
    v_rcp_f32 v248, v248
    v_rcp_f32 v249, v249
    v_mfma_f32_16x16x32_bf16 v[204:207], v[52:55], v[240:243], v[204:207]
    v_rcp_f32 v250, v250
    v_rcp_f32 v251, v251
    v_mul_f32 v252, v168, v248
    v_mul_f32 v253, v169, v249
    s_nop 0
    buffer_load_dwordx4 v11, s[16:19], s45 offen offset:1024 lds
    ds_read_b64_tr_b16 v[236:237], v3 offset:46272
    ds_read_b64_tr_b16 v[238:239], v3 offset:50880
    s_waitcnt lgkmcnt(4)
    v_mfma_f32_16x16x32_bf16 v[208:211], v[48:51], v[244:247], v[208:211]
    v_mul_f32 v254, v170, v250
    v_mul_f32 v255, v171, v251
    v_cvt_pk_bf16_f32 v168, v252, v253
    v_cvt_pk_bf16_f32 v169, v254, v255
    v_mfma_f32_16x16x32_bf16 v[212:215], v[52:55], v[244:247], v[212:215]
    v_fmaak_f32 v248, v172, v172, 0x41b2e92f
    v_fmaak_f32 v249, v173, v173, 0x41b2e92f
    v_fmaak_f32 v250, v174, v174, 0x41b2e92f
    v_fmaak_f32 v251, v175, v175, 0x41b2e92f
    ds_read_b64_tr_b16 v[240:241], v3 offset:46312
    ds_read_b64_tr_b16 v[242:243], v3 offset:50920
    s_waitcnt lgkmcnt(4)
    v_mfma_f32_16x16x32_bf16 v[216:219], v[48:51], v[232:235], v[216:219]
    v_mul_f32 v252, s47, v172
    v_mul_f32 v253, s47, v173
    v_mul_f32 v254, s47, v174
    v_mul_f32 v255, s47, v175
    v_mfma_f32_16x16x32_bf16 v[220:223], v[52:55], v[232:235], v[220:223]
    v_mul_f32 v248, v248, v252
    v_mul_f32 v249, v249, v253
    v_mul_f32 v250, v250, v254
    v_mul_f32 v251, v251, v255
    s_mov_b32 exec_hi, 0
    buffer_load_dwordx4 v12, s[16:19], s45 offen offset:2048 lds
    s_mov_b32 exec_hi, -1
    ds_read_b64_tr_b16 v[244:245], v5 offset:46080
    ds_read_b64_tr_b16 v[246:247], v5 offset:50688
    s_waitcnt lgkmcnt(4)
    v_mfma_f32_16x16x32_bf16 v[200:203], v[56:59], v[236:239], v[200:203]
    v_exp_f32 v248, v248
    v_exp_f32 v249, v249
    v_exp_f32 v250, v250
    v_exp_f32 v251, v251
    v_mfma_f32_16x16x32_bf16 v[204:207], v[60:63], v[236:239], v[204:207]
    v_add_f32 v248, 1.0, v248
    v_add_f32 v249, 1.0, v249
    v_add_f32 v250, 1.0, v250
    v_add_f32 v251, 1.0, v251
    s_waitcnt vmcnt(10)
    s_barrier
    ds_read_b64_tr_b16 v[232:233], v4 offset:192
    ds_read_b64_tr_b16 v[234:235], v4 offset:4800
    s_waitcnt lgkmcnt(4)
    v_mfma_f32_16x16x32_bf16 v[208:211], v[56:59], v[240:243], v[208:211]
    v_rcp_f32 v248, v248
    v_rcp_f32 v249, v249
    v_rcp_f32 v250, v250
    v_rcp_f32 v251, v251
    v_mfma_f32_16x16x32_bf16 v[212:215], v[60:63], v[240:243], v[212:215]
    v_mul_f32 v252, v172, v248
    v_mul_f32 v253, v173, v249
    v_mul_f32 v254, v174, v250
    v_mul_f32 v255, v175, v251
    s_add_u32 s45, s56, 1548288
    s_add_u32 m0, s46, 18432
    s_nop 0
    buffer_load_dwordx4 v10, s[16:19], s45 offen offset:0 lds
    ds_read_b64_tr_b16 v[236:237], v4 offset:232
    ds_read_b64_tr_b16 v[238:239], v4 offset:4840
    s_waitcnt lgkmcnt(4)
    v_mfma_f32_16x16x32_bf16 v[216:219], v[56:59], v[244:247], v[216:219]
    v_cvt_pk_bf16_f32 v170, v252, v253
    v_cvt_pk_bf16_f32 v171, v254, v255
    buffer_store_dwordx4 v[168:171], v2, s[24:27], s62 offen offset:1024
    v_fmaak_f32 v248, v176, v176, 0x41b2e92f
    v_mfma_f32_16x16x32_bf16 v[220:223], v[60:63], v[244:247], v[220:223]
    v_fmaak_f32 v249, v177, v177, 0x41b2e92f
    v_fmaak_f32 v250, v178, v178, 0x41b2e92f
    v_fmaak_f32 v251, v179, v179, 0x41b2e92f
    v_mul_f32 v252, s47, v176
    ds_read_b64_tr_b16 v[240:241], v6 offset:0
    ds_read_b64_tr_b16 v[242:243], v6 offset:4608
    s_lshl_b32 s6, s58, 13
    s_add_u32 s7, s6, 4096
    buffer_load_dwordx4 v[16:19], v2, s[36:39], s6 offen offset:0 sc1
    buffer_load_dwordx4 v[20:23], v2, s[36:39], s6 offen offset:1024 sc1
    buffer_load_dwordx4 v[24:27], v2, s[36:39], s6 offen offset:2048 sc1
    buffer_load_dwordx4 v[28:31], v2, s[36:39], s6 offen offset:3072 sc1
    buffer_load_dwordx4 v[32:35], v2, s[36:39], s7 offen offset:0 sc1
    buffer_load_dwordx4 v[36:39], v2, s[36:39], s7 offen offset:1024 sc1
    buffer_load_dwordx4 v[40:43], v2, s[36:39], s7 offen offset:2048 sc1
    buffer_load_dwordx4 v[44:47], v2, s[36:39], s7 offen offset:3072 sc1
    s_waitcnt lgkmcnt(4)
    v_mfma_f32_16x16x32_bf16 v[200:203], v[64:67], v[232:235], v[200:203]
    v_mul_f32 v253, s47, v177
    v_mul_f32 v254, s47, v178
    v_mul_f32 v255, s47, v179
    v_mul_f32 v248, v248, v252
    v_mfma_f32_16x16x32_bf16 v[204:207], v[68:71], v[232:235], v[204:207]
    v_mul_f32 v249, v249, v253
    v_mul_f32 v250, v250, v254
    v_mul_f32 v251, v251, v255
    v_exp_f32 v248, v248
    s_nop 0
    buffer_load_dwordx4 v11, s[16:19], s45 offen offset:1024 lds
    ds_read_b64_tr_b16 v[244:245], v4 offset:9408
    ds_read_b64_tr_b16 v[246:247], v4 offset:14016
    s_waitcnt lgkmcnt(4)
    v_mfma_f32_16x16x32_bf16 v[208:211], v[64:67], v[236:239], v[208:211]
    v_exp_f32 v249, v249
    v_exp_f32 v250, v250
    v_exp_f32 v251, v251
    v_add_f32 v248, 1.0, v248
    v_mfma_f32_16x16x32_bf16 v[212:215], v[68:71], v[236:239], v[212:215]
    v_add_f32 v249, 1.0, v249
    v_add_f32 v250, 1.0, v250
    v_add_f32 v251, 1.0, v251
    v_rcp_f32 v248, v248
    ds_read_b64_tr_b16 v[232:233], v4 offset:9448
    ds_read_b64_tr_b16 v[234:235], v4 offset:14056
    s_waitcnt lgkmcnt(4)
    v_mfma_f32_16x16x32_bf16 v[216:219], v[64:67], v[240:243], v[216:219]
    v_rcp_f32 v249, v249
    v_rcp_f32 v250, v250
    v_rcp_f32 v251, v251
    v_mul_f32 v252, v176, v248
    v_mfma_f32_16x16x32_bf16 v[220:223], v[68:71], v[240:243], v[220:223]
    v_mul_f32 v253, v177, v249
    v_mul_f32 v254, v178, v250
    v_mul_f32 v255, v179, v251
    v_cvt_pk_bf16_f32 v176, v252, v253
    s_mov_b32 exec_hi, 0
    buffer_load_dwordx4 v12, s[16:19], s45 offen offset:2048 lds
    s_mov_b32 exec_hi, -1
    ds_read_b64_tr_b16 v[236:237], v6 offset:9216
    ds_read_b64_tr_b16 v[238:239], v6 offset:13824
    s_waitcnt lgkmcnt(4)
    v_mfma_f32_16x16x32_bf16 v[200:203], v[72:75], v[244:247], v[200:203]
    v_cvt_pk_bf16_f32 v177, v254, v255
    v_fmaak_f32 v248, v180, v180, 0x41b2e92f
    v_fmaak_f32 v249, v181, v181, 0x41b2e92f
    v_fmaak_f32 v250, v182, v182, 0x41b2e92f
    v_mfma_f32_16x16x32_bf16 v[204:207], v[76:79], v[244:247], v[204:207]
    v_fmaak_f32 v251, v183, v183, 0x41b2e92f
    v_mul_f32 v252, s47, v180
    v_mul_f32 v253, s47, v181
    v_mul_f32 v254, s47, v182
    s_waitcnt vmcnt(19)
    s_barrier
    ds_read_b64_tr_b16 v[240:241], v4 offset:18624
    ds_read_b64_tr_b16 v[242:243], v4 offset:23232
    s_waitcnt lgkmcnt(4)
    v_mfma_f32_16x16x32_bf16 v[208:211], v[72:75], v[232:235], v[208:211]
    v_mul_f32 v255, s47, v183
    v_mul_f32 v248, v248, v252
    v_mul_f32 v249, v249, v253
    v_mul_f32 v250, v250, v254
    v_mfma_f32_16x16x32_bf16 v[212:215], v[76:79], v[232:235], v[212:215]
    v_mul_f32 v251, v251, v255
    v_exp_f32 v248, v248
    v_exp_f32 v249, v249
    v_exp_f32 v250, v250
    s_add_u32 s45, s56, 1769472
    s_add_u32 m0, s46, 36864
    s_nop 0
    buffer_load_dwordx4 v10, s[16:19], s45 offen offset:0 lds
    ds_read_b64_tr_b16 v[244:245], v4 offset:18664
    ds_read_b64_tr_b16 v[246:247], v4 offset:23272
    s_waitcnt lgkmcnt(4)
    v_mfma_f32_16x16x32_bf16 v[216:219], v[72:75], v[236:239], v[216:219]
    v_exp_f32 v251, v251
    v_add_f32 v248, 1.0, v248
    v_add_f32 v249, 1.0, v249
    v_add_f32 v250, 1.0, v250
    v_mfma_f32_16x16x32_bf16 v[220:223], v[76:79], v[236:239], v[220:223]
    v_add_f32 v251, 1.0, v251
    v_rcp_f32 v248, v248
    v_rcp_f32 v249, v249
    v_rcp_f32 v250, v250
    ds_read_b64_tr_b16 v[232:233], v6 offset:18432
    ds_read_b64_tr_b16 v[234:235], v6 offset:23040
    s_waitcnt lgkmcnt(4)
    v_mfma_f32_16x16x32_bf16 v[200:203], v[80:83], v[240:243], v[200:203]
    v_rcp_f32 v251, v251
    v_mul_f32 v252, v180, v248
    v_mul_f32 v253, v181, v249
    v_mul_f32 v254, v182, v250
    v_mfma_f32_16x16x32_bf16 v[204:207], v[84:87], v[240:243], v[204:207]
    v_mul_f32 v255, v183, v251
    v_cvt_pk_bf16_f32 v178, v252, v253
    v_cvt_pk_bf16_f32 v179, v254, v255
    buffer_store_dwordx4 v[176:179], v2, s[24:27], s62 offen offset:2048
    s_nop 0
    buffer_load_dwordx4 v11, s[16:19], s45 offen offset:1024 lds
    ds_read_b64_tr_b16 v[236:237], v4 offset:27840
    ds_read_b64_tr_b16 v[238:239], v4 offset:32448
    s_waitcnt lgkmcnt(4)
    v_mfma_f32_16x16x32_bf16 v[208:211], v[80:83], v[244:247], v[208:211]
    v_fmaak_f32 v248, v184, v184, 0x41b2e92f
    v_fmaak_f32 v249, v185, v185, 0x41b2e92f
    v_fmaak_f32 v250, v186, v186, 0x41b2e92f
    v_fmaak_f32 v251, v187, v187, 0x41b2e92f
    v_mfma_f32_16x16x32_bf16 v[212:215], v[84:87], v[244:247], v[212:215]
    v_mul_f32 v252, s47, v184
    v_mul_f32 v253, s47, v185
    v_mul_f32 v254, s47, v186
    v_mul_f32 v255, s47, v187
    ds_read_b64_tr_b16 v[240:241], v4 offset:27880
    ds_read_b64_tr_b16 v[242:243], v4 offset:32488
    s_waitcnt lgkmcnt(4)
    v_mfma_f32_16x16x32_bf16 v[216:219], v[80:83], v[232:235], v[216:219]
    v_mul_f32 v248, v248, v252
    v_mul_f32 v249, v249, v253
    v_mul_f32 v250, v250, v254
    v_mul_f32 v251, v251, v255
    v_mfma_f32_16x16x32_bf16 v[220:223], v[84:87], v[232:235], v[220:223]
    v_exp_f32 v248, v248
    v_exp_f32 v249, v249
    v_exp_f32 v250, v250
    v_exp_f32 v251, v251
    s_mov_b32 exec_hi, 0
    buffer_load_dwordx4 v12, s[16:19], s45 offen offset:2048 lds
    s_mov_b32 exec_hi, -1
    ds_read_b64_tr_b16 v[244:245], v6 offset:27648
    ds_read_b64_tr_b16 v[246:247], v6 offset:32256
    s_waitcnt lgkmcnt(4)
    v_mfma_f32_16x16x32_bf16 v[200:203], v[88:91], v[236:239], v[200:203]
    v_add_f32 v248, 1.0, v248
    v_add_f32 v249, 1.0, v249
    v_add_f32 v250, 1.0, v250
    v_add_f32 v251, 1.0, v251
    v_mfma_f32_16x16x32_bf16 v[204:207], v[92:95], v[236:239], v[204:207]
    v_rcp_f32 v248, v248
    v_rcp_f32 v249, v249
    v_rcp_f32 v250, v250
    v_rcp_f32 v251, v251
    s_waitcnt vmcnt(20)
    s_barrier
    ds_read_b64_tr_b16 v[232:233], v4 offset:37056
    ds_read_b64_tr_b16 v[234:235], v4 offset:41664
    s_waitcnt lgkmcnt(4)
    v_mfma_f32_16x16x32_bf16 v[208:211], v[88:91], v[240:243], v[208:211]
    v_mul_f32 v252, v184, v248
    v_mul_f32 v253, v185, v249
    v_mul_f32 v254, v186, v250
    v_mul_f32 v255, v187, v251
    v_mfma_f32_16x16x32_bf16 v[212:215], v[92:95], v[240:243], v[212:215]
    v_cvt_pk_bf16_f32 v184, v252, v253
    v_cvt_pk_bf16_f32 v185, v254, v255
    v_fmaak_f32 v248, v188, v188, 0x41b2e92f
    v_fmaak_f32 v249, v189, v189, 0x41b2e92f
    ds_read_b64_tr_b16 v[236:237], v4 offset:37096
    ds_read_b64_tr_b16 v[238:239], v4 offset:41704
    s_waitcnt lgkmcnt(4)
    v_mfma_f32_16x16x32_bf16 v[216:219], v[88:91], v[244:247], v[216:219]
    v_fmaak_f32 v250, v190, v190, 0x41b2e92f
    v_fmaak_f32 v251, v191, v191, 0x41b2e92f
    v_mul_f32 v252, s47, v188
    v_mul_f32 v253, s47, v189
    v_mfma_f32_16x16x32_bf16 v[220:223], v[92:95], v[244:247], v[220:223]
    v_mul_f32 v254, s47, v190
    v_mul_f32 v255, s47, v191
    v_mul_f32 v248, v248, v252
    v_mul_f32 v249, v249, v253
    ds_read_b64_tr_b16 v[240:241], v6 offset:36864
    ds_read_b64_tr_b16 v[242:243], v6 offset:41472
    s_waitcnt lgkmcnt(4)
    v_mfma_f32_16x16x32_bf16 v[200:203], v[96:99], v[232:235], v[200:203]
    v_mul_f32 v250, v250, v254
    v_mul_f32 v251, v251, v255
    v_exp_f32 v248, v248
    v_exp_f32 v249, v249
    v_mfma_f32_16x16x32_bf16 v[204:207], v[100:103], v[232:235], v[204:207]
    v_exp_f32 v250, v250
    v_exp_f32 v251, v251
    v_add_f32 v248, 1.0, v248
    v_add_f32 v249, 1.0, v249
    ds_read_b64_tr_b16 v[244:245], v4 offset:46272
    ds_read_b64_tr_b16 v[246:247], v4 offset:50880
    s_waitcnt lgkmcnt(4)
    v_mfma_f32_16x16x32_bf16 v[208:211], v[96:99], v[236:239], v[208:211]
    v_add_f32 v250, 1.0, v250
    v_add_f32 v251, 1.0, v251
    v_rcp_f32 v248, v248
    v_rcp_f32 v249, v249
    v_mfma_f32_16x16x32_bf16 v[212:215], v[100:103], v[236:239], v[212:215]
    v_rcp_f32 v250, v250
    v_rcp_f32 v251, v251
    v_mul_f32 v252, v188, v248
    v_mul_f32 v253, v189, v249
    ds_read_b64_tr_b16 v[232:233], v4 offset:46312
    ds_read_b64_tr_b16 v[234:235], v4 offset:50920
    s_waitcnt lgkmcnt(4)
    v_mfma_f32_16x16x32_bf16 v[216:219], v[96:99], v[240:243], v[216:219]
    v_mul_f32 v254, v190, v250
    v_mul_f32 v255, v191, v251
    v_cvt_pk_bf16_f32 v186, v252, v253
    v_cvt_pk_bf16_f32 v187, v254, v255
    v_mfma_f32_16x16x32_bf16 v[220:223], v[100:103], v[240:243], v[220:223]
    buffer_store_dwordx4 v[184:187], v2, s[24:27], s62 offen offset:3072
    v_fmaak_f32 v248, v192, v192, 0x41b2e92f
    v_fmaak_f32 v249, v193, v193, 0x41b2e92f
    v_fmaak_f32 v250, v194, v194, 0x41b2e92f
    ds_read_b64_tr_b16 v[236:237], v6 offset:46080
    ds_read_b64_tr_b16 v[238:239], v6 offset:50688
    s_waitcnt lgkmcnt(4)
    v_mfma_f32_16x16x32_bf16 v[200:203], v[104:107], v[244:247], v[200:203]
    v_fmaak_f32 v251, v195, v195, 0x41b2e92f
    v_mul_f32 v252, s47, v192
    v_mul_f32 v253, s47, v193
    v_mul_f32 v254, s47, v194
    v_mfma_f32_16x16x32_bf16 v[204:207], v[108:111], v[244:247], v[204:207]
    v_mul_f32 v255, s47, v195
    v_mul_f32 v248, v248, v252
    v_mul_f32 v249, v249, v253
    v_mul_f32 v250, v250, v254
    s_waitcnt vmcnt(17)
    s_barrier
    ds_read_b64_tr_b16 v[240:241], v3 offset:192
    ds_read_b64_tr_b16 v[242:243], v3 offset:4800
    s_waitcnt lgkmcnt(4)
    v_mfma_f32_16x16x32_bf16 v[208:211], v[104:107], v[232:235], v[208:211]
    v_mul_f32 v251, v251, v255
    v_exp_f32 v248, v248
    v_exp_f32 v249, v249
    v_exp_f32 v250, v250
    v_mfma_f32_16x16x32_bf16 v[212:215], v[108:111], v[232:235], v[212:215]
    v_exp_f32 v251, v251
    v_add_f32 v248, 1.0, v248
    v_add_f32 v249, 1.0, v249
    v_add_f32 v250, 1.0, v250
    ds_read_b64_tr_b16 v[244:245], v3 offset:232
    ds_read_b64_tr_b16 v[246:247], v3 offset:4840
    s_waitcnt lgkmcnt(4)
    v_mfma_f32_16x16x32_bf16 v[216:219], v[104:107], v[236:239], v[216:219]
    v_add_f32 v251, 1.0, v251
    v_rcp_f32 v248, v248
    v_rcp_f32 v249, v249
    v_rcp_f32 v250, v250
    v_mfma_f32_16x16x32_bf16 v[220:223], v[108:111], v[236:239], v[220:223]
    v_rcp_f32 v251, v251
    v_mul_f32 v252, v192, v248
    v_mul_f32 v253, v193, v249
    v_mul_f32 v254, v194, v250
    ds_read_b64_tr_b16 v[232:233], v5 offset:0
    ds_read_b64_tr_b16 v[234:235], v5 offset:4608
    s_waitcnt lgkmcnt(4)
    v_mfma_f32_16x16x32_bf16 v[200:203], v[112:115], v[240:243], v[200:203]
    v_mul_f32 v255, v195, v251
    v_cvt_pk_bf16_f32 v192, v252, v253
    v_cvt_pk_bf16_f32 v193, v254, v255
    v_fmaak_f32 v248, v196, v196, 0x41b2e92f
    v_mfma_f32_16x16x32_bf16 v[204:207], v[116:119], v[240:243], v[204:207]
    v_fmaak_f32 v249, v197, v197, 0x41b2e92f
    v_fmaak_f32 v250, v198, v198, 0x41b2e92f
    v_fmaak_f32 v251, v199, v199, 0x41b2e92f
    v_mul_f32 v252, s47, v196
    ds_read_b64_tr_b16 v[236:237], v3 offset:9408
    ds_read_b64_tr_b16 v[238:239], v3 offset:14016
    s_waitcnt lgkmcnt(4)
    v_mfma_f32_16x16x32_bf16 v[208:211], v[112:115], v[244:247], v[208:211]
    v_mul_f32 v253, s47, v197
    v_mul_f32 v254, s47, v198
    v_mul_f32 v255, s47, v199
    v_mul_f32 v248, v248, v252
    v_mfma_f32_16x16x32_bf16 v[212:215], v[116:119], v[244:247], v[212:215]
    v_mul_f32 v249, v249, v253
    v_mul_f32 v250, v250, v254
    v_mul_f32 v251, v251, v255
    v_exp_f32 v248, v248
    ds_read_b64_tr_b16 v[240:241], v3 offset:9448
    ds_read_b64_tr_b16 v[242:243], v3 offset:14056
    s_waitcnt lgkmcnt(4)
    v_mfma_f32_16x16x32_bf16 v[216:219], v[112:115], v[232:235], v[216:219]
    v_exp_f32 v249, v249
    v_exp_f32 v250, v250
    v_exp_f32 v251, v251
    v_add_f32 v248, 1.0, v248
    v_mfma_f32_16x16x32_bf16 v[220:223], v[116:119], v[232:235], v[220:223]
    v_add_f32 v249, 1.0, v249
    v_add_f32 v250, 1.0, v250
    v_add_f32 v251, 1.0, v251
    v_rcp_f32 v248, v248
    ds_read_b64_tr_b16 v[244:245], v5 offset:9216
    ds_read_b64_tr_b16 v[246:247], v5 offset:13824
    s_waitcnt lgkmcnt(4)
    v_mfma_f32_16x16x32_bf16 v[200:203], v[120:123], v[236:239], v[200:203]
    v_rcp_f32 v249, v249
    v_rcp_f32 v250, v250
    v_rcp_f32 v251, v251
    v_mul_f32 v252, v196, v248
    v_mfma_f32_16x16x32_bf16 v[204:207], v[124:127], v[236:239], v[204:207]
    v_mul_f32 v253, v197, v249
    v_mul_f32 v254, v198, v250
    v_mul_f32 v255, v199, v251
    v_cvt_pk_bf16_f32 v194, v252, v253
    s_waitcnt vmcnt(5)
    s_barrier
    ds_read_b64_tr_b16 v[232:233], v3 offset:18624
    ds_read_b64_tr_b16 v[234:235], v3 offset:23232
    s_waitcnt lgkmcnt(4)
    v_mfma_f32_16x16x32_bf16 v[208:211], v[120:123], v[240:243], v[208:211]
    v_cvt_pk_bf16_f32 v195, v254, v255
    buffer_store_dwordx4 v[192:195], v2, s[24:27], s63 offen offset:0
    ds_read2st64_b32 v[48:49], v13 offset0:0 offset1:1
    ds_read2st64_b32 v[50:51], v13 offset0:2 offset1:3
    v_mfma_f32_16x16x32_bf16 v[212:215], v[124:127], v[240:243], v[212:215]
    ds_read2st64_b32 v[52:53], v13 offset0:4 offset1:5
    ds_read2st64_b32 v[54:55], v13 offset0:6 offset1:7
    ds_read2st64_b32 v[56:57], v13 offset0:8 offset1:9
    ds_read2st64_b32 v[58:59], v13 offset0:10 offset1:11
    ds_read_b64_tr_b16 v[236:237], v3 offset:18664
    ds_read_b64_tr_b16 v[238:239], v3 offset:23272
    s_waitcnt lgkmcnt(10)
    v_mfma_f32_16x16x32_bf16 v[216:219], v[120:123], v[244:247], v[216:219]
    ds_read2st64_b32 v[60:61], v13 offset0:12 offset1:13
    ds_read2st64_b32 v[62:63], v13 offset0:14 offset1:15
    s_mov_b32 s66, 4096
g1_chk1:
    v_min3_u32 v248, v17, v19, v21
    v_min3_u32 v248, v248, v23, v25
    v_min3_u32 v248, v248, v27, v29
    v_min3_u32 v248, v248, v31, v33
    v_min3_u32 v248, v248, v35, v37
    v_min3_u32 v248, v248, v39, v41
    v_min3_u32 v248, v248, v43, v45
    v_min_u32 v248, v248, v47
    v_max3_u32 v249, v17, v19, v21
    v_max3_u32 v249, v249, v23, v25
    v_max3_u32 v249, v249, v27, v29
    v_max3_u32 v249, v249, v31, v33
    v_max3_u32 v249, v249, v35, v37
    v_max3_u32 v249, v249, v39, v41
    v_max3_u32 v249, v249, v43, v45
    v_max_u32 v249, v249, v47
    v_cmp_ne_u32 vcc, s48, v248
    v_cmp_ne_u32 s[60:61], s48, v249
    s_or_b64 vcc, vcc, s[60:61]
    s_cbranch_vccz g1_ok1
    s_sub_u32 s66, s66, 1
    s_cmp_eq_u32 s66, 0
    s_cbranch_scc1 g1_ok1
    s_lshl_b32 s6, s58, 13
    s_add_u32 s7, s6, 4096
    buffer_load_dwordx4 v[16:19], v2, s[36:39], s6 offen offset:0 sc1
    buffer_load_dwordx4 v[20:23], v2, s[36:39], s6 offen offset:1024 sc1
    buffer_load_dwordx4 v[24:27], v2, s[36:39], s6 offen offset:2048 sc1
    buffer_load_dwordx4 v[28:31], v2, s[36:39], s6 offen offset:3072 sc1
    buffer_load_dwordx4 v[32:35], v2, s[36:39], s7 offen offset:0 sc1
    buffer_load_dwordx4 v[36:39], v2, s[36:39], s7 offen offset:1024 sc1
    buffer_load_dwordx4 v[40:43], v2, s[36:39], s7 offen offset:2048 sc1
    buffer_load_dwordx4 v[44:47], v2, s[36:39], s7 offen offset:3072 sc1
    s_waitcnt vmcnt(0)
    s_branch g1_chk1
g1_ok1:
    v_add_f32 v16, v16, v32
    v_mfma_f32_16x16x32_bf16 v[220:223], v[124:127], v[244:247], v[220:223]
    v_add_f32 v18, v18, v34
    v_add_f32 v20, v20, v36
    v_add_f32 v22, v22, v38
    v_add_f32 v24, v24, v40
    ds_read_b64_tr_b16 v[240:241], v5 offset:18432
    ds_read_b64_tr_b16 v[242:243], v5 offset:23040
    s_waitcnt lgkmcnt(12)
    v_mfma_f32_16x16x32_bf16 v[200:203], v[128:131], v[232:235], v[200:203]
    v_add_f32 v26, v26, v42
    v_add_f32 v28, v28, v44
    v_add_f32 v30, v30, v46
    v_add_f32 v16, v16, v24
    v_mfma_f32_16x16x32_bf16 v[204:207], v[132:135], v[232:235], v[204:207]
    v_add_f32 v18, v18, v26
    v_add_f32 v20, v20, v28
    v_add_f32 v22, v22, v30
    v_add_f32 v16, v16, v20
    ds_read_b64_tr_b16 v[244:245], v3 offset:27840
    ds_read_b64_tr_b16 v[246:247], v3 offset:32448
    s_waitcnt lgkmcnt(6)
    v_mfma_f32_16x16x32_bf16 v[208:211], v[128:131], v[236:239], v[208:211]
    v_add_f32 v18, v18, v22
    v_mov_b32 v17, v16
    v_mov_b32 v19, v18
    v_and_b32 v250, 31, v1
    v_mfma_f32_16x16x32_bf16 v[212:215], v[132:135], v[236:239], v[212:215]
    v_lshlrev_b32 v250, 3, v250
    v_permlane32_swap_b32 v16, v17
    v_permlane32_swap_b32 v18, v19
    s_lshl_b32 s60, s3, 8
    ds_read_b64_tr_b16 v[232:233], v3 offset:27880
    ds_read_b64_tr_b16 v[234:235], v3 offset:32488
    s_waitcnt lgkmcnt(4)
    v_mfma_f32_16x16x32_bf16 v[216:219], v[128:131], v[240:243], v[216:219]
    s_add_u32 s60, s60, 157952
    v_add_f32 v16, v16, v17
    v_add_f32 v18, v18, v19
    v_mul_f32 v16, 0x39e38e39, v16
    v_mfma_f32_16x16x32_bf16 v[220:223], v[132:135], v[240:243], v[220:223]
    v_mul_f32 v18, 0x39e38e39, v18
    v_fma_f32 v18, -v16, v16, v18
    v_add_f32 v18, 0x3727c5ac, v18
    v_rsq_f32 v18, v18
    ds_read_b64_tr_b16 v[236:237], v5 offset:27648
    ds_read_b64_tr_b16 v[238:239], v5 offset:32256
    s_waitcnt lgkmcnt(4)
    v_mfma_f32_16x16x32_bf16 v[200:203], v[136:139], v[244:247], v[200:203]
    v_add_u32 v250, s60, v250
    v_mul_f32 v19, v16, v18
    v_lshrrev_b32 v251, 4, v1
    v_lshlrev_b32 v251, 6, v251
    v_mfma_f32_16x16x32_bf16 v[204:207], v[140:143], v[244:247], v[204:207]
    v_add_u32 v251, s60, v251
    ds_write_b64 v250, v[18:19]
    ds_read_b128 v[24:27], v251 offset:0
    ds_read_b128 v[28:31], v251 offset:16
    s_waitcnt vmcnt(2)
    s_barrier
    ds_read_b64_tr_b16 v[240:241], v3 offset:37056
    ds_read_b64_tr_b16 v[242:243], v3 offset:41664
    s_waitcnt lgkmcnt(7)
    v_mfma_f32_16x16x32_bf16 v[208:211], v[136:139], v[232:235], v[208:211]
    ds_read_b128 v[32:35], v251 offset:32
    ds_read_b128 v[36:39], v251 offset:48
    s_lshl_b32 s60, s5, 6
    s_add_u32 s60, s60, s58
    s_mul_i32 s60, s60, 9216
    s_add_u32 s62, s60, 5120
    s_add_u32 s63, s62, 4096
    v_mfma_f32_16x16x32_bf16 v[212:215], v[140:143], v[232:235], v[212:215]
    ds_read_b64_tr_b16 v[244:245], v3 offset:37096
    ds_read_b64_tr_b16 v[246:247], v3 offset:41704
    s_waitcnt lgkmcnt(9)
    v_mfma_f32_16x16x32_bf16 v[216:219], v[136:139], v[236:239], v[216:219]
    v_mfma_f32_16x16x32_bf16 v[220:223], v[140:143], v[236:239], v[220:223]
    s_waitcnt lgkmcnt(2)
    v_lshlrev_b32 v248, 16, v48
    v_and_b32 v249, 0xffff0000, v48
    v_lshlrev_b32 v250, 16, v49
    ds_read_b64_tr_b16 v[232:233], v5 offset:36864
    ds_read_b64_tr_b16 v[234:235], v5 offset:41472
    v_mfma_f32_16x16x32_bf16 v[200:203], v[144:147], v[240:243], v[200:203]
    v_and_b32 v251, 0xffff0000, v49
    v_lshlrev_b32 v252, 16, v50
    v_and_b32 v253, 0xffff0000, v50
    v_lshlrev_b32 v254, 16, v51
    v_mfma_f32_16x16x32_bf16 v[204:207], v[148:151], v[240:243], v[204:207]
    v_and_b32 v255, 0xffff0000, v51
    v_fma_f32 v248, v248, v24, -v25
    v_fma_f32 v249, v249, v26, -v27
    v_fma_f32 v250, v250, v28, -v29
    ds_read_b64_tr_b16 v[236:237], v3 offset:46272
    ds_read_b64_tr_b16 v[238:239], v3 offset:50880
    s_waitcnt lgkmcnt(4)
    v_mfma_f32_16x16x32_bf16 v[208:211], v[144:147], v[244:247], v[208:211]
    v_fma_f32 v251, v251, v30, -v31
    v_fma_f32 v252, v252, v32, -v33
    v_fma_f32 v253, v253, v34, -v35
    v_fma_f32 v254, v254, v36, -v37
    v_mfma_f32_16x16x32_bf16 v[212:215], v[148:151], v[244:247], v[212:215]
    v_fma_f32 v255, v255, v38, -v39
    v_cvt_pk_bf16_f32 v48, v248, v249
    v_cvt_pk_bf16_f32 v49, v250, v251
    v_cvt_pk_bf16_f32 v50, v252, v253
    ds_read_b64_tr_b16 v[240:241], v3 offset:46312
    ds_read_b64_tr_b16 v[242:243], v3 offset:50920
    s_waitcnt lgkmcnt(4)
    v_mfma_f32_16x16x32_bf16 v[216:219], v[144:147], v[232:235], v[216:219]
    v_cvt_pk_bf16_f32 v51, v254, v255
    buffer_store_dwordx4 v[48:51], v2, s[20:23], s62 offen offset:0
    v_lshlrev_b32 v248, 16, v52
    v_and_b32 v249, 0xffff0000, v52
    v_mfma_f32_16x16x32_bf16 v[220:223], v[148:151], v[232:235], v[220:223]
    v_lshlrev_b32 v250, 16, v53
    v_and_b32 v251, 0xffff0000, v53
    v_lshlrev_b32 v252, 16, v54
    v_and_b32 v253, 0xffff0000, v54
    ds_read_b64_tr_b16 v[244:245], v5 offset:46080
    ds_read_b64_tr_b16 v[246:247], v5 offset:50688
    s_waitcnt lgkmcnt(4)
    v_mfma_f32_16x16x32_bf16 v[200:203], v[152:155], v[236:239], v[200:203]
    v_lshlrev_b32 v254, 16, v55
    v_and_b32 v255, 0xffff0000, v55
    v_fma_f32 v248, v248, v24, -v25
    v_fma_f32 v249, v249, v26, -v27
    v_mfma_f32_16x16x32_bf16 v[204:207], v[156:159], v[236:239], v[204:207]
    v_fma_f32 v250, v250, v28, -v29
    v_fma_f32 v251, v251, v30, -v31
    v_fma_f32 v252, v252, v32, -v33
    v_fma_f32 v253, v253, v34, -v35
    s_waitcnt lgkmcnt(2)
    v_mfma_f32_16x16x32_bf16 v[208:211], v[152:155], v[240:243], v[208:211]
    v_fma_f32 v254, v254, v36, -v37
    v_fma_f32 v255, v255, v38, -v39
    v_cvt_pk_bf16_f32 v52, v248, v249
    v_cvt_pk_bf16_f32 v53, v250, v251
    v_mfma_f32_16x16x32_bf16 v[212:215], v[156:159], v[240:243], v[212:215]
    v_cvt_pk_bf16_f32 v54, v252, v253
    v_cvt_pk_bf16_f32 v55, v254, v255
    buffer_store_dwordx4 v[52:55], v2, s[20:23], s62 offen offset:1024
    v_lshlrev_b32 v248, 16, v56
    s_waitcnt lgkmcnt(0)
    v_mfma_f32_16x16x32_bf16 v[216:219], v[152:155], v[244:247], v[216:219]
    v_and_b32 v249, 0xffff0000, v56
    v_lshlrev_b32 v250, 16, v57
    v_and_b32 v251, 0xffff0000, v57
    v_lshlrev_b32 v252, 16, v58
    v_mfma_f32_16x16x32_bf16 v[220:223], v[156:159], v[244:247], v[220:223]
    v_and_b32 v253, 0xffff0000, v58
    v_lshlrev_b32 v254, 16, v59
    v_and_b32 v255, 0xffff0000, v59
    v_fma_f32 v248, v248, v24, -v25
    v_fma_f32 v249, v249, v26, -v27
    v_fma_f32 v250, v250, v28, -v29
    v_fma_f32 v251, v251, v30, -v31
    v_fma_f32 v252, v252, v32, -v33
    v_fma_f32 v253, v253, v34, -v35
    v_fma_f32 v254, v254, v36, -v37
    v_fma_f32 v255, v255, v38, -v39
    v_cvt_pk_bf16_f32 v56, v248, v249
    v_cvt_pk_bf16_f32 v57, v250, v251
    v_cvt_pk_bf16_f32 v58, v252, v253
    v_cvt_pk_bf16_f32 v59, v254, v255
    buffer_store_dwordx4 v[56:59], v2, s[20:23], s62 offen offset:2048
    v_lshlrev_b32 v248, 16, v60
    v_and_b32 v249, 0xffff0000, v60
    v_lshlrev_b32 v250, 16, v61
    v_and_b32 v251, 0xffff0000, v61
    v_lshlrev_b32 v252, 16, v62
    v_and_b32 v253, 0xffff0000, v62
    v_lshlrev_b32 v254, 16, v63
    v_and_b32 v255, 0xffff0000, v63
    v_fma_f32 v248, v248, v24, -v25
    v_fma_f32 v249, v249, v26, -v27
    v_fma_f32 v250, v250, v28, -v29
    v_fma_f32 v251, v251, v30, -v31
    v_fma_f32 v252, v252, v32, -v33
    v_fma_f32 v253, v253, v34, -v35
    v_fma_f32 v254, v254, v36, -v37
    v_fma_f32 v255, v255, v38, -v39
    v_cvt_pk_bf16_f32 v60, v248, v249
    v_cvt_pk_bf16_f32 v61, v250, v251
    v_cvt_pk_bf16_f32 v62, v252, v253
    v_cvt_pk_bf16_f32 v63, v254, v255
    buffer_store_dwordx4 v[60:63], v2, s[20:23], s62 offen offset:3072
    s_nop 4
    s_lshl_b32 s6, s5, 7
    s_add_u32 s6, s6, s58
    s_mul_i32 s64, s6, 2688
    s_add_u32 s65, s64, 172032
    v_bfe_u32 v255, v1, 1, 1
    v_mul_u32_u24 v255, 172032, v255
    v_and_b32 v254, 1, v1
    v_lshl_add_u32 v255, v254, 6, v255
    v_lshrrev_b32 v254, 4, v1
    v_lshl_add_u32 v255, v254, 4, v255
    v_cvt_pk_bf16_f32 v200, v200, v201
    v_cvt_pk_bf16_f32 v201, v202, v203
    v_cvt_pk_bf16_f32 v202, v204, v205
    v_cvt_pk_bf16_f32 v203, v206, v207
    v_cvt_pk_bf16_f32 v208, v208, v209
    v_cvt_pk_bf16_f32 v209, v210, v211
    v_cvt_pk_bf16_f32 v210, v212, v213
    v_cvt_pk_bf16_f32 v211, v214, v215
    v_cvt_pk_bf16_f32 v216, v216, v217
    v_cvt_pk_bf16_f32 v217, v218, v219
    v_cvt_pk_bf16_f32 v218, v220, v221
    v_cvt_pk_bf16_f32 v219, v222, v223
    buffer_store_dwordx4 v[200:203], v2, s[32:35], s64 offen offset:1536
    buffer_store_dwordx4 v[208:211], v2, s[32:35], s65 offen offset:1536
    s_mov_b32 exec_lo, 0x000f000f
    s_mov_b32 exec_hi, 0x000f000f
    buffer_store_dwordx4 v[216:219], v255, s[32:35], s64 offen offset:2560
    s_mov_b64 exec, -1
    s_endpgm
g1_end:
    s_endpgm
.globl g2_kernel
.p2align 8
.type g2_kernel,@function
g2_kernel:
    s_cmp_ge_u32 s2, 256
    s_cbranch_scc1 g2_end
    s_load_dwordx2 s[8:9], s[0:1], 40
    s_load_dwordx2 s[12:13], s[0:1], 80
    s_load_dwordx2 s[16:17], s[0:1], 80
    s_load_dwordx2 s[20:21], s[0:1], 80
    s_load_dwordx2 s[24:25], s[0:1], 48
    v_lshrrev_b32 v1, 6, v0
    v_and_b32 v2, 63, v0
    s_nop 0
    v_readfirstlane_b32 s3, v1
    s_and_b32 s4, s2, 1
    s_lshl_b32 s4, s4, 3
    s_bfe_u32 s6, s2, 0x30003
    s_add_u32 s4, s4, s6
    s_bfe_u32 s5, s2, 0x20001
    s_lshl_b32 s5, s5, 2
    s_lshr_b32 s6, s2, 6
    s_add_u32 s5, s5, s6
    s_cmp_ge_u32 s3, 4
    s_cbranch_scc1 g2_prod
    s_setprio 0
    s_waitcnt lgkmcnt(0)
    s_add_u32 s16, s16, 20971520
    s_addc_u32 s17, s17, 0
    s_and_b32 s17, s17, 0xffff
    s_mov_b32 s18, 9437184
    s_mov_b32 s19, 0x00020000
    s_add_u32 s20, s20, 31457280
    s_addc_u32 s21, s21, 0
    s_and_b32 s21, s21, 0xffff
    s_mov_b32 s22, 9437184
    s_mov_b32 s23, 0x00020000
    s_and_b32 s25, s25, 0xffff
    s_mov_b32 s26, 4096
    s_mov_b32 s27, 0x00020000
    s_lshl_b32 s6, s4, 4
    s_add_u32 s6, s6, s5
    s_lshl_b32 s6, s6, 2
    s_add_u32 s6, s6, s3
    s_mul_i32 s6, s6, 9216
    v_lshlrev_b32 v3, 4, v2
    s_add_u32 s7, s6, 4096
    s_add_u32 s28, s6, 8192
    v_and_b32 v4, 15, v2
    v_lshrrev_b32 v5, 2, v4
    v_lshlrev_b32 v5, 3, v5
    v_and_b32 v6, 3, v4
    v_add_u32 v5, v5, v6
    v_lshlrev_b32 v5, 1, v5
    s_lshl_b32 s29, s4, 2
    s_add_u32 s29, s29, s3
    s_lshl_b32 s30, s29, 6
    buffer_load_ushort v14, v5, s[24:27], s30 offen
    buffer_load_ushort v15, v5, s[24:27], s30 offen offset:8
    v_lshrrev_b32 v8, 2, v4
    v_lshlrev_b32 v9, 1, v8
    v_bfe_u32 v10, v4, 1, 1
    v_or_b32 v9, v9, v10
    v_lshrrev_b32 v10, 4, v2
    v_xor_b32 v9, v9, v10
    v_lshlrev_b32 v9, 4, v9
    v_lshlrev_b32 v8, 12, v8
    v_add_u32 v8, v8, v9
    v_and_b32 v9, 3, v4
    v_lshlrev_b32 v9, 7, v9
    v_add_u32 v8, v8, v9
    s_lshl_b32 s31, s3, 10
    s_add_u32 s31, s31, 18432
    v_add_u32 v8, s31, v8
    v_xor_b32 v9, 64, v8
    v_add_u32 v10, 69632, v8
    v_add_u32 v11, 69632, v9
    v_mov_b32 v6, v3
    v_add_u32 v7, 69632, v3
    v_mov_b32 v16, 0
    v_mov_b32 v17, 0
    v_mov_b32 v18, 0
    v_mov_b32 v19, 0
    v_mov_b32 v20, 0
    v_mov_b32 v21, 0
    v_mov_b32 v22, 0
    v_mov_b32 v23, 0
    v_mov_b32 v24, 0
    v_mov_b32 v25, 0
    v_mov_b32 v26, 0
    v_mov_b32 v27, 0
    v_mov_b32 v28, 0
    v_mov_b32 v29, 0
    v_mov_b32 v30, 0
    v_mov_b32 v31, 0
    v_mov_b32 v32, 0
    v_mov_b32 v33, 0
    v_mov_b32 v34, 0
    v_mov_b32 v35, 0
    v_mov_b32 v36, 0
    v_mov_b32 v37, 0
    v_mov_b32 v38, 0
    v_mov_b32 v39, 0
    v_mov_b32 v40, 0
    v_mov_b32 v41, 0
    v_mov_b32 v42, 0
    v_mov_b32 v43, 0
    v_mov_b32 v44, 0
    v_mov_b32 v45, 0
    v_mov_b32 v46, 0
    v_mov_b32 v47, 0
    v_mov_b32 v48, 0
    v_mov_b32 v49, 0
    v_mov_b32 v50, 0
    v_mov_b32 v51, 0
    v_mov_b32 v52, 0
    v_mov_b32 v53, 0
    v_mov_b32 v54, 0
    v_mov_b32 v55, 0
    v_mov_b32 v56, 0
    v_mov_b32 v57, 0
    v_mov_b32 v58, 0
    v_mov_b32 v59, 0
    v_mov_b32 v60, 0
    v_mov_b32 v61, 0
    v_mov_b32 v62, 0
    v_mov_b32 v63, 0
    v_mov_b32 v64, 0
    v_mov_b32 v65, 0
    v_mov_b32 v66, 0
    v_mov_b32 v67, 0
    v_mov_b32 v68, 0
    v_mov_b32 v69, 0
    v_mov_b32 v70, 0
    v_mov_b32 v71, 0
    v_mov_b32 v72, 0
    v_mov_b32 v73, 0
    v_mov_b32 v74, 0
    v_mov_b32 v75, 0
    v_mov_b32 v76, 0
    v_mov_b32 v77, 0
    v_mov_b32 v78, 0
    v_mov_b32 v79, 0
    v_mov_b32 v80, 0
    v_mov_b32 v81, 0
    v_mov_b32 v82, 0
    v_mov_b32 v83, 0
    v_mov_b32 v84, 0
    v_mov_b32 v85, 0
    v_mov_b32 v86, 0
    v_mov_b32 v87, 0
    s_barrier
    ds_read_b128 v[88:91], v8 offset:0
    ds_read_b128 v[92:95], v8 offset:512
    ds_read_b128 v[96:99], v6 offset:0
    ds_read_b128 v[100:103], v6 offset:1024
    ds_read_b128 v[104:107], v6 offset:2048
    ds_read_b128 v[108:111], v6 offset:3072
    ds_read_b128 v[112:115], v6 offset:4096
    ds_read_b128 v[116:119], v6 offset:5120
    ds_read_b128 v[120:123], v6 offset:6144
    ds_read_b128 v[124:127], v6 offset:7168
    ds_read_b128 v[128:131], v6 offset:8192
    s_mov_b32 s32, 8
g2_cloop:
    s_waitcnt lgkmcnt(0)
    v_mfma_f32_16x16x32_bf16 v[16:19], v[96:99], v[88:91], v[16:19]
    ds_read_b128 v[132:135], v9 offset:0
    v_mfma_f32_16x16x32_bf16 v[20:23], v[96:99], v[92:95], v[20:23]
    ds_read_b128 v[136:139], v9 offset:512
    v_mfma_f32_16x16x32_bf16 v[24:27], v[100:103], v[88:91], v[24:27]
    ds_read_b128 v[140:143], v6 offset:9216
    v_mfma_f32_16x16x32_bf16 v[28:31], v[100:103], v[92:95], v[28:31]
    ds_read_b128 v[144:147], v6 offset:10240
    v_mfma_f32_16x16x32_bf16 v[32:35], v[104:107], v[88:91], v[32:35]
    ds_read_b128 v[148:151], v6 offset:11264
    v_mfma_f32_16x16x32_bf16 v[36:39], v[104:107], v[92:95], v[36:39]
    ds_read_b128 v[152:155], v6 offset:12288
    v_mfma_f32_16x16x32_bf16 v[40:43], v[108:111], v[88:91], v[40:43]
    ds_read_b128 v[156:159], v6 offset:13312
    v_mfma_f32_16x16x32_bf16 v[44:47], v[108:111], v[92:95], v[44:47]
    ds_read_b128 v[160:163], v6 offset:14336
    v_mfma_f32_16x16x32_bf16 v[48:51], v[112:115], v[88:91], v[48:51]
    ds_read_b128 v[164:167], v6 offset:15360
    v_mfma_f32_16x16x32_bf16 v[52:55], v[112:115], v[92:95], v[52:55]
    ds_read_b128 v[168:171], v6 offset:16384
    v_mfma_f32_16x16x32_bf16 v[56:59], v[116:119], v[88:91], v[56:59]
    ds_read_b128 v[172:175], v6 offset:17408
    v_mfma_f32_16x16x32_bf16 v[60:63], v[116:119], v[92:95], v[60:63]
    v_mfma_f32_16x16x32_bf16 v[64:67], v[120:123], v[88:91], v[64:67]
    v_mfma_f32_16x16x32_bf16 v[68:71], v[120:123], v[92:95], v[68:71]
    v_mfma_f32_16x16x32_bf16 v[72:75], v[124:127], v[88:91], v[72:75]
    v_mfma_f32_16x16x32_bf16 v[76:79], v[124:127], v[92:95], v[76:79]
    v_mfma_f32_16x16x32_bf16 v[80:83], v[128:131], v[88:91], v[80:83]
    v_mfma_f32_16x16x32_bf16 v[84:87], v[128:131], v[92:95], v[84:87]
    s_waitcnt lgkmcnt(0)
    s_barrier
    v_mfma_f32_16x16x32_bf16 v[16:19], v[140:143], v[132:135], v[16:19]
    ds_read_b128 v[88:91], v8 offset:34816
    v_mfma_f32_16x16x32_bf16 v[20:23], v[140:143], v[136:139], v[20:23]
    ds_read_b128 v[92:95], v8 offset:35328
    v_mfma_f32_16x16x32_bf16 v[24:27], v[144:147], v[132:135], v[24:27]
    ds_read_b128 v[96:99], v6 offset:34816
    v_mfma_f32_16x16x32_bf16 v[28:31], v[144:147], v[136:139], v[28:31]
    ds_read_b128 v[100:103], v6 offset:35840
    v_mfma_f32_16x16x32_bf16 v[32:35], v[148:151], v[132:135], v[32:35]
    ds_read_b128 v[104:107], v6 offset:36864
    v_mfma_f32_16x16x32_bf16 v[36:39], v[148:151], v[136:139], v[36:39]
    ds_read_b128 v[108:111], v6 offset:37888
    v_mfma_f32_16x16x32_bf16 v[40:43], v[152:155], v[132:135], v[40:43]
    ds_read_b128 v[112:115], v6 offset:38912
    v_mfma_f32_16x16x32_bf16 v[44:47], v[152:155], v[136:139], v[44:47]
    ds_read_b128 v[116:119], v6 offset:39936
    v_mfma_f32_16x16x32_bf16 v[48:51], v[156:159], v[132:135], v[48:51]
    ds_read_b128 v[120:123], v6 offset:40960
    v_mfma_f32_16x16x32_bf16 v[52:55], v[156:159], v[136:139], v[52:55]
    ds_read_b128 v[124:127], v6 offset:41984
    v_mfma_f32_16x16x32_bf16 v[56:59], v[160:163], v[132:135], v[56:59]
    ds_read_b128 v[128:131], v6 offset:43008
    v_mfma_f32_16x16x32_bf16 v[60:63], v[160:163], v[136:139], v[60:63]
    v_mfma_f32_16x16x32_bf16 v[64:67], v[164:167], v[132:135], v[64:67]
    v_mfma_f32_16x16x32_bf16 v[68:71], v[164:167], v[136:139], v[68:71]
    v_mfma_f32_16x16x32_bf16 v[72:75], v[168:171], v[132:135], v[72:75]
    v_mfma_f32_16x16x32_bf16 v[76:79], v[168:171], v[136:139], v[76:79]
    v_mfma_f32_16x16x32_bf16 v[80:83], v[172:175], v[132:135], v[80:83]
    v_mfma_f32_16x16x32_bf16 v[84:87], v[172:175], v[136:139], v[84:87]
    s_waitcnt lgkmcnt(0)
    v_mfma_f32_16x16x32_bf16 v[16:19], v[96:99], v[88:91], v[16:19]
    ds_read_b128 v[132:135], v9 offset:34816
    v_mfma_f32_16x16x32_bf16 v[20:23], v[96:99], v[92:95], v[20:23]
    ds_read_b128 v[136:139], v9 offset:35328
    v_mfma_f32_16x16x32_bf16 v[24:27], v[100:103], v[88:91], v[24:27]
    ds_read_b128 v[140:143], v6 offset:44032
    v_mfma_f32_16x16x32_bf16 v[28:31], v[100:103], v[92:95], v[28:31]
    ds_read_b128 v[144:147], v6 offset:45056
    v_mfma_f32_16x16x32_bf16 v[32:35], v[104:107], v[88:91], v[32:35]
    ds_read_b128 v[148:151], v6 offset:46080
    v_mfma_f32_16x16x32_bf16 v[36:39], v[104:107], v[92:95], v[36:39]
    ds_read_b128 v[152:155], v6 offset:47104
    v_mfma_f32_16x16x32_bf16 v[40:43], v[108:111], v[88:91], v[40:43]
    ds_read_b128 v[156:159], v6 offset:48128
    v_mfma_f32_16x16x32_bf16 v[44:47], v[108:111], v[92:95], v[44:47]
    ds_read_b128 v[160:163], v6 offset:49152
    v_mfma_f32_16x16x32_bf16 v[48:51], v[112:115], v[88:91], v[48:51]
    ds_read_b128 v[164:167], v6 offset:50176
    v_mfma_f32_16x16x32_bf16 v[52:55], v[112:115], v[92:95], v[52:55]
    ds_read_b128 v[168:171], v6 offset:51200
    v_mfma_f32_16x16x32_bf16 v[56:59], v[116:119], v[88:91], v[56:59]
    ds_read_b128 v[172:175], v6 offset:52224
    v_mfma_f32_16x16x32_bf16 v[60:63], v[116:119], v[92:95], v[60:63]
    v_mfma_f32_16x16x32_bf16 v[64:67], v[120:123], v[88:91], v[64:67]
    v_mfma_f32_16x16x32_bf16 v[68:71], v[120:123], v[92:95], v[68:71]
    v_mfma_f32_16x16x32_bf16 v[72:75], v[124:127], v[88:91], v[72:75]
    v_mfma_f32_16x16x32_bf16 v[76:79], v[124:127], v[92:95], v[76:79]
    v_mfma_f32_16x16x32_bf16 v[80:83], v[128:131], v[88:91], v[80:83]
    v_mfma_f32_16x16x32_bf16 v[84:87], v[128:131], v[92:95], v[84:87]
    s_waitcnt lgkmcnt(0)
    s_barrier
    v_mfma_f32_16x16x32_bf16 v[16:19], v[140:143], v[132:135], v[16:19]
    ds_read_b128 v[88:91], v10 offset:0
    v_mfma_f32_16x16x32_bf16 v[20:23], v[140:143], v[136:139], v[20:23]
    ds_read_b128 v[92:95], v10 offset:512
    v_mfma_f32_16x16x32_bf16 v[24:27], v[144:147], v[132:135], v[24:27]
    ds_read_b128 v[96:99], v7 offset:0
    v_mfma_f32_16x16x32_bf16 v[28:31], v[144:147], v[136:139], v[28:31]
    ds_read_b128 v[100:103], v7 offset:1024
    v_mfma_f32_16x16x32_bf16 v[32:35], v[148:151], v[132:135], v[32:35]
    ds_read_b128 v[104:107], v7 offset:2048
    v_mfma_f32_16x16x32_bf16 v[36:39], v[148:151], v[136:139], v[36:39]
    ds_read_b128 v[108:111], v7 offset:3072
    v_mfma_f32_16x16x32_bf16 v[40:43], v[152:155], v[132:135], v[40:43]
    ds_read_b128 v[112:115], v7 offset:4096
    v_mfma_f32_16x16x32_bf16 v[44:47], v[152:155], v[136:139], v[44:47]
    ds_read_b128 v[116:119], v7 offset:5120
    v_mfma_f32_16x16x32_bf16 v[48:51], v[156:159], v[132:135], v[48:51]
    ds_read_b128 v[120:123], v7 offset:6144
    v_mfma_f32_16x16x32_bf16 v[52:55], v[156:159], v[136:139], v[52:55]
    ds_read_b128 v[124:127], v7 offset:7168
    v_mfma_f32_16x16x32_bf16 v[56:59], v[160:163], v[132:135], v[56:59]
    ds_read_b128 v[128:131], v7 offset:8192
    v_mfma_f32_16x16x32_bf16 v[60:63], v[160:163], v[136:139], v[60:63]
    v_mfma_f32_16x16x32_bf16 v[64:67], v[164:167], v[132:135], v[64:67]
    v_mfma_f32_16x16x32_bf16 v[68:71], v[164:167], v[136:139], v[68:71]
    v_mfma_f32_16x16x32_bf16 v[72:75], v[168:171], v[132:135], v[72:75]
    v_mfma_f32_16x16x32_bf16 v[76:79], v[168:171], v[136:139], v[76:79]
    v_mfma_f32_16x16x32_bf16 v[80:83], v[172:175], v[132:135], v[80:83]
    v_mfma_f32_16x16x32_bf16 v[84:87], v[172:175], v[136:139], v[84:87]
    s_waitcnt lgkmcnt(0)
    v_mfma_f32_16x16x32_bf16 v[16:19], v[96:99], v[88:91], v[16:19]
    ds_read_b128 v[132:135], v11 offset:0
    v_mfma_f32_16x16x32_bf16 v[20:23], v[96:99], v[92:95], v[20:23]
    ds_read_b128 v[136:139], v11 offset:512
    v_mfma_f32_16x16x32_bf16 v[24:27], v[100:103], v[88:91], v[24:27]
    ds_read_b128 v[140:143], v7 offset:9216
    v_mfma_f32_16x16x32_bf16 v[28:31], v[100:103], v[92:95], v[28:31]
    ds_read_b128 v[144:147], v7 offset:10240
    v_mfma_f32_16x16x32_bf16 v[32:35], v[104:107], v[88:91], v[32:35]
    ds_read_b128 v[148:151], v7 offset:11264
    v_mfma_f32_16x16x32_bf16 v[36:39], v[104:107], v[92:95], v[36:39]
    ds_read_b128 v[152:155], v7 offset:12288
    v_mfma_f32_16x16x32_bf16 v[40:43], v[108:111], v[88:91], v[40:43]
    ds_read_b128 v[156:159], v7 offset:13312
    v_mfma_f32_16x16x32_bf16 v[44:47], v[108:111], v[92:95], v[44:47]
    ds_read_b128 v[160:163], v7 offset:14336
    v_mfma_f32_16x16x32_bf16 v[48:51], v[112:115], v[88:91], v[48:51]
    ds_read_b128 v[164:167], v7 offset:15360
    v_mfma_f32_16x16x32_bf16 v[52:55], v[112:115], v[92:95], v[52:55]
    ds_read_b128 v[168:171], v7 offset:16384
    v_mfma_f32_16x16x32_bf16 v[56:59], v[116:119], v[88:91], v[56:59]
    ds_read_b128 v[172:175], v7 offset:17408
    v_mfma_f32_16x16x32_bf16 v[60:63], v[116:119], v[92:95], v[60:63]
    v_mfma_f32_16x16x32_bf16 v[64:67], v[120:123], v[88:91], v[64:67]
    v_mfma_f32_16x16x32_bf16 v[68:71], v[120:123], v[92:95], v[68:71]
    v_mfma_f32_16x16x32_bf16 v[72:75], v[124:127], v[88:91], v[72:75]
    v_mfma_f32_16x16x32_bf16 v[76:79], v[124:127], v[92:95], v[76:79]
    v_mfma_f32_16x16x32_bf16 v[80:83], v[128:131], v[88:91], v[80:83]
    v_mfma_f32_16x16x32_bf16 v[84:87], v[128:131], v[92:95], v[84:87]
    s_waitcnt lgkmcnt(0)
    s_barrier
    v_mfma_f32_16x16x32_bf16 v[16:19], v[140:143], v[132:135], v[16:19]
    ds_read_b128 v[88:91], v10 offset:34816
    v_mfma_f32_16x16x32_bf16 v[20:23], v[140:143], v[136:139], v[20:23]
    ds_read_b128 v[92:95], v10 offset:35328
    v_mfma_f32_16x16x32_bf16 v[24:27], v[144:147], v[132:135], v[24:27]
    ds_read_b128 v[96:99], v7 offset:34816
    v_mfma_f32_16x16x32_bf16 v[28:31], v[144:147], v[136:139], v[28:31]
    ds_read_b128 v[100:103], v7 offset:35840
    v_mfma_f32_16x16x32_bf16 v[32:35], v[148:151], v[132:135], v[32:35]
    ds_read_b128 v[104:107], v7 offset:36864
    v_mfma_f32_16x16x32_bf16 v[36:39], v[148:151], v[136:139], v[36:39]
    ds_read_b128 v[108:111], v7 offset:37888
    v_mfma_f32_16x16x32_bf16 v[40:43], v[152:155], v[132:135], v[40:43]
    ds_read_b128 v[112:115], v7 offset:38912
    v_mfma_f32_16x16x32_bf16 v[44:47], v[152:155], v[136:139], v[44:47]
    ds_read_b128 v[116:119], v7 offset:39936
    v_mfma_f32_16x16x32_bf16 v[48:51], v[156:159], v[132:135], v[48:51]
    ds_read_b128 v[120:123], v7 offset:40960
    v_mfma_f32_16x16x32_bf16 v[52:55], v[156:159], v[136:139], v[52:55]
    ds_read_b128 v[124:127], v7 offset:41984
    v_mfma_f32_16x16x32_bf16 v[56:59], v[160:163], v[132:135], v[56:59]
    ds_read_b128 v[128:131], v7 offset:43008
    v_mfma_f32_16x16x32_bf16 v[60:63], v[160:163], v[136:139], v[60:63]
    v_mfma_f32_16x16x32_bf16 v[64:67], v[164:167], v[132:135], v[64:67]
    v_mfma_f32_16x16x32_bf16 v[68:71], v[164:167], v[136:139], v[68:71]
    v_mfma_f32_16x16x32_bf16 v[72:75], v[168:171], v[132:135], v[72:75]
    v_mfma_f32_16x16x32_bf16 v[76:79], v[168:171], v[136:139], v[76:79]
    v_mfma_f32_16x16x32_bf16 v[80:83], v[172:175], v[132:135], v[80:83]
    v_mfma_f32_16x16x32_bf16 v[84:87], v[172:175], v[136:139], v[84:87]
    s_waitcnt lgkmcnt(0)
    v_mfma_f32_16x16x32_bf16 v[16:19], v[96:99], v[88:91], v[16:19]
    ds_read_b128 v[132:135], v11 offset:34816
    v_mfma_f32_16x16x32_bf16 v[20:23], v[96:99], v[92:95], v[20:23]
    ds_read_b128 v[136:139], v11 offset:35328
    v_mfma_f32_16x16x32_bf16 v[24:27], v[100:103], v[88:91], v[24:27]
    ds_read_b128 v[140:143], v7 offset:44032
    v_mfma_f32_16x16x32_bf16 v[28:31], v[100:103], v[92:95], v[28:31]
    ds_read_b128 v[144:147], v7 offset:45056
    v_mfma_f32_16x16x32_bf16 v[32:35], v[104:107], v[88:91], v[32:35]
    ds_read_b128 v[148:151], v7 offset:46080
    v_mfma_f32_16x16x32_bf16 v[36:39], v[104:107], v[92:95], v[36:39]
    ds_read_b128 v[152:155], v7 offset:47104
    v_mfma_f32_16x16x32_bf16 v[40:43], v[108:111], v[88:91], v[40:43]
    ds_read_b128 v[156:159], v7 offset:48128
    v_mfma_f32_16x16x32_bf16 v[44:47], v[108:111], v[92:95], v[44:47]
    ds_read_b128 v[160:163], v7 offset:49152
    v_mfma_f32_16x16x32_bf16 v[48:51], v[112:115], v[88:91], v[48:51]
    ds_read_b128 v[164:167], v7 offset:50176
    v_mfma_f32_16x16x32_bf16 v[52:55], v[112:115], v[92:95], v[52:55]
    ds_read_b128 v[168:171], v7 offset:51200
    v_mfma_f32_16x16x32_bf16 v[56:59], v[116:119], v[88:91], v[56:59]
    ds_read_b128 v[172:175], v7 offset:52224
    v_mfma_f32_16x16x32_bf16 v[60:63], v[116:119], v[92:95], v[60:63]
    v_mfma_f32_16x16x32_bf16 v[64:67], v[120:123], v[88:91], v[64:67]
    v_mfma_f32_16x16x32_bf16 v[68:71], v[120:123], v[92:95], v[68:71]
    v_mfma_f32_16x16x32_bf16 v[72:75], v[124:127], v[88:91], v[72:75]
    v_mfma_f32_16x16x32_bf16 v[76:79], v[124:127], v[92:95], v[76:79]
    v_mfma_f32_16x16x32_bf16 v[80:83], v[128:131], v[88:91], v[80:83]
    v_mfma_f32_16x16x32_bf16 v[84:87], v[128:131], v[92:95], v[84:87]
    s_waitcnt lgkmcnt(0)
    s_barrier
    v_mfma_f32_16x16x32_bf16 v[16:19], v[140:143], v[132:135], v[16:19]
    ds_read_b128 v[88:91], v8 offset:0
    v_mfma_f32_16x16x32_bf16 v[20:23], v[140:143], v[136:139], v[20:23]
    ds_read_b128 v[92:95], v8 offset:512
    v_mfma_f32_16x16x32_bf16 v[24:27], v[144:147], v[132:135], v[24:27]
    ds_read_b128 v[96:99], v6 offset:0
    v_mfma_f32_16x16x32_bf16 v[28:31], v[144:147], v[136:139], v[28:31]
    ds_read_b128 v[100:103], v6 offset:1024
    v_mfma_f32_16x16x32_bf16 v[32:35], v[148:151], v[132:135], v[32:35]
    ds_read_b128 v[104:107], v6 offset:2048
    v_mfma_f32_16x16x32_bf16 v[36:39], v[148:151], v[136:139], v[36:39]
    ds_read_b128 v[108:111], v6 offset:3072
    v_mfma_f32_16x16x32_bf16 v[40:43], v[152:155], v[132:135], v[40:43]
    ds_read_b128 v[112:115], v6 offset:4096
    v_mfma_f32_16x16x32_bf16 v[44:47], v[152:155], v[136:139], v[44:47]
    ds_read_b128 v[116:119], v6 offset:5120
    v_mfma_f32_16x16x32_bf16 v[48:51], v[156:159], v[132:135], v[48:51]
    ds_read_b128 v[120:123], v6 offset:6144
    v_mfma_f32_16x16x32_bf16 v[52:55], v[156:159], v[136:139], v[52:55]
    ds_read_b128 v[124:127], v6 offset:7168
    v_mfma_f32_16x16x32_bf16 v[56:59], v[160:163], v[132:135], v[56:59]
    ds_read_b128 v[128:131], v6 offset:8192
    v_mfma_f32_16x16x32_bf16 v[60:63], v[160:163], v[136:139], v[60:63]
    v_mfma_f32_16x16x32_bf16 v[64:67], v[164:167], v[132:135], v[64:67]
    v_mfma_f32_16x16x32_bf16 v[68:71], v[164:167], v[136:139], v[68:71]
    v_mfma_f32_16x16x32_bf16 v[72:75], v[168:171], v[132:135], v[72:75]
    v_mfma_f32_16x16x32_bf16 v[76:79], v[168:171], v[136:139], v[76:79]
    v_mfma_f32_16x16x32_bf16 v[80:83], v[172:175], v[132:135], v[80:83]
    v_mfma_f32_16x16x32_bf16 v[84:87], v[172:175], v[136:139], v[84:87]
    s_sub_u32 s32, s32, 1
    s_cmp_lg_u32 s32, 1
    s_cbranch_scc1 g2_cloop
    s_waitcnt lgkmcnt(0)
    v_mfma_f32_16x16x32_bf16 v[16:19], v[96:99], v[88:91], v[16:19]
    ds_read_b128 v[132:135], v9 offset:0
    v_mfma_f32_16x16x32_bf16 v[20:23], v[96:99], v[92:95], v[20:23]
    ds_read_b128 v[136:139], v9 offset:512
    v_mfma_f32_16x16x32_bf16 v[24:27], v[100:103], v[88:91], v[24:27]
    ds_read_b128 v[140:143], v6 offset:9216
    v_mfma_f32_16x16x32_bf16 v[28:31], v[100:103], v[92:95], v[28:31]
    ds_read_b128 v[144:147], v6 offset:10240
    v_mfma_f32_16x16x32_bf16 v[32:35], v[104:107], v[88:91], v[32:35]
    ds_read_b128 v[148:151], v6 offset:11264
    v_mfma_f32_16x16x32_bf16 v[36:39], v[104:107], v[92:95], v[36:39]
    ds_read_b128 v[152:155], v6 offset:12288
    v_mfma_f32_16x16x32_bf16 v[40:43], v[108:111], v[88:91], v[40:43]
    ds_read_b128 v[156:159], v6 offset:13312
    v_mfma_f32_16x16x32_bf16 v[44:47], v[108:111], v[92:95], v[44:47]
    ds_read_b128 v[160:163], v6 offset:14336
    v_mfma_f32_16x16x32_bf16 v[48:51], v[112:115], v[88:91], v[48:51]
    ds_read_b128 v[164:167], v6 offset:15360
    v_mfma_f32_16x16x32_bf16 v[52:55], v[112:115], v[92:95], v[52:55]
    ds_read_b128 v[168:171], v6 offset:16384
    v_mfma_f32_16x16x32_bf16 v[56:59], v[116:119], v[88:91], v[56:59]
    ds_read_b128 v[172:175], v6 offset:17408
    v_mfma_f32_16x16x32_bf16 v[60:63], v[116:119], v[92:95], v[60:63]
    buffer_load_dwordx4 v[176:179], v3, s[16:19], s6 offen offset:0
    v_mfma_f32_16x16x32_bf16 v[64:67], v[120:123], v[88:91], v[64:67]
    buffer_load_dwordx4 v[180:183], v3, s[16:19], s6 offen offset:1024
    v_mfma_f32_16x16x32_bf16 v[68:71], v[120:123], v[92:95], v[68:71]
    v_mfma_f32_16x16x32_bf16 v[72:75], v[124:127], v[88:91], v[72:75]
    v_mfma_f32_16x16x32_bf16 v[76:79], v[124:127], v[92:95], v[76:79]
    v_mfma_f32_16x16x32_bf16 v[80:83], v[128:131], v[88:91], v[80:83]
    v_mfma_f32_16x16x32_bf16 v[84:87], v[128:131], v[92:95], v[84:87]
    s_waitcnt lgkmcnt(0)
    s_barrier
    v_mfma_f32_16x16x32_bf16 v[16:19], v[140:143], v[132:135], v[16:19]
    ds_read_b128 v[88:91], v8 offset:34816
    v_mfma_f32_16x16x32_bf16 v[20:23], v[140:143], v[136:139], v[20:23]
    ds_read_b128 v[92:95], v8 offset:35328
    v_mfma_f32_16x16x32_bf16 v[24:27], v[144:147], v[132:135], v[24:27]
    ds_read_b128 v[96:99], v6 offset:34816
    v_mfma_f32_16x16x32_bf16 v[28:31], v[144:147], v[136:139], v[28:31]
    ds_read_b128 v[100:103], v6 offset:35840
    v_mfma_f32_16x16x32_bf16 v[32:35], v[148:151], v[132:135], v[32:35]
    ds_read_b128 v[104:107], v6 offset:36864
    v_mfma_f32_16x16x32_bf16 v[36:39], v[148:151], v[136:139], v[36:39]
    ds_read_b128 v[108:111], v6 offset:37888
    v_mfma_f32_16x16x32_bf16 v[40:43], v[152:155], v[132:135], v[40:43]
    ds_read_b128 v[112:115], v6 offset:38912
    v_mfma_f32_16x16x32_bf16 v[44:47], v[152:155], v[136:139], v[44:47]
    ds_read_b128 v[116:119], v6 offset:39936
    v_mfma_f32_16x16x32_bf16 v[48:51], v[156:159], v[132:135], v[48:51]
    ds_read_b128 v[120:123], v6 offset:40960
    v_mfma_f32_16x16x32_bf16 v[52:55], v[156:159], v[136:139], v[52:55]
    ds_read_b128 v[124:127], v6 offset:41984
    v_mfma_f32_16x16x32_bf16 v[56:59], v[160:163], v[132:135], v[56:59]
    ds_read_b128 v[128:131], v6 offset:43008
    v_mfma_f32_16x16x32_bf16 v[60:63], v[160:163], v[136:139], v[60:63]
    v_mfma_f32_16x16x32_bf16 v[64:67], v[164:167], v[132:135], v[64:67]
    v_mfma_f32_16x16x32_bf16 v[68:71], v[164:167], v[136:139], v[68:71]
    v_mfma_f32_16x16x32_bf16 v[72:75], v[168:171], v[132:135], v[72:75]
    v_mfma_f32_16x16x32_bf16 v[76:79], v[168:171], v[136:139], v[76:79]
    v_mfma_f32_16x16x32_bf16 v[80:83], v[172:175], v[132:135], v[80:83]
    v_mfma_f32_16x16x32_bf16 v[84:87], v[172:175], v[136:139], v[84:87]
    s_waitcnt lgkmcnt(0)
    v_mfma_f32_16x16x32_bf16 v[16:19], v[96:99], v[88:91], v[16:19]
    ds_read_b128 v[132:135], v9 offset:34816
    v_mfma_f32_16x16x32_bf16 v[20:23], v[96:99], v[92:95], v[20:23]
    ds_read_b128 v[136:139], v9 offset:35328
    v_mfma_f32_16x16x32_bf16 v[24:27], v[100:103], v[88:91], v[24:27]
    ds_read_b128 v[140:143], v6 offset:44032
    v_mfma_f32_16x16x32_bf16 v[28:31], v[100:103], v[92:95], v[28:31]
    ds_read_b128 v[144:147], v6 offset:45056
    v_mfma_f32_16x16x32_bf16 v[32:35], v[104:107], v[88:91], v[32:35]
    ds_read_b128 v[148:151], v6 offset:46080
    v_mfma_f32_16x16x32_bf16 v[36:39], v[104:107], v[92:95], v[36:39]
    ds_read_b128 v[152:155], v6 offset:47104
    v_mfma_f32_16x16x32_bf16 v[40:43], v[108:111], v[88:91], v[40:43]
    ds_read_b128 v[156:159], v6 offset:48128
    v_mfma_f32_16x16x32_bf16 v[44:47], v[108:111], v[92:95], v[44:47]
    ds_read_b128 v[160:163], v6 offset:49152
    v_mfma_f32_16x16x32_bf16 v[48:51], v[112:115], v[88:91], v[48:51]
    ds_read_b128 v[164:167], v6 offset:50176
    v_mfma_f32_16x16x32_bf16 v[52:55], v[112:115], v[92:95], v[52:55]
    ds_read_b128 v[168:171], v6 offset:51200
    v_mfma_f32_16x16x32_bf16 v[56:59], v[116:119], v[88:91], v[56:59]
    ds_read_b128 v[172:175], v6 offset:52224
    v_mfma_f32_16x16x32_bf16 v[60:63], v[116:119], v[92:95], v[60:63]
    buffer_load_dwordx4 v[184:187], v3, s[16:19], s6 offen offset:2048
    v_mfma_f32_16x16x32_bf16 v[64:67], v[120:123], v[88:91], v[64:67]
    buffer_load_dwordx4 v[188:191], v3, s[16:19], s6 offen offset:3072
    v_mfma_f32_16x16x32_bf16 v[68:71], v[120:123], v[92:95], v[68:71]
    buffer_load_dwordx4 v[192:195], v3, s[16:19], s7 offen offset:0
    v_mfma_f32_16x16x32_bf16 v[72:75], v[124:127], v[88:91], v[72:75]
    buffer_load_dwordx4 v[196:199], v3, s[16:19], s7 offen offset:1024
    v_mfma_f32_16x16x32_bf16 v[76:79], v[124:127], v[92:95], v[76:79]
    buffer_load_dwordx4 v[200:203], v3, s[16:19], s7 offen offset:2048
    v_mfma_f32_16x16x32_bf16 v[80:83], v[128:131], v[88:91], v[80:83]
    buffer_load_dwordx4 v[204:207], v3, s[16:19], s7 offen offset:3072
    v_mfma_f32_16x16x32_bf16 v[84:87], v[128:131], v[92:95], v[84:87]
    buffer_load_dwordx4 v[208:211], v3, s[16:19], s28 offen offset:0
    s_waitcnt lgkmcnt(0)
    s_barrier
    v_mfma_f32_16x16x32_bf16 v[16:19], v[140:143], v[132:135], v[16:19]
    ds_read_b128 v[88:91], v10 offset:0
    v_mfma_f32_16x16x32_bf16 v[20:23], v[140:143], v[136:139], v[20:23]
    ds_read_b128 v[92:95], v10 offset:512
    v_mfma_f32_16x16x32_bf16 v[24:27], v[144:147], v[132:135], v[24:27]
    ds_read_b128 v[96:99], v7 offset:0
    v_mfma_f32_16x16x32_bf16 v[28:31], v[144:147], v[136:139], v[28:31]
    ds_read_b128 v[100:103], v7 offset:1024
    v_mfma_f32_16x16x32_bf16 v[32:35], v[148:151], v[132:135], v[32:35]
    ds_read_b128 v[104:107], v7 offset:2048
    v_mfma_f32_16x16x32_bf16 v[36:39], v[148:151], v[136:139], v[36:39]
    ds_read_b128 v[108:111], v7 offset:3072
    v_mfma_f32_16x16x32_bf16 v[40:43], v[152:155], v[132:135], v[40:43]
    ds_read_b128 v[112:115], v7 offset:4096
    v_mfma_f32_16x16x32_bf16 v[44:47], v[152:155], v[136:139], v[44:47]
    ds_read_b128 v[116:119], v7 offset:5120
    v_mfma_f32_16x16x32_bf16 v[48:51], v[156:159], v[132:135], v[48:51]
    ds_read_b128 v[120:123], v7 offset:6144
    v_mfma_f32_16x16x32_bf16 v[52:55], v[156:159], v[136:139], v[52:55]
    ds_read_b128 v[124:127], v7 offset:7168
    v_mfma_f32_16x16x32_bf16 v[56:59], v[160:163], v[132:135], v[56:59]
    ds_read_b128 v[128:131], v7 offset:8192
    v_mfma_f32_16x16x32_bf16 v[60:63], v[160:163], v[136:139], v[60:63]
    v_mfma_f32_16x16x32_bf16 v[64:67], v[164:167], v[132:135], v[64:67]
    v_mfma_f32_16x16x32_bf16 v[68:71], v[164:167], v[136:139], v[68:71]
    v_mfma_f32_16x16x32_bf16 v[72:75], v[168:171], v[132:135], v[72:75]
    v_mfma_f32_16x16x32_bf16 v[76:79], v[168:171], v[136:139], v[76:79]
    v_mfma_f32_16x16x32_bf16 v[80:83], v[172:175], v[132:135], v[80:83]
    v_mfma_f32_16x16x32_bf16 v[84:87], v[172:175], v[136:139], v[84:87]
    s_waitcnt lgkmcnt(0)
    v_mfma_f32_16x16x32_bf16 v[16:19], v[96:99], v[88:91], v[16:19]
    ds_read_b128 v[132:135], v11 offset:0
    v_mfma_f32_16x16x32_bf16 v[20:23], v[96:99], v[92:95], v[20:23]
    ds_read_b128 v[136:139], v11 offset:512
    v_mfma_f32_16x16x32_bf16 v[24:27], v[100:103], v[88:91], v[24:27]
    ds_read_b128 v[140:143], v7 offset:9216
    v_mfma_f32_16x16x32_bf16 v[28:31], v[100:103], v[92:95], v[28:31]
    ds_read_b128 v[144:147], v7 offset:10240
    v_mfma_f32_16x16x32_bf16 v[32:35], v[104:107], v[88:91], v[32:35]
    ds_read_b128 v[148:151], v7 offset:11264
    v_mfma_f32_16x16x32_bf16 v[36:39], v[104:107], v[92:95], v[36:39]
    ds_read_b128 v[152:155], v7 offset:12288
    v_mfma_f32_16x16x32_bf16 v[40:43], v[108:111], v[88:91], v[40:43]
    ds_read_b128 v[156:159], v7 offset:13312
    v_mfma_f32_16x16x32_bf16 v[44:47], v[108:111], v[92:95], v[44:47]
    ds_read_b128 v[160:163], v7 offset:14336
    v_mfma_f32_16x16x32_bf16 v[48:51], v[112:115], v[88:91], v[48:51]
    ds_read_b128 v[164:167], v7 offset:15360
    v_mfma_f32_16x16x32_bf16 v[52:55], v[112:115], v[92:95], v[52:55]
    ds_read_b128 v[168:171], v7 offset:16384
    v_mfma_f32_16x16x32_bf16 v[56:59], v[116:119], v[88:91], v[56:59]
    ds_read_b128 v[172:175], v7 offset:17408
    v_mfma_f32_16x16x32_bf16 v[60:63], v[116:119], v[92:95], v[60:63]
    v_mfma_f32_16x16x32_bf16 v[64:67], v[120:123], v[88:91], v[64:67]
    v_mfma_f32_16x16x32_bf16 v[68:71], v[120:123], v[92:95], v[68:71]
    v_mfma_f32_16x16x32_bf16 v[72:75], v[124:127], v[88:91], v[72:75]
    v_mfma_f32_16x16x32_bf16 v[76:79], v[124:127], v[92:95], v[76:79]
    v_mfma_f32_16x16x32_bf16 v[80:83], v[128:131], v[88:91], v[80:83]
    v_mfma_f32_16x16x32_bf16 v[84:87], v[128:131], v[92:95], v[84:87]
    s_waitcnt lgkmcnt(0)
    s_barrier
    v_mfma_f32_16x16x32_bf16 v[16:19], v[140:143], v[132:135], v[16:19]
    ds_read_b128 v[88:91], v10 offset:34816
    v_mfma_f32_16x16x32_bf16 v[20:23], v[140:143], v[136:139], v[20:23]
    ds_read_b128 v[92:95], v10 offset:35328
    v_mfma_f32_16x16x32_bf16 v[24:27], v[144:147], v[132:135], v[24:27]
    ds_read_b128 v[96:99], v7 offset:34816
    v_mfma_f32_16x16x32_bf16 v[28:31], v[144:147], v[136:139], v[28:31]
    ds_read_b128 v[100:103], v7 offset:35840
    v_mfma_f32_16x16x32_bf16 v[32:35], v[148:151], v[132:135], v[32:35]
    ds_read_b128 v[104:107], v7 offset:36864
    v_mfma_f32_16x16x32_bf16 v[36:39], v[148:151], v[136:139], v[36:39]
    ds_read_b128 v[108:111], v7 offset:37888
    v_mfma_f32_16x16x32_bf16 v[40:43], v[152:155], v[132:135], v[40:43]
    ds_read_b128 v[112:115], v7 offset:38912
    v_mfma_f32_16x16x32_bf16 v[44:47], v[152:155], v[136:139], v[44:47]
    ds_read_b128 v[116:119], v7 offset:39936
    v_mfma_f32_16x16x32_bf16 v[48:51], v[156:159], v[132:135], v[48:51]
    ds_read_b128 v[120:123], v7 offset:40960
    v_mfma_f32_16x16x32_bf16 v[52:55], v[156:159], v[136:139], v[52:55]
    ds_read_b128 v[124:127], v7 offset:41984
    v_mfma_f32_16x16x32_bf16 v[56:59], v[160:163], v[132:135], v[56:59]
    ds_read_b128 v[128:131], v7 offset:43008
    v_mfma_f32_16x16x32_bf16 v[60:63], v[160:163], v[136:139], v[60:63]
    v_mfma_f32_16x16x32_bf16 v[64:67], v[164:167], v[132:135], v[64:67]
    v_mfma_f32_16x16x32_bf16 v[68:71], v[164:167], v[136:139], v[68:71]
    v_mfma_f32_16x16x32_bf16 v[72:75], v[168:171], v[132:135], v[72:75]
    v_mfma_f32_16x16x32_bf16 v[76:79], v[168:171], v[136:139], v[76:79]
    v_mfma_f32_16x16x32_bf16 v[80:83], v[172:175], v[132:135], v[80:83]
    v_mfma_f32_16x16x32_bf16 v[84:87], v[172:175], v[136:139], v[84:87]
    s_waitcnt lgkmcnt(0)
    v_mfma_f32_16x16x32_bf16 v[16:19], v[96:99], v[88:91], v[16:19]
    ds_read_b128 v[132:135], v11 offset:34816
    v_mfma_f32_16x16x32_bf16 v[20:23], v[96:99], v[92:95], v[20:23]
    ds_read_b128 v[136:139], v11 offset:35328
    v_mfma_f32_16x16x32_bf16 v[24:27], v[100:103], v[88:91], v[24:27]
    ds_read_b128 v[140:143], v7 offset:44032
    v_mfma_f32_16x16x32_bf16 v[28:31], v[100:103], v[92:95], v[28:31]
    ds_read_b128 v[144:147], v7 offset:45056
    v_mfma_f32_16x16x32_bf16 v[32:35], v[104:107], v[88:91], v[32:35]
    ds_read_b128 v[148:151], v7 offset:46080
    v_mfma_f32_16x16x32_bf16 v[36:39], v[104:107], v[92:95], v[36:39]
    ds_read_b128 v[152:155], v7 offset:47104
    v_mfma_f32_16x16x32_bf16 v[40:43], v[108:111], v[88:91], v[40:43]
    ds_read_b128 v[156:159], v7 offset:48128
    v_mfma_f32_16x16x32_bf16 v[44:47], v[108:111], v[92:95], v[44:47]
    ds_read_b128 v[160:163], v7 offset:49152
    v_mfma_f32_16x16x32_bf16 v[48:51], v[112:115], v[88:91], v[48:51]
    ds_read_b128 v[164:167], v7 offset:50176
    v_mfma_f32_16x16x32_bf16 v[52:55], v[112:115], v[92:95], v[52:55]
    ds_read_b128 v[168:171], v7 offset:51200
    v_mfma_f32_16x16x32_bf16 v[56:59], v[116:119], v[88:91], v[56:59]
    ds_read_b128 v[172:175], v7 offset:52224
    v_mfma_f32_16x16x32_bf16 v[60:63], v[116:119], v[92:95], v[60:63]
    v_mfma_f32_16x16x32_bf16 v[64:67], v[120:123], v[88:91], v[64:67]
    v_mfma_f32_16x16x32_bf16 v[68:71], v[120:123], v[92:95], v[68:71]
    v_mfma_f32_16x16x32_bf16 v[72:75], v[124:127], v[88:91], v[72:75]
    v_mfma_f32_16x16x32_bf16 v[76:79], v[124:127], v[92:95], v[76:79]
    v_mfma_f32_16x16x32_bf16 v[80:83], v[128:131], v[88:91], v[80:83]
    v_mfma_f32_16x16x32_bf16 v[84:87], v[128:131], v[92:95], v[84:87]
    s_waitcnt lgkmcnt(0)
    v_mfma_f32_16x16x32_bf16 v[16:19], v[140:143], v[132:135], v[16:19]
    v_mfma_f32_16x16x32_bf16 v[20:23], v[140:143], v[136:139], v[20:23]
    v_mfma_f32_16x16x32_bf16 v[24:27], v[144:147], v[132:135], v[24:27]
    v_mfma_f32_16x16x32_bf16 v[28:31], v[144:147], v[136:139], v[28:31]
    v_mfma_f32_16x16x32_bf16 v[32:35], v[148:151], v[132:135], v[32:35]
    v_mfma_f32_16x16x32_bf16 v[36:39], v[148:151], v[136:139], v[36:39]
    v_mfma_f32_16x16x32_bf16 v[40:43], v[152:155], v[132:135], v[40:43]
    v_mfma_f32_16x16x32_bf16 v[44:47], v[152:155], v[136:139], v[44:47]
    v_mfma_f32_16x16x32_bf16 v[48:51], v[156:159], v[132:135], v[48:51]
    v_mfma_f32_16x16x32_bf16 v[52:55], v[156:159], v[136:139], v[52:55]
    v_mfma_f32_16x16x32_bf16 v[56:59], v[160:163], v[132:135], v[56:59]
    v_mfma_f32_16x16x32_bf16 v[60:63], v[160:163], v[136:139], v[60:63]
    v_mfma_f32_16x16x32_bf16 v[64:67], v[164:167], v[132:135], v[64:67]
    v_mfma_f32_16x16x32_bf16 v[68:71], v[164:167], v[136:139], v[68:71]
    v_mfma_f32_16x16x32_bf16 v[72:75], v[168:171], v[132:135], v[72:75]
    v_mfma_f32_16x16x32_bf16 v[76:79], v[168:171], v[136:139], v[76:79]
    v_mfma_f32_16x16x32_bf16 v[80:83], v[172:175], v[132:135], v[80:83]
    v_mfma_f32_16x16x32_bf16 v[84:87], v[172:175], v[136:139], v[84:87]
    s_waitcnt vmcnt(0) lgkmcnt(0)
    v_lshlrev_b32 v14, 16, v14
    v_lshlrev_b32 v15, 16, v15
    s_lshl_b32 s6, s29, 4
    s_add_u32 s6, s6, s5
    s_mul_i32 s6, s6, 9216
    s_add_u32 s7, s6, 4096
    s_add_u32 s28, s6, 8192
    s_nop 4
    v_lshlrev_b32 v88, 16, v176
    v_and_b32 v89, 0xffff0000, v176
    v_lshlrev_b32 v90, 16, v177
    v_and_b32 v91, 0xffff0000, v177
    v_add_f32 v16, v16, v14
    v_add_f32 v17, v17, v14
    v_add_f32 v18, v18, v14
    v_add_f32 v19, v19, v14
    v_mul_f32 v16, v16, v88
    v_mul_f32 v17, v17, v89
    v_mul_f32 v18, v18, v90
    v_mul_f32 v19, v19, v91
    v_cvt_pk_bf16_f32 v132, v16, v17
    v_cvt_pk_bf16_f32 v133, v18, v19
    v_lshlrev_b32 v92, 16, v178
    v_and_b32 v93, 0xffff0000, v178
    v_lshlrev_b32 v94, 16, v179
    v_and_b32 v95, 0xffff0000, v179
    v_add_f32 v20, v20, v15
    v_add_f32 v21, v21, v15
    v_add_f32 v22, v22, v15
    v_add_f32 v23, v23, v15
    v_mul_f32 v20, v20, v92
    v_mul_f32 v21, v21, v93
    v_mul_f32 v22, v22, v94
    v_mul_f32 v23, v23, v95
    v_cvt_pk_bf16_f32 v136, v20, v21
    v_cvt_pk_bf16_f32 v137, v22, v23
    v_lshlrev_b32 v96, 16, v180
    v_and_b32 v97, 0xffff0000, v180
    v_lshlrev_b32 v98, 16, v181
    v_and_b32 v99, 0xffff0000, v181
    v_add_f32 v24, v24, v14
    v_add_f32 v25, v25, v14
    v_add_f32 v26, v26, v14
    v_add_f32 v27, v27, v14
    v_mul_f32 v24, v24, v96
    v_mul_f32 v25, v25, v97
    v_mul_f32 v26, v26, v98
    v_mul_f32 v27, v27, v99
    v_cvt_pk_bf16_f32 v134, v24, v25
    v_cvt_pk_bf16_f32 v135, v26, v27
    v_lshlrev_b32 v100, 16, v182
    v_and_b32 v101, 0xffff0000, v182
    v_lshlrev_b32 v102, 16, v183
    v_and_b32 v103, 0xffff0000, v183
    v_add_f32 v28, v28, v15
    v_add_f32 v29, v29, v15
    v_add_f32 v30, v30, v15
    v_add_f32 v31, v31, v15
    v_mul_f32 v28, v28, v100
    v_mul_f32 v29, v29, v101
    v_mul_f32 v30, v30, v102
    v_mul_f32 v31, v31, v103
    v_cvt_pk_bf16_f32 v138, v28, v29
    v_cvt_pk_bf16_f32 v139, v30, v31
    buffer_store_dwordx4 v[132:135], v3, s[20:23], s6 offen offset:0 sc1
    buffer_store_dwordx4 v[136:139], v3, s[20:23], s6 offen offset:1024 sc1
    v_lshlrev_b32 v88, 16, v184
    v_and_b32 v89, 0xffff0000, v184
    v_lshlrev_b32 v90, 16, v185
    v_and_b32 v91, 0xffff0000, v185
    v_add_f32 v32, v32, v14
    v_add_f32 v33, v33, v14
    v_add_f32 v34, v34, v14
    v_add_f32 v35, v35, v14
    v_mul_f32 v32, v32, v88
    v_mul_f32 v33, v33, v89
    v_mul_f32 v34, v34, v90
    v_mul_f32 v35, v35, v91
    v_cvt_pk_bf16_f32 v140, v32, v33
    v_cvt_pk_bf16_f32 v141, v34, v35
    v_lshlrev_b32 v92, 16, v186
    v_and_b32 v93, 0xffff0000, v186
    v_lshlrev_b32 v94, 16, v187
    v_and_b32 v95, 0xffff0000, v187
    v_add_f32 v36, v36, v15
    v_add_f32 v37, v37, v15
    v_add_f32 v38, v38, v15
    v_add_f32 v39, v39, v15
    v_mul_f32 v36, v36, v92
    v_mul_f32 v37, v37, v93
    v_mul_f32 v38, v38, v94
    v_mul_f32 v39, v39, v95
    v_cvt_pk_bf16_f32 v144, v36, v37
    v_cvt_pk_bf16_f32 v145, v38, v39
    v_lshlrev_b32 v96, 16, v188
    v_and_b32 v97, 0xffff0000, v188
    v_lshlrev_b32 v98, 16, v189
    v_and_b32 v99, 0xffff0000, v189
    v_add_f32 v40, v40, v14
    v_add_f32 v41, v41, v14
    v_add_f32 v42, v42, v14
    v_add_f32 v43, v43, v14
    v_mul_f32 v40, v40, v96
    v_mul_f32 v41, v41, v97
    v_mul_f32 v42, v42, v98
    v_mul_f32 v43, v43, v99
    v_cvt_pk_bf16_f32 v142, v40, v41
    v_cvt_pk_bf16_f32 v143, v42, v43
    v_lshlrev_b32 v100, 16, v190
    v_and_b32 v101, 0xffff0000, v190
    v_lshlrev_b32 v102, 16, v191
    v_and_b32 v103, 0xffff0000, v191
    v_add_f32 v44, v44, v15
    v_add_f32 v45, v45, v15
    v_add_f32 v46, v46, v15
    v_add_f32 v47, v47, v15
    v_mul_f32 v44, v44, v100
    v_mul_f32 v45, v45, v101
    v_mul_f32 v46, v46, v102
    v_mul_f32 v47, v47, v103
    v_cvt_pk_bf16_f32 v146, v44, v45
    v_cvt_pk_bf16_f32 v147, v46, v47
    buffer_store_dwordx4 v[140:143], v3, s[20:23], s6 offen offset:2048 sc1
    buffer_store_dwordx4 v[144:147], v3, s[20:23], s6 offen offset:3072 sc1
    v_lshlrev_b32 v88, 16, v192
    v_and_b32 v89, 0xffff0000, v192
    v_lshlrev_b32 v90, 16, v193
    v_and_b32 v91, 0xffff0000, v193
    v_add_f32 v48, v48, v14
    v_add_f32 v49, v49, v14
    v_add_f32 v50, v50, v14
    v_add_f32 v51, v51, v14
    v_mul_f32 v48, v48, v88
    v_mul_f32 v49, v49, v89
    v_mul_f32 v50, v50, v90
    v_mul_f32 v51, v51, v91
    v_cvt_pk_bf16_f32 v148, v48, v49
    v_cvt_pk_bf16_f32 v149, v50, v51
    v_lshlrev_b32 v92, 16, v194
    v_and_b32 v93, 0xffff0000, v194
    v_lshlrev_b32 v94, 16, v195
    v_and_b32 v95, 0xffff0000, v195
    v_add_f32 v52, v52, v15
    v_add_f32 v53, v53, v15
    v_add_f32 v54, v54, v15
    v_add_f32 v55, v55, v15
    v_mul_f32 v52, v52, v92
    v_mul_f32 v53, v53, v93
    v_mul_f32 v54, v54, v94
    v_mul_f32 v55, v55, v95
    v_cvt_pk_bf16_f32 v152, v52, v53
    v_cvt_pk_bf16_f32 v153, v54, v55
    v_lshlrev_b32 v96, 16, v196
    v_and_b32 v97, 0xffff0000, v196
    v_lshlrev_b32 v98, 16, v197
    v_and_b32 v99, 0xffff0000, v197
    v_add_f32 v56, v56, v14
    v_add_f32 v57, v57, v14
    v_add_f32 v58, v58, v14
    v_add_f32 v59, v59, v14
    v_mul_f32 v56, v56, v96
    v_mul_f32 v57, v57, v97
    v_mul_f32 v58, v58, v98
    v_mul_f32 v59, v59, v99
    v_cvt_pk_bf16_f32 v150, v56, v57
    v_cvt_pk_bf16_f32 v151, v58, v59
    v_lshlrev_b32 v100, 16, v198
    v_and_b32 v101, 0xffff0000, v198
    v_lshlrev_b32 v102, 16, v199
    v_and_b32 v103, 0xffff0000, v199
    v_add_f32 v60, v60, v15
    v_add_f32 v61, v61, v15
    v_add_f32 v62, v62, v15
    v_add_f32 v63, v63, v15
    v_mul_f32 v60, v60, v100
    v_mul_f32 v61, v61, v101
    v_mul_f32 v62, v62, v102
    v_mul_f32 v63, v63, v103
    v_cvt_pk_bf16_f32 v154, v60, v61
    v_cvt_pk_bf16_f32 v155, v62, v63
    buffer_store_dwordx4 v[148:151], v3, s[20:23], s7 offen offset:0 sc1
    buffer_store_dwordx4 v[152:155], v3, s[20:23], s7 offen offset:1024 sc1
    v_lshlrev_b32 v88, 16, v200
    v_and_b32 v89, 0xffff0000, v200
    v_lshlrev_b32 v90, 16, v201
    v_and_b32 v91, 0xffff0000, v201
    v_add_f32 v64, v64, v14
    v_add_f32 v65, v65, v14
    v_add_f32 v66, v66, v14
    v_add_f32 v67, v67, v14
    v_mul_f32 v64, v64, v88
    v_mul_f32 v65, v65, v89
    v_mul_f32 v66, v66, v90
    v_mul_f32 v67, v67, v91
    v_cvt_pk_bf16_f32 v156, v64, v65
    v_cvt_pk_bf16_f32 v157, v66, v67
    v_lshlrev_b32 v92, 16, v202
    v_and_b32 v93, 0xffff0000, v202
    v_lshlrev_b32 v94, 16, v203
    v_and_b32 v95, 0xffff0000, v203
    v_add_f32 v68, v68, v15
    v_add_f32 v69, v69, v15
    v_add_f32 v70, v70, v15
    v_add_f32 v71, v71, v15
    v_mul_f32 v68, v68, v92
    v_mul_f32 v69, v69, v93
    v_mul_f32 v70, v70, v94
    v_mul_f32 v71, v71, v95
    v_cvt_pk_bf16_f32 v160, v68, v69
    v_cvt_pk_bf16_f32 v161, v70, v71
    v_lshlrev_b32 v96, 16, v204
    v_and_b32 v97, 0xffff0000, v204
    v_lshlrev_b32 v98, 16, v205
    v_and_b32 v99, 0xffff0000, v205
    v_add_f32 v72, v72, v14
    v_add_f32 v73, v73, v14
    v_add_f32 v74, v74, v14
    v_add_f32 v75, v75, v14
    v_mul_f32 v72, v72, v96
    v_mul_f32 v73, v73, v97
    v_mul_f32 v74, v74, v98
    v_mul_f32 v75, v75, v99
    v_cvt_pk_bf16_f32 v158, v72, v73
    v_cvt_pk_bf16_f32 v159, v74, v75
    v_lshlrev_b32 v100, 16, v206
    v_and_b32 v101, 0xffff0000, v206
    v_lshlrev_b32 v102, 16, v207
    v_and_b32 v103, 0xffff0000, v207
    v_add_f32 v76, v76, v15
    v_add_f32 v77, v77, v15
    v_add_f32 v78, v78, v15
    v_add_f32 v79, v79, v15
    v_mul_f32 v76, v76, v100
    v_mul_f32 v77, v77, v101
    v_mul_f32 v78, v78, v102
    v_mul_f32 v79, v79, v103
    v_cvt_pk_bf16_f32 v162, v76, v77
    v_cvt_pk_bf16_f32 v163, v78, v79
    buffer_store_dwordx4 v[156:159], v3, s[20:23], s7 offen offset:2048 sc1
    buffer_store_dwordx4 v[160:163], v3, s[20:23], s7 offen offset:3072 sc1
    v_lshlrev_b32 v88, 16, v208
    v_and_b32 v89, 0xffff0000, v208
    v_lshlrev_b32 v90, 16, v209
    v_and_b32 v91, 0xffff0000, v209
    v_add_f32 v80, v80, v14
    v_add_f32 v81, v81, v14
    v_add_f32 v82, v82, v14
    v_add_f32 v83, v83, v14
    v_mul_f32 v80, v80, v88
    v_mul_f32 v81, v81, v89
    v_mul_f32 v82, v82, v90
    v_mul_f32 v83, v83, v91
    v_cvt_pk_bf16_f32 v164, v80, v81
    v_cvt_pk_bf16_f32 v165, v82, v83
    v_lshlrev_b32 v92, 16, v210
    v_and_b32 v93, 0xffff0000, v210
    v_lshlrev_b32 v94, 16, v211
    v_and_b32 v95, 0xffff0000, v211
    v_add_f32 v84, v84, v15
    v_add_f32 v85, v85, v15
    v_add_f32 v86, v86, v15
    v_add_f32 v87, v87, v15
    v_mul_f32 v84, v84, v92
    v_mul_f32 v85, v85, v93
    v_mul_f32 v86, v86, v94
    v_mul_f32 v87, v87, v95
    v_cvt_pk_bf16_f32 v166, v84, v85
    v_cvt_pk_bf16_f32 v167, v86, v87
    buffer_store_dwordx4 v[164:167], v3, s[20:23], s28 offen offset:0 sc1
    s_endpgm
g2_prod:
    s_sub_u32 s3, s3, 4
    s_setprio 1
    s_waitcnt lgkmcnt(0)
    s_and_b32 s9, s9, 0xffff
    s_mov_b32 s10, 8388608
    s_mov_b32 s11, 0x00020000
    s_add_u32 s12, s12, 10485760
    s_addc_u32 s13, s13, 0
    s_and_b32 s13, s13, 0xffff
    s_mov_b32 s14, 9437184
    s_mov_b32 s15, 0x00020000
    v_lshrrev_b32 v3, 3, v2
    v_lshlrev_b32 v3, 12, v3
    v_bfe_u32 v4, v2, 4, 1
    s_lshl_b32 s6, s3, 1
    v_or_b32 v4, s6, v4
    v_and_b32 v5, 7, v2
    v_xor_b32 v4, v4, v5
    v_lshlrev_b32 v4, 4, v4
    v_add_u32 v3, v3, v4
    s_lshl_b32 s6, s4, 4
    s_add_u32 s6, s6, s3
    s_lshl_b32 s6, s6, 15
    v_add_u32 v4, s6, v3
    v_add_u32 v5, 130048, v4
    v_add_u32 v6, 260096, v4
    v_add_u32 v7, 390144, v4
    s_mul_i32 s33, s3, 4608
    v_lshlrev_b32 v0, 4, v2
    v_add_u32 v8, s33, v0
    s_mul_i32 s6, s5, 589824
    v_add_u32 v8, s6, v8
    v_add_u32 v9, 4096, v8
    s_lshl_b32 s34, s3, 12
    s_add_u32 s34, s34, 18432
    s_add_u32 s35, s4, s5
    s_and_b32 s35, s35, 3
    s_lshl_b32 s35, s35, 3
    s_or_b32 s35, s35, 0x80000
    s_bfe_u32 s37, 0x0, s35
    s_mul_i32 s36, s37, 18432
    s_lshl_b32 s37, s37, 7
    s_add_u32 m0, s34, 0
    s_nop 0
    buffer_load_dwordx4 v4, s[8:11], s37 offen offset:0 lds
    buffer_load_dwordx4 v5, s[8:11], s37 offen offset:1024 lds
    buffer_load_dwordx4 v6, s[8:11], s37 offen offset:2048 lds
    buffer_load_dwordx4 v7, s[8:11], s37 offen offset:3072 lds
    s_add_u32 m0, s33, 0
    s_nop 0
    buffer_load_dwordx4 v8, s[12:15], s36 offen offset:0 lds
    buffer_load_dwordx4 v8, s[12:15], s36 offen offset:1024 lds
    buffer_load_dwordx4 v8, s[12:15], s36 offen offset:2048 lds
    buffer_load_dwordx4 v8, s[12:15], s36 offen offset:3072 lds
    s_add_u32 m0, m0, 4096
    s_mov_b32 exec_hi, 0
    buffer_load_dwordx4 v9, s[12:15], s36 offen lds
    s_mov_b32 exec_hi, -1
    s_bfe_u32 s37, 0x1010104, s35
    s_mul_i32 s36, s37, 18432
    s_lshl_b32 s37, s37, 7
    s_add_u32 m0, s34, 34816
    s_nop 0
    buffer_load_dwordx4 v4, s[8:11], s37 offen offset:0 lds
    buffer_load_dwordx4 v5, s[8:11], s37 offen offset:1024 lds
    buffer_load_dwordx4 v6, s[8:11], s37 offen offset:2048 lds
    buffer_load_dwordx4 v7, s[8:11], s37 offen offset:3072 lds
    s_add_u32 m0, s33, 34816
    s_nop 0
    buffer_load_dwordx4 v8, s[12:15], s36 offen offset:0 lds
    buffer_load_dwordx4 v8, s[12:15], s36 offen offset:1024 lds
    buffer_load_dwordx4 v8, s[12:15], s36 offen offset:2048 lds
    buffer_load_dwordx4 v8, s[12:15], s36 offen offset:3072 lds
    s_add_u32 m0, m0, 4096
    s_mov_b32 exec_hi, 0
    buffer_load_dwordx4 v9, s[12:15], s36 offen lds
    s_mov_b32 exec_hi, -1
    s_bfe_u32 s37, 0x2020501, s35
    s_mul_i32 s36, s37, 18432
    s_lshl_b32 s37, s37, 7
    s_add_u32 m0, s34, 69632
    s_nop 0
    buffer_load_dwordx4 v4, s[8:11], s37 offen offset:0 lds
    buffer_load_dwordx4 v5, s[8:11], s37 offen offset:1024 lds
    buffer_load_dwordx4 v6, s[8:11], s37 offen offset:2048 lds
    buffer_load_dwordx4 v7, s[8:11], s37 offen offset:3072 lds
    s_add_u32 m0, s33, 69632
    s_nop 0
    buffer_load_dwordx4 v8, s[12:15], s36 offen offset:0 lds
    buffer_load_dwordx4 v8, s[12:15], s36 offen offset:1024 lds
    buffer_load_dwordx4 v8, s[12:15], s36 offen offset:2048 lds
    buffer_load_dwordx4 v8, s[12:15], s36 offen offset:3072 lds
    s_add_u32 m0, m0, 4096
    s_mov_b32 exec_hi, 0
    buffer_load_dwordx4 v9, s[12:15], s36 offen lds
    s_mov_b32 exec_hi, -1
    s_add_u32 s16, s16, 42991616
    s_addc_u32 s17, s17, 0
    s_and_b32 s17, s17, 0xffff
    s_mov_b32 s18, 12845056
    s_mov_b32 s19, 0x00020000
    s_and_b32 s6, s3, 1
    s_lshl_b32 s28, s5, 1
    s_add_u32 s28, s28, s6
    s_lshl_b32 s29, s4, 2
    s_and_b32 s6, s3, 2
    s_add_u32 s29, s29, s6
    v_mul_u32_u24 v1, 12, v2
    v_and_b32 v3, 15, v2
    v_lshlrev_b32 v3, 6, v3
    v_lshrrev_b32 v30, 4, v2
    v_lshl_add_u32 v3, v30, 4, v3
    s_lshl_b32 s6, s28, 6
    s_add_u32 s74, s6, s29
    s_mul_i32 s74, s74, 1536
    s_add_i32 s38, s29, -8
    s_max_i32 s39, s38, 0
    s_add_u32 s39, s39, s6
    s_mul_i32 s39, s39, 2688
    s_add_u32 s40, s39, 4194304
    s_add_i32 s38, s29, -7
    s_max_i32 s39, s38, 0
    s_add_u32 s39, s39, s6
    s_mul_i32 s39, s39, 2688
    s_add_u32 s41, s39, 4194304
    s_add_i32 s38, s29, -6
    s_max_i32 s39, s38, 0
    s_add_u32 s39, s39, s6
    s_mul_i32 s39, s39, 2688
    s_add_u32 s42, s39, 4194304
    s_add_i32 s38, s29, -5
    s_max_i32 s39, s38, 0
    s_add_u32 s39, s39, s6
    s_mul_i32 s39, s39, 2688
    s_add_u32 s43, s39, 4194304
    s_add_i32 s38, s29, -4
    s_max_i32 s39, s38, 0
    s_add_u32 s39, s39, s6
    s_mul_i32 s39, s39, 2688
    s_add_u32 s44, s39, 4194304
    s_add_i32 s38, s29, -3
    s_max_i32 s39, s38, 0
    s_add_u32 s39, s39, s6
    s_mul_i32 s39, s39, 2688
    s_add_u32 s45, s39, 4194304
    s_add_i32 s38, s29, -2
    s_max_i32 s39, s38, 0
    s_add_u32 s39, s39, s6
    s_mul_i32 s39, s39, 2688
    s_add_u32 s46, s39, 4194304
    s_add_i32 s38, s29, -1
    s_max_i32 s39, s38, 0
    s_add_u32 s39, s39, s6
    s_mul_i32 s39, s39, 2688
    s_add_u32 s47, s39, 4194304
    s_add_i32 s38, s29, 0
    s_max_i32 s39, s38, 0
    s_add_u32 s39, s39, s6
    s_mul_i32 s39, s39, 2688
    s_add_u32 s48, s39, 4194304
    s_add_i32 s38, s29, 1
    s_max_i32 s39, s38, 0
    s_add_u32 s39, s39, s6
    s_mul_i32 s39, s39, 2688
    s_add_u32 s49, s39, 4194304
    v_mov_b32 v140, 0x3f803f80
    v_mov_b32 v141, 0x3f803f80
    v_mov_b32 v142, 0x3f803f80
    v_mov_b32 v143, 0x3f803f80
    v_mov_b32 v144, 0x3f803f80
    v_mov_b32 v145, 0x3f803f80
    v_mov_b32 v146, 0x3f803f80
    v_mov_b32 v147, 0x3f803f80
    v_mov_b32 v148, 0x3f803f80
    v_mov_b32 v149, 0x3f803f80
    v_mov_b32 v150, 0x3f803f80
    v_mov_b32 v151, 0x3f803f80
    v_mov_b32 v152, 0x3f803f80
    v_mov_b32 v153, 0x3f803f80
    v_mov_b32 v154, 0x3f803f80
    v_mov_b32 v155, 0x3f803f80
    v_mov_b32 v156, 0x3f803f80
    v_mov_b32 v157, 0x3f803f80
    v_mov_b32 v158, 0x3f803f80
    v_mov_b32 v159, 0x3f803f80
    v_mov_b32 v160, 0x3f803f80
    v_mov_b32 v161, 0x3f803f80
    v_mov_b32 v162, 0x3f803f80
    v_mov_b32 v163, 0x3f803f80
    v_mov_b32 v164, 0x3f803f80
    v_mov_b32 v165, 0x3f803f80
    v_mov_b32 v166, 0x3f803f80
    v_mov_b32 v167, 0x3f803f80
    v_mov_b32 v168, 0x3f803f80
    v_mov_b32 v169, 0x3f803f80
    v_mov_b32 v170, 0x3f803f80
    v_mov_b32 v171, 0x3f803f80
    v_mov_b32 v172, 0x3f803f80
    v_mov_b32 v173, 0x3f803f80
    v_mov_b32 v174, 0x3f803f80
    v_mov_b32 v175, 0x3f803f80
    v_mov_b32 v179, 0x3f803f80
    v_mov_b32 v183, 0x3f803f80
    s_add_i32 s38, s29, -8
    s_cmp_lt_i32 s38, 0
    s_cselect_b32 s38, 0xf149f149, 0
    v_mov_b32 v35, s38
    v_mov_b32 v39, s38
    s_add_i32 s38, s29, -7
    s_cmp_lt_i32 s38, 0
    s_cselect_b32 s38, 0xf149f149, 0
    v_mov_b32 v43, s38
    v_mov_b32 v47, s38
    s_add_i32 s38, s29, -6
    s_cmp_lt_i32 s38, 0
    s_cselect_b32 s38, 0xf149f149, 0
    v_mov_b32 v51, s38
    v_mov_b32 v55, s38
    s_add_i32 s38, s29, -5
    s_cmp_lt_i32 s38, 0
    s_cselect_b32 s38, 0xf149f149, 0
    v_mov_b32 v59, s38
    v_mov_b32 v63, s38
    s_add_i32 s38, s29, -4
    s_cmp_lt_i32 s38, 0
    s_cselect_b32 s38, 0xf149f149, 0
    v_mov_b32 v67, s38
    v_mov_b32 v71, s38
    s_add_i32 s38, s29, -3
    s_cmp_lt_i32 s38, 0
    s_cselect_b32 s38, 0xf149f149, 0
    v_mov_b32 v75, s38
    v_mov_b32 v79, s38
    s_add_i32 s38, s29, -2
    s_cmp_lt_i32 s38, 0
    s_cselect_b32 s38, 0xf149f149, 0
    v_mov_b32 v83, s38
    v_mov_b32 v87, s38
    s_add_i32 s38, s29, -1
    s_cmp_lt_i32 s38, 0
    s_cselect_b32 s38, 0xf149f149, 0
    v_mov_b32 v91, s38
    v_mov_b32 v95, s38
    v_mov_b32 v99, 0
    v_mov_b32 v103, 0
    s_mov_b32 s50, 0xfff0ffff
    s_mov_b32 s51, 0xf000ff00
    s_mov_b32 s52, 0xfff0ffff
    s_mov_b32 s53, 0xf000ff00
    s_mov_b32 s54, 0xfff0ffff
    s_mov_b32 s55, 0xf000ff00
    s_mov_b32 s56, 0xfff0ffff
    s_mov_b32 s57, 0xf000ff00
    s_mov_b32 s58, 0xfff0ffff
    s_mov_b32 s59, 0xf000ff00
    s_mov_b32 s60, 0xffe0fffe
    s_mov_b32 s61, 0xe000fe00
    s_mov_b32 s62, 0xffc0fffc
    s_mov_b32 s63, 0xc000fc00
    s_mov_b32 s64, 0xff80fff8
    s_mov_b32 s65, 0x8000f800
    s_mov_b32 s66, 0xff00fff0
    s_mov_b32 s67, 0xf000
    s_mov_b32 s68, 0xff00fff0
    s_mov_b32 s69, 0xf000
    s_mov_b32 s70, 0xff00fff0
    s_mov_b32 s71, 0xf000
    s_mov_b32 s72, 0xff00fff0
    s_mov_b32 s73, 0xf000
    v_mov_b32 v30, 0xffff
    v_mov_b32 v31, 0xffff0000
    v_cndmask_b32 v10, 0, v30, s[58:59]
    v_cndmask_b32 v18, 0, v31, s[60:61]
    v_or_b32 v10, v10, v18
    v_cndmask_b32 v11, 0, v30, s[62:63]
    v_cndmask_b32 v18, 0, v31, s[64:65]
    v_or_b32 v11, v11, v18
    v_cndmask_b32 v12, 0, v30, s[66:67]
    v_cndmask_b32 v18, 0, v31, s[68:69]
    v_or_b32 v12, v12, v18
    v_cndmask_b32 v13, 0, v30, s[70:71]
    v_cndmask_b32 v18, 0, v31, s[72:73]
    v_or_b32 v13, v13, v18
    v_cndmask_b32 v14, 0, v30, s[50:51]
    v_cndmask_b32 v18, 0, v31, s[52:53]
    v_or_b32 v14, v14, v18
    v_cndmask_b32 v15, 0, v30, s[54:55]
    v_cndmask_b32 v18, 0, v31, s[56:57]
    v_or_b32 v15, v15, v18
    v_cndmask_b32 v16, 0, v30, s[58:59]
    v_cndmask_b32 v18, 0, v31, s[60:61]
    v_or_b32 v16, v16, v18
    v_cndmask_b32 v17, 0, v30, s[62:63]
    v_cndmask_b32 v18, 0, v31, s[64:65]
    v_or_b32 v17, v17, v18
    s_mov_b32 s76, 0x3eae1a93
    s_lshl_b32 s6, s29, 5
    s_add_u32 s6, s6, s28
    s_lshl_b32 s6, s6, 10
    s_add_u32 s6, s6, 10485760
    s_add_u32 s7, s6, 32768
    s_lshl_b32 s38, s29, 12
    s_lshr_b32 s39, s28, 4
    s_lshl_b32 s39, s39, 11
    s_add_u32 s38, s38, s39
    s_bfe_u32 s39, s28, 0x20002
    s_lshl_b32 s39, s39, 8
    s_add_u32 s38, s38, s39
    s_and_b32 s39, s28, 3
    s_lshl_b32 s39, s39, 2
    s_add_u32 s38, s38, s39
    s_add_u32 s38, s38, 12582912
    s_add_u32 s39, s38, 4096
    s_waitcnt vmcnt(18)
    s_barrier
    s_bfe_u32 s37, 0x3060202, s35
    s_mul_i32 s36, s37, 18432
    s_lshl_b32 s37, s37, 7
    s_add_u32 m0, s34, 104448
    s_nop 0
    buffer_load_dwordx4 v4, s[8:11], s37 offen offset:0 lds
    buffer_load_dwordx3 v[176:178], v1, s[16:19], s74 offen offset:0
    buffer_load_dwordx3 v[180:182], v1, s[16:19], s74 offen offset:768
    buffer_load_dwordx3 v[32:34], v1, s[16:19], s40 offen offset:0
    buffer_load_dwordx3 v[36:38], v1, s[16:19], s40 offen offset:768
    buffer_load_dwordx3 v[40:42], v1, s[16:19], s41 offen offset:0
    buffer_load_dwordx3 v[44:46], v1, s[16:19], s41 offen offset:768
    buffer_load_dwordx3 v[48:50], v1, s[16:19], s42 offen offset:0
    buffer_load_dwordx3 v[52:54], v1, s[16:19], s42 offen offset:768
    buffer_load_dwordx3 v[56:58], v1, s[16:19], s43 offen offset:0
    buffer_load_dwordx3 v[60:62], v1, s[16:19], s43 offen offset:768
    buffer_load_dwordx4 v5, s[8:11], s37 offen offset:1024 lds
    buffer_load_dwordx4 v6, s[8:11], s37 offen offset:2048 lds
    buffer_load_dwordx4 v7, s[8:11], s37 offen offset:3072 lds
    s_add_u32 m0, s33, 104448
    s_nop 0
    buffer_load_dwordx4 v8, s[12:15], s36 offen offset:0 lds
    buffer_load_dwordx4 v8, s[12:15], s36 offen offset:1024 lds
    buffer_load_dwordx4 v8, s[12:15], s36 offen offset:2048 lds
    buffer_load_dwordx4 v8, s[12:15], s36 offen offset:3072 lds
    s_add_u32 m0, m0, 4096
    s_mov_b32 exec_hi, 0
    buffer_load_dwordx4 v9, s[12:15], s36 offen lds
    s_mov_b32 exec_hi, -1
    s_waitcnt vmcnt(28)
    s_barrier
    s_bfe_u32 s37, 0x7030303, s35
    s_mul_i32 s36, s37, 18432
    s_lshl_b32 s37, s37, 7
    s_add_u32 m0, s34, 0
    s_nop 0
    buffer_load_dwordx4 v4, s[8:11], s37 offen offset:0 lds
    buffer_load_dwordx3 v[64:66], v1, s[16:19], s44 offen offset:0
    buffer_load_dwordx3 v[68:70], v1, s[16:19], s44 offen offset:768
    buffer_load_dwordx3 v[72:74], v1, s[16:19], s45 offen offset:0
    buffer_load_dwordx3 v[76:78], v1, s[16:19], s45 offen offset:768
    buffer_load_dwordx3 v[80:82], v1, s[16:19], s46 offen offset:0
    buffer_load_dwordx3 v[84:86], v1, s[16:19], s46 offen offset:768
    buffer_load_dwordx3 v[88:90], v1, s[16:19], s47 offen offset:0
    buffer_load_dwordx3 v[92:94], v1, s[16:19], s47 offen offset:768
    buffer_load_dwordx3 v[96:98], v1, s[16:19], s48 offen offset:0
    buffer_load_dwordx3 v[100:102], v1, s[16:19], s48 offen offset:768
    buffer_load_dwordx4 v5, s[8:11], s37 offen offset:1024 lds
    buffer_load_dwordx4 v6, s[8:11], s37 offen offset:2048 lds
    buffer_load_dwordx4 v7, s[8:11], s37 offen offset:3072 lds
    s_add_u32 m0, s33, 0
    s_nop 0
    buffer_load_dwordx4 v8, s[12:15], s36 offen offset:0 lds
    buffer_load_dwordx4 v8, s[12:15], s36 offen offset:1024 lds
    buffer_load_dwordx4 v8, s[12:15], s36 offen offset:2048 lds
    buffer_load_dwordx4 v8, s[12:15], s36 offen offset:3072 lds
    s_add_u32 m0, m0, 4096
    s_mov_b32 exec_hi, 0
    buffer_load_dwordx4 v9, s[12:15], s36 offen lds
    s_mov_b32 exec_hi, -1
    s_waitcnt vmcnt(38)
    s_barrier
    s_bfe_u32 s37, 0x4040408, s35
    s_mul_i32 s36, s37, 18432
    s_lshl_b32 s37, s37, 7
    s_add_u32 m0, s34, 34816
    s_nop 0
    buffer_load_dwordx4 v4, s[8:11], s37 offen offset:0 lds
    buffer_load_dwordx4 v[104:107], v0, s[16:19], s40 offen offset:1536
    buffer_load_dwordx4 v[108:111], v0, s[16:19], s41 offen offset:1536
    buffer_load_dwordx4 v[112:115], v0, s[16:19], s42 offen offset:1536
    buffer_load_dwordx4 v[116:119], v0, s[16:19], s43 offen offset:1536
    buffer_load_dwordx4 v[120:123], v0, s[16:19], s44 offen offset:1536
    buffer_load_dwordx4 v[124:127], v0, s[16:19], s45 offen offset:1536
    buffer_load_dwordx4 v[128:131], v0, s[16:19], s46 offen offset:1536
    buffer_load_dwordx4 v[132:135], v0, s[16:19], s47 offen offset:1536
    buffer_load_dwordx4 v[136:139], v0, s[16:19], s48 offen offset:1536
    buffer_load_dwordx4 v5, s[8:11], s37 offen offset:1024 lds
    buffer_load_dwordx4 v6, s[8:11], s37 offen offset:2048 lds
    buffer_load_dwordx4 v7, s[8:11], s37 offen offset:3072 lds
    s_add_u32 m0, s33, 34816
    s_nop 0
    buffer_load_dwordx4 v8, s[12:15], s36 offen offset:0 lds
    buffer_load_dwordx4 v8, s[12:15], s36 offen offset:1024 lds
    buffer_load_dwordx4 v8, s[12:15], s36 offen offset:2048 lds
    buffer_load_dwordx4 v8, s[12:15], s36 offen offset:3072 lds
    s_add_u32 m0, m0, 4096
    s_mov_b32 exec_hi, 0
    buffer_load_dwordx4 v9, s[12:15], s36 offen lds
    s_mov_b32 exec_hi, -1
    s_waitcnt vmcnt(37)
    s_barrier
    s_bfe_u32 s37, 0x5050905, s35
    s_mul_i32 s36, s37, 18432
    s_lshl_b32 s37, s37, 7
    s_add_u32 m0, s34, 69632
    s_nop 0
    buffer_load_dwordx4 v4, s[8:11], s37 offen offset:0 lds
    s_mov_b32 exec_lo, 0x00030003
    s_mov_b32 exec_hi, 0x00030003
    buffer_load_dwordx4 v[140:143], v3, s[16:19], s40 offen offset:2560
    buffer_load_dwordx4 v[144:147], v3, s[16:19], s41 offen offset:2560
    buffer_load_dwordx4 v[148:151], v3, s[16:19], s42 offen offset:2560
    buffer_load_dwordx4 v[152:155], v3, s[16:19], s43 offen offset:2560
    buffer_load_dwordx4 v[156:159], v3, s[16:19], s44 offen offset:2560
    buffer_load_dwordx4 v[160:163], v3, s[16:19], s45 offen offset:2560
    buffer_load_dwordx4 v[164:167], v3, s[16:19], s46 offen offset:2560
    buffer_load_dwordx4 v[168:171], v3, s[16:19], s47 offen offset:2560
    buffer_load_dwordx4 v[172:175], v3, s[16:19], s48 offen offset:2560
    s_mov_b64 exec, -1
    v_mfma_f32_16x16x32_bf16 v[184:187], v[32:35], v[176:179], 0
    v_mfma_f32_16x16x32_bf16 v[188:191], v[36:39], v[176:179], 0
    buffer_load_dwordx4 v5, s[8:11], s37 offen offset:1024 lds
    v_mfma_f32_16x16x32_bf16 v[192:195], v[40:43], v[176:179], 0
    v_mfma_f32_16x16x32_bf16 v[196:199], v[44:47], v[176:179], 0
    buffer_load_dwordx4 v6, s[8:11], s37 offen offset:2048 lds
    v_mfma_f32_16x16x32_bf16 v[200:203], v[48:51], v[176:179], 0
    v_mfma_f32_16x16x32_bf16 v[204:207], v[52:55], v[176:179], 0
    buffer_load_dwordx4 v7, s[8:11], s37 offen offset:3072 lds
    v_mfma_f32_16x16x32_bf16 v[208:211], v[56:59], v[176:179], 0
    v_mfma_f32_16x16x32_bf16 v[212:215], v[60:63], v[176:179], 0
    s_add_u32 m0, s33, 69632
    s_nop 0
    buffer_load_dwordx4 v8, s[12:15], s36 offen offset:0 lds
    s_waitcnt vmcnt(48)
    v_mfma_f32_16x16x32_bf16 v[216:219], v[64:67], v[176:179], 0
    v_mfma_f32_16x16x32_bf16 v[220:223], v[68:71], v[176:179], 0
    buffer_load_dwordx4 v8, s[12:15], s36 offen offset:1024 lds
    s_waitcnt vmcnt(47)
    v_mfma_f32_16x16x32_bf16 v[224:227], v[72:75], v[176:179], 0
    buffer_load_dwordx4 v8, s[12:15], s36 offen offset:2048 lds
    v_mfma_f32_16x16x32_bf16 v[228:231], v[76:79], v[176:179], 0
    s_waitcnt vmcnt(46)
    v_mfma_f32_16x16x32_bf16 v[232:235], v[80:83], v[176:179], 0
    buffer_load_dwordx4 v8, s[12:15], s36 offen offset:3072 lds
    v_mfma_f32_16x16x32_bf16 v[236:239], v[84:87], v[176:179], 0
    s_waitcnt vmcnt(45)
    v_mfma_f32_16x16x32_bf16 v[240:243], v[88:91], v[176:179], 0
    s_add_u32 m0, m0, 4096
    s_mov_b32 exec_hi, 0
    buffer_load_dwordx4 v9, s[12:15], s36 offen lds
    s_mov_b32 exec_hi, -1
    v_mfma_f32_16x16x32_bf16 v[244:247], v[92:95], v[176:179], 0
    s_waitcnt vmcnt(44)
    v_mfma_f32_16x16x32_bf16 v[248:251], v[96:99], v[176:179], 0
    s_waitcnt vmcnt(36)
    s_barrier
    s_bfe_u32 s37, 0x60a0606, s35
    s_mul_i32 s36, s37, 18432
    s_lshl_b32 s37, s37, 7
    s_add_u32 m0, s34, 104448
    s_nop 0
    buffer_load_dwordx4 v4, s[8:11], s37 offen offset:0 lds
    v_mfma_f32_16x16x32_bf16 v[252:255], v[100:103], v[176:179], 0
    s_nop 7
    buffer_load_dwordx3 v[176:178], v1, s[16:19], s74 offen offset:1536
    v_cndmask_b32 v248, v184, v248, s[58:59]
    v_cndmask_b32 v249, v185, v249, s[60:61]
    v_cndmask_b32 v250, v186, v250, s[62:63]
    v_cndmask_b32 v251, v187, v251, s[64:65]
    buffer_load_dwordx4 v5, s[8:11], s37 offen offset:1024 lds
    v_cndmask_b32 v252, v188, v252, s[66:67]
    v_cndmask_b32 v253, v189, v253, s[68:69]
    v_cndmask_b32 v254, v190, v254, s[70:71]
    v_cndmask_b32 v255, v191, v255, s[72:73]
    v_max3_f32 v188, v192, v193, v194
    v_max3_f32 v189, v208, v209, v210
    v_max3_f32 v190, v224, v225, v226
    buffer_load_dwordx4 v6, s[8:11], s37 offen offset:2048 lds
    v_max3_f32 v191, v240, v241, v242
    v_max3_f32 v188, v188, v195, v196
    v_max3_f32 v189, v189, v211, v212
    v_max3_f32 v190, v190, v227, v228
    v_max3_f32 v191, v191, v243, v244
    v_max3_f32 v188, v188, v197, v198
    v_max3_f32 v189, v189, v213, v214
    buffer_load_dwordx4 v7, s[8:11], s37 offen offset:3072 lds
    v_max3_f32 v190, v190, v229, v230
    v_max3_f32 v191, v191, v245, v246
    v_max3_f32 v188, v188, v199, v200
    v_max3_f32 v189, v189, v215, v216
    v_max3_f32 v190, v190, v231, v232
    v_max3_f32 v191, v191, v247, v248
    v_max3_f32 v188, v188, v201, v202
    v_max3_f32 v189, v189, v217, v218
    s_add_u32 m0, s33, 104448
    s_nop 0
    buffer_load_dwordx4 v8, s[12:15], s36 offen offset:0 lds
    v_max3_f32 v190, v190, v233, v234
    v_max3_f32 v191, v191, v249, v250
    v_max3_f32 v188, v188, v203, v204
    v_max3_f32 v189, v189, v219, v220
    v_max3_f32 v190, v190, v235, v236
    v_max3_f32 v191, v191, v251, v252
    v_max3_f32 v188, v188, v205, v206
    buffer_load_dwordx4 v8, s[12:15], s36 offen offset:1024 lds
    v_max3_f32 v189, v189, v221, v222
    v_max3_f32 v190, v190, v237, v238
    v_max3_f32 v191, v191, v253, v254
    v_max3_f32 v188, v188, v207, v223
    v_max3_f32 v190, v190, v239, v255
    v_max3_f32 v188, v188, v189, v191
    v_max_f32 v188, v188, v190
    buffer_load_dwordx4 v8, s[12:15], s36 offen offset:2048 lds
    v_mov_b32 v189, v188
    s_nop 1
    v_permlane16_swap_b32 v188, v189
    v_max_f32 v188, v188, v189
    v_mov_b32 v189, v188
    s_nop 1
    v_permlane32_swap_b32 v188, v189
    v_max_f32 v188, v188, v189
    v_mul_f32 v188, s76, v188
    v_fma_f32 v248, v248, s76, -v188
    buffer_load_dwordx4 v8, s[12:15], s36 offen offset:3072 lds
    v_fma_f32 v249, v249, s76, -v188
    v_fma_f32 v250, v250, s76, -v188
    v_fma_f32 v251, v251, s76, -v188
    v_fma_f32 v252, v252, s76, -v188
    v_fma_f32 v253, v253, s76, -v188
    v_fma_f32 v254, v254, s76, -v188
    v_fma_f32 v255, v255, s76, -v188
    s_add_u32 m0, m0, 4096
    s_mov_b32 exec_hi, 0
    buffer_load_dwordx4 v9, s[12:15], s36 offen lds
    s_mov_b32 exec_hi, -1
    v_exp_f32 v248, v248
    v_exp_f32 v249, v249
    v_exp_f32 v250, v250
    v_exp_f32 v251, v251
    s_waitcnt vmcnt(28)
    s_barrier
    s_bfe_u32 s37, 0xb070707, s35
    s_mul_i32 s36, s37, 18432
    s_lshl_b32 s37, s37, 7
    s_add_u32 m0, s34, 0
    s_nop 0
    buffer_load_dwordx4 v4, s[8:11], s37 offen offset:0 lds
    v_exp_f32 v252, v252
    v_exp_f32 v253, v253
    v_exp_f32 v254, v254
    v_exp_f32 v255, v255
    buffer_load_dwordx4 v5, s[8:11], s37 offen offset:1024 lds
    v_cvt_pk_bf16_f32 v248, v248, v249
    v_cvt_pk_bf16_f32 v249, v250, v251
    v_cvt_pk_bf16_f32 v250, v252, v253
    v_cvt_pk_bf16_f32 v251, v254, v255
    v_bfi_b32 v184, v10, 0, v248
    v_bfi_b32 v185, v11, 0, v249
    v_bfi_b32 v186, v12, 0, v250
    buffer_load_dwordx4 v6, s[8:11], s37 offen offset:2048 lds
    v_bfi_b32 v187, v13, 0, v251
    v_and_b32 v248, v10, v248
    v_and_b32 v249, v11, v249
    v_and_b32 v250, v12, v250
    v_and_b32 v251, v13, v251
    v_fma_f32 v192, v192, s76, -v188
    v_fma_f32 v193, v193, s76, -v188
    buffer_load_dwordx4 v7, s[8:11], s37 offen offset:3072 lds
    v_fma_f32 v194, v194, s76, -v188
    v_fma_f32 v195, v195, s76, -v188
    v_fma_f32 v196, v196, s76, -v188
    v_fma_f32 v197, v197, s76, -v188
    v_fma_f32 v198, v198, s76, -v188
    v_fma_f32 v199, v199, s76, -v188
    v_exp_f32 v192, v192
    s_add_u32 m0, s33, 0
    s_nop 0
    buffer_load_dwordx4 v8, s[12:15], s36 offen offset:0 lds
    v_exp_f32 v193, v193
    v_exp_f32 v194, v194
    v_exp_f32 v195, v195
    v_exp_f32 v196, v196
    buffer_load_dwordx4 v8, s[12:15], s36 offen offset:1024 lds
    v_exp_f32 v197, v197
    v_exp_f32 v198, v198
    v_exp_f32 v199, v199
    buffer_load_dwordx4 v8, s[12:15], s36 offen offset:2048 lds
    v_cvt_pk_bf16_f32 v192, v192, v193
    v_cvt_pk_bf16_f32 v193, v194, v195
    v_cvt_pk_bf16_f32 v194, v196, v197
    v_cvt_pk_bf16_f32 v195, v198, v199
    v_fma_f32 v200, v200, s76, -v188
    v_fma_f32 v201, v201, s76, -v188
    v_fma_f32 v202, v202, s76, -v188
    v_fma_f32 v203, v203, s76, -v188
    buffer_load_dwordx4 v8, s[12:15], s36 offen offset:3072 lds
    v_fma_f32 v204, v204, s76, -v188
    v_fma_f32 v205, v205, s76, -v188
    v_fma_f32 v206, v206, s76, -v188
    v_fma_f32 v207, v207, s76, -v188
    v_exp_f32 v200, v200
    v_exp_f32 v201, v201
    s_add_u32 m0, m0, 4096
    s_mov_b32 exec_hi, 0
    buffer_load_dwordx4 v9, s[12:15], s36 offen lds
    s_mov_b32 exec_hi, -1
    v_exp_f32 v202, v202
    v_exp_f32 v203, v203
    v_exp_f32 v204, v204
    s_waitcnt vmcnt(19)
    s_barrier
    s_bfe_u32 s37, 0x808080c, s35
    s_mul_i32 s36, s37, 18432
    s_lshl_b32 s37, s37, 7
    s_add_u32 m0, s34, 34816
    s_nop 0
    buffer_load_dwordx4 v4, s[8:11], s37 offen offset:0 lds
    v_exp_f32 v205, v205
    v_exp_f32 v206, v206
    v_exp_f32 v207, v207
    v_cvt_pk_bf16_f32 v200, v200, v201
    v_cvt_pk_bf16_f32 v201, v202, v203
    buffer_load_dwordx4 v5, s[8:11], s37 offen offset:1024 lds
    v_cvt_pk_bf16_f32 v202, v204, v205
    v_cvt_pk_bf16_f32 v203, v206, v207
    v_fma_f32 v208, v208, s76, -v188
    v_fma_f32 v209, v209, s76, -v188
    v_fma_f32 v210, v210, s76, -v188
    v_fma_f32 v211, v211, s76, -v188
    v_fma_f32 v212, v212, s76, -v188
    buffer_load_dwordx4 v6, s[8:11], s37 offen offset:2048 lds
    v_fma_f32 v213, v213, s76, -v188
    v_fma_f32 v214, v214, s76, -v188
    v_fma_f32 v215, v215, s76, -v188
    v_exp_f32 v208, v208
    v_exp_f32 v209, v209
    buffer_load_dwordx4 v7, s[8:11], s37 offen offset:3072 lds
    v_exp_f32 v210, v210
    v_exp_f32 v211, v211
    v_exp_f32 v212, v212
    v_exp_f32 v213, v213
    s_add_u32 m0, s33, 34816
    s_nop 0
    buffer_load_dwordx4 v8, s[12:15], s36 offen offset:0 lds
    v_exp_f32 v214, v214
    v_exp_f32 v215, v215
    v_cvt_pk_bf16_f32 v208, v208, v209
    v_cvt_pk_bf16_f32 v209, v210, v211
    v_cvt_pk_bf16_f32 v210, v212, v213
    buffer_load_dwordx4 v8, s[12:15], s36 offen offset:1024 lds
    v_cvt_pk_bf16_f32 v211, v214, v215
    v_fma_f32 v216, v216, s76, -v188
    v_fma_f32 v217, v217, s76, -v188
    v_fma_f32 v218, v218, s76, -v188
    v_fma_f32 v219, v219, s76, -v188
    v_fma_f32 v220, v220, s76, -v188
    v_fma_f32 v221, v221, s76, -v188
    buffer_load_dwordx4 v8, s[12:15], s36 offen offset:2048 lds
    v_fma_f32 v222, v222, s76, -v188
    v_fma_f32 v223, v223, s76, -v188
    v_exp_f32 v216, v216
    v_exp_f32 v217, v217
    v_exp_f32 v218, v218
    buffer_load_dwordx4 v8, s[12:15], s36 offen offset:3072 lds
    v_exp_f32 v219, v219
    v_exp_f32 v220, v220
    v_exp_f32 v221, v221
    v_exp_f32 v222, v222
    s_add_u32 m0, m0, 4096
    s_mov_b32 exec_hi, 0
    buffer_load_dwordx4 v9, s[12:15], s36 offen lds
    s_mov_b32 exec_hi, -1
    v_exp_f32 v223, v223
    v_cvt_pk_bf16_f32 v216, v216, v217
    v_cvt_pk_bf16_f32 v217, v218, v219
    v_cvt_pk_bf16_f32 v218, v220, v221
    v_cvt_pk_bf16_f32 v219, v222, v223
    s_waitcnt vmcnt(18)
    s_barrier
    s_bfe_u32 s37, 0x9090d09, s35
    s_mul_i32 s36, s37, 18432
    s_lshl_b32 s37, s37, 7
    s_add_u32 m0, s34, 69632
    s_nop 0
    buffer_load_dwordx4 v4, s[8:11], s37 offen offset:0 lds
    v_fma_f32 v224, v224, s76, -v188
    v_fma_f32 v225, v225, s76, -v188
    v_fma_f32 v226, v226, s76, -v188
    v_fma_f32 v227, v227, s76, -v188
    v_fma_f32 v228, v228, s76, -v188
    v_fma_f32 v229, v229, s76, -v188
    v_fma_f32 v230, v230, s76, -v188
    v_fma_f32 v231, v231, s76, -v188
    buffer_load_dwordx4 v5, s[8:11], s37 offen offset:1024 lds
    v_exp_f32 v224, v224
    v_exp_f32 v225, v225
    v_exp_f32 v226, v226
    v_exp_f32 v227, v227
    buffer_load_dwordx4 v6, s[8:11], s37 offen offset:2048 lds
    v_exp_f32 v228, v228
    v_exp_f32 v229, v229
    v_exp_f32 v230, v230
    buffer_load_dwordx4 v7, s[8:11], s37 offen offset:3072 lds
    v_exp_f32 v231, v231
    v_cvt_pk_bf16_f32 v224, v224, v225
    v_cvt_pk_bf16_f32 v225, v226, v227
    v_cvt_pk_bf16_f32 v226, v228, v229
    v_cvt_pk_bf16_f32 v227, v230, v231
    v_fma_f32 v232, v232, s76, -v188
    v_fma_f32 v233, v233, s76, -v188
    s_add_u32 m0, s33, 69632
    s_nop 0
    buffer_load_dwordx4 v8, s[12:15], s36 offen offset:0 lds
    v_fma_f32 v234, v234, s76, -v188
    v_fma_f32 v235, v235, s76, -v188
    v_fma_f32 v236, v236, s76, -v188
    v_fma_f32 v237, v237, s76, -v188
    v_fma_f32 v238, v238, s76, -v188
    v_fma_f32 v239, v239, s76, -v188
    v_exp_f32 v232, v232
    buffer_load_dwordx4 v8, s[12:15], s36 offen offset:1024 lds
    v_exp_f32 v233, v233
    v_exp_f32 v234, v234
    v_exp_f32 v235, v235
    buffer_load_dwordx4 v8, s[12:15], s36 offen offset:2048 lds
    v_exp_f32 v236, v236
    v_exp_f32 v237, v237
    v_exp_f32 v238, v238
    v_exp_f32 v239, v239
    buffer_load_dwordx4 v8, s[12:15], s36 offen offset:3072 lds
    v_cvt_pk_bf16_f32 v232, v232, v233
    v_cvt_pk_bf16_f32 v233, v234, v235
    v_cvt_pk_bf16_f32 v234, v236, v237
    v_cvt_pk_bf16_f32 v235, v238, v239
    v_fma_f32 v240, v240, s76, -v188
    v_fma_f32 v241, v241, s76, -v188
    v_fma_f32 v242, v242, s76, -v188
    s_add_u32 m0, m0, 4096
    s_mov_b32 exec_hi, 0
    buffer_load_dwordx4 v9, s[12:15], s36 offen lds
    s_mov_b32 exec_hi, -1
    v_fma_f32 v243, v243, s76, -v188
    v_fma_f32 v244, v244, s76, -v188
    v_fma_f32 v245, v245, s76, -v188
    v_fma_f32 v246, v246, s76, -v188
    v_fma_f32 v247, v247, s76, -v188
    v_exp_f32 v240, v240
    s_waitcnt vmcnt(18)
    s_barrier
    s_bfe_u32 s37, 0xa0e0a0a, s35
    s_mul_i32 s36, s37, 18432
    s_lshl_b32 s37, s37, 7
    s_add_u32 m0, s34, 104448
    s_nop 0
    buffer_load_dwordx4 v4, s[8:11], s37 offen offset:0 lds
    v_exp_f32 v241, v241
    v_exp_f32 v242, v242
    v_exp_f32 v243, v243
    v_exp_f32 v244, v244
    buffer_load_dwordx4 v5, s[8:11], s37 offen offset:1024 lds
    v_exp_f32 v245, v245
    v_exp_f32 v246, v246
    v_exp_f32 v247, v247
    v_cvt_pk_bf16_f32 v240, v240, v241
    buffer_load_dwordx4 v6, s[8:11], s37 offen offset:2048 lds
    v_cvt_pk_bf16_f32 v241, v242, v243
    v_cvt_pk_bf16_f32 v242, v244, v245
    v_cvt_pk_bf16_f32 v243, v246, v247
    s_nop 1
    v_mfma_f32_16x16x32_bf16 v[22:25], v[104:107], v[184:187], 0
    buffer_load_dwordx4 v7, s[8:11], s37 offen offset:3072 lds
    v_mfma_f32_16x16x32_bf16 v[26:29], v[140:143], v[184:187], 0
    v_mfma_f32_16x16x32_bf16 v[22:25], v[108:111], v[192:195], v[22:25]
    s_add_u32 m0, s33, 104448
    s_nop 0
    buffer_load_dwordx4 v8, s[12:15], s36 offen offset:0 lds
    v_mfma_f32_16x16x32_bf16 v[26:29], v[144:147], v[192:195], v[26:29]
    v_mfma_f32_16x16x32_bf16 v[22:25], v[112:115], v[200:203], v[22:25]
    buffer_load_dwordx4 v8, s[12:15], s36 offen offset:1024 lds
    v_mfma_f32_16x16x32_bf16 v[26:29], v[148:151], v[200:203], v[26:29]
    v_mfma_f32_16x16x32_bf16 v[22:25], v[116:119], v[208:211], v[22:25]
    buffer_load_dwordx4 v8, s[12:15], s36 offen offset:2048 lds
    v_mfma_f32_16x16x32_bf16 v[26:29], v[152:155], v[208:211], v[26:29]
    v_mfma_f32_16x16x32_bf16 v[22:25], v[120:123], v[216:219], v[22:25]
    buffer_load_dwordx4 v8, s[12:15], s36 offen offset:3072 lds
    v_mfma_f32_16x16x32_bf16 v[26:29], v[156:159], v[216:219], v[26:29]
    v_mfma_f32_16x16x32_bf16 v[22:25], v[124:127], v[224:227], v[22:25]
    s_add_u32 m0, m0, 4096
    s_mov_b32 exec_hi, 0
    buffer_load_dwordx4 v9, s[12:15], s36 offen lds
    s_mov_b32 exec_hi, -1
    v_mfma_f32_16x16x32_bf16 v[26:29], v[160:163], v[224:227], v[26:29]
    s_waitcnt vmcnt(18)
    s_barrier
    s_bfe_u32 s37, 0xf0b0b0b, s35
    s_mul_i32 s36, s37, 18432
    s_lshl_b32 s37, s37, 7
    s_add_u32 m0, s34, 0
    s_nop 0
    buffer_load_dwordx4 v4, s[8:11], s37 offen offset:0 lds
    v_mfma_f32_16x16x32_bf16 v[22:25], v[128:131], v[232:235], v[22:25]
    v_mfma_f32_16x16x32_bf16 v[26:29], v[164:167], v[232:235], v[26:29]
    buffer_load_dwordx4 v5, s[8:11], s37 offen offset:1024 lds
    v_mfma_f32_16x16x32_bf16 v[22:25], v[132:135], v[240:243], v[22:25]
    v_mfma_f32_16x16x32_bf16 v[26:29], v[168:171], v[240:243], v[26:29]
    buffer_load_dwordx4 v6, s[8:11], s37 offen offset:2048 lds
    v_mfma_f32_16x16x32_bf16 v[22:25], v[136:139], v[248:251], v[22:25]
    v_mfma_f32_16x16x32_bf16 v[26:29], v[172:175], v[248:251], v[26:29]
    buffer_load_dwordx4 v7, s[8:11], s37 offen offset:3072 lds
    s_nop 7
    s_nop 1
    v_rcp_f32 v28, v28
    s_nop 0
    v_mul_f32 v22, v22, v28
    v_mul_f32 v23, v23, v28
    v_mul_f32 v24, v24, v28
    v_mul_f32 v25, v25, v28
    s_add_u32 m0, s33, 0
    s_nop 0
    buffer_load_dwordx4 v8, s[12:15], s36 offen offset:0 lds
    v_mul_f32 v26, v26, v28
    v_mul_f32 v27, v27, v28
    v_cvt_pk_bf16_f32 v18, v22, v23
    v_cvt_pk_bf16_f32 v19, v24, v25
    v_cvt_pk_bf16_f32 v30, v26, v27
    s_mov_b64 exec, 0xffff
    buffer_store_dword v30, v0, s[16:19], s38 offen offset:0 sc1
    s_mov_b64 exec, -1
    v_mfma_f32_16x16x32_bf16 v[184:187], v[32:35], v[180:183], 0
    buffer_load_dwordx4 v8, s[12:15], s36 offen offset:1024 lds
    v_mfma_f32_16x16x32_bf16 v[188:191], v[36:39], v[180:183], 0
    v_mfma_f32_16x16x32_bf16 v[192:195], v[40:43], v[180:183], 0
    buffer_load_dwordx4 v8, s[12:15], s36 offen offset:2048 lds
    v_mfma_f32_16x16x32_bf16 v[196:199], v[44:47], v[180:183], 0
    v_mfma_f32_16x16x32_bf16 v[200:203], v[48:51], v[180:183], 0
    buffer_load_dwordx4 v8, s[12:15], s36 offen offset:3072 lds
    v_mfma_f32_16x16x32_bf16 v[204:207], v[52:55], v[180:183], 0
    s_add_u32 m0, m0, 4096
    s_mov_b32 exec_hi, 0
    buffer_load_dwordx4 v9, s[12:15], s36 offen lds
    s_mov_b32 exec_hi, -1
    v_mfma_f32_16x16x32_bf16 v[208:211], v[56:59], v[180:183], 0
    v_mfma_f32_16x16x32_bf16 v[212:215], v[60:63], v[180:183], 0
    s_waitcnt vmcnt(19)
    s_barrier
    s_bfe_u32 s37, 0xc0c0c10, s35
    s_mul_i32 s36, s37, 18432
    s_lshl_b32 s37, s37, 7
    s_add_u32 m0, s34, 34816
    s_nop 0
    buffer_load_dwordx4 v4, s[8:11], s37 offen offset:0 lds
    v_mfma_f32_16x16x32_bf16 v[216:219], v[64:67], v[180:183], 0
    v_mfma_f32_16x16x32_bf16 v[220:223], v[68:71], v[180:183], 0
    buffer_load_dwordx4 v5, s[8:11], s37 offen offset:1024 lds
    v_mfma_f32_16x16x32_bf16 v[224:227], v[72:75], v[180:183], 0
    v_mfma_f32_16x16x32_bf16 v[228:231], v[76:79], v[180:183], 0
    buffer_load_dwordx4 v6, s[8:11], s37 offen offset:2048 lds
    v_mfma_f32_16x16x32_bf16 v[232:235], v[80:83], v[180:183], 0
    v_mfma_f32_16x16x32_bf16 v[236:239], v[84:87], v[180:183], 0
    buffer_load_dwordx4 v7, s[8:11], s37 offen offset:3072 lds
    v_mfma_f32_16x16x32_bf16 v[240:243], v[88:91], v[180:183], 0
    v_mfma_f32_16x16x32_bf16 v[244:247], v[92:95], v[180:183], 0
    s_add_u32 m0, s33, 34816
    s_nop 0
    buffer_load_dwordx4 v8, s[12:15], s36 offen offset:0 lds
    v_mfma_f32_16x16x32_bf16 v[248:251], v[96:99], v[180:183], 0
    v_mfma_f32_16x16x32_bf16 v[252:255], v[100:103], v[180:183], 0
    buffer_load_dwordx4 v8, s[12:15], s36 offen offset:1024 lds
    s_nop 7
    buffer_load_dwordx3 v[180:182], v1, s[16:19], s74 offen offset:2304
    buffer_load_dwordx3 v[32:34], v1, s[16:19], s49 offen offset:0
    buffer_load_dwordx3 v[36:38], v1, s[16:19], s49 offen offset:768
    v_mov_b32 v35, 0
    v_mov_b32 v39, 0
    v_cndmask_b32 v248, v184, v248, s[50:51]
    v_cndmask_b32 v249, v185, v249, s[52:53]
    buffer_load_dwordx4 v8, s[12:15], s36 offen offset:2048 lds
    v_cndmask_b32 v250, v186, v250, s[54:55]
    v_cndmask_b32 v251, v187, v251, s[56:57]
    v_cndmask_b32 v252, v188, v252, s[58:59]
    v_cndmask_b32 v253, v189, v253, s[60:61]
    v_cndmask_b32 v254, v190, v254, s[62:63]
    v_cndmask_b32 v255, v191, v255, s[64:65]
    v_max3_f32 v188, v192, v193, v194
    v_max3_f32 v189, v208, v209, v210
    buffer_load_dwordx4 v8, s[12:15], s36 offen offset:3072 lds
    v_max3_f32 v190, v224, v225, v226
    v_max3_f32 v191, v240, v241, v242
    v_max3_f32 v188, v188, v195, v196
    v_max3_f32 v189, v189, v211, v212
    v_max3_f32 v190, v190, v227, v228
    v_max3_f32 v191, v191, v243, v244
    v_max3_f32 v188, v188, v197, v198
    s_add_u32 m0, m0, 4096
    s_mov_b32 exec_hi, 0
    buffer_load_dwordx4 v9, s[12:15], s36 offen lds
    s_mov_b32 exec_hi, -1
    v_max3_f32 v189, v189, v213, v214
    v_max3_f32 v190, v190, v229, v230
    v_max3_f32 v191, v191, v245, v246
    v_max3_f32 v188, v188, v199, v200
    v_max3_f32 v189, v189, v215, v216
    v_max3_f32 v190, v190, v231, v232
    v_max3_f32 v191, v191, v247, v248
    s_waitcnt vmcnt(22)
    s_barrier
    s_bfe_u32 s37, 0xd0d110d, s35
    s_mul_i32 s36, s37, 18432
    s_lshl_b32 s37, s37, 7
    s_add_u32 m0, s34, 69632
    s_nop 0
    buffer_load_dwordx4 v4, s[8:11], s37 offen offset:0 lds
    v_max3_f32 v188, v188, v201, v202
    v_max3_f32 v189, v189, v217, v218
    v_max3_f32 v190, v190, v233, v234
    v_max3_f32 v191, v191, v249, v250
    v_max3_f32 v188, v188, v203, v204
    v_max3_f32 v189, v189, v219, v220
    v_max3_f32 v190, v190, v235, v236
    v_max3_f32 v191, v191, v251, v252
    buffer_load_dwordx4 v5, s[8:11], s37 offen offset:1024 lds
    v_max3_f32 v188, v188, v205, v206
    v_max3_f32 v189, v189, v221, v222
    v_max3_f32 v190, v190, v237, v238
    v_max3_f32 v191, v191, v253, v254
    v_max3_f32 v188, v188, v207, v223
    v_max3_f32 v190, v190, v239, v255
    v_max3_f32 v188, v188, v189, v191
    buffer_load_dwordx4 v6, s[8:11], s37 offen offset:2048 lds
    v_max_f32 v188, v188, v190
    v_mov_b32 v189, v188
    s_nop 1
    v_permlane16_swap_b32 v188, v189
    v_max_f32 v188, v188, v189
    v_mov_b32 v189, v188
    s_nop 1
    v_permlane32_swap_b32 v188, v189
    v_max_f32 v188, v188, v189
    buffer_load_dwordx4 v7, s[8:11], s37 offen offset:3072 lds
    v_mul_f32 v188, s76, v188
    v_fma_f32 v248, v248, s76, -v188
    v_fma_f32 v249, v249, s76, -v188
    v_fma_f32 v250, v250, s76, -v188
    v_fma_f32 v251, v251, s76, -v188
    v_fma_f32 v252, v252, s76, -v188
    v_fma_f32 v253, v253, s76, -v188
    v_fma_f32 v254, v254, s76, -v188
    s_add_u32 m0, s33, 69632
    s_nop 0
    buffer_load_dwordx4 v8, s[12:15], s36 offen offset:0 lds
    v_fma_f32 v255, v255, s76, -v188
    v_exp_f32 v248, v248
    v_exp_f32 v249, v249
    v_exp_f32 v250, v250
    buffer_load_dwordx4 v8, s[12:15], s36 offen offset:1024 lds
    v_exp_f32 v251, v251
    v_exp_f32 v252, v252
    v_exp_f32 v253, v253
    v_exp_f32 v254, v254
    buffer_load_dwordx4 v8, s[12:15], s36 offen offset:2048 lds
    v_exp_f32 v255, v255
    v_cvt_pk_bf16_f32 v248, v248, v249
    v_cvt_pk_bf16_f32 v249, v250, v251
    v_cvt_pk_bf16_f32 v250, v252, v253
    v_cvt_pk_bf16_f32 v251, v254, v255
    v_bfi_b32 v184, v14, 0, v248
    buffer_load_dwordx4 v8, s[12:15], s36 offen offset:3072 lds
    v_bfi_b32 v185, v15, 0, v249
    v_bfi_b32 v186, v16, 0, v250
    v_bfi_b32 v187, v17, 0, v251
    v_and_b32 v248, v14, v248
    v_and_b32 v249, v15, v249
    v_and_b32 v250, v16, v250
    v_and_b32 v251, v17, v251
    s_add_u32 m0, m0, 4096
    s_mov_b32 exec_hi, 0
    buffer_load_dwordx4 v9, s[12:15], s36 offen lds
    s_mov_b32 exec_hi, -1
    v_fma_f32 v192, v192, s76, -v188
    v_fma_f32 v193, v193, s76, -v188
    v_fma_f32 v194, v194, s76, -v188
    v_fma_f32 v195, v195, s76, -v188
    v_fma_f32 v196, v196, s76, -v188
    v_fma_f32 v197, v197, s76, -v188
    v_fma_f32 v198, v198, s76, -v188
    s_waitcnt vmcnt(21)
    s_barrier
    s_bfe_u32 s37, 0xe120e0e, s35
    s_mul_i32 s36, s37, 18432
    s_lshl_b32 s37, s37, 7
    s_add_u32 m0, s34, 104448
    s_nop 0
    buffer_load_dwordx4 v4, s[8:11], s37 offen offset:0 lds
    v_fma_f32 v199, v199, s76, -v188
    v_exp_f32 v192, v192
    v_exp_f32 v193, v193
    v_exp_f32 v194, v194
    v_exp_f32 v195, v195
    buffer_load_dwordx4 v5, s[8:11], s37 offen offset:1024 lds
    v_exp_f32 v196, v196
    v_exp_f32 v197, v197
    v_exp_f32 v198, v198
    buffer_load_dwordx4 v6, s[8:11], s37 offen offset:2048 lds
    v_exp_f32 v199, v199
    v_cvt_pk_bf16_f32 v192, v192, v193
    v_cvt_pk_bf16_f32 v193, v194, v195
    v_cvt_pk_bf16_f32 v194, v196, v197
    v_cvt_pk_bf16_f32 v195, v198, v199
    v_fma_f32 v200, v200, s76, -v188
    buffer_load_dwordx4 v7, s[8:11], s37 offen offset:3072 lds
    v_fma_f32 v201, v201, s76, -v188
    v_fma_f32 v202, v202, s76, -v188
    v_fma_f32 v203, v203, s76, -v188
    v_fma_f32 v204, v204, s76, -v188
    v_fma_f32 v205, v205, s76, -v188
    v_fma_f32 v206, v206, s76, -v188
    v_fma_f32 v207, v207, s76, -v188
    v_exp_f32 v200, v200
    s_add_u32 m0, s33, 104448
    s_nop 0
    buffer_load_dwordx4 v8, s[12:15], s36 offen offset:0 lds
    v_exp_f32 v201, v201
    v_exp_f32 v202, v202
    v_exp_f32 v203, v203
    buffer_load_dwordx4 v8, s[12:15], s36 offen offset:1024 lds
    v_exp_f32 v204, v204
    v_exp_f32 v205, v205
    v_exp_f32 v206, v206
    v_exp_f32 v207, v207
    buffer_load_dwordx4 v8, s[12:15], s36 offen offset:2048 lds
    v_cvt_pk_bf16_f32 v200, v200, v201
    v_cvt_pk_bf16_f32 v201, v202, v203
    v_cvt_pk_bf16_f32 v202, v204, v205
    v_cvt_pk_bf16_f32 v203, v206, v207
    v_fma_f32 v208, v208, s76, -v188
    v_fma_f32 v209, v209, s76, -v188
    v_fma_f32 v210, v210, s76, -v188
    buffer_load_dwordx4 v8, s[12:15], s36 offen offset:3072 lds
    v_fma_f32 v211, v211, s76, -v188
    v_fma_f32 v212, v212, s76, -v188
    v_fma_f32 v213, v213, s76, -v188
    v_fma_f32 v214, v214, s76, -v188
    v_fma_f32 v215, v215, s76, -v188
    v_exp_f32 v208, v208
    s_add_u32 m0, m0, 4096
    s_mov_b32 exec_hi, 0
    buffer_load_dwordx4 v9, s[12:15], s36 offen lds
    s_mov_b32 exec_hi, -1
    v_exp_f32 v209, v209
    v_exp_f32 v210, v210
    v_exp_f32 v211, v211
    v_exp_f32 v212, v212
    s_waitcnt vmcnt(18)
    s_barrier
    s_bfe_u32 s37, 0x130f0f0f, s35
    s_mul_i32 s36, s37, 18432
    s_lshl_b32 s37, s37, 7
    s_add_u32 m0, s34, 0
    s_nop 0
    buffer_load_dwordx4 v4, s[8:11], s37 offen offset:0 lds
    v_exp_f32 v213, v213
    v_exp_f32 v214, v214
    v_exp_f32 v215, v215
    v_cvt_pk_bf16_f32 v208, v208, v209
    v_cvt_pk_bf16_f32 v209, v210, v211
    buffer_load_dwordx4 v5, s[8:11], s37 offen offset:1024 lds
    v_cvt_pk_bf16_f32 v210, v212, v213
    v_cvt_pk_bf16_f32 v211, v214, v215
    v_fma_f32 v216, v216, s76, -v188
    v_fma_f32 v217, v217, s76, -v188
    v_fma_f32 v218, v218, s76, -v188
    v_fma_f32 v219, v219, s76, -v188
    v_fma_f32 v220, v220, s76, -v188
    buffer_load_dwordx4 v6, s[8:11], s37 offen offset:2048 lds
    v_fma_f32 v221, v221, s76, -v188
    v_fma_f32 v222, v222, s76, -v188
    v_fma_f32 v223, v223, s76, -v188
    v_exp_f32 v216, v216
    v_exp_f32 v217, v217
    buffer_load_dwordx4 v7, s[8:11], s37 offen offset:3072 lds
    v_exp_f32 v218, v218
    v_exp_f32 v219, v219
    v_exp_f32 v220, v220
    v_exp_f32 v221, v221
    s_add_u32 m0, s33, 0
    s_nop 0
    buffer_load_dwordx4 v8, s[12:15], s36 offen offset:0 lds
    v_exp_f32 v222, v222
    v_exp_f32 v223, v223
    v_cvt_pk_bf16_f32 v216, v216, v217
    v_cvt_pk_bf16_f32 v217, v218, v219
    v_cvt_pk_bf16_f32 v218, v220, v221
    buffer_load_dwordx4 v8, s[12:15], s36 offen offset:1024 lds
    v_cvt_pk_bf16_f32 v219, v222, v223
    v_fma_f32 v224, v224, s76, -v188
    v_fma_f32 v225, v225, s76, -v188
    v_fma_f32 v226, v226, s76, -v188
    v_fma_f32 v227, v227, s76, -v188
    v_fma_f32 v228, v228, s76, -v188
    v_fma_f32 v229, v229, s76, -v188
    buffer_load_dwordx4 v8, s[12:15], s36 offen offset:2048 lds
    v_fma_f32 v230, v230, s76, -v188
    v_fma_f32 v231, v231, s76, -v188
    v_exp_f32 v224, v224
    v_exp_f32 v225, v225
    v_exp_f32 v226, v226
    buffer_load_dwordx4 v8, s[12:15], s36 offen offset:3072 lds
    v_exp_f32 v227, v227
    v_exp_f32 v228, v228
    v_exp_f32 v229, v229
    v_exp_f32 v230, v230
    s_add_u32 m0, m0, 4096
    s_mov_b32 exec_hi, 0
    buffer_load_dwordx4 v9, s[12:15], s36 offen lds
    s_mov_b32 exec_hi, -1
    v_exp_f32 v231, v231
    v_cvt_pk_bf16_f32 v224, v224, v225
    v_cvt_pk_bf16_f32 v225, v226, v227
    v_cvt_pk_bf16_f32 v226, v228, v229
    v_cvt_pk_bf16_f32 v227, v230, v231
    s_waitcnt vmcnt(18)
    s_barrier
    s_bfe_u32 s37, 0x10101014, s35
    s_mul_i32 s36, s37, 18432
    s_lshl_b32 s37, s37, 7
    s_add_u32 m0, s34, 34816
    s_nop 0
    buffer_load_dwordx4 v4, s[8:11], s37 offen offset:0 lds
    v_fma_f32 v232, v232, s76, -v188
    v_fma_f32 v233, v233, s76, -v188
    v_fma_f32 v234, v234, s76, -v188
    v_fma_f32 v235, v235, s76, -v188
    v_fma_f32 v236, v236, s76, -v188
    v_fma_f32 v237, v237, s76, -v188
    v_fma_f32 v238, v238, s76, -v188
    v_fma_f32 v239, v239, s76, -v188
    buffer_load_dwordx4 v5, s[8:11], s37 offen offset:1024 lds
    v_exp_f32 v232, v232
    v_exp_f32 v233, v233
    v_exp_f32 v234, v234
    v_exp_f32 v235, v235
    buffer_load_dwordx4 v6, s[8:11], s37 offen offset:2048 lds
    v_exp_f32 v236, v236
    v_exp_f32 v237, v237
    v_exp_f32 v238, v238
    buffer_load_dwordx4 v7, s[8:11], s37 offen offset:3072 lds
    v_exp_f32 v239, v239
    v_cvt_pk_bf16_f32 v232, v232, v233
    v_cvt_pk_bf16_f32 v233, v234, v235
    v_cvt_pk_bf16_f32 v234, v236, v237
    v_cvt_pk_bf16_f32 v235, v238, v239
    v_fma_f32 v240, v240, s76, -v188
    v_fma_f32 v241, v241, s76, -v188
    s_add_u32 m0, s33, 34816
    s_nop 0
    buffer_load_dwordx4 v8, s[12:15], s36 offen offset:0 lds
    v_fma_f32 v242, v242, s76, -v188
    v_fma_f32 v243, v243, s76, -v188
    v_fma_f32 v244, v244, s76, -v188
    v_fma_f32 v245, v245, s76, -v188
    v_fma_f32 v246, v246, s76, -v188
    v_fma_f32 v247, v247, s76, -v188
    v_exp_f32 v240, v240
    buffer_load_dwordx4 v8, s[12:15], s36 offen offset:1024 lds
    v_exp_f32 v241, v241
    v_exp_f32 v242, v242
    v_exp_f32 v243, v243
    buffer_load_dwordx4 v8, s[12:15], s36 offen offset:2048 lds
    v_exp_f32 v244, v244
    v_exp_f32 v245, v245
    v_exp_f32 v246, v246
    v_exp_f32 v247, v247
    buffer_load_dwordx4 v8, s[12:15], s36 offen offset:3072 lds
    v_cvt_pk_bf16_f32 v240, v240, v241
    v_cvt_pk_bf16_f32 v241, v242, v243
    v_cvt_pk_bf16_f32 v242, v244, v245
    v_cvt_pk_bf16_f32 v243, v246, v247
    s_nop 1
    v_mfma_f32_16x16x32_bf16 v[22:25], v[104:107], v[184:187], 0
    s_add_u32 m0, m0, 4096
    s_mov_b32 exec_hi, 0
    buffer_load_dwordx4 v9, s[12:15], s36 offen lds
    s_mov_b32 exec_hi, -1
    v_mfma_f32_16x16x32_bf16 v[26:29], v[140:143], v[184:187], 0
    v_mfma_f32_16x16x32_bf16 v[22:25], v[108:111], v[192:195], v[22:25]
    s_waitcnt vmcnt(18)
    s_barrier
    s_bfe_u32 s37, 0x11111511, s35
    s_mul_i32 s36, s37, 18432
    s_lshl_b32 s37, s37, 7
    s_add_u32 m0, s34, 69632
    s_nop 0
    buffer_load_dwordx4 v4, s[8:11], s37 offen offset:0 lds
    v_mfma_f32_16x16x32_bf16 v[26:29], v[144:147], v[192:195], v[26:29]
    v_mfma_f32_16x16x32_bf16 v[22:25], v[112:115], v[200:203], v[22:25]
    buffer_load_dwordx4 v5, s[8:11], s37 offen offset:1024 lds
    v_mfma_f32_16x16x32_bf16 v[26:29], v[148:151], v[200:203], v[26:29]
    v_mfma_f32_16x16x32_bf16 v[22:25], v[116:119], v[208:211], v[22:25]
    buffer_load_dwordx4 v6, s[8:11], s37 offen offset:2048 lds
    v_mfma_f32_16x16x32_bf16 v[26:29], v[152:155], v[208:211], v[26:29]
    v_mfma_f32_16x16x32_bf16 v[22:25], v[120:123], v[216:219], v[22:25]
    buffer_load_dwordx4 v7, s[8:11], s37 offen offset:3072 lds
    v_mfma_f32_16x16x32_bf16 v[26:29], v[156:159], v[216:219], v[26:29]
    v_mfma_f32_16x16x32_bf16 v[22:25], v[124:127], v[224:227], v[22:25]
    s_add_u32 m0, s33, 69632
    s_nop 0
    buffer_load_dwordx4 v8, s[12:15], s36 offen offset:0 lds
    v_mfma_f32_16x16x32_bf16 v[26:29], v[160:163], v[224:227], v[26:29]
    v_mfma_f32_16x16x32_bf16 v[22:25], v[128:131], v[232:235], v[22:25]
    buffer_load_dwordx4 v8, s[12:15], s36 offen offset:1024 lds
    v_mfma_f32_16x16x32_bf16 v[26:29], v[164:167], v[232:235], v[26:29]
    buffer_load_dwordx4 v8, s[12:15], s36 offen offset:2048 lds
    v_mfma_f32_16x16x32_bf16 v[22:25], v[132:135], v[240:243], v[22:25]
    v_mfma_f32_16x16x32_bf16 v[26:29], v[168:171], v[240:243], v[26:29]
    buffer_load_dwordx4 v8, s[12:15], s36 offen offset:3072 lds
    v_mfma_f32_16x16x32_bf16 v[22:25], v[136:139], v[248:251], v[22:25]
    v_mfma_f32_16x16x32_bf16 v[26:29], v[172:175], v[248:251], v[26:29]
    s_add_u32 m0, m0, 4096
    s_mov_b32 exec_hi, 0
    buffer_load_dwordx4 v9, s[12:15], s36 offen lds
    s_mov_b32 exec_hi, -1
    s_nop 7
    s_nop 1
    buffer_load_dwordx4 v[104:107], v0, s[16:19], s49 offen offset:1536
    s_mov_b32 exec_lo, 0x00030003
    s_mov_b32 exec_hi, 0x00030003
    buffer_load_dwordx4 v[140:143], v3, s[16:19], s49 offen offset:2560
    s_mov_b64 exec, -1
    v_rcp_f32 v28, v28
    s_nop 0
    v_mul_f32 v22, v22, v28
    v_mul_f32 v23, v23, v28
    v_mul_f32 v24, v24, v28
    v_mul_f32 v25, v25, v28
    s_waitcnt vmcnt(20)
    s_barrier
    s_bfe_u32 s37, 0x12161212, s35
    s_mul_i32 s36, s37, 18432
    s_lshl_b32 s37, s37, 7
    s_add_u32 m0, s34, 104448
    s_nop 0
    buffer_load_dwordx4 v4, s[8:11], s37 offen offset:0 lds
    v_mul_f32 v26, v26, v28
    v_mul_f32 v27, v27, v28
    v_cvt_pk_bf16_f32 v20, v22, v23
    v_cvt_pk_bf16_f32 v21, v24, v25
    v_cvt_pk_bf16_f32 v31, v26, v27
    s_mov_b64 exec, 0xffff
    buffer_store_dword v31, v0, s[16:19], s38 offen offset:1024 sc1
    s_mov_b64 exec, -1
    buffer_store_dwordx4 v[18:21], v0, s[16:19], s6 offen sc1
    v_mfma_f32_16x16x32_bf16 v[184:187], v[40:43], v[176:179], 0
    buffer_load_dwordx4 v5, s[8:11], s37 offen offset:1024 lds
    v_mfma_f32_16x16x32_bf16 v[188:191], v[44:47], v[176:179], 0
    v_mfma_f32_16x16x32_bf16 v[192:195], v[48:51], v[176:179], 0
    buffer_load_dwordx4 v6, s[8:11], s37 offen offset:2048 lds
    v_mfma_f32_16x16x32_bf16 v[196:199], v[52:55], v[176:179], 0
    v_mfma_f32_16x16x32_bf16 v[200:203], v[56:59], v[176:179], 0
    buffer_load_dwordx4 v7, s[8:11], s37 offen offset:3072 lds
    v_mfma_f32_16x16x32_bf16 v[204:207], v[60:63], v[176:179], 0
    v_mfma_f32_16x16x32_bf16 v[208:211], v[64:67], v[176:179], 0
    s_add_u32 m0, s33, 104448
    s_nop 0
    buffer_load_dwordx4 v8, s[12:15], s36 offen offset:0 lds
    v_mfma_f32_16x16x32_bf16 v[212:215], v[68:71], v[176:179], 0
    buffer_load_dwordx4 v8, s[12:15], s36 offen offset:1024 lds
    v_mfma_f32_16x16x32_bf16 v[216:219], v[72:75], v[176:179], 0
    v_mfma_f32_16x16x32_bf16 v[220:223], v[76:79], v[176:179], 0
    buffer_load_dwordx4 v8, s[12:15], s36 offen offset:2048 lds
    v_mfma_f32_16x16x32_bf16 v[224:227], v[80:83], v[176:179], 0
    v_mfma_f32_16x16x32_bf16 v[228:231], v[84:87], v[176:179], 0
    buffer_load_dwordx4 v8, s[12:15], s36 offen offset:3072 lds
    v_mfma_f32_16x16x32_bf16 v[232:235], v[88:91], v[176:179], 0
    v_mfma_f32_16x16x32_bf16 v[236:239], v[92:95], v[176:179], 0
    s_add_u32 m0, m0, 4096
    s_mov_b32 exec_hi, 0
    buffer_load_dwordx4 v9, s[12:15], s36 offen lds
    s_mov_b32 exec_hi, -1
    v_mfma_f32_16x16x32_bf16 v[240:243], v[96:99], v[176:179], 0
    v_mfma_f32_16x16x32_bf16 v[244:247], v[100:103], v[176:179], 0
    s_waitcnt vmcnt(22)
    s_barrier
    s_bfe_u32 s37, 0x17131313, s35
    s_mul_i32 s36, s37, 18432
    s_lshl_b32 s37, s37, 7
    s_add_u32 m0, s34, 0
    s_nop 0
    buffer_load_dwordx4 v4, s[8:11], s37 offen offset:0 lds
    v_mfma_f32_16x16x32_bf16 v[248:251], v[32:35], v[176:179], 0
    v_mfma_f32_16x16x32_bf16 v[252:255], v[36:39], v[176:179], 0
    buffer_load_dwordx4 v5, s[8:11], s37 offen offset:1024 lds
    s_nop 7
    v_cndmask_b32 v248, v184, v248, s[58:59]
    v_cndmask_b32 v249, v185, v249, s[60:61]
    v_cndmask_b32 v250, v186, v250, s[62:63]
    v_cndmask_b32 v251, v187, v251, s[64:65]
    v_cndmask_b32 v252, v188, v252, s[66:67]
    v_cndmask_b32 v253, v189, v253, s[68:69]
    v_cndmask_b32 v254, v190, v254, s[70:71]
    buffer_load_dwordx4 v6, s[8:11], s37 offen offset:2048 lds
    v_cndmask_b32 v255, v191, v255, s[72:73]
    v_max3_f32 v188, v192, v193, v194
    v_max3_f32 v189, v208, v209, v210
    v_max3_f32 v190, v224, v225, v226
    v_max3_f32 v191, v240, v241, v242
    v_max3_f32 v188, v188, v195, v196
    v_max3_f32 v189, v189, v211, v212
    buffer_load_dwordx4 v7, s[8:11], s37 offen offset:3072 lds
    v_max3_f32 v190, v190, v227, v228
    v_max3_f32 v191, v191, v243, v244
    v_max3_f32 v188, v188, v197, v198
    v_max3_f32 v189, v189, v213, v214
    v_max3_f32 v190, v190, v229, v230
    v_max3_f32 v191, v191, v245, v246
    v_max3_f32 v188, v188, v199, v200
    v_max3_f32 v189, v189, v215, v216
    s_add_u32 m0, s33, 0
    s_nop 0
    buffer_load_dwordx4 v8, s[12:15], s36 offen offset:0 lds
    v_max3_f32 v190, v190, v231, v232
    v_max3_f32 v191, v191, v247, v248
    v_max3_f32 v188, v188, v201, v202
    v_max3_f32 v189, v189, v217, v218
    v_max3_f32 v190, v190, v233, v234
    v_max3_f32 v191, v191, v249, v250
    v_max3_f32 v188, v188, v203, v204
    buffer_load_dwordx4 v8, s[12:15], s36 offen offset:1024 lds
    v_max3_f32 v189, v189, v219, v220
    v_max3_f32 v190, v190, v235, v236
    v_max3_f32 v191, v191, v251, v252
    v_max3_f32 v188, v188, v205, v206
    v_max3_f32 v189, v189, v221, v222
    v_max3_f32 v190, v190, v237, v238
    v_max3_f32 v191, v191, v253, v254
    buffer_load_dwordx4 v8, s[12:15], s36 offen offset:2048 lds
    v_max3_f32 v188, v188, v207, v223
    v_max3_f32 v190, v190, v239, v255
    v_max3_f32 v188, v188, v189, v191
    v_max_f32 v188, v188, v190
    v_mov_b32 v189, v188
    s_nop 1
    v_permlane16_swap_b32 v188, v189
    v_max_f32 v188, v188, v189
    v_mov_b32 v189, v188
    s_nop 1
    v_permlane32_swap_b32 v188, v189
    buffer_load_dwordx4 v8, s[12:15], s36 offen offset:3072 lds
    v_max_f32 v188, v188, v189
    v_mul_f32 v188, s76, v188
    v_fma_f32 v248, v248, s76, -v188
    v_fma_f32 v249, v249, s76, -v188
    v_fma_f32 v250, v250, s76, -v188
    v_fma_f32 v251, v251, s76, -v188
    s_add_u32 m0, m0, 4096
    s_mov_b32 exec_hi, 0
    buffer_load_dwordx4 v9, s[12:15], s36 offen lds
    s_mov_b32 exec_hi, -1
    v_fma_f32 v252, v252, s76, -v188
    v_fma_f32 v253, v253, s76, -v188
    v_fma_f32 v254, v254, s76, -v188
    v_fma_f32 v255, v255, s76, -v188
    v_exp_f32 v248, v248
    v_exp_f32 v249, v249
    s_waitcnt vmcnt(22)
    s_barrier
    s_bfe_u32 s37, 0x14141418, s35
    s_mul_i32 s36, s37, 18432
    s_lshl_b32 s37, s37, 7
    s_add_u32 m0, s34, 34816
    s_nop 0
    buffer_load_dwordx4 v4, s[8:11], s37 offen offset:0 lds
    v_exp_f32 v250, v250
    v_exp_f32 v251, v251
    v_exp_f32 v252, v252
    v_exp_f32 v253, v253
    buffer_load_dwordx4 v5, s[8:11], s37 offen offset:1024 lds
    v_exp_f32 v254, v254
    v_exp_f32 v255, v255
    v_cvt_pk_bf16_f32 v248, v248, v249
    v_cvt_pk_bf16_f32 v249, v250, v251
    v_cvt_pk_bf16_f32 v250, v252, v253
    buffer_load_dwordx4 v6, s[8:11], s37 offen offset:2048 lds
    v_cvt_pk_bf16_f32 v251, v254, v255
    v_bfi_b32 v184, v10, 0, v248
    v_bfi_b32 v185, v11, 0, v249
    v_bfi_b32 v186, v12, 0, v250
    v_bfi_b32 v187, v13, 0, v251
    v_and_b32 v248, v10, v248
    v_and_b32 v249, v11, v249
    buffer_load_dwordx4 v7, s[8:11], s37 offen offset:3072 lds
    v_and_b32 v250, v12, v250
    v_and_b32 v251, v13, v251
    v_fma_f32 v192, v192, s76, -v188
    v_fma_f32 v193, v193, s76, -v188
    v_fma_f32 v194, v194, s76, -v188
    v_fma_f32 v195, v195, s76, -v188
    v_fma_f32 v196, v196, s76, -v188
    v_fma_f32 v197, v197, s76, -v188
    s_add_u32 m0, s33, 34816
    s_nop 0
    buffer_load_dwordx4 v8, s[12:15], s36 offen offset:0 lds
    v_fma_f32 v198, v198, s76, -v188
    v_fma_f32 v199, v199, s76, -v188
    v_exp_f32 v192, v192
    v_exp_f32 v193, v193
    v_exp_f32 v194, v194
    buffer_load_dwordx4 v8, s[12:15], s36 offen offset:1024 lds
    v_exp_f32 v195, v195
    v_exp_f32 v196, v196
    v_exp_f32 v197, v197
    buffer_load_dwordx4 v8, s[12:15], s36 offen offset:2048 lds
    v_exp_f32 v198, v198
    v_exp_f32 v199, v199
    v_cvt_pk_bf16_f32 v192, v192, v193
    v_cvt_pk_bf16_f32 v193, v194, v195
    v_cvt_pk_bf16_f32 v194, v196, v197
    v_cvt_pk_bf16_f32 v195, v198, v199
    buffer_load_dwordx4 v8, s[12:15], s36 offen offset:3072 lds
    v_fma_f32 v200, v200, s76, -v188
    v_fma_f32 v201, v201, s76, -v188
    v_fma_f32 v202, v202, s76, -v188
    v_fma_f32 v203, v203, s76, -v188
    v_fma_f32 v204, v204, s76, -v188
    v_fma_f32 v205, v205, s76, -v188
    v_fma_f32 v206, v206, s76, -v188
    s_add_u32 m0, m0, 4096
    s_mov_b32 exec_hi, 0
    buffer_load_dwordx4 v9, s[12:15], s36 offen lds
    s_mov_b32 exec_hi, -1
    v_fma_f32 v207, v207, s76, -v188
    v_exp_f32 v200, v200
    v_exp_f32 v201, v201
    v_exp_f32 v202, v202
    s_waitcnt vmcnt(18)
    s_barrier
    s_bfe_u32 s37, 0x15151915, s35
    s_mul_i32 s36, s37, 18432
    s_lshl_b32 s37, s37, 7
    s_add_u32 m0, s34, 69632
    s_nop 0
    buffer_load_dwordx4 v4, s[8:11], s37 offen offset:0 lds
    v_exp_f32 v203, v203
    v_exp_f32 v204, v204
    v_exp_f32 v205, v205
    v_exp_f32 v206, v206
    buffer_load_dwordx4 v5, s[8:11], s37 offen offset:1024 lds
    v_exp_f32 v207, v207
    v_cvt_pk_bf16_f32 v200, v200, v201
    v_cvt_pk_bf16_f32 v201, v202, v203
    v_cvt_pk_bf16_f32 v202, v204, v205
    v_cvt_pk_bf16_f32 v203, v206, v207
    v_fma_f32 v208, v208, s76, -v188
    buffer_load_dwordx4 v6, s[8:11], s37 offen offset:2048 lds
    v_fma_f32 v209, v209, s76, -v188
    v_fma_f32 v210, v210, s76, -v188
    v_fma_f32 v211, v211, s76, -v188
    v_fma_f32 v212, v212, s76, -v188
    v_fma_f32 v213, v213, s76, -v188
    v_fma_f32 v214, v214, s76, -v188
    v_fma_f32 v215, v215, s76, -v188
    buffer_load_dwordx4 v7, s[8:11], s37 offen offset:3072 lds
    v_exp_f32 v208, v208
    v_exp_f32 v209, v209
    v_exp_f32 v210, v210
    v_exp_f32 v211, v211
    s_add_u32 m0, s33, 69632
    s_nop 0
    buffer_load_dwordx4 v8, s[12:15], s36 offen offset:0 lds
    v_exp_f32 v212, v212
    v_exp_f32 v213, v213
    v_exp_f32 v214, v214
    v_exp_f32 v215, v215
    buffer_load_dwordx4 v8, s[12:15], s36 offen offset:1024 lds
    v_cvt_pk_bf16_f32 v208, v208, v209
    v_cvt_pk_bf16_f32 v209, v210, v211
    v_cvt_pk_bf16_f32 v210, v212, v213
    v_cvt_pk_bf16_f32 v211, v214, v215
    v_fma_f32 v216, v216, s76, -v188
    v_fma_f32 v217, v217, s76, -v188
    buffer_load_dwordx4 v8, s[12:15], s36 offen offset:2048 lds
    v_fma_f32 v218, v218, s76, -v188
    v_fma_f32 v219, v219, s76, -v188
    v_fma_f32 v220, v220, s76, -v188
    v_fma_f32 v221, v221, s76, -v188
    v_fma_f32 v222, v222, s76, -v188
    v_fma_f32 v223, v223, s76, -v188
    v_exp_f32 v216, v216
    buffer_load_dwordx4 v8, s[12:15], s36 offen offset:3072 lds
    v_exp_f32 v217, v217
    v_exp_f32 v218, v218
    v_exp_f32 v219, v219
    v_exp_f32 v220, v220
    s_add_u32 m0, m0, 4096
    s_mov_b32 exec_hi, 0
    buffer_load_dwordx4 v9, s[12:15], s36 offen lds
    s_mov_b32 exec_hi, -1
    v_exp_f32 v221, v221
    v_exp_f32 v222, v222
    v_exp_f32 v223, v223
    s_waitcnt vmcnt(18)
    s_barrier
    s_bfe_u32 s37, 0x161a1616, s35
    s_mul_i32 s36, s37, 18432
    s_lshl_b32 s37, s37, 7
    s_add_u32 m0, s34, 104448
    s_nop 0
    buffer_load_dwordx4 v4, s[8:11], s37 offen offset:0 lds
    v_cvt_pk_bf16_f32 v216, v216, v217
    v_cvt_pk_bf16_f32 v217, v218, v219
    v_cvt_pk_bf16_f32 v218, v220, v221
    v_cvt_pk_bf16_f32 v219, v222, v223
    v_fma_f32 v224, v224, s76, -v188
    v_fma_f32 v225, v225, s76, -v188
    v_fma_f32 v226, v226, s76, -v188
    v_fma_f32 v227, v227, s76, -v188
    buffer_load_dwordx4 v5, s[8:11], s37 offen offset:1024 lds
    v_fma_f32 v228, v228, s76, -v188
    v_fma_f32 v229, v229, s76, -v188
    v_fma_f32 v230, v230, s76, -v188
    v_fma_f32 v231, v231, s76, -v188
    v_exp_f32 v224, v224
    v_exp_f32 v225, v225
    buffer_load_dwordx4 v6, s[8:11], s37 offen offset:2048 lds
    v_exp_f32 v226, v226
    v_exp_f32 v227, v227
    v_exp_f32 v228, v228
    buffer_load_dwordx4 v7, s[8:11], s37 offen offset:3072 lds
    v_exp_f32 v229, v229
    v_exp_f32 v230, v230
    v_exp_f32 v231, v231
    v_cvt_pk_bf16_f32 v224, v224, v225
    v_cvt_pk_bf16_f32 v225, v226, v227
    s_add_u32 m0, s33, 104448
    s_nop 0
    buffer_load_dwordx4 v8, s[12:15], s36 offen offset:0 lds
    v_cvt_pk_bf16_f32 v226, v228, v229
    v_cvt_pk_bf16_f32 v227, v230, v231
    v_fma_f32 v232, v232, s76, -v188
    v_fma_f32 v233, v233, s76, -v188
    v_fma_f32 v234, v234, s76, -v188
    v_fma_f32 v235, v235, s76, -v188
    v_fma_f32 v236, v236, s76, -v188
    buffer_load_dwordx4 v8, s[12:15], s36 offen offset:1024 lds
    v_fma_f32 v237, v237, s76, -v188
    v_fma_f32 v238, v238, s76, -v188
    v_fma_f32 v239, v239, s76, -v188
    v_exp_f32 v232, v232
    v_exp_f32 v233, v233
    buffer_load_dwordx4 v8, s[12:15], s36 offen offset:2048 lds
    v_exp_f32 v234, v234
    v_exp_f32 v235, v235
    v_exp_f32 v236, v236
    v_exp_f32 v237, v237
    buffer_load_dwordx4 v8, s[12:15], s36 offen offset:3072 lds
    v_exp_f32 v238, v238
    v_exp_f32 v239, v239
    v_cvt_pk_bf16_f32 v232, v232, v233
    v_cvt_pk_bf16_f32 v233, v234, v235
    v_cvt_pk_bf16_f32 v234, v236, v237
    s_add_u32 m0, m0, 4096
    s_mov_b32 exec_hi, 0
    buffer_load_dwordx4 v9, s[12:15], s36 offen lds
    s_mov_b32 exec_hi, -1
    v_cvt_pk_bf16_f32 v235, v238, v239
    v_fma_f32 v240, v240, s76, -v188
    v_fma_f32 v241, v241, s76, -v188
    v_fma_f32 v242, v242, s76, -v188
    v_fma_f32 v243, v243, s76, -v188
    v_fma_f32 v244, v244, s76, -v188
    v_fma_f32 v245, v245, s76, -v188
    s_waitcnt vmcnt(18)
    s_barrier
    s_bfe_u32 s37, 0x1b171717, s35
    s_mul_i32 s36, s37, 18432
    s_lshl_b32 s37, s37, 7
    s_add_u32 m0, s34, 0
    s_nop 0
    buffer_load_dwordx4 v4, s[8:11], s37 offen offset:0 lds
    v_fma_f32 v246, v246, s76, -v188
    v_fma_f32 v247, v247, s76, -v188
    v_exp_f32 v240, v240
    v_exp_f32 v241, v241
    v_exp_f32 v242, v242
    buffer_load_dwordx4 v5, s[8:11], s37 offen offset:1024 lds
    v_exp_f32 v243, v243
    v_exp_f32 v244, v244
    v_exp_f32 v245, v245
    v_exp_f32 v246, v246
    buffer_load_dwordx4 v6, s[8:11], s37 offen offset:2048 lds
    v_exp_f32 v247, v247
    v_cvt_pk_bf16_f32 v240, v240, v241
    v_cvt_pk_bf16_f32 v241, v242, v243
    v_cvt_pk_bf16_f32 v242, v244, v245
    v_cvt_pk_bf16_f32 v243, v246, v247
    buffer_load_dwordx4 v7, s[8:11], s37 offen offset:3072 lds
    s_nop 1
    v_mfma_f32_16x16x32_bf16 v[22:25], v[108:111], v[184:187], 0
    v_mfma_f32_16x16x32_bf16 v[26:29], v[144:147], v[184:187], 0
    s_add_u32 m0, s33, 0
    s_nop 0
    buffer_load_dwordx4 v8, s[12:15], s36 offen offset:0 lds
    v_mfma_f32_16x16x32_bf16 v[22:25], v[112:115], v[192:195], v[22:25]
    v_mfma_f32_16x16x32_bf16 v[26:29], v[148:151], v[192:195], v[26:29]
    buffer_load_dwordx4 v8, s[12:15], s36 offen offset:1024 lds
    v_mfma_f32_16x16x32_bf16 v[22:25], v[116:119], v[200:203], v[22:25]
    v_mfma_f32_16x16x32_bf16 v[26:29], v[152:155], v[200:203], v[26:29]
    buffer_load_dwordx4 v8, s[12:15], s36 offen offset:2048 lds
    v_mfma_f32_16x16x32_bf16 v[22:25], v[120:123], v[208:211], v[22:25]
    v_mfma_f32_16x16x32_bf16 v[26:29], v[156:159], v[208:211], v[26:29]
    buffer_load_dwordx4 v8, s[12:15], s36 offen offset:3072 lds
    v_mfma_f32_16x16x32_bf16 v[22:25], v[124:127], v[216:219], v[22:25]
    v_mfma_f32_16x16x32_bf16 v[26:29], v[160:163], v[216:219], v[26:29]
    s_add_u32 m0, m0, 4096
    s_mov_b32 exec_hi, 0
    buffer_load_dwordx4 v9, s[12:15], s36 offen lds
    s_mov_b32 exec_hi, -1
    v_mfma_f32_16x16x32_bf16 v[22:25], v[128:131], v[224:227], v[22:25]
    s_waitcnt vmcnt(18)
    s_barrier
    s_bfe_u32 s37, 0x1818181c, s35
    s_mul_i32 s36, s37, 18432
    s_lshl_b32 s37, s37, 7
    s_add_u32 m0, s34, 34816
    s_nop 0
    buffer_load_dwordx4 v4, s[8:11], s37 offen offset:0 lds
    v_mfma_f32_16x16x32_bf16 v[26:29], v[164:167], v[224:227], v[26:29]
    v_mfma_f32_16x16x32_bf16 v[22:25], v[132:135], v[232:235], v[22:25]
    buffer_load_dwordx4 v5, s[8:11], s37 offen offset:1024 lds
    v_mfma_f32_16x16x32_bf16 v[26:29], v[168:171], v[232:235], v[26:29]
    v_mfma_f32_16x16x32_bf16 v[22:25], v[136:139], v[240:243], v[22:25]
    buffer_load_dwordx4 v6, s[8:11], s37 offen offset:2048 lds
    v_mfma_f32_16x16x32_bf16 v[26:29], v[172:175], v[240:243], v[26:29]
    v_mfma_f32_16x16x32_bf16 v[22:25], v[104:107], v[248:251], v[22:25]
    buffer_load_dwordx4 v7, s[8:11], s37 offen offset:3072 lds
    v_mfma_f32_16x16x32_bf16 v[26:29], v[140:143], v[248:251], v[26:29]
    s_nop 7
    s_nop 1
    v_rcp_f32 v28, v28
    s_nop 0
    s_add_u32 m0, s33, 34816
    s_nop 0
    buffer_load_dwordx4 v8, s[12:15], s36 offen offset:0 lds
    v_mul_f32 v22, v22, v28
    v_mul_f32 v23, v23, v28
    v_mul_f32 v24, v24, v28
    v_mul_f32 v25, v25, v28
    v_mul_f32 v26, v26, v28
    v_mul_f32 v27, v27, v28
    v_cvt_pk_bf16_f32 v18, v22, v23
    buffer_load_dwordx4 v8, s[12:15], s36 offen offset:1024 lds
    v_cvt_pk_bf16_f32 v19, v24, v25
    v_cvt_pk_bf16_f32 v30, v26, v27
    s_mov_b64 exec, 0xffff
    buffer_store_dword v30, v0, s[16:19], s39 offen offset:0 sc1
    s_mov_b64 exec, -1
    v_mfma_f32_16x16x32_bf16 v[184:187], v[40:43], v[180:183], 0
    v_mfma_f32_16x16x32_bf16 v[188:191], v[44:47], v[180:183], 0
    buffer_load_dwordx4 v8, s[12:15], s36 offen offset:2048 lds
    v_mfma_f32_16x16x32_bf16 v[192:195], v[48:51], v[180:183], 0
    v_mfma_f32_16x16x32_bf16 v[196:199], v[52:55], v[180:183], 0
    buffer_load_dwordx4 v8, s[12:15], s36 offen offset:3072 lds
    v_mfma_f32_16x16x32_bf16 v[200:203], v[56:59], v[180:183], 0
    s_add_u32 m0, m0, 4096
    s_mov_b32 exec_hi, 0
    buffer_load_dwordx4 v9, s[12:15], s36 offen lds
    s_mov_b32 exec_hi, -1
    v_mfma_f32_16x16x32_bf16 v[204:207], v[60:63], v[180:183], 0
    v_mfma_f32_16x16x32_bf16 v[208:211], v[64:67], v[180:183], 0
    s_waitcnt vmcnt(19)
    s_barrier
    s_bfe_u32 s37, 0x19191d19, s35
    s_mul_i32 s36, s37, 18432
    s_lshl_b32 s37, s37, 7
    s_add_u32 m0, s34, 69632
    s_nop 0
    buffer_load_dwordx4 v4, s[8:11], s37 offen offset:0 lds
    v_mfma_f32_16x16x32_bf16 v[212:215], v[68:71], v[180:183], 0
    v_mfma_f32_16x16x32_bf16 v[216:219], v[72:75], v[180:183], 0
    buffer_load_dwordx4 v5, s[8:11], s37 offen offset:1024 lds
    v_mfma_f32_16x16x32_bf16 v[220:223], v[76:79], v[180:183], 0
    v_mfma_f32_16x16x32_bf16 v[224:227], v[80:83], v[180:183], 0
    buffer_load_dwordx4 v6, s[8:11], s37 offen offset:2048 lds
    v_mfma_f32_16x16x32_bf16 v[228:231], v[84:87], v[180:183], 0
    v_mfma_f32_16x16x32_bf16 v[232:235], v[88:91], v[180:183], 0
    buffer_load_dwordx4 v7, s[8:11], s37 offen offset:3072 lds
    v_mfma_f32_16x16x32_bf16 v[236:239], v[92:95], v[180:183], 0
    v_mfma_f32_16x16x32_bf16 v[240:243], v[96:99], v[180:183], 0
    s_add_u32 m0, s33, 69632
    s_nop 0
    buffer_load_dwordx4 v8, s[12:15], s36 offen offset:0 lds
    v_mfma_f32_16x16x32_bf16 v[244:247], v[100:103], v[180:183], 0
    v_mfma_f32_16x16x32_bf16 v[248:251], v[32:35], v[180:183], 0
    buffer_load_dwordx4 v8, s[12:15], s36 offen offset:1024 lds
    v_mfma_f32_16x16x32_bf16 v[252:255], v[36:39], v[180:183], 0
    buffer_load_dwordx4 v8, s[12:15], s36 offen offset:2048 lds
    s_nop 7
    v_cndmask_b32 v248, v184, v248, s[50:51]
    v_cndmask_b32 v249, v185, v249, s[52:53]
    v_cndmask_b32 v250, v186, v250, s[54:55]
    v_cndmask_b32 v251, v187, v251, s[56:57]
    v_cndmask_b32 v252, v188, v252, s[58:59]
    v_cndmask_b32 v253, v189, v253, s[60:61]
    v_cndmask_b32 v254, v190, v254, s[62:63]
    v_cndmask_b32 v255, v191, v255, s[64:65]
    buffer_load_dwordx4 v8, s[12:15], s36 offen offset:3072 lds
    v_max3_f32 v188, v192, v193, v194
    v_max3_f32 v189, v208, v209, v210
    v_max3_f32 v190, v224, v225, v226
    v_max3_f32 v191, v240, v241, v242
    v_max3_f32 v188, v188, v195, v196
    v_max3_f32 v189, v189, v211, v212
    v_max3_f32 v190, v190, v227, v228
    s_add_u32 m0, m0, 4096
    s_mov_b32 exec_hi, 0
    buffer_load_dwordx4 v9, s[12:15], s36 offen lds
    s_mov_b32 exec_hi, -1
    v_max3_f32 v191, v191, v243, v244
    v_max3_f32 v188, v188, v197, v198
    v_max3_f32 v189, v189, v213, v214
    v_max3_f32 v190, v190, v229, v230
    v_max3_f32 v191, v191, v245, v246
    v_max3_f32 v188, v188, v199, v200
    v_max3_f32 v189, v189, v215, v216
    s_waitcnt vmcnt(19)
    s_barrier
    s_bfe_u32 s37, 0x1a1e1a1a, s35
    s_mul_i32 s36, s37, 18432
    s_lshl_b32 s37, s37, 7
    s_add_u32 m0, s34, 104448
    s_nop 0
    buffer_load_dwordx4 v4, s[8:11], s37 offen offset:0 lds
    v_max3_f32 v190, v190, v231, v232
    v_max3_f32 v191, v191, v247, v248
    v_max3_f32 v188, v188, v201, v202
    v_max3_f32 v189, v189, v217, v218
    v_max3_f32 v190, v190, v233, v234
    v_max3_f32 v191, v191, v249, v250
    v_max3_f32 v188, v188, v203, v204
    v_max3_f32 v189, v189, v219, v220
    buffer_load_dwordx4 v5, s[8:11], s37 offen offset:1024 lds
    v_max3_f32 v190, v190, v235, v236
    v_max3_f32 v191, v191, v251, v252
    v_max3_f32 v188, v188, v205, v206
    v_max3_f32 v189, v189, v221, v222
    v_max3_f32 v190, v190, v237, v238
    v_max3_f32 v191, v191, v253, v254
    v_max3_f32 v188, v188, v207, v223
    buffer_load_dwordx4 v6, s[8:11], s37 offen offset:2048 lds
    v_max3_f32 v190, v190, v239, v255
    v_max3_f32 v188, v188, v189, v191
    v_max_f32 v188, v188, v190
    v_mov_b32 v189, v188
    s_nop 1
    v_permlane16_swap_b32 v188, v189
    v_max_f32 v188, v188, v189
    v_mov_b32 v189, v188
    s_nop 1
    v_permlane32_swap_b32 v188, v189
    buffer_load_dwordx4 v7, s[8:11], s37 offen offset:3072 lds
    v_max_f32 v188, v188, v189
    v_mul_f32 v188, s76, v188
    v_fma_f32 v248, v248, s76, -v188
    v_fma_f32 v249, v249, s76, -v188
    v_fma_f32 v250, v250, s76, -v188
    v_fma_f32 v251, v251, s76, -v188
    v_fma_f32 v252, v252, s76, -v188
    s_add_u32 m0, s33, 104448
    s_nop 0
    buffer_load_dwordx4 v8, s[12:15], s36 offen offset:0 lds
    v_fma_f32 v253, v253, s76, -v188
    v_fma_f32 v254, v254, s76, -v188
    v_fma_f32 v255, v255, s76, -v188
    v_exp_f32 v248, v248
    v_exp_f32 v249, v249
    buffer_load_dwordx4 v8, s[12:15], s36 offen offset:1024 lds
    v_exp_f32 v250, v250
    v_exp_f32 v251, v251
    v_exp_f32 v252, v252
    v_exp_f32 v253, v253
    buffer_load_dwordx4 v8, s[12:15], s36 offen offset:2048 lds
    v_exp_f32 v254, v254
    v_exp_f32 v255, v255
    v_cvt_pk_bf16_f32 v248, v248, v249
    v_cvt_pk_bf16_f32 v249, v250, v251
    v_cvt_pk_bf16_f32 v250, v252, v253
    buffer_load_dwordx4 v8, s[12:15], s36 offen offset:3072 lds
    v_cvt_pk_bf16_f32 v251, v254, v255
    v_bfi_b32 v184, v14, 0, v248
    v_bfi_b32 v185, v15, 0, v249
    v_bfi_b32 v186, v16, 0, v250
    v_bfi_b32 v187, v17, 0, v251
    v_and_b32 v248, v14, v248
    v_and_b32 v249, v15, v249
    s_add_u32 m0, m0, 4096
    s_mov_b32 exec_hi, 0
    buffer_load_dwordx4 v9, s[12:15], s36 offen lds
    s_mov_b32 exec_hi, -1
    v_and_b32 v250, v16, v250
    v_and_b32 v251, v17, v251
    v_fma_f32 v192, v192, s76, -v188
    v_fma_f32 v193, v193, s76, -v188
    v_fma_f32 v194, v194, s76, -v188
    v_fma_f32 v195, v195, s76, -v188
    v_fma_f32 v196, v196, s76, -v188
    s_waitcnt vmcnt(18)
    s_barrier
    s_bfe_u32 s37, 0x1f1b1b1b, s35
    s_mul_i32 s36, s37, 18432
    s_lshl_b32 s37, s37, 7
    s_add_u32 m0, s34, 0
    s_nop 0
    buffer_load_dwordx4 v4, s[8:11], s37 offen offset:0 lds
    v_fma_f32 v197, v197, s76, -v188
    v_fma_f32 v198, v198, s76, -v188
    v_fma_f32 v199, v199, s76, -v188
    v_exp_f32 v192, v192
    v_exp_f32 v193, v193
    v_exp_f32 v194, v194
    buffer_load_dwordx4 v5, s[8:11], s37 offen offset:1024 lds
    v_exp_f32 v195, v195
    v_exp_f32 v196, v196
    v_exp_f32 v197, v197
    buffer_load_dwordx4 v6, s[8:11], s37 offen offset:2048 lds
    v_exp_f32 v198, v198
    v_exp_f32 v199, v199
    v_cvt_pk_bf16_f32 v192, v192, v193
    v_cvt_pk_bf16_f32 v193, v194, v195
    v_cvt_pk_bf16_f32 v194, v196, v197
    buffer_load_dwordx4 v7, s[8:11], s37 offen offset:3072 lds
    v_cvt_pk_bf16_f32 v195, v198, v199
    v_fma_f32 v200, v200, s76, -v188
    v_fma_f32 v201, v201, s76, -v188
    v_fma_f32 v202, v202, s76, -v188
    v_fma_f32 v203, v203, s76, -v188
    v_fma_f32 v204, v204, s76, -v188
    v_fma_f32 v205, v205, s76, -v188
    v_fma_f32 v206, v206, s76, -v188
    s_add_u32 m0, s33, 0
    s_nop 0
    buffer_load_dwordx4 v8, s[12:15], s36 offen offset:0 lds
    v_fma_f32 v207, v207, s76, -v188
    v_exp_f32 v200, v200
    v_exp_f32 v201, v201
    v_exp_f32 v202, v202
    buffer_load_dwordx4 v8, s[12:15], s36 offen offset:1024 lds
    v_exp_f32 v203, v203
    v_exp_f32 v204, v204
    v_exp_f32 v205, v205
    v_exp_f32 v206, v206
    buffer_load_dwordx4 v8, s[12:15], s36 offen offset:2048 lds
    v_exp_f32 v207, v207
    v_cvt_pk_bf16_f32 v200, v200, v201
    v_cvt_pk_bf16_f32 v201, v202, v203
    v_cvt_pk_bf16_f32 v202, v204, v205
    v_cvt_pk_bf16_f32 v203, v206, v207
    v_fma_f32 v208, v208, s76, -v188
    buffer_load_dwordx4 v8, s[12:15], s36 offen offset:3072 lds
    v_fma_f32 v209, v209, s76, -v188
    v_fma_f32 v210, v210, s76, -v188
    v_fma_f32 v211, v211, s76, -v188
    v_fma_f32 v212, v212, s76, -v188
    v_fma_f32 v213, v213, s76, -v188
    v_fma_f32 v214, v214, s76, -v188
    v_fma_f32 v215, v215, s76, -v188
    s_add_u32 m0, m0, 4096
    s_mov_b32 exec_hi, 0
    buffer_load_dwordx4 v9, s[12:15], s36 offen lds
    s_mov_b32 exec_hi, -1
    v_exp_f32 v208, v208
    v_exp_f32 v209, v209
    v_exp_f32 v210, v210
    v_exp_f32 v211, v211
    s_waitcnt vmcnt(18)
    s_barrier
    s_bfe_u32 s37, 0x1c1c1c1d, s35
    s_mul_i32 s36, s37, 18432
    s_lshl_b32 s37, s37, 7
    s_add_u32 m0, s34, 34816
    s_nop 0
    buffer_load_dwordx4 v4, s[8:11], s37 offen offset:0 lds
    v_exp_f32 v212, v212
    v_exp_f32 v213, v213
    v_exp_f32 v214, v214
    v_exp_f32 v215, v215
    buffer_load_dwordx4 v5, s[8:11], s37 offen offset:1024 lds
    v_cvt_pk_bf16_f32 v208, v208, v209
    v_cvt_pk_bf16_f32 v209, v210, v211
    v_cvt_pk_bf16_f32 v210, v212, v213
    v_cvt_pk_bf16_f32 v211, v214, v215
    v_fma_f32 v216, v216, s76, -v188
    v_fma_f32 v217, v217, s76, -v188
    v_fma_f32 v218, v218, s76, -v188
    buffer_load_dwordx4 v6, s[8:11], s37 offen offset:2048 lds
    v_fma_f32 v219, v219, s76, -v188
    v_fma_f32 v220, v220, s76, -v188
    v_fma_f32 v221, v221, s76, -v188
    v_fma_f32 v222, v222, s76, -v188
    v_fma_f32 v223, v223, s76, -v188
    v_exp_f32 v216, v216
    buffer_load_dwordx4 v7, s[8:11], s37 offen offset:3072 lds
    v_exp_f32 v217, v217
    v_exp_f32 v218, v218
    v_exp_f32 v219, v219
    v_exp_f32 v220, v220
    s_add_u32 m0, s33, 34816
    s_nop 0
    buffer_load_dwordx4 v8, s[12:15], s36 offen offset:0 lds
    v_exp_f32 v221, v221
    v_exp_f32 v222, v222
    v_exp_f32 v223, v223
    v_cvt_pk_bf16_f32 v216, v216, v217
    buffer_load_dwordx4 v8, s[12:15], s36 offen offset:1024 lds
    v_cvt_pk_bf16_f32 v217, v218, v219
    v_cvt_pk_bf16_f32 v218, v220, v221
    v_cvt_pk_bf16_f32 v219, v222, v223
    v_fma_f32 v224, v224, s76, -v188
    v_fma_f32 v225, v225, s76, -v188
    v_fma_f32 v226, v226, s76, -v188
    v_fma_f32 v227, v227, s76, -v188
    buffer_load_dwordx4 v8, s[12:15], s36 offen offset:2048 lds
    v_fma_f32 v228, v228, s76, -v188
    v_fma_f32 v229, v229, s76, -v188
    v_fma_f32 v230, v230, s76, -v188
    v_fma_f32 v231, v231, s76, -v188
    v_exp_f32 v224, v224
    v_exp_f32 v225, v225
    buffer_load_dwordx4 v8, s[12:15], s36 offen offset:3072 lds
    v_exp_f32 v226, v226
    v_exp_f32 v227, v227
    v_exp_f32 v228, v228
    v_exp_f32 v229, v229
    s_add_u32 m0, m0, 4096
    s_mov_b32 exec_hi, 0
    buffer_load_dwordx4 v9, s[12:15], s36 offen lds
    s_mov_b32 exec_hi, -1
    v_exp_f32 v230, v230
    v_exp_f32 v231, v231
    v_cvt_pk_bf16_f32 v224, v224, v225
    v_cvt_pk_bf16_f32 v225, v226, v227
    s_waitcnt vmcnt(18)
    s_barrier
    s_bfe_u32 s37, 0x1d1d1e1e, s35
    s_mul_i32 s36, s37, 18432
    s_lshl_b32 s37, s37, 7
    s_add_u32 m0, s34, 69632
    s_nop 0
    buffer_load_dwordx4 v4, s[8:11], s37 offen offset:0 lds
    v_cvt_pk_bf16_f32 v226, v228, v229
    v_cvt_pk_bf16_f32 v227, v230, v231
    v_fma_f32 v232, v232, s76, -v188
    v_fma_f32 v233, v233, s76, -v188
    v_fma_f32 v234, v234, s76, -v188
    v_fma_f32 v235, v235, s76, -v188
    v_fma_f32 v236, v236, s76, -v188
    v_fma_f32 v237, v237, s76, -v188
    buffer_load_dwordx4 v5, s[8:11], s37 offen offset:1024 lds
    v_fma_f32 v238, v238, s76, -v188
    v_fma_f32 v239, v239, s76, -v188
    v_exp_f32 v232, v232
    v_exp_f32 v233, v233
    v_exp_f32 v234, v234
    buffer_load_dwordx4 v6, s[8:11], s37 offen offset:2048 lds
    v_exp_f32 v235, v235
    v_exp_f32 v236, v236
    v_exp_f32 v237, v237
    buffer_load_dwordx4 v7, s[8:11], s37 offen offset:3072 lds
    v_exp_f32 v238, v238
    v_exp_f32 v239, v239
    v_cvt_pk_bf16_f32 v232, v232, v233
    v_cvt_pk_bf16_f32 v233, v234, v235
    v_cvt_pk_bf16_f32 v234, v236, v237
    v_cvt_pk_bf16_f32 v235, v238, v239
    s_add_u32 m0, s33, 69632
    s_nop 0
    buffer_load_dwordx4 v8, s[12:15], s36 offen offset:0 lds
    v_fma_f32 v240, v240, s76, -v188
    v_fma_f32 v241, v241, s76, -v188
    v_fma_f32 v242, v242, s76, -v188
    v_fma_f32 v243, v243, s76, -v188
    v_fma_f32 v244, v244, s76, -v188
    v_fma_f32 v245, v245, s76, -v188
    v_fma_f32 v246, v246, s76, -v188
    buffer_load_dwordx4 v8, s[12:15], s36 offen offset:1024 lds
    v_fma_f32 v247, v247, s76, -v188
    v_exp_f32 v240, v240
    v_exp_f32 v241, v241
    v_exp_f32 v242, v242
    buffer_load_dwordx4 v8, s[12:15], s36 offen offset:2048 lds
    v_exp_f32 v243, v243
    v_exp_f32 v244, v244
    v_exp_f32 v245, v245
    v_exp_f32 v246, v246
    buffer_load_dwordx4 v8, s[12:15], s36 offen offset:3072 lds
    v_exp_f32 v247, v247
    v_cvt_pk_bf16_f32 v240, v240, v241
    v_cvt_pk_bf16_f32 v241, v242, v243
    v_cvt_pk_bf16_f32 v242, v244, v245
    v_cvt_pk_bf16_f32 v243, v246, v247
    s_nop 1
    v_mfma_f32_16x16x32_bf16 v[22:25], v[108:111], v[184:187], 0
    s_add_u32 m0, m0, 4096
    s_mov_b32 exec_hi, 0
    buffer_load_dwordx4 v9, s[12:15], s36 offen lds
    s_mov_b32 exec_hi, -1
    v_mfma_f32_16x16x32_bf16 v[26:29], v[144:147], v[184:187], 0
    s_waitcnt vmcnt(18)
    s_barrier
    s_bfe_u32 s37, 0x1e1f1f1f, s35
    s_mul_i32 s36, s37, 18432
    s_lshl_b32 s37, s37, 7
    s_add_u32 m0, s34, 104448
    s_nop 0
    buffer_load_dwordx4 v4, s[8:11], s37 offen offset:0 lds
    v_mfma_f32_16x16x32_bf16 v[22:25], v[112:115], v[192:195], v[22:25]
    v_mfma_f32_16x16x32_bf16 v[26:29], v[148:151], v[192:195], v[26:29]
    buffer_load_dwordx4 v5, s[8:11], s37 offen offset:1024 lds
    v_mfma_f32_16x16x32_bf16 v[22:25], v[116:119], v[200:203], v[22:25]
    v_mfma_f32_16x16x32_bf16 v[26:29], v[152:155], v[200:203], v[26:29]
    buffer_load_dwordx4 v6, s[8:11], s37 offen offset:2048 lds
    v_mfma_f32_16x16x32_bf16 v[22:25], v[120:123], v[208:211], v[22:25]
    v_mfma_f32_16x16x32_bf16 v[26:29], v[156:159], v[208:211], v[26:29]
    buffer_load_dwordx4 v7, s[8:11], s37 offen offset:3072 lds
    v_mfma_f32_16x16x32_bf16 v[22:25], v[124:127], v[216:219], v[22:25]
    v_mfma_f32_16x16x32_bf16 v[26:29], v[160:163], v[216:219], v[26:29]
    s_add_u32 m0, s33, 104448
    s_nop 0
    buffer_load_dwordx4 v8, s[12:15], s36 offen offset:0 lds
    v_mfma_f32_16x16x32_bf16 v[22:25], v[128:131], v[224:227], v[22:25]
    v_mfma_f32_16x16x32_bf16 v[26:29], v[164:167], v[224:227], v[26:29]
    buffer_load_dwordx4 v8, s[12:15], s36 offen offset:1024 lds
    v_mfma_f32_16x16x32_bf16 v[22:25], v[132:135], v[232:235], v[22:25]
    buffer_load_dwordx4 v8, s[12:15], s36 offen offset:2048 lds
    v_mfma_f32_16x16x32_bf16 v[26:29], v[168:171], v[232:235], v[26:29]
    v_mfma_f32_16x16x32_bf16 v[22:25], v[136:139], v[240:243], v[22:25]
    buffer_load_dwordx4 v8, s[12:15], s36 offen offset:3072 lds
    v_mfma_f32_16x16x32_bf16 v[26:29], v[172:175], v[240:243], v[26:29]
    v_mfma_f32_16x16x32_bf16 v[22:25], v[104:107], v[248:251], v[22:25]
    s_add_u32 m0, m0, 4096
    s_mov_b32 exec_hi, 0
    buffer_load_dwordx4 v9, s[12:15], s36 offen lds
    s_mov_b32 exec_hi, -1
    v_mfma_f32_16x16x32_bf16 v[26:29], v[140:143], v[248:251], v[26:29]
    s_nop 7
    s_nop 1
    v_rcp_f32 v28, v28
    s_nop 0
    s_waitcnt vmcnt(18)
    s_barrier
    v_mul_f32 v22, v22, v28
    v_mul_f32 v23, v23, v28
    v_mul_f32 v24, v24, v28
    v_mul_f32 v25, v25, v28
    v_mul_f32 v26, v26, v28
    v_mul_f32 v27, v27, v28
    v_cvt_pk_bf16_f32 v20, v22, v23
    v_cvt_pk_bf16_f32 v21, v24, v25
    v_cvt_pk_bf16_f32 v31, v26, v27
    s_mov_b64 exec, 0xffff
    buffer_store_dword v31, v0, s[16:19], s39 offen offset:1024 sc1
    s_mov_b64 exec, -1
    buffer_store_dwordx4 v[18:21], v0, s[16:19], s7 offen sc1
    s_waitcnt vmcnt(11)
    s_barrier
    s_waitcnt vmcnt(2)
    s_barrier
    s_endpgm
g2_end:
    s_endpgm
.globl g3_kernel
.p2align 8
.type g3_kernel,@function
g3_kernel:
    s_cmp_ge_u32 s2, 256
    s_cbranch_scc1 g3_end
    s_load_dwordx2 s[8:9], s[0:1], 80
    s_load_dwordx2 s[24:25], s[0:1], 0
    s_load_dwordx2 s[28:29], s[0:1], 64
    v_lshrrev_b32 v1, 6, v0
    v_and_b32 v2, 63, v0
    s_nop 0
    v_readfirstlane_b32 s3, v1
    s_and_b32 s4, s2, 1
    s_lshl_b32 s4, s4, 4
    s_bfe_u32 s6, s2, 0x10001
    s_lshl_b32 s6, s6, 3
    s_add_u32 s4, s4, s6
    s_bfe_u32 s6, s2, 0x30003
    s_add_u32 s4, s4, s6
    s_bfe_u32 s5, s2, 0x10002
    s_lshl_b32 s5, s5, 2
    s_lshr_b32 s6, s2, 6
    s_add_u32 s5, s5, s6
    v_lshlrev_b32 v3, 4, v2
    v_lshrrev_b32 v4, 4, v2
    v_lshlrev_b32 v4, 3, v4
    v_and_b32 v5, 7, v2
    v_add_u32 v4, v4, v5
    v_lshlrev_b32 v4, 4, v4
    v_add_u32 v4, 4096, v4
    v_bfe_u32 v5, v2, 3, 1
    v_mul_u32_u24 v5, 4608, v5
    v_add_u32 v4, v4, v5
    s_lshl_b32 s6, s4, 5
    s_lshl_b32 s7, s3, 2
    s_add_u32 s6, s6, s7
    s_mul_i32 s6, s6, 9216
    v_add_u32 v5, s6, v3
    v_add_u32 v6, 147456, v5
    s_lshl_b32 s6, s4, 6
    s_lshl_b32 s7, s3, 3
    s_add_u32 s6, s6, s7
    s_lshl_b32 s6, s6, 10
    v_add_u32 v7, s6, v3
    v_add_u32 v8, 32768, v7
    s_lshl_b32 s6, s4, 3
    s_lshl_b32 s7, s3, 1
    s_add_u32 s6, s6, s7
    s_lshl_b32 s6, s6, 10
    v_add_u32 v9, s6, v3
    v_add_u32 v10, 4096, v9
    s_lshl_b32 s6, s5, 2
    s_add_u32 s6, s6, s3
    s_mul_i32 s32, s6, 105984
    v_and_b32 v11, 15, v2
    v_lshrrev_b32 v12, 2, v11
    v_lshlrev_b32 v12, 3, v12
    v_and_b32 v11, 3, v11
    v_add_u32 v11, v11, v12
    s_lshl_b32 s6, s4, 6
    s_lshr_b32 s7, s3, 1
    s_lshl_b32 s7, s7, 5
    s_add_u32 s6, s6, s7
    s_and_b32 s7, s3, 1
    s_lshl_b32 s7, s7, 2
    s_add_u32 s6, s6, s7
    v_add_u32 v11, s6, v11
    v_mul_u32_u24 v11, 1152, v11
    s_mul_i32 s6, s5, 144
    v_add_u32 v11, s6, v11
    v_lshrrev_b32 v12, 4, v2
    v_lshlrev_b32 v13, 3, v12
    v_add_u32 v13, v13, v11
    v_lshlrev_b32 v12, 4, v12
    v_add_u32 v12, v12, v11
    s_waitcnt lgkmcnt(0)
    s_mov_b64 s[12:13], s[8:9]
    s_mov_b64 s[16:17], s[8:9]
    s_mov_b64 s[20:21], s[8:9]
    s_add_u32 s8, s8, 31457280
    s_addc_u32 s9, s9, 0
    s_and_b32 s9, s9, 0xffff
    s_mov_b32 s10, 9437184
    s_mov_b32 s11, 0x00020000
    s_add_u32 s12, s12, 56623104
    s_addc_u32 s13, s13, 0
    s_and_b32 s13, s13, 0xffff
    s_mov_b32 s14, 3391488
    s_mov_b32 s15, 0x00020000
    s_add_u32 s16, s16, 53477376
    s_addc_u32 s17, s17, 0
    s_and_b32 s17, s17, 0xffff
    s_mov_b32 s18, 2097152
    s_mov_b32 s19, 0x00020000
    s_add_u32 s20, s20, 55574528
    s_addc_u32 s21, s21, 0
    s_and_b32 s21, s21, 0xffff
    s_mov_b32 s22, 262144
    s_mov_b32 s23, 0x00020000
    s_and_b32 s25, s25, 0xffff
    s_mov_b32 s26, 2359296
    s_mov_b32 s27, 0x00020000
    s_and_b32 s29, s29, 0xffff
    s_mov_b32 s30, 2359296
    s_mov_b32 s31, 0x00020000
    buffer_load_dwordx4 v[16:19], v12, s[24:27], 0 offen
    buffer_load_dwordx4 v[20:23], v12, s[24:27], 0 offen offset:64
    buffer_load_dwordx2 v[24:25], v13, s[24:27], 0 offen offset:128
    s_cmp_ge_u32 s3, 2
    s_cbranch_scc1 g3_no0
    buffer_load_dwordx4 v[44:47], v9, s[20:23], 0 offen offset:0
    buffer_load_dwordx4 v[48:51], v9, s[20:23], 0 offen offset:1024
    buffer_load_dwordx4 v[52:55], v10, s[20:23], 0 offen offset:0
    buffer_load_dwordx4 v[56:59], v10, s[20:23], 0 offen offset:1024
    s_add_u32 s40, s32, 0
    buffer_load_dwordx4 v[60:63], v3, s[12:15], s40 offen offset:0
    buffer_load_dwordx4 v[64:67], v3, s[12:15], s40 offen offset:1024
    buffer_load_dwordx4 v[68:71], v3, s[12:15], s40 offen offset:2048
    buffer_load_dwordx4 v[72:75], v3, s[12:15], s40 offen offset:3072
    buffer_load_dwordx4 v[28:31], v4, s[12:15], s40 offen
g3_no0:
g3_c0:
    buffer_load_dwordx4 v[76:79], v5, s[8:11], 0 offen offset:0
    buffer_load_dwordx4 v[80:83], v5, s[8:11], 0 offen offset:1024
    buffer_load_dwordx4 v[84:87], v6, s[8:11], 0 offen offset:0
    buffer_load_dwordx4 v[88:91], v6, s[8:11], 0 offen offset:1024
    s_add_u32 s41, s32, 4608
    buffer_load_dwordx4 v[92:95], v3, s[12:15], s41 offen offset:0
    buffer_load_dwordx4 v[96:99], v3, s[12:15], s41 offen offset:1024
    buffer_load_dwordx4 v[100:103], v3, s[12:15], s41 offen offset:2048
    buffer_load_dwordx4 v[104:107], v3, s[12:15], s41 offen offset:3072
    buffer_load_dwordx4 v[32:35], v4, s[12:15], s41 offen
    v_accvgpr_write_b32 a0, 0
    v_accvgpr_write_b32 a1, 0
    v_accvgpr_write_b32 a2, 0
    v_accvgpr_write_b32 a3, 0
    v_accvgpr_write_b32 a4, 0
    v_accvgpr_write_b32 a5, 0
    v_accvgpr_write_b32 a6, 0
    v_accvgpr_write_b32 a7, 0
    v_accvgpr_write_b32 a8, 0
    v_accvgpr_write_b32 a9, 0
    v_accvgpr_write_b32 a10, 0
    v_accvgpr_write_b32 a11, 0
    v_accvgpr_write_b32 a12, 0
    v_accvgpr_write_b32 a13, 0
    v_accvgpr_write_b32 a14, 0
    v_accvgpr_write_b32 a15, 0
    v_accvgpr_write_b32 a16, 0
    v_accvgpr_write_b32 a17, 0
    v_accvgpr_write_b32 a18, 0
    v_accvgpr_write_b32 a19, 0
    v_accvgpr_write_b32 a20, 0
    v_accvgpr_write_b32 a21, 0
    v_accvgpr_write_b32 a22, 0
    v_accvgpr_write_b32 a23, 0
    v_accvgpr_write_b32 a24, 0
    v_accvgpr_write_b32 a25, 0
    v_accvgpr_write_b32 a26, 0
    v_accvgpr_write_b32 a27, 0
    v_accvgpr_write_b32 a28, 0
    v_accvgpr_write_b32 a29, 0
    v_accvgpr_write_b32 a30, 0
    v_accvgpr_write_b32 a31, 0
    v_accvgpr_write_b32 a32, 0
    v_accvgpr_write_b32 a33, 0
    v_accvgpr_write_b32 a34, 0
    v_accvgpr_write_b32 a35, 0
    v_accvgpr_write_b32 a36, 0
    v_accvgpr_write_b32 a37, 0
    v_accvgpr_write_b32 a38, 0
    v_accvgpr_write_b32 a39, 0
    v_accvgpr_write_b32 a40, 0
    v_accvgpr_write_b32 a41, 0
    v_accvgpr_write_b32 a42, 0
    v_accvgpr_write_b32 a43, 0
    v_accvgpr_write_b32 a44, 0
    v_accvgpr_write_b32 a45, 0
    v_accvgpr_write_b32 a46, 0
    v_accvgpr_write_b32 a47, 0
    v_accvgpr_write_b32 a48, 0
    v_accvgpr_write_b32 a49, 0
    v_accvgpr_write_b32 a50, 0
    v_accvgpr_write_b32 a51, 0
    v_accvgpr_write_b32 a52, 0
    v_accvgpr_write_b32 a53, 0
    v_accvgpr_write_b32 a54, 0
    v_accvgpr_write_b32 a55, 0
    v_accvgpr_write_b32 a56, 0
    v_accvgpr_write_b32 a57, 0
    v_accvgpr_write_b32 a58, 0
    v_accvgpr_write_b32 a59, 0
    v_accvgpr_write_b32 a60, 0
    v_accvgpr_write_b32 a61, 0
    v_accvgpr_write_b32 a62, 0
    v_accvgpr_write_b32 a63, 0
    v_accvgpr_write_b32 a64, 0
    v_accvgpr_write_b32 a65, 0
    v_accvgpr_write_b32 a66, 0
    v_accvgpr_write_b32 a67, 0
    v_accvgpr_write_b32 a68, 0
    v_accvgpr_write_b32 a69, 0
    v_accvgpr_write_b32 a70, 0
    v_accvgpr_write_b32 a71, 0
    v_accvgpr_write_b32 a72, 0
    v_accvgpr_write_b32 a73, 0
    v_accvgpr_write_b32 a74, 0
    v_accvgpr_write_b32 a75, 0
    v_accvgpr_write_b32 a76, 0
    v_accvgpr_write_b32 a77, 0
    v_accvgpr_write_b32 a78, 0
    v_accvgpr_write_b32 a79, 0
    v_accvgpr_write_b32 a80, 0
    v_accvgpr_write_b32 a81, 0
    v_accvgpr_write_b32 a82, 0
    v_accvgpr_write_b32 a83, 0
    v_accvgpr_write_b32 a84, 0
    v_accvgpr_write_b32 a85, 0
    v_accvgpr_write_b32 a86, 0
    v_accvgpr_write_b32 a87, 0
    v_accvgpr_write_b32 a88, 0
    v_accvgpr_write_b32 a89, 0
    v_accvgpr_write_b32 a90, 0
    v_accvgpr_write_b32 a91, 0
    v_accvgpr_write_b32 a92, 0
    v_accvgpr_write_b32 a93, 0
    v_accvgpr_write_b32 a94, 0
    v_accvgpr_write_b32 a95, 0
    s_mov_b32 s42, 2048
    buffer_load_dwordx4 v[108:111], v5, s[8:11], s42 offen offset:0
    buffer_load_dwordx4 v[112:115], v5, s[8:11], s42 offen offset:1024
    buffer_load_dwordx4 v[116:119], v6, s[8:11], s42 offen offset:0
    buffer_load_dwordx4 v[120:123], v6, s[8:11], s42 offen offset:1024
    s_add_u32 s43, s32, 9216
    buffer_load_dwordx4 v[124:127], v3, s[12:15], s43 offen offset:0
    buffer_load_dwordx4 v[128:131], v3, s[12:15], s43 offen offset:1024
    buffer_load_dwordx4 v[132:135], v3, s[12:15], s43 offen offset:2048
    buffer_load_dwordx4 v[136:139], v3, s[12:15], s43 offen offset:3072
    s_waitcnt vmcnt(17)
    s_cmp_lg_u32 s3, 0
    s_cbranch_scc1 g3_x00
    v_lshlrev_b32 v26, 16, v16
    v_and_b32 v27, 0xffff0000, v16
    v_accvgpr_write_b32 a0, v26
    v_accvgpr_write_b32 a1, v27
    v_lshlrev_b32 v26, 16, v17
    v_and_b32 v27, 0xffff0000, v17
    v_accvgpr_write_b32 a2, v26
    v_accvgpr_write_b32 a3, v27
    v_lshlrev_b32 v26, 16, v18
    v_and_b32 v27, 0xffff0000, v18
    v_accvgpr_write_b32 a4, v26
    v_accvgpr_write_b32 a5, v27
    v_lshlrev_b32 v26, 16, v19
    v_and_b32 v27, 0xffff0000, v19
    v_accvgpr_write_b32 a6, v26
    v_accvgpr_write_b32 a7, v27
    v_lshlrev_b32 v26, 16, v20
    v_and_b32 v27, 0xffff0000, v20
    v_accvgpr_write_b32 a8, v26
    v_accvgpr_write_b32 a9, v27
    v_lshlrev_b32 v26, 16, v21
    v_and_b32 v27, 0xffff0000, v21
    v_accvgpr_write_b32 a10, v26
    v_accvgpr_write_b32 a11, v27
    v_lshlrev_b32 v26, 16, v22
    v_and_b32 v27, 0xffff0000, v22
    v_accvgpr_write_b32 a12, v26
    v_accvgpr_write_b32 a13, v27
    v_lshlrev_b32 v26, 16, v23
    v_and_b32 v27, 0xffff0000, v23
    v_accvgpr_write_b32 a14, v26
    v_accvgpr_write_b32 a15, v27
    v_lshlrev_b32 v26, 16, v24
    v_and_b32 v27, 0xffff0000, v24
    v_accvgpr_write_b32 a16, v26
    v_accvgpr_write_b32 a17, v27
    v_lshlrev_b32 v26, 16, v25
    v_and_b32 v27, 0xffff0000, v25
    v_accvgpr_write_b32 a18, v26
    v_accvgpr_write_b32 a19, v27
g3_x00:
    s_cmp_lg_u32 s3, 1
    s_cbranch_scc1 g3_x01
    v_lshlrev_b32 v26, 16, v16
    v_and_b32 v27, 0xffff0000, v16
    v_accvgpr_write_b32 a20, v26
    v_accvgpr_write_b32 a21, v27
    v_lshlrev_b32 v26, 16, v17
    v_and_b32 v27, 0xffff0000, v17
    v_accvgpr_write_b32 a22, v26
    v_accvgpr_write_b32 a23, v27
    v_lshlrev_b32 v26, 16, v18
    v_and_b32 v27, 0xffff0000, v18
    v_accvgpr_write_b32 a24, v26
    v_accvgpr_write_b32 a25, v27
    v_lshlrev_b32 v26, 16, v19
    v_and_b32 v27, 0xffff0000, v19
    v_accvgpr_write_b32 a26, v26
    v_accvgpr_write_b32 a27, v27
    v_lshlrev_b32 v26, 16, v20
    v_and_b32 v27, 0xffff0000, v20
    v_accvgpr_write_b32 a28, v26
    v_accvgpr_write_b32 a29, v27
    v_lshlrev_b32 v26, 16, v21
    v_and_b32 v27, 0xffff0000, v21
    v_accvgpr_write_b32 a30, v26
    v_accvgpr_write_b32 a31, v27
    v_lshlrev_b32 v26, 16, v22
    v_and_b32 v27, 0xffff0000, v22
    v_accvgpr_write_b32 a32, v26
    v_accvgpr_write_b32 a33, v27
    v_lshlrev_b32 v26, 16, v23
    v_and_b32 v27, 0xffff0000, v23
    v_accvgpr_write_b32 a34, v26
    v_accvgpr_write_b32 a35, v27
    v_lshlrev_b32 v26, 16, v24
    v_and_b32 v27, 0xffff0000, v24
    v_accvgpr_write_b32 a36, v26
    v_accvgpr_write_b32 a37, v27
    v_lshlrev_b32 v26, 16, v25
    v_and_b32 v27, 0xffff0000, v25
    v_accvgpr_write_b32 a38, v26
    v_accvgpr_write_b32 a39, v27
g3_x01:
    s_cmp_lg_u32 s3, 2
    s_cbranch_scc1 g3_x02
    v_lshlrev_b32 v26, 16, v16
    v_and_b32 v27, 0xffff0000, v16
    v_accvgpr_write_b32 a40, v26
    v_accvgpr_write_b32 a41, v27
    v_lshlrev_b32 v26, 16, v17
    v_and_b32 v27, 0xffff0000, v17
    v_accvgpr_write_b32 a42, v26
    v_accvgpr_write_b32 a43, v27
    v_lshlrev_b32 v26, 16, v18
    v_and_b32 v27, 0xffff0000, v18
    v_accvgpr_write_b32 a44, v26
    v_accvgpr_write_b32 a45, v27
    v_lshlrev_b32 v26, 16, v19
    v_and_b32 v27, 0xffff0000, v19
    v_accvgpr_write_b32 a46, v26
    v_accvgpr_write_b32 a47, v27
    v_lshlrev_b32 v26, 16, v20
    v_and_b32 v27, 0xffff0000, v20
    v_accvgpr_write_b32 a48, v26
    v_accvgpr_write_b32 a49, v27
    v_lshlrev_b32 v26, 16, v21
    v_and_b32 v27, 0xffff0000, v21
    v_accvgpr_write_b32 a50, v26
    v_accvgpr_write_b32 a51, v27
    v_lshlrev_b32 v26, 16, v22
    v_and_b32 v27, 0xffff0000, v22
    v_accvgpr_write_b32 a52, v26
    v_accvgpr_write_b32 a53, v27
    v_lshlrev_b32 v26, 16, v23
    v_and_b32 v27, 0xffff0000, v23
    v_accvgpr_write_b32 a54, v26
    v_accvgpr_write_b32 a55, v27
    v_lshlrev_b32 v26, 16, v24
    v_and_b32 v27, 0xffff0000, v24
    v_accvgpr_write_b32 a56, v26
    v_accvgpr_write_b32 a57, v27
    v_lshlrev_b32 v26, 16, v25
    v_and_b32 v27, 0xffff0000, v25
    v_accvgpr_write_b32 a58, v26
    v_accvgpr_write_b32 a59, v27
g3_x02:
    s_cmp_lg_u32 s3, 3
    s_cbranch_scc1 g3_x03
    v_lshlrev_b32 v26, 16, v16
    v_and_b32 v27, 0xffff0000, v16
    v_accvgpr_write_b32 a60, v26
    v_accvgpr_write_b32 a61, v27
    v_lshlrev_b32 v26, 16, v17
    v_and_b32 v27, 0xffff0000, v17
    v_accvgpr_write_b32 a62, v26
    v_accvgpr_write_b32 a63, v27
    v_lshlrev_b32 v26, 16, v18
    v_and_b32 v27, 0xffff0000, v18
    v_accvgpr_write_b32 a64, v26
    v_accvgpr_write_b32 a65, v27
    v_lshlrev_b32 v26, 16, v19
    v_and_b32 v27, 0xffff0000, v19
    v_accvgpr_write_b32 a66, v26
    v_accvgpr_write_b32 a67, v27
    v_lshlrev_b32 v26, 16, v20
    v_and_b32 v27, 0xffff0000, v20
    v_accvgpr_write_b32 a68, v26
    v_accvgpr_write_b32 a69, v27
    v_lshlrev_b32 v26, 16, v21
    v_and_b32 v27, 0xffff0000, v21
    v_accvgpr_write_b32 a70, v26
    v_accvgpr_write_b32 a71, v27
    v_lshlrev_b32 v26, 16, v22
    v_and_b32 v27, 0xffff0000, v22
    v_accvgpr_write_b32 a72, v26
    v_accvgpr_write_b32 a73, v27
    v_lshlrev_b32 v26, 16, v23
    v_and_b32 v27, 0xffff0000, v23
    v_accvgpr_write_b32 a74, v26
    v_accvgpr_write_b32 a75, v27
    v_lshlrev_b32 v26, 16, v24
    v_and_b32 v27, 0xffff0000, v24
    v_accvgpr_write_b32 a76, v26
    v_accvgpr_write_b32 a77, v27
    v_lshlrev_b32 v26, 16, v25
    v_and_b32 v27, 0xffff0000, v25
    v_accvgpr_write_b32 a78, v26
    v_accvgpr_write_b32 a79, v27
g3_x03:
    s_nop 1
    s_cmp_ge_u32 s3, 2
    s_cbranch_scc1 g3_no0b0
    v_mfma_f32_16x16x32_bf16 a[0:3], v[60:63], v[44:47], a[0:3]
    v_mfma_f32_16x16x32_bf16 a[20:23], v[60:63], v[48:51], a[20:23]
    v_mfma_f32_16x16x32_bf16 a[40:43], v[60:63], v[52:55], a[40:43]
    v_mfma_f32_16x16x32_bf16 a[60:63], v[60:63], v[56:59], a[60:63]
    v_mfma_f32_16x16x32_bf16 a[4:7], v[64:67], v[44:47], a[4:7]
    v_mfma_f32_16x16x32_bf16 a[24:27], v[64:67], v[48:51], a[24:27]
    v_mfma_f32_16x16x32_bf16 a[44:47], v[64:67], v[52:55], a[44:47]
    v_mfma_f32_16x16x32_bf16 a[64:67], v[64:67], v[56:59], a[64:67]
    v_mfma_f32_16x16x32_bf16 a[8:11], v[68:71], v[44:47], a[8:11]
    v_mfma_f32_16x16x32_bf16 a[28:31], v[68:71], v[48:51], a[28:31]
    v_mfma_f32_16x16x32_bf16 a[48:51], v[68:71], v[52:55], a[48:51]
    v_mfma_f32_16x16x32_bf16 a[68:71], v[68:71], v[56:59], a[68:71]
    v_mfma_f32_16x16x32_bf16 a[12:15], v[72:75], v[44:47], a[12:15]
    v_mfma_f32_16x16x32_bf16 a[32:35], v[72:75], v[48:51], a[32:35]
    v_mfma_f32_16x16x32_bf16 a[52:55], v[72:75], v[52:55], a[52:55]
    v_mfma_f32_16x16x32_bf16 a[72:75], v[72:75], v[56:59], a[72:75]
    v_mfma_f32_16x16x32_bf16 a[16:19], v[28:31], v[44:47], a[16:19]
    v_mfma_f32_16x16x32_bf16 a[36:39], v[28:31], v[48:51], a[36:39]
    v_mfma_f32_16x16x32_bf16 a[56:59], v[28:31], v[52:55], a[56:59]
    v_mfma_f32_16x16x32_bf16 a[76:79], v[28:31], v[56:59], a[76:79]
g3_no0b0:
    s_waitcnt vmcnt(8)
    v_mfma_f32_16x16x32_bf16 a[0:3], v[92:95], v[76:79], a[0:3]
    s_mov_b32 s44, 4096
    buffer_load_dwordx4 v[44:47], v5, s[8:11], s44 offen offset:0
    v_mfma_f32_16x16x32_bf16 a[20:23], v[92:95], v[80:83], a[20:23]
    v_mfma_f32_16x16x32_bf16 a[40:43], v[92:95], v[84:87], a[40:43]
    buffer_load_dwordx4 v[48:51], v5, s[8:11], s44 offen offset:1024
    v_mfma_f32_16x16x32_bf16 a[60:63], v[92:95], v[88:91], a[60:63]
    v_mfma_f32_16x16x32_bf16 a[4:7], v[96:99], v[76:79], a[4:7]
    buffer_load_dwordx4 v[52:55], v6, s[8:11], s44 offen offset:0
    v_mfma_f32_16x16x32_bf16 a[24:27], v[96:99], v[80:83], a[24:27]
    v_mfma_f32_16x16x32_bf16 a[44:47], v[96:99], v[84:87], a[44:47]
    buffer_load_dwordx4 v[56:59], v6, s[8:11], s44 offen offset:1024
    v_mfma_f32_16x16x32_bf16 a[64:67], v[96:99], v[88:91], a[64:67]
    v_mfma_f32_16x16x32_bf16 a[8:11], v[100:103], v[76:79], a[8:11]
    s_add_u32 s45, s32, 13824
    buffer_load_dwordx4 v[60:63], v3, s[12:15], s45 offen offset:0
    v_mfma_f32_16x16x32_bf16 a[28:31], v[100:103], v[80:83], a[28:31]
    v_mfma_f32_16x16x32_bf16 a[48:51], v[100:103], v[84:87], a[48:51]
    buffer_load_dwordx4 v[64:67], v3, s[12:15], s45 offen offset:1024
    v_mfma_f32_16x16x32_bf16 a[68:71], v[100:103], v[88:91], a[68:71]
    v_mfma_f32_16x16x32_bf16 a[12:15], v[104:107], v[76:79], a[12:15]
    buffer_load_dwordx4 v[68:71], v3, s[12:15], s45 offen offset:2048
    v_mfma_f32_16x16x32_bf16 a[32:35], v[104:107], v[80:83], a[32:35]
    v_mfma_f32_16x16x32_bf16 a[52:55], v[104:107], v[84:87], a[52:55]
    buffer_load_dwordx4 v[72:75], v3, s[12:15], s45 offen offset:3072
    v_mfma_f32_16x16x32_bf16 a[72:75], v[104:107], v[88:91], a[72:75]
    v_mfma_f32_16x16x32_bf16 a[16:19], v[32:35], v[76:79], a[16:19]
    buffer_load_dwordx4 v[36:39], v4, s[12:15], s45 offen
    v_mfma_f32_16x16x32_bf16 a[36:39], v[32:35], v[80:83], a[36:39]
    v_mfma_f32_16x16x32_bf16 a[56:59], v[32:35], v[84:87], a[56:59]
    v_mfma_f32_16x16x32_bf16 a[76:79], v[32:35], v[88:91], a[76:79]
    s_waitcnt vmcnt(9)
    v_mfma_f32_16x16x32_bf16 a[0:3], v[124:127], v[108:111], a[0:3]
    s_mov_b32 s46, 6144
    buffer_load_dwordx4 v[76:79], v5, s[8:11], s46 offen offset:0
    v_mfma_f32_16x16x32_bf16 a[20:23], v[124:127], v[112:115], a[20:23]
    v_mfma_f32_16x16x32_bf16 a[40:43], v[124:127], v[116:119], a[40:43]
    buffer_load_dwordx4 v[80:83], v5, s[8:11], s46 offen offset:1024
    v_mfma_f32_16x16x32_bf16 a[60:63], v[124:127], v[120:123], a[60:63]
    v_mfma_f32_16x16x32_bf16 a[4:7], v[128:131], v[108:111], a[4:7]
    buffer_load_dwordx4 v[84:87], v6, s[8:11], s46 offen offset:0
    v_mfma_f32_16x16x32_bf16 a[24:27], v[128:131], v[112:115], a[24:27]
    v_mfma_f32_16x16x32_bf16 a[44:47], v[128:131], v[116:119], a[44:47]
    buffer_load_dwordx4 v[88:91], v6, s[8:11], s46 offen offset:1024
    v_mfma_f32_16x16x32_bf16 a[64:67], v[128:131], v[120:123], a[64:67]
    v_mfma_f32_16x16x32_bf16 a[8:11], v[132:135], v[108:111], a[8:11]
    s_add_u32 s47, s32, 18432
    buffer_load_dwordx4 v[92:95], v3, s[12:15], s47 offen offset:0
    v_mfma_f32_16x16x32_bf16 a[28:31], v[132:135], v[112:115], a[28:31]
    v_mfma_f32_16x16x32_bf16 a[48:51], v[132:135], v[116:119], a[48:51]
    buffer_load_dwordx4 v[96:99], v3, s[12:15], s47 offen offset:1024
    v_mfma_f32_16x16x32_bf16 a[68:71], v[132:135], v[120:123], a[68:71]
    v_mfma_f32_16x16x32_bf16 a[12:15], v[136:139], v[108:111], a[12:15]
    buffer_load_dwordx4 v[100:103], v3, s[12:15], s47 offen offset:2048
    v_mfma_f32_16x16x32_bf16 a[32:35], v[136:139], v[112:115], a[32:35]
    v_mfma_f32_16x16x32_bf16 a[52:55], v[136:139], v[116:119], a[52:55]
    buffer_load_dwordx4 v[104:107], v3, s[12:15], s47 offen offset:3072
    v_mfma_f32_16x16x32_bf16 a[72:75], v[136:139], v[120:123], a[72:75]
    v_mfma_f32_16x16x32_bf16 a[80:83], v[32:35], v[108:111], a[80:83]
    v_mfma_f32_16x16x32_bf16 a[84:87], v[32:35], v[112:115], a[84:87]
    v_mfma_f32_16x16x32_bf16 a[88:91], v[32:35], v[116:119], a[88:91]
    v_mfma_f32_16x16x32_bf16 a[92:95], v[32:35], v[120:123], a[92:95]
    s_waitcnt vmcnt(8)
    v_mfma_f32_16x16x32_bf16 a[0:3], v[60:63], v[44:47], a[0:3]
    s_mov_b32 s48, 9216
    buffer_load_dwordx4 v[108:111], v5, s[8:11], s48 offen offset:0
    v_mfma_f32_16x16x32_bf16 a[20:23], v[60:63], v[48:51], a[20:23]
    v_mfma_f32_16x16x32_bf16 a[40:43], v[60:63], v[52:55], a[40:43]
    buffer_load_dwordx4 v[112:115], v5, s[8:11], s48 offen offset:1024
    v_mfma_f32_16x16x32_bf16 a[60:63], v[60:63], v[56:59], a[60:63]
    v_mfma_f32_16x16x32_bf16 a[4:7], v[64:67], v[44:47], a[4:7]
    buffer_load_dwordx4 v[116:119], v6, s[8:11], s48 offen offset:0
    v_mfma_f32_16x16x32_bf16 a[24:27], v[64:67], v[48:51], a[24:27]
    v_mfma_f32_16x16x32_bf16 a[44:47], v[64:67], v[52:55], a[44:47]
    buffer_load_dwordx4 v[120:123], v6, s[8:11], s48 offen offset:1024
    v_mfma_f32_16x16x32_bf16 a[64:67], v[64:67], v[56:59], a[64:67]
    v_mfma_f32_16x16x32_bf16 a[8:11], v[68:71], v[44:47], a[8:11]
    s_add_u32 s49, s32, 23040
    buffer_load_dwordx4 v[124:127], v3, s[12:15], s49 offen offset:0
    v_mfma_f32_16x16x32_bf16 a[28:31], v[68:71], v[48:51], a[28:31]
    v_mfma_f32_16x16x32_bf16 a[48:51], v[68:71], v[52:55], a[48:51]
    buffer_load_dwordx4 v[128:131], v3, s[12:15], s49 offen offset:1024
    v_mfma_f32_16x16x32_bf16 a[68:71], v[68:71], v[56:59], a[68:71]
    v_mfma_f32_16x16x32_bf16 a[12:15], v[72:75], v[44:47], a[12:15]
    buffer_load_dwordx4 v[132:135], v3, s[12:15], s49 offen offset:2048
    v_mfma_f32_16x16x32_bf16 a[32:35], v[72:75], v[48:51], a[32:35]
    v_mfma_f32_16x16x32_bf16 a[52:55], v[72:75], v[52:55], a[52:55]
    buffer_load_dwordx4 v[136:139], v3, s[12:15], s49 offen offset:3072
    v_mfma_f32_16x16x32_bf16 a[72:75], v[72:75], v[56:59], a[72:75]
    v_mfma_f32_16x16x32_bf16 a[16:19], v[36:39], v[44:47], a[16:19]
    buffer_load_dwordx4 v[40:43], v4, s[12:15], s49 offen
    v_mfma_f32_16x16x32_bf16 a[36:39], v[36:39], v[48:51], a[36:39]
    v_mfma_f32_16x16x32_bf16 a[56:59], v[36:39], v[52:55], a[56:59]
    v_mfma_f32_16x16x32_bf16 a[76:79], v[36:39], v[56:59], a[76:79]
    s_waitcnt vmcnt(9)
    v_mfma_f32_16x16x32_bf16 a[0:3], v[92:95], v[76:79], a[0:3]
    s_mov_b32 s50, 11264
    buffer_load_dwordx4 v[44:47], v5, s[8:11], s50 offen offset:0
    v_mfma_f32_16x16x32_bf16 a[20:23], v[92:95], v[80:83], a[20:23]
    v_mfma_f32_16x16x32_bf16 a[40:43], v[92:95], v[84:87], a[40:43]
    buffer_load_dwordx4 v[48:51], v5, s[8:11], s50 offen offset:1024
    v_mfma_f32_16x16x32_bf16 a[60:63], v[92:95], v[88:91], a[60:63]
    v_mfma_f32_16x16x32_bf16 a[4:7], v[96:99], v[76:79], a[4:7]
    buffer_load_dwordx4 v[52:55], v6, s[8:11], s50 offen offset:0
    v_mfma_f32_16x16x32_bf16 a[24:27], v[96:99], v[80:83], a[24:27]
    v_mfma_f32_16x16x32_bf16 a[44:47], v[96:99], v[84:87], a[44:47]
    buffer_load_dwordx4 v[56:59], v6, s[8:11], s50 offen offset:1024
    v_mfma_f32_16x16x32_bf16 a[64:67], v[96:99], v[88:91], a[64:67]
    v_mfma_f32_16x16x32_bf16 a[8:11], v[100:103], v[76:79], a[8:11]
    s_add_u32 s51, s32, 27648
    buffer_load_dwordx4 v[60:63], v3, s[12:15], s51 offen offset:0
    v_mfma_f32_16x16x32_bf16 a[28:31], v[100:103], v[80:83], a[28:31]
    v_mfma_f32_16x16x32_bf16 a[48:51], v[100:103], v[84:87], a[48:51]
    buffer_load_dwordx4 v[64:67], v3, s[12:15], s51 offen offset:1024
    v_mfma_f32_16x16x32_bf16 a[68:71], v[100:103], v[88:91], a[68:71]
    v_mfma_f32_16x16x32_bf16 a[12:15], v[104:107], v[76:79], a[12:15]
    buffer_load_dwordx4 v[68:71], v3, s[12:15], s51 offen offset:2048
    v_mfma_f32_16x16x32_bf16 a[32:35], v[104:107], v[80:83], a[32:35]
    v_mfma_f32_16x16x32_bf16 a[52:55], v[104:107], v[84:87], a[52:55]
    buffer_load_dwordx4 v[72:75], v3, s[12:15], s51 offen offset:3072
    v_mfma_f32_16x16x32_bf16 a[72:75], v[104:107], v[88:91], a[72:75]
    v_mfma_f32_16x16x32_bf16 a[80:83], v[36:39], v[76:79], a[80:83]
    v_mfma_f32_16x16x32_bf16 a[84:87], v[36:39], v[80:83], a[84:87]
    v_mfma_f32_16x16x32_bf16 a[88:91], v[36:39], v[84:87], a[88:91]
    v_mfma_f32_16x16x32_bf16 a[92:95], v[36:39], v[88:91], a[92:95]
    s_waitcnt vmcnt(8)
    v_mfma_f32_16x16x32_bf16 a[0:3], v[124:127], v[108:111], a[0:3]
    s_mov_b32 s52, 13312
    buffer_load_dwordx4 v[76:79], v5, s[8:11], s52 offen offset:0
    v_mfma_f32_16x16x32_bf16 a[20:23], v[124:127], v[112:115], a[20:23]
    v_mfma_f32_16x16x32_bf16 a[40:43], v[124:127], v[116:119], a[40:43]
    buffer_load_dwordx4 v[80:83], v5, s[8:11], s52 offen offset:1024
    v_mfma_f32_16x16x32_bf16 a[60:63], v[124:127], v[120:123], a[60:63]
    v_mfma_f32_16x16x32_bf16 a[4:7], v[128:131], v[108:111], a[4:7]
    buffer_load_dwordx4 v[84:87], v6, s[8:11], s52 offen offset:0
    v_mfma_f32_16x16x32_bf16 a[24:27], v[128:131], v[112:115], a[24:27]
    v_mfma_f32_16x16x32_bf16 a[44:47], v[128:131], v[116:119], a[44:47]
    buffer_load_dwordx4 v[88:91], v6, s[8:11], s52 offen offset:1024
    v_mfma_f32_16x16x32_bf16 a[64:67], v[128:131], v[120:123], a[64:67]
    v_mfma_f32_16x16x32_bf16 a[8:11], v[132:135], v[108:111], a[8:11]
    s_add_u32 s53, s32, 32256
    buffer_load_dwordx4 v[92:95], v3, s[12:15], s53 offen offset:0
    v_mfma_f32_16x16x32_bf16 a[28:31], v[132:135], v[112:115], a[28:31]
    v_mfma_f32_16x16x32_bf16 a[48:51], v[132:135], v[116:119], a[48:51]
    buffer_load_dwordx4 v[96:99], v3, s[12:15], s53 offen offset:1024
    v_mfma_f32_16x16x32_bf16 a[68:71], v[132:135], v[120:123], a[68:71]
    v_mfma_f32_16x16x32_bf16 a[12:15], v[136:139], v[108:111], a[12:15]
    buffer_load_dwordx4 v[100:103], v3, s[12:15], s53 offen offset:2048
    v_mfma_f32_16x16x32_bf16 a[32:35], v[136:139], v[112:115], a[32:35]
    v_mfma_f32_16x16x32_bf16 a[52:55], v[136:139], v[116:119], a[52:55]
    buffer_load_dwordx4 v[104:107], v3, s[12:15], s53 offen offset:3072
    v_mfma_f32_16x16x32_bf16 a[72:75], v[136:139], v[120:123], a[72:75]
    v_mfma_f32_16x16x32_bf16 a[16:19], v[40:43], v[108:111], a[16:19]
    buffer_load_dwordx4 v[28:31], v4, s[12:15], s53 offen
    v_mfma_f32_16x16x32_bf16 a[36:39], v[40:43], v[112:115], a[36:39]
    v_mfma_f32_16x16x32_bf16 a[56:59], v[40:43], v[116:119], a[56:59]
    v_mfma_f32_16x16x32_bf16 a[76:79], v[40:43], v[120:123], a[76:79]
    s_waitcnt vmcnt(9)
    v_mfma_f32_16x16x32_bf16 a[0:3], v[60:63], v[44:47], a[0:3]
    s_mov_b32 s54, 15360
    buffer_load_dwordx4 v[108:111], v5, s[8:11], s54 offen offset:0
    v_mfma_f32_16x16x32_bf16 a[20:23], v[60:63], v[48:51], a[20:23]
    v_mfma_f32_16x16x32_bf16 a[40:43], v[60:63], v[52:55], a[40:43]
    buffer_load_dwordx4 v[112:115], v5, s[8:11], s54 offen offset:1024
    v_mfma_f32_16x16x32_bf16 a[60:63], v[60:63], v[56:59], a[60:63]
    v_mfma_f32_16x16x32_bf16 a[4:7], v[64:67], v[44:47], a[4:7]
    buffer_load_dwordx4 v[116:119], v6, s[8:11], s54 offen offset:0
    v_mfma_f32_16x16x32_bf16 a[24:27], v[64:67], v[48:51], a[24:27]
    v_mfma_f32_16x16x32_bf16 a[44:47], v[64:67], v[52:55], a[44:47]
    buffer_load_dwordx4 v[120:123], v6, s[8:11], s54 offen offset:1024
    v_mfma_f32_16x16x32_bf16 a[64:67], v[64:67], v[56:59], a[64:67]
    v_mfma_f32_16x16x32_bf16 a[8:11], v[68:71], v[44:47], a[8:11]
    s_add_u32 s55, s32, 36864
    buffer_load_dwordx4 v[124:127], v3, s[12:15], s55 offen offset:0
    v_mfma_f32_16x16x32_bf16 a[28:31], v[68:71], v[48:51], a[28:31]
    v_mfma_f32_16x16x32_bf16 a[48:51], v[68:71], v[52:55], a[48:51]
    buffer_load_dwordx4 v[128:131], v3, s[12:15], s55 offen offset:1024
    v_mfma_f32_16x16x32_bf16 a[68:71], v[68:71], v[56:59], a[68:71]
    v_mfma_f32_16x16x32_bf16 a[12:15], v[72:75], v[44:47], a[12:15]
    buffer_load_dwordx4 v[132:135], v3, s[12:15], s55 offen offset:2048
    v_mfma_f32_16x16x32_bf16 a[32:35], v[72:75], v[48:51], a[32:35]
    v_mfma_f32_16x16x32_bf16 a[52:55], v[72:75], v[52:55], a[52:55]
    buffer_load_dwordx4 v[136:139], v3, s[12:15], s55 offen offset:3072
    v_mfma_f32_16x16x32_bf16 a[72:75], v[72:75], v[56:59], a[72:75]
    v_mfma_f32_16x16x32_bf16 a[80:83], v[40:43], v[44:47], a[80:83]
    v_mfma_f32_16x16x32_bf16 a[84:87], v[40:43], v[48:51], a[84:87]
    v_mfma_f32_16x16x32_bf16 a[88:91], v[40:43], v[52:55], a[88:91]
    v_mfma_f32_16x16x32_bf16 a[92:95], v[40:43], v[56:59], a[92:95]
    s_waitcnt vmcnt(8)
    v_mfma_f32_16x16x32_bf16 a[0:3], v[92:95], v[76:79], a[0:3]
    s_mov_b32 s40, 18432
    buffer_load_dwordx4 v[44:47], v5, s[8:11], s40 offen offset:0
    v_mfma_f32_16x16x32_bf16 a[20:23], v[92:95], v[80:83], a[20:23]
    v_mfma_f32_16x16x32_bf16 a[40:43], v[92:95], v[84:87], a[40:43]
    buffer_load_dwordx4 v[48:51], v5, s[8:11], s40 offen offset:1024
    v_mfma_f32_16x16x32_bf16 a[60:63], v[92:95], v[88:91], a[60:63]
    v_mfma_f32_16x16x32_bf16 a[4:7], v[96:99], v[76:79], a[4:7]
    buffer_load_dwordx4 v[52:55], v6, s[8:11], s40 offen offset:0
    v_mfma_f32_16x16x32_bf16 a[24:27], v[96:99], v[80:83], a[24:27]
    v_mfma_f32_16x16x32_bf16 a[44:47], v[96:99], v[84:87], a[44:47]
    buffer_load_dwordx4 v[56:59], v6, s[8:11], s40 offen offset:1024
    v_mfma_f32_16x16x32_bf16 a[64:67], v[96:99], v[88:91], a[64:67]
    v_mfma_f32_16x16x32_bf16 a[8:11], v[100:103], v[76:79], a[8:11]
    s_add_u32 s41, s32, 41472
    buffer_load_dwordx4 v[60:63], v3, s[12:15], s41 offen offset:0
    v_mfma_f32_16x16x32_bf16 a[28:31], v[100:103], v[80:83], a[28:31]
    v_mfma_f32_16x16x32_bf16 a[48:51], v[100:103], v[84:87], a[48:51]
    buffer_load_dwordx4 v[64:67], v3, s[12:15], s41 offen offset:1024
    v_mfma_f32_16x16x32_bf16 a[68:71], v[100:103], v[88:91], a[68:71]
    v_mfma_f32_16x16x32_bf16 a[12:15], v[104:107], v[76:79], a[12:15]
    buffer_load_dwordx4 v[68:71], v3, s[12:15], s41 offen offset:2048
    v_mfma_f32_16x16x32_bf16 a[32:35], v[104:107], v[80:83], a[32:35]
    v_mfma_f32_16x16x32_bf16 a[52:55], v[104:107], v[84:87], a[52:55]
    buffer_load_dwordx4 v[72:75], v3, s[12:15], s41 offen offset:3072
    v_mfma_f32_16x16x32_bf16 a[72:75], v[104:107], v[88:91], a[72:75]
    v_mfma_f32_16x16x32_bf16 a[16:19], v[28:31], v[76:79], a[16:19]
    buffer_load_dwordx4 v[32:35], v4, s[12:15], s41 offen
    v_mfma_f32_16x16x32_bf16 a[36:39], v[28:31], v[80:83], a[36:39]
    v_mfma_f32_16x16x32_bf16 a[56:59], v[28:31], v[84:87], a[56:59]
    v_mfma_f32_16x16x32_bf16 a[76:79], v[28:31], v[88:91], a[76:79]
    s_waitcnt vmcnt(9)
    v_mfma_f32_16x16x32_bf16 a[0:3], v[124:127], v[108:111], a[0:3]
    s_mov_b32 s42, 20480
    buffer_load_dwordx4 v[76:79], v5, s[8:11], s42 offen offset:0
    v_mfma_f32_16x16x32_bf16 a[20:23], v[124:127], v[112:115], a[20:23]
    v_mfma_f32_16x16x32_bf16 a[40:43], v[124:127], v[116:119], a[40:43]
    buffer_load_dwordx4 v[80:83], v5, s[8:11], s42 offen offset:1024
    v_mfma_f32_16x16x32_bf16 a[60:63], v[124:127], v[120:123], a[60:63]
    v_mfma_f32_16x16x32_bf16 a[4:7], v[128:131], v[108:111], a[4:7]
    buffer_load_dwordx4 v[84:87], v6, s[8:11], s42 offen offset:0
    v_mfma_f32_16x16x32_bf16 a[24:27], v[128:131], v[112:115], a[24:27]
    v_mfma_f32_16x16x32_bf16 a[44:47], v[128:131], v[116:119], a[44:47]
    buffer_load_dwordx4 v[88:91], v6, s[8:11], s42 offen offset:1024
    v_mfma_f32_16x16x32_bf16 a[64:67], v[128:131], v[120:123], a[64:67]
    v_mfma_f32_16x16x32_bf16 a[8:11], v[132:135], v[108:111], a[8:11]
    s_add_u32 s43, s32, 46080
    buffer_load_dwordx4 v[92:95], v3, s[12:15], s43 offen offset:0
    v_mfma_f32_16x16x32_bf16 a[28:31], v[132:135], v[112:115], a[28:31]
    v_mfma_f32_16x16x32_bf16 a[48:51], v[132:135], v[116:119], a[48:51]
    buffer_load_dwordx4 v[96:99], v3, s[12:15], s43 offen offset:1024
    v_mfma_f32_16x16x32_bf16 a[68:71], v[132:135], v[120:123], a[68:71]
    v_mfma_f32_16x16x32_bf16 a[12:15], v[136:139], v[108:111], a[12:15]
    buffer_load_dwordx4 v[100:103], v3, s[12:15], s43 offen offset:2048
    v_mfma_f32_16x16x32_bf16 a[32:35], v[136:139], v[112:115], a[32:35]
    v_mfma_f32_16x16x32_bf16 a[52:55], v[136:139], v[116:119], a[52:55]
    buffer_load_dwordx4 v[104:107], v3, s[12:15], s43 offen offset:3072
    v_mfma_f32_16x16x32_bf16 a[72:75], v[136:139], v[120:123], a[72:75]
    v_mfma_f32_16x16x32_bf16 a[80:83], v[28:31], v[108:111], a[80:83]
    v_mfma_f32_16x16x32_bf16 a[84:87], v[28:31], v[112:115], a[84:87]
    v_mfma_f32_16x16x32_bf16 a[88:91], v[28:31], v[116:119], a[88:91]
    v_mfma_f32_16x16x32_bf16 a[92:95], v[28:31], v[120:123], a[92:95]
    s_waitcnt vmcnt(8)
    v_mfma_f32_16x16x32_bf16 a[0:3], v[60:63], v[44:47], a[0:3]
    s_mov_b32 s44, 22528
    buffer_load_dwordx4 v[108:111], v5, s[8:11], s44 offen offset:0
    v_mfma_f32_16x16x32_bf16 a[20:23], v[60:63], v[48:51], a[20:23]
    v_mfma_f32_16x16x32_bf16 a[40:43], v[60:63], v[52:55], a[40:43]
    buffer_load_dwordx4 v[112:115], v5, s[8:11], s44 offen offset:1024
    v_mfma_f32_16x16x32_bf16 a[60:63], v[60:63], v[56:59], a[60:63]
    v_mfma_f32_16x16x32_bf16 a[4:7], v[64:67], v[44:47], a[4:7]
    buffer_load_dwordx4 v[116:119], v6, s[8:11], s44 offen offset:0
    v_mfma_f32_16x16x32_bf16 a[24:27], v[64:67], v[48:51], a[24:27]
    v_mfma_f32_16x16x32_bf16 a[44:47], v[64:67], v[52:55], a[44:47]
    buffer_load_dwordx4 v[120:123], v6, s[8:11], s44 offen offset:1024
    v_mfma_f32_16x16x32_bf16 a[64:67], v[64:67], v[56:59], a[64:67]
    v_mfma_f32_16x16x32_bf16 a[8:11], v[68:71], v[44:47], a[8:11]
    s_add_u32 s45, s32, 50688
    buffer_load_dwordx4 v[124:127], v3, s[12:15], s45 offen offset:0
    v_mfma_f32_16x16x32_bf16 a[28:31], v[68:71], v[48:51], a[28:31]
    v_mfma_f32_16x16x32_bf16 a[48:51], v[68:71], v[52:55], a[48:51]
    buffer_load_dwordx4 v[128:131], v3, s[12:15], s45 offen offset:1024
    v_mfma_f32_16x16x32_bf16 a[68:71], v[68:71], v[56:59], a[68:71]
    v_mfma_f32_16x16x32_bf16 a[12:15], v[72:75], v[44:47], a[12:15]
    buffer_load_dwordx4 v[132:135], v3, s[12:15], s45 offen offset:2048
    v_mfma_f32_16x16x32_bf16 a[32:35], v[72:75], v[48:51], a[32:35]
    v_mfma_f32_16x16x32_bf16 a[52:55], v[72:75], v[52:55], a[52:55]
    buffer_load_dwordx4 v[136:139], v3, s[12:15], s45 offen offset:3072
    v_mfma_f32_16x16x32_bf16 a[72:75], v[72:75], v[56:59], a[72:75]
    v_mfma_f32_16x16x32_bf16 a[16:19], v[32:35], v[44:47], a[16:19]
    buffer_load_dwordx4 v[36:39], v4, s[12:15], s45 offen
    v_mfma_f32_16x16x32_bf16 a[36:39], v[32:35], v[48:51], a[36:39]
    v_mfma_f32_16x16x32_bf16 a[56:59], v[32:35], v[52:55], a[56:59]
    v_mfma_f32_16x16x32_bf16 a[76:79], v[32:35], v[56:59], a[76:79]
    s_waitcnt vmcnt(9)
    v_mfma_f32_16x16x32_bf16 a[0:3], v[92:95], v[76:79], a[0:3]
    s_mov_b32 s46, 24576
    buffer_load_dwordx4 v[44:47], v5, s[8:11], s46 offen offset:0
    v_mfma_f32_16x16x32_bf16 a[20:23], v[92:95], v[80:83], a[20:23]
    v_mfma_f32_16x16x32_bf16 a[40:43], v[92:95], v[84:87], a[40:43]
    buffer_load_dwordx4 v[48:51], v5, s[8:11], s46 offen offset:1024
    v_mfma_f32_16x16x32_bf16 a[60:63], v[92:95], v[88:91], a[60:63]
    v_mfma_f32_16x16x32_bf16 a[4:7], v[96:99], v[76:79], a[4:7]
    buffer_load_dwordx4 v[52:55], v6, s[8:11], s46 offen offset:0
    v_mfma_f32_16x16x32_bf16 a[24:27], v[96:99], v[80:83], a[24:27]
    v_mfma_f32_16x16x32_bf16 a[44:47], v[96:99], v[84:87], a[44:47]
    buffer_load_dwordx4 v[56:59], v6, s[8:11], s46 offen offset:1024
    v_mfma_f32_16x16x32_bf16 a[64:67], v[96:99], v[88:91], a[64:67]
    v_mfma_f32_16x16x32_bf16 a[8:11], v[100:103], v[76:79], a[8:11]
    s_add_u32 s47, s32, 55296
    buffer_load_dwordx4 v[60:63], v3, s[12:15], s47 offen offset:0
    v_mfma_f32_16x16x32_bf16 a[28:31], v[100:103], v[80:83], a[28:31]
    v_mfma_f32_16x16x32_bf16 a[48:51], v[100:103], v[84:87], a[48:51]
    buffer_load_dwordx4 v[64:67], v3, s[12:15], s47 offen offset:1024
    v_mfma_f32_16x16x32_bf16 a[68:71], v[100:103], v[88:91], a[68:71]
    v_mfma_f32_16x16x32_bf16 a[12:15], v[104:107], v[76:79], a[12:15]
    buffer_load_dwordx4 v[68:71], v3, s[12:15], s47 offen offset:2048
    v_mfma_f32_16x16x32_bf16 a[32:35], v[104:107], v[80:83], a[32:35]
    v_mfma_f32_16x16x32_bf16 a[52:55], v[104:107], v[84:87], a[52:55]
    buffer_load_dwordx4 v[72:75], v3, s[12:15], s47 offen offset:3072
    v_mfma_f32_16x16x32_bf16 a[72:75], v[104:107], v[88:91], a[72:75]
    v_mfma_f32_16x16x32_bf16 a[80:83], v[32:35], v[76:79], a[80:83]
    v_mfma_f32_16x16x32_bf16 a[84:87], v[32:35], v[80:83], a[84:87]
    v_mfma_f32_16x16x32_bf16 a[88:91], v[32:35], v[84:87], a[88:91]
    v_mfma_f32_16x16x32_bf16 a[92:95], v[32:35], v[88:91], a[92:95]
    s_waitcnt vmcnt(8)
    v_mfma_f32_16x16x32_bf16 a[0:3], v[124:127], v[108:111], a[0:3]
    s_mov_b32 s48, 27648
    buffer_load_dwordx4 v[76:79], v5, s[8:11], s48 offen offset:0
    v_mfma_f32_16x16x32_bf16 a[20:23], v[124:127], v[112:115], a[20:23]
    v_mfma_f32_16x16x32_bf16 a[40:43], v[124:127], v[116:119], a[40:43]
    buffer_load_dwordx4 v[80:83], v5, s[8:11], s48 offen offset:1024
    v_mfma_f32_16x16x32_bf16 a[60:63], v[124:127], v[120:123], a[60:63]
    v_mfma_f32_16x16x32_bf16 a[4:7], v[128:131], v[108:111], a[4:7]
    buffer_load_dwordx4 v[84:87], v6, s[8:11], s48 offen offset:0
    v_mfma_f32_16x16x32_bf16 a[24:27], v[128:131], v[112:115], a[24:27]
    v_mfma_f32_16x16x32_bf16 a[44:47], v[128:131], v[116:119], a[44:47]
    buffer_load_dwordx4 v[88:91], v6, s[8:11], s48 offen offset:1024
    v_mfma_f32_16x16x32_bf16 a[64:67], v[128:131], v[120:123], a[64:67]
    v_mfma_f32_16x16x32_bf16 a[8:11], v[132:135], v[108:111], a[8:11]
    s_add_u32 s49, s32, 59904
    buffer_load_dwordx4 v[92:95], v3, s[12:15], s49 offen offset:0
    v_mfma_f32_16x16x32_bf16 a[28:31], v[132:135], v[112:115], a[28:31]
    v_mfma_f32_16x16x32_bf16 a[48:51], v[132:135], v[116:119], a[48:51]
    buffer_load_dwordx4 v[96:99], v3, s[12:15], s49 offen offset:1024
    v_mfma_f32_16x16x32_bf16 a[68:71], v[132:135], v[120:123], a[68:71]
    v_mfma_f32_16x16x32_bf16 a[12:15], v[136:139], v[108:111], a[12:15]
    buffer_load_dwordx4 v[100:103], v3, s[12:15], s49 offen offset:2048
    v_mfma_f32_16x16x32_bf16 a[32:35], v[136:139], v[112:115], a[32:35]
    v_mfma_f32_16x16x32_bf16 a[52:55], v[136:139], v[116:119], a[52:55]
    buffer_load_dwordx4 v[104:107], v3, s[12:15], s49 offen offset:3072
    v_mfma_f32_16x16x32_bf16 a[72:75], v[136:139], v[120:123], a[72:75]
    v_mfma_f32_16x16x32_bf16 a[16:19], v[36:39], v[108:111], a[16:19]
    buffer_load_dwordx4 v[40:43], v4, s[12:15], s49 offen
    v_mfma_f32_16x16x32_bf16 a[36:39], v[36:39], v[112:115], a[36:39]
    v_mfma_f32_16x16x32_bf16 a[56:59], v[36:39], v[116:119], a[56:59]
    v_mfma_f32_16x16x32_bf16 a[76:79], v[36:39], v[120:123], a[76:79]
    s_waitcnt vmcnt(9)
    v_mfma_f32_16x16x32_bf16 a[0:3], v[60:63], v[44:47], a[0:3]
    s_mov_b32 s50, 29696
    buffer_load_dwordx4 v[108:111], v5, s[8:11], s50 offen offset:0
    v_mfma_f32_16x16x32_bf16 a[20:23], v[60:63], v[48:51], a[20:23]
    v_mfma_f32_16x16x32_bf16 a[40:43], v[60:63], v[52:55], a[40:43]
    buffer_load_dwordx4 v[112:115], v5, s[8:11], s50 offen offset:1024
    v_mfma_f32_16x16x32_bf16 a[60:63], v[60:63], v[56:59], a[60:63]
    v_mfma_f32_16x16x32_bf16 a[4:7], v[64:67], v[44:47], a[4:7]
    buffer_load_dwordx4 v[116:119], v6, s[8:11], s50 offen offset:0
    v_mfma_f32_16x16x32_bf16 a[24:27], v[64:67], v[48:51], a[24:27]
    v_mfma_f32_16x16x32_bf16 a[44:47], v[64:67], v[52:55], a[44:47]
    buffer_load_dwordx4 v[120:123], v6, s[8:11], s50 offen offset:1024
    v_mfma_f32_16x16x32_bf16 a[64:67], v[64:67], v[56:59], a[64:67]
    v_mfma_f32_16x16x32_bf16 a[8:11], v[68:71], v[44:47], a[8:11]
    s_add_u32 s51, s32, 64512
    buffer_load_dwordx4 v[124:127], v3, s[12:15], s51 offen offset:0
    v_mfma_f32_16x16x32_bf16 a[28:31], v[68:71], v[48:51], a[28:31]
    v_mfma_f32_16x16x32_bf16 a[48:51], v[68:71], v[52:55], a[48:51]
    buffer_load_dwordx4 v[128:131], v3, s[12:15], s51 offen offset:1024
    v_mfma_f32_16x16x32_bf16 a[68:71], v[68:71], v[56:59], a[68:71]
    v_mfma_f32_16x16x32_bf16 a[12:15], v[72:75], v[44:47], a[12:15]
    buffer_load_dwordx4 v[132:135], v3, s[12:15], s51 offen offset:2048
    v_mfma_f32_16x16x32_bf16 a[32:35], v[72:75], v[48:51], a[32:35]
    v_mfma_f32_16x16x32_bf16 a[52:55], v[72:75], v[52:55], a[52:55]
    buffer_load_dwordx4 v[136:139], v3, s[12:15], s51 offen offset:3072
    v_mfma_f32_16x16x32_bf16 a[72:75], v[72:75], v[56:59], a[72:75]
    v_mfma_f32_16x16x32_bf16 a[80:83], v[36:39], v[44:47], a[80:83]
    v_mfma_f32_16x16x32_bf16 a[84:87], v[36:39], v[48:51], a[84:87]
    v_mfma_f32_16x16x32_bf16 a[88:91], v[36:39], v[52:55], a[88:91]
    v_mfma_f32_16x16x32_bf16 a[92:95], v[36:39], v[56:59], a[92:95]
    s_waitcnt vmcnt(8)
    v_mfma_f32_16x16x32_bf16 a[0:3], v[92:95], v[76:79], a[0:3]
    s_mov_b32 s52, 31744
    buffer_load_dwordx4 v[44:47], v5, s[8:11], s52 offen offset:0
    v_mfma_f32_16x16x32_bf16 a[20:23], v[92:95], v[80:83], a[20:23]
    v_mfma_f32_16x16x32_bf16 a[40:43], v[92:95], v[84:87], a[40:43]
    buffer_load_dwordx4 v[48:51], v5, s[8:11], s52 offen offset:1024
    v_mfma_f32_16x16x32_bf16 a[60:63], v[92:95], v[88:91], a[60:63]
    v_mfma_f32_16x16x32_bf16 a[4:7], v[96:99], v[76:79], a[4:7]
    buffer_load_dwordx4 v[52:55], v6, s[8:11], s52 offen offset:0
    v_mfma_f32_16x16x32_bf16 a[24:27], v[96:99], v[80:83], a[24:27]
    v_mfma_f32_16x16x32_bf16 a[44:47], v[96:99], v[84:87], a[44:47]
    buffer_load_dwordx4 v[56:59], v6, s[8:11], s52 offen offset:1024
    v_mfma_f32_16x16x32_bf16 a[64:67], v[96:99], v[88:91], a[64:67]
    v_mfma_f32_16x16x32_bf16 a[8:11], v[100:103], v[76:79], a[8:11]
    s_add_u32 s53, s32, 69120
    buffer_load_dwordx4 v[60:63], v3, s[12:15], s53 offen offset:0
    v_mfma_f32_16x16x32_bf16 a[28:31], v[100:103], v[80:83], a[28:31]
    v_mfma_f32_16x16x32_bf16 a[48:51], v[100:103], v[84:87], a[48:51]
    buffer_load_dwordx4 v[64:67], v3, s[12:15], s53 offen offset:1024
    v_mfma_f32_16x16x32_bf16 a[68:71], v[100:103], v[88:91], a[68:71]
    v_mfma_f32_16x16x32_bf16 a[12:15], v[104:107], v[76:79], a[12:15]
    buffer_load_dwordx4 v[68:71], v3, s[12:15], s53 offen offset:2048
    v_mfma_f32_16x16x32_bf16 a[32:35], v[104:107], v[80:83], a[32:35]
    v_mfma_f32_16x16x32_bf16 a[52:55], v[104:107], v[84:87], a[52:55]
    buffer_load_dwordx4 v[72:75], v3, s[12:15], s53 offen offset:3072
    v_mfma_f32_16x16x32_bf16 a[72:75], v[104:107], v[88:91], a[72:75]
    v_mfma_f32_16x16x32_bf16 a[16:19], v[40:43], v[76:79], a[16:19]
    buffer_load_dwordx4 v[28:31], v4, s[12:15], s53 offen
    v_mfma_f32_16x16x32_bf16 a[36:39], v[40:43], v[80:83], a[36:39]
    v_mfma_f32_16x16x32_bf16 a[56:59], v[40:43], v[84:87], a[56:59]
    v_mfma_f32_16x16x32_bf16 a[76:79], v[40:43], v[88:91], a[76:79]
    s_waitcnt vmcnt(9)
    v_mfma_f32_16x16x32_bf16 a[0:3], v[124:127], v[108:111], a[0:3]
    s_mov_b32 s54, 33792
    buffer_load_dwordx4 v[76:79], v5, s[8:11], s54 offen offset:0
    v_mfma_f32_16x16x32_bf16 a[20:23], v[124:127], v[112:115], a[20:23]
    v_mfma_f32_16x16x32_bf16 a[40:43], v[124:127], v[116:119], a[40:43]
    buffer_load_dwordx4 v[80:83], v5, s[8:11], s54 offen offset:1024
    v_mfma_f32_16x16x32_bf16 a[60:63], v[124:127], v[120:123], a[60:63]
    v_mfma_f32_16x16x32_bf16 a[4:7], v[128:131], v[108:111], a[4:7]
    buffer_load_dwordx4 v[84:87], v6, s[8:11], s54 offen offset:0
    v_mfma_f32_16x16x32_bf16 a[24:27], v[128:131], v[112:115], a[24:27]
    v_mfma_f32_16x16x32_bf16 a[44:47], v[128:131], v[116:119], a[44:47]
    buffer_load_dwordx4 v[88:91], v6, s[8:11], s54 offen offset:1024
    v_mfma_f32_16x16x32_bf16 a[64:67], v[128:131], v[120:123], a[64:67]
    v_mfma_f32_16x16x32_bf16 a[8:11], v[132:135], v[108:111], a[8:11]
    s_add_u32 s55, s32, 73728
    buffer_load_dwordx4 v[92:95], v3, s[12:15], s55 offen offset:0
    v_mfma_f32_16x16x32_bf16 a[28:31], v[132:135], v[112:115], a[28:31]
    v_mfma_f32_16x16x32_bf16 a[48:51], v[132:135], v[116:119], a[48:51]
    buffer_load_dwordx4 v[96:99], v3, s[12:15], s55 offen offset:1024
    v_mfma_f32_16x16x32_bf16 a[68:71], v[132:135], v[120:123], a[68:71]
    v_mfma_f32_16x16x32_bf16 a[12:15], v[136:139], v[108:111], a[12:15]
    buffer_load_dwordx4 v[100:103], v3, s[12:15], s55 offen offset:2048
    v_mfma_f32_16x16x32_bf16 a[32:35], v[136:139], v[112:115], a[32:35]
    v_mfma_f32_16x16x32_bf16 a[52:55], v[136:139], v[116:119], a[52:55]
    buffer_load_dwordx4 v[104:107], v3, s[12:15], s55 offen offset:3072
    v_mfma_f32_16x16x32_bf16 a[72:75], v[136:139], v[120:123], a[72:75]
    v_mfma_f32_16x16x32_bf16 a[80:83], v[40:43], v[108:111], a[80:83]
    v_mfma_f32_16x16x32_bf16 a[84:87], v[40:43], v[112:115], a[84:87]
    v_mfma_f32_16x16x32_bf16 a[88:91], v[40:43], v[116:119], a[88:91]
    v_mfma_f32_16x16x32_bf16 a[92:95], v[40:43], v[120:123], a[92:95]
    s_waitcnt vmcnt(8)
    v_mfma_f32_16x16x32_bf16 a[0:3], v[60:63], v[44:47], a[0:3]
    s_mov_b32 s40, 8192
    buffer_load_dwordx4 v[108:111], v5, s[8:11], s40 offen
    v_mfma_f32_16x16x32_bf16 a[20:23], v[60:63], v[48:51], a[20:23]
    v_mfma_f32_16x16x32_bf16 a[40:43], v[60:63], v[52:55], a[40:43]
    buffer_load_dwordx4 v[116:119], v6, s[8:11], s40 offen
    v_mfma_f32_16x16x32_bf16 a[60:63], v[60:63], v[56:59], a[60:63]
    v_mfma_f32_16x16x32_bf16 a[4:7], v[64:67], v[44:47], a[4:7]
    s_mov_b32 s41, 17408
    buffer_load_dwordx4 v[112:115], v5, s[8:11], s41 offen
    v_mfma_f32_16x16x32_bf16 a[24:27], v[64:67], v[48:51], a[24:27]
    v_mfma_f32_16x16x32_bf16 a[44:47], v[64:67], v[52:55], a[44:47]
    buffer_load_dwordx4 v[120:123], v6, s[8:11], s41 offen
    v_mfma_f32_16x16x32_bf16 a[64:67], v[64:67], v[56:59], a[64:67]
    v_mfma_f32_16x16x32_bf16 a[8:11], v[68:71], v[44:47], a[8:11]
    s_add_u32 s42, s32, 78336
    buffer_load_dwordx4 v[124:127], v3, s[12:15], s42 offen offset:0
    v_mfma_f32_16x16x32_bf16 a[28:31], v[68:71], v[48:51], a[28:31]
    v_mfma_f32_16x16x32_bf16 a[48:51], v[68:71], v[52:55], a[48:51]
    buffer_load_dwordx4 v[128:131], v3, s[12:15], s42 offen offset:1024
    v_mfma_f32_16x16x32_bf16 a[68:71], v[68:71], v[56:59], a[68:71]
    v_mfma_f32_16x16x32_bf16 a[12:15], v[72:75], v[44:47], a[12:15]
    buffer_load_dwordx4 v[132:135], v3, s[12:15], s42 offen offset:2048
    v_mfma_f32_16x16x32_bf16 a[32:35], v[72:75], v[48:51], a[32:35]
    v_mfma_f32_16x16x32_bf16 a[52:55], v[72:75], v[52:55], a[52:55]
    buffer_load_dwordx4 v[136:139], v3, s[12:15], s42 offen offset:3072
    v_mfma_f32_16x16x32_bf16 a[72:75], v[72:75], v[56:59], a[72:75]
    v_mfma_f32_16x16x32_bf16 a[16:19], v[28:31], v[44:47], a[16:19]
    buffer_load_dwordx4 v[32:35], v4, s[12:15], s42 offen
    v_mfma_f32_16x16x32_bf16 a[36:39], v[28:31], v[48:51], a[36:39]
    v_mfma_f32_16x16x32_bf16 a[56:59], v[28:31], v[52:55], a[56:59]
    v_mfma_f32_16x16x32_bf16 a[76:79], v[28:31], v[56:59], a[76:79]
    s_waitcnt vmcnt(9)
    v_mfma_f32_16x16x32_bf16 a[0:3], v[92:95], v[76:79], a[0:3]
    s_mov_b32 s43, 26624
    buffer_load_dwordx4 v[44:47], v5, s[8:11], s43 offen
    v_mfma_f32_16x16x32_bf16 a[20:23], v[92:95], v[80:83], a[20:23]
    v_mfma_f32_16x16x32_bf16 a[40:43], v[92:95], v[84:87], a[40:43]
    buffer_load_dwordx4 v[52:55], v6, s[8:11], s43 offen
    v_mfma_f32_16x16x32_bf16 a[60:63], v[92:95], v[88:91], a[60:63]
    v_mfma_f32_16x16x32_bf16 a[4:7], v[96:99], v[76:79], a[4:7]
    s_mov_b32 s44, 35840
    buffer_load_dwordx4 v[48:51], v5, s[8:11], s44 offen
    v_mfma_f32_16x16x32_bf16 a[24:27], v[96:99], v[80:83], a[24:27]
    v_mfma_f32_16x16x32_bf16 a[44:47], v[96:99], v[84:87], a[44:47]
    buffer_load_dwordx4 v[56:59], v6, s[8:11], s44 offen
    v_mfma_f32_16x16x32_bf16 a[64:67], v[96:99], v[88:91], a[64:67]
    v_mfma_f32_16x16x32_bf16 a[8:11], v[100:103], v[76:79], a[8:11]
    s_add_u32 s45, s32, 82944
    buffer_load_dwordx4 v[60:63], v3, s[12:15], s45 offen offset:0
    v_mfma_f32_16x16x32_bf16 a[28:31], v[100:103], v[80:83], a[28:31]
    v_mfma_f32_16x16x32_bf16 a[48:51], v[100:103], v[84:87], a[48:51]
    buffer_load_dwordx4 v[64:67], v3, s[12:15], s45 offen offset:1024
    v_mfma_f32_16x16x32_bf16 a[68:71], v[100:103], v[88:91], a[68:71]
    v_mfma_f32_16x16x32_bf16 a[12:15], v[104:107], v[76:79], a[12:15]
    buffer_load_dwordx4 v[68:71], v3, s[12:15], s45 offen offset:2048
    v_mfma_f32_16x16x32_bf16 a[32:35], v[104:107], v[80:83], a[32:35]
    v_mfma_f32_16x16x32_bf16 a[52:55], v[104:107], v[84:87], a[52:55]
    buffer_load_dwordx4 v[72:75], v3, s[12:15], s45 offen offset:3072
    v_mfma_f32_16x16x32_bf16 a[72:75], v[104:107], v[88:91], a[72:75]
    v_mfma_f32_16x16x32_bf16 a[80:83], v[28:31], v[76:79], a[80:83]
    v_mfma_f32_16x16x32_bf16 a[84:87], v[28:31], v[80:83], a[84:87]
    v_mfma_f32_16x16x32_bf16 a[88:91], v[28:31], v[84:87], a[88:91]
    v_mfma_f32_16x16x32_bf16 a[92:95], v[28:31], v[88:91], a[92:95]
    s_waitcnt vmcnt(8)
    v_swap_b32 v110, v112
    v_swap_b32 v111, v113
    v_swap_b32 v118, v120
    v_swap_b32 v119, v121
    s_nop 1
    v_mfma_f32_16x16x32_bf16 a[0:3], v[124:127], v[108:111], a[0:3]
    buffer_load_dwordx4 v[76:79], v7, s[16:19], 0 offen offset:0
    v_mfma_f32_16x16x32_bf16 a[20:23], v[124:127], v[112:115], a[20:23]
    v_mfma_f32_16x16x32_bf16 a[40:43], v[124:127], v[116:119], a[40:43]
    buffer_load_dwordx4 v[80:83], v7, s[16:19], 0 offen offset:1024
    v_mfma_f32_16x16x32_bf16 a[60:63], v[124:127], v[120:123], a[60:63]
    v_mfma_f32_16x16x32_bf16 a[4:7], v[128:131], v[108:111], a[4:7]
    buffer_load_dwordx4 v[84:87], v8, s[16:19], 0 offen offset:0
    v_mfma_f32_16x16x32_bf16 a[24:27], v[128:131], v[112:115], a[24:27]
    v_mfma_f32_16x16x32_bf16 a[44:47], v[128:131], v[116:119], a[44:47]
    buffer_load_dwordx4 v[88:91], v8, s[16:19], 0 offen offset:1024
    v_mfma_f32_16x16x32_bf16 a[64:67], v[128:131], v[120:123], a[64:67]
    v_mfma_f32_16x16x32_bf16 a[8:11], v[132:135], v[108:111], a[8:11]
    s_add_u32 s46, s32, 87552
    buffer_load_dwordx4 v[92:95], v3, s[12:15], s46 offen offset:0
    v_mfma_f32_16x16x32_bf16 a[28:31], v[132:135], v[112:115], a[28:31]
    v_mfma_f32_16x16x32_bf16 a[48:51], v[132:135], v[116:119], a[48:51]
    buffer_load_dwordx4 v[96:99], v3, s[12:15], s46 offen offset:1024
    v_mfma_f32_16x16x32_bf16 a[68:71], v[132:135], v[120:123], a[68:71]
    v_mfma_f32_16x16x32_bf16 a[12:15], v[136:139], v[108:111], a[12:15]
    buffer_load_dwordx4 v[100:103], v3, s[12:15], s46 offen offset:2048
    v_mfma_f32_16x16x32_bf16 a[32:35], v[136:139], v[112:115], a[32:35]
    v_mfma_f32_16x16x32_bf16 a[52:55], v[136:139], v[116:119], a[52:55]
    buffer_load_dwordx4 v[104:107], v3, s[12:15], s46 offen offset:3072
    v_mfma_f32_16x16x32_bf16 a[72:75], v[136:139], v[120:123], a[72:75]
    v_mfma_f32_16x16x32_bf16 a[16:19], v[32:35], v[108:111], a[16:19]
    buffer_load_dwordx4 v[36:39], v4, s[12:15], s46 offen
    v_mfma_f32_16x16x32_bf16 a[36:39], v[32:35], v[112:115], a[36:39]
    v_mfma_f32_16x16x32_bf16 a[56:59], v[32:35], v[116:119], a[56:59]
    v_mfma_f32_16x16x32_bf16 a[76:79], v[32:35], v[120:123], a[76:79]
    s_waitcnt vmcnt(9)
    v_swap_b32 v46, v48
    v_swap_b32 v47, v49
    v_swap_b32 v54, v56
    v_swap_b32 v55, v57
    s_nop 1
    v_mfma_f32_16x16x32_bf16 a[0:3], v[60:63], v[44:47], a[0:3]
    s_mov_b32 s47, 2048
    buffer_load_dwordx4 v[108:111], v7, s[16:19], s47 offen offset:0
    v_mfma_f32_16x16x32_bf16 a[20:23], v[60:63], v[48:51], a[20:23]
    v_mfma_f32_16x16x32_bf16 a[40:43], v[60:63], v[52:55], a[40:43]
    buffer_load_dwordx4 v[112:115], v7, s[16:19], s47 offen offset:1024
    v_mfma_f32_16x16x32_bf16 a[60:63], v[60:63], v[56:59], a[60:63]
    v_mfma_f32_16x16x32_bf16 a[4:7], v[64:67], v[44:47], a[4:7]
    buffer_load_dwordx4 v[116:119], v8, s[16:19], s47 offen offset:0
    v_mfma_f32_16x16x32_bf16 a[24:27], v[64:67], v[48:51], a[24:27]
    v_mfma_f32_16x16x32_bf16 a[44:47], v[64:67], v[52:55], a[44:47]
    buffer_load_dwordx4 v[120:123], v8, s[16:19], s47 offen offset:1024
    v_mfma_f32_16x16x32_bf16 a[64:67], v[64:67], v[56:59], a[64:67]
    v_mfma_f32_16x16x32_bf16 a[8:11], v[68:71], v[44:47], a[8:11]
    s_add_u32 s48, s32, 92160
    buffer_load_dwordx4 v[124:127], v3, s[12:15], s48 offen offset:0
    v_mfma_f32_16x16x32_bf16 a[28:31], v[68:71], v[48:51], a[28:31]
    v_mfma_f32_16x16x32_bf16 a[48:51], v[68:71], v[52:55], a[48:51]
    buffer_load_dwordx4 v[128:131], v3, s[12:15], s48 offen offset:1024
    v_mfma_f32_16x16x32_bf16 a[68:71], v[68:71], v[56:59], a[68:71]
    v_mfma_f32_16x16x32_bf16 a[12:15], v[72:75], v[44:47], a[12:15]
    buffer_load_dwordx4 v[132:135], v3, s[12:15], s48 offen offset:2048
    v_mfma_f32_16x16x32_bf16 a[32:35], v[72:75], v[48:51], a[32:35]
    v_mfma_f32_16x16x32_bf16 a[52:55], v[72:75], v[52:55], a[52:55]
    buffer_load_dwordx4 v[136:139], v3, s[12:15], s48 offen offset:3072
    v_mfma_f32_16x16x32_bf16 a[72:75], v[72:75], v[56:59], a[72:75]
    v_mfma_f32_16x16x32_bf16 a[80:83], v[32:35], v[44:47], a[80:83]
    v_mfma_f32_16x16x32_bf16 a[84:87], v[32:35], v[48:51], a[84:87]
    v_mfma_f32_16x16x32_bf16 a[88:91], v[32:35], v[52:55], a[88:91]
    v_mfma_f32_16x16x32_bf16 a[92:95], v[32:35], v[56:59], a[92:95]
    s_waitcnt vmcnt(8)
    v_swap_b32 v78, v80
    v_swap_b32 v79, v81
    v_swap_b32 v86, v88
    v_swap_b32 v87, v89
    s_nop 1
    v_mfma_f32_16x16x32_bf16 a[0:3], v[92:95], v[76:79], a[0:3]
    s_mov_b32 s49, 4096
    buffer_load_dwordx4 v[44:47], v7, s[16:19], s49 offen offset:0
    v_mfma_f32_16x16x32_bf16 a[20:23], v[92:95], v[80:83], a[20:23]
    v_mfma_f32_16x16x32_bf16 a[40:43], v[92:95], v[84:87], a[40:43]
    buffer_load_dwordx4 v[48:51], v7, s[16:19], s49 offen offset:1024
    v_mfma_f32_16x16x32_bf16 a[60:63], v[92:95], v[88:91], a[60:63]
    v_mfma_f32_16x16x32_bf16 a[4:7], v[96:99], v[76:79], a[4:7]
    buffer_load_dwordx4 v[52:55], v8, s[16:19], s49 offen offset:0
    v_mfma_f32_16x16x32_bf16 a[24:27], v[96:99], v[80:83], a[24:27]
    v_mfma_f32_16x16x32_bf16 a[44:47], v[96:99], v[84:87], a[44:47]
    buffer_load_dwordx4 v[56:59], v8, s[16:19], s49 offen offset:1024
    v_mfma_f32_16x16x32_bf16 a[64:67], v[96:99], v[88:91], a[64:67]
    v_mfma_f32_16x16x32_bf16 a[8:11], v[100:103], v[76:79], a[8:11]
    s_add_u32 s50, s32, 96768
    buffer_load_dwordx4 v[60:63], v3, s[12:15], s50 offen offset:0
    v_mfma_f32_16x16x32_bf16 a[28:31], v[100:103], v[80:83], a[28:31]
    v_mfma_f32_16x16x32_bf16 a[48:51], v[100:103], v[84:87], a[48:51]
    buffer_load_dwordx4 v[64:67], v3, s[12:15], s50 offen offset:1024
    v_mfma_f32_16x16x32_bf16 a[68:71], v[100:103], v[88:91], a[68:71]
    v_mfma_f32_16x16x32_bf16 a[12:15], v[104:107], v[76:79], a[12:15]
    buffer_load_dwordx4 v[68:71], v3, s[12:15], s50 offen offset:2048
    v_mfma_f32_16x16x32_bf16 a[32:35], v[104:107], v[80:83], a[32:35]
    v_mfma_f32_16x16x32_bf16 a[52:55], v[104:107], v[84:87], a[52:55]
    buffer_load_dwordx4 v[72:75], v3, s[12:15], s50 offen offset:3072
    v_mfma_f32_16x16x32_bf16 a[72:75], v[104:107], v[88:91], a[72:75]
    v_mfma_f32_16x16x32_bf16 a[16:19], v[36:39], v[76:79], a[16:19]
    buffer_load_dwordx4 v[40:43], v4, s[12:15], s50 offen
    v_mfma_f32_16x16x32_bf16 a[36:39], v[36:39], v[80:83], a[36:39]
    v_mfma_f32_16x16x32_bf16 a[56:59], v[36:39], v[84:87], a[56:59]
    v_mfma_f32_16x16x32_bf16 a[76:79], v[36:39], v[88:91], a[76:79]
    s_waitcnt vmcnt(9)
    v_swap_b32 v110, v112
    v_swap_b32 v111, v113
    v_swap_b32 v118, v120
    v_swap_b32 v119, v121
    s_nop 1
    v_mfma_f32_16x16x32_bf16 a[0:3], v[124:127], v[108:111], a[0:3]
    s_mov_b32 s51, 6144
    buffer_load_dwordx4 v[76:79], v7, s[16:19], s51 offen offset:0
    v_mfma_f32_16x16x32_bf16 a[20:23], v[124:127], v[112:115], a[20:23]
    v_mfma_f32_16x16x32_bf16 a[40:43], v[124:127], v[116:119], a[40:43]
    buffer_load_dwordx4 v[80:83], v7, s[16:19], s51 offen offset:1024
    v_mfma_f32_16x16x32_bf16 a[60:63], v[124:127], v[120:123], a[60:63]
    v_mfma_f32_16x16x32_bf16 a[4:7], v[128:131], v[108:111], a[4:7]
    buffer_load_dwordx4 v[84:87], v8, s[16:19], s51 offen offset:0
    v_mfma_f32_16x16x32_bf16 a[24:27], v[128:131], v[112:115], a[24:27]
    v_mfma_f32_16x16x32_bf16 a[44:47], v[128:131], v[116:119], a[44:47]
    buffer_load_dwordx4 v[88:91], v8, s[16:19], s51 offen offset:1024
    v_mfma_f32_16x16x32_bf16 a[64:67], v[128:131], v[120:123], a[64:67]
    v_mfma_f32_16x16x32_bf16 a[8:11], v[132:135], v[108:111], a[8:11]
    s_add_u32 s52, s32, 101376
    buffer_load_dwordx4 v[92:95], v3, s[12:15], s52 offen offset:0
    v_mfma_f32_16x16x32_bf16 a[28:31], v[132:135], v[112:115], a[28:31]
    v_mfma_f32_16x16x32_bf16 a[48:51], v[132:135], v[116:119], a[48:51]
    buffer_load_dwordx4 v[96:99], v3, s[12:15], s52 offen offset:1024
    v_mfma_f32_16x16x32_bf16 a[68:71], v[132:135], v[120:123], a[68:71]
    v_mfma_f32_16x16x32_bf16 a[12:15], v[136:139], v[108:111], a[12:15]
    buffer_load_dwordx4 v[100:103], v3, s[12:15], s52 offen offset:2048
    v_mfma_f32_16x16x32_bf16 a[32:35], v[136:139], v[112:115], a[32:35]
    v_mfma_f32_16x16x32_bf16 a[52:55], v[136:139], v[116:119], a[52:55]
    buffer_load_dwordx4 v[104:107], v3, s[12:15], s52 offen offset:3072
    v_mfma_f32_16x16x32_bf16 a[72:75], v[136:139], v[120:123], a[72:75]
    v_mfma_f32_16x16x32_bf16 a[80:83], v[36:39], v[108:111], a[80:83]
    v_mfma_f32_16x16x32_bf16 a[84:87], v[36:39], v[112:115], a[84:87]
    v_mfma_f32_16x16x32_bf16 a[88:91], v[36:39], v[116:119], a[88:91]
    v_mfma_f32_16x16x32_bf16 a[92:95], v[36:39], v[120:123], a[92:95]
    s_waitcnt vmcnt(8)
    v_swap_b32 v46, v48
    v_swap_b32 v47, v49
    v_swap_b32 v54, v56
    v_swap_b32 v55, v57
    s_nop 1
    v_mfma_f32_16x16x32_bf16 a[0:3], v[60:63], v[44:47], a[0:3]
    v_mfma_f32_16x16x32_bf16 a[20:23], v[60:63], v[48:51], a[20:23]
    v_mfma_f32_16x16x32_bf16 a[40:43], v[60:63], v[52:55], a[40:43]
    v_mfma_f32_16x16x32_bf16 a[60:63], v[60:63], v[56:59], a[60:63]
    v_mfma_f32_16x16x32_bf16 a[4:7], v[64:67], v[44:47], a[4:7]
    v_mfma_f32_16x16x32_bf16 a[24:27], v[64:67], v[48:51], a[24:27]
    v_mfma_f32_16x16x32_bf16 a[44:47], v[64:67], v[52:55], a[44:47]
    v_mfma_f32_16x16x32_bf16 a[64:67], v[64:67], v[56:59], a[64:67]
    v_mfma_f32_16x16x32_bf16 a[8:11], v[68:71], v[44:47], a[8:11]
    v_mfma_f32_16x16x32_bf16 a[28:31], v[68:71], v[48:51], a[28:31]
    v_mfma_f32_16x16x32_bf16 a[48:51], v[68:71], v[52:55], a[48:51]
    v_mfma_f32_16x16x32_bf16 a[68:71], v[68:71], v[56:59], a[68:71]
    v_mfma_f32_16x16x32_bf16 a[12:15], v[72:75], v[44:47], a[12:15]
    v_mfma_f32_16x16x32_bf16 a[32:35], v[72:75], v[48:51], a[32:35]
    v_mfma_f32_16x16x32_bf16 a[52:55], v[72:75], v[52:55], a[52:55]
    v_mfma_f32_16x16x32_bf16 a[72:75], v[72:75], v[56:59], a[72:75]
    v_mfma_f32_16x16x32_bf16 a[16:19], v[40:43], v[44:47], a[16:19]
    v_mfma_f32_16x16x32_bf16 a[36:39], v[40:43], v[48:51], a[36:39]
    v_mfma_f32_16x16x32_bf16 a[56:59], v[40:43], v[52:55], a[56:59]
    v_mfma_f32_16x16x32_bf16 a[76:79], v[40:43], v[56:59], a[76:79]
    s_waitcnt vmcnt(0)
    v_swap_b32 v78, v80
    v_swap_b32 v79, v81
    v_swap_b32 v86, v88
    v_swap_b32 v87, v89
    s_nop 1
    v_mfma_f32_16x16x32_bf16 a[0:3], v[92:95], v[76:79], a[0:3]
    v_mfma_f32_16x16x32_bf16 a[20:23], v[92:95], v[80:83], a[20:23]
    v_mfma_f32_16x16x32_bf16 a[40:43], v[92:95], v[84:87], a[40:43]
    v_mfma_f32_16x16x32_bf16 a[60:63], v[92:95], v[88:91], a[60:63]
    v_mfma_f32_16x16x32_bf16 a[4:7], v[96:99], v[76:79], a[4:7]
    v_mfma_f32_16x16x32_bf16 a[24:27], v[96:99], v[80:83], a[24:27]
    v_mfma_f32_16x16x32_bf16 a[44:47], v[96:99], v[84:87], a[44:47]
    v_mfma_f32_16x16x32_bf16 a[64:67], v[96:99], v[88:91], a[64:67]
    v_mfma_f32_16x16x32_bf16 a[8:11], v[100:103], v[76:79], a[8:11]
    v_mfma_f32_16x16x32_bf16 a[28:31], v[100:103], v[80:83], a[28:31]
    v_mfma_f32_16x16x32_bf16 a[48:51], v[100:103], v[84:87], a[48:51]
    v_mfma_f32_16x16x32_bf16 a[68:71], v[100:103], v[88:91], a[68:71]
    v_mfma_f32_16x16x32_bf16 a[12:15], v[104:107], v[76:79], a[12:15]
    v_mfma_f32_16x16x32_bf16 a[32:35], v[104:107], v[80:83], a[32:35]
    v_mfma_f32_16x16x32_bf16 a[52:55], v[104:107], v[84:87], a[52:55]
    v_mfma_f32_16x16x32_bf16 a[72:75], v[104:107], v[88:91], a[72:75]
    v_mfma_f32_16x16x32_bf16 a[80:83], v[40:43], v[76:79], a[80:83]
    v_mfma_f32_16x16x32_bf16 a[84:87], v[40:43], v[80:83], a[84:87]
    v_mfma_f32_16x16x32_bf16 a[88:91], v[40:43], v[84:87], a[88:91]
    v_mfma_f32_16x16x32_bf16 a[92:95], v[40:43], v[88:91], a[92:95]
g3_fin:
    s_mul_i32 s6, s3, 15360
    v_add_u32 v14, s6, v3
    s_nop 5
    s_cmp_lg_u32 s3, 0
    s_cbranch_scc1 g3_red0
    ds_write_b128 v3, a[20:23] offset:25600
    ds_write_b128 v3, a[40:43] offset:35840
    ds_write_b128 v3, a[60:63] offset:46080
    ds_write_b128 v3, a[24:27] offset:26624
    ds_write_b128 v3, a[44:47] offset:36864
    ds_write_b128 v3, a[64:67] offset:47104
    ds_write_b128 v3, a[28:31] offset:27648
    ds_write_b128 v3, a[48:51] offset:37888
    ds_write_b128 v3, a[68:71] offset:48128
    ds_write_b128 v3, a[32:35] offset:28672
    ds_write_b128 v3, a[52:55] offset:38912
    ds_write_b128 v3, a[72:75] offset:49152
    s_mov_b32 exec_hi, 0
    ds_write_b128 v3, a[36:39] offset:29696
    s_not_b64 exec, exec
    ds_write_b128 v3, a[84:87] offset:29696
    s_mov_b64 exec, -1
    s_mov_b32 exec_hi, 0
    ds_write_b128 v3, a[56:59] offset:39936
    s_not_b64 exec, exec
    ds_write_b128 v3, a[88:91] offset:39936
    s_mov_b64 exec, -1
    s_mov_b32 exec_hi, 0
    ds_write_b128 v3, a[76:79] offset:50176
    s_not_b64 exec, exec
    ds_write_b128 v3, a[92:95] offset:50176
    s_mov_b64 exec, -1
    v_accvgpr_read_b32 v104, a0
    v_accvgpr_read_b32 v105, a1
    v_accvgpr_read_b32 v106, a2
    v_accvgpr_read_b32 v107, a3
    v_accvgpr_read_b32 v108, a4
    v_accvgpr_read_b32 v109, a5
    v_accvgpr_read_b32 v110, a6
    v_accvgpr_read_b32 v111, a7
    v_accvgpr_read_b32 v112, a8
    v_accvgpr_read_b32 v113, a9
    v_accvgpr_read_b32 v114, a10
    v_accvgpr_read_b32 v115, a11
    v_accvgpr_read_b32 v116, a12
    v_accvgpr_read_b32 v117, a13
    v_accvgpr_read_b32 v118, a14
    v_accvgpr_read_b32 v119, a15
    v_accvgpr_read_b32 v120, a16
    v_accvgpr_read_b32 v121, a17
    v_accvgpr_read_b32 v122, a18
    v_accvgpr_read_b32 v123, a19
    s_mov_b32 exec_lo, 0
    v_accvgpr_read_b32 v120, a80
    v_accvgpr_read_b32 v121, a81
    v_accvgpr_read_b32 v122, a82
    v_accvgpr_read_b32 v123, a83
    s_mov_b32 exec_lo, -1
g3_red0:
    s_cmp_lg_u32 s3, 1
    s_cbranch_scc1 g3_red1
    ds_write_b128 v3, a[0:3] offset:0
    ds_write_b128 v3, a[40:43] offset:40960
    ds_write_b128 v3, a[60:63] offset:51200
    ds_write_b128 v3, a[4:7] offset:1024
    ds_write_b128 v3, a[44:47] offset:41984
    ds_write_b128 v3, a[64:67] offset:52224
    ds_write_b128 v3, a[8:11] offset:2048
    ds_write_b128 v3, a[48:51] offset:43008
    ds_write_b128 v3, a[68:71] offset:53248
    ds_write_b128 v3, a[12:15] offset:3072
    ds_write_b128 v3, a[52:55] offset:44032
    ds_write_b128 v3, a[72:75] offset:54272
    s_mov_b32 exec_hi, 0
    ds_write_b128 v3, a[16:19] offset:4096
    s_not_b64 exec, exec
    ds_write_b128 v3, a[80:83] offset:4096
    s_mov_b64 exec, -1
    s_mov_b32 exec_hi, 0
    ds_write_b128 v3, a[56:59] offset:45056
    s_not_b64 exec, exec
    ds_write_b128 v3, a[88:91] offset:45056
    s_mov_b64 exec, -1
    s_mov_b32 exec_hi, 0
    ds_write_b128 v3, a[76:79] offset:55296
    s_not_b64 exec, exec
    ds_write_b128 v3, a[92:95] offset:55296
    s_mov_b64 exec, -1
    v_accvgpr_read_b32 v104, a20
    v_accvgpr_read_b32 v105, a21
    v_accvgpr_read_b32 v106, a22
    v_accvgpr_read_b32 v107, a23
    v_accvgpr_read_b32 v108, a24
    v_accvgpr_read_b32 v109, a25
    v_accvgpr_read_b32 v110, a26
    v_accvgpr_read_b32 v111, a27
    v_accvgpr_read_b32 v112, a28
    v_accvgpr_read_b32 v113, a29
    v_accvgpr_read_b32 v114, a30
    v_accvgpr_read_b32 v115, a31
    v_accvgpr_read_b32 v116, a32
    v_accvgpr_read_b32 v117, a33
    v_accvgpr_read_b32 v118, a34
    v_accvgpr_read_b32 v119, a35
    v_accvgpr_read_b32 v120, a36
    v_accvgpr_read_b32 v121, a37
    v_accvgpr_read_b32 v122, a38
    v_accvgpr_read_b32 v123, a39
    s_mov_b32 exec_lo, 0
    v_accvgpr_read_b32 v120, a84
    v_accvgpr_read_b32 v121, a85
    v_accvgpr_read_b32 v122, a86
    v_accvgpr_read_b32 v123, a87
    s_mov_b32 exec_lo, -1
g3_red1:
    s_cmp_lg_u32 s3, 2
    s_cbranch_scc1 g3_red2
    ds_write_b128 v3, a[0:3] offset:5120
    ds_write_b128 v3, a[20:23] offset:15360
    ds_write_b128 v3, a[60:63] offset:56320
    ds_write_b128 v3, a[4:7] offset:6144
    ds_write_b128 v3, a[24:27] offset:16384
    ds_write_b128 v3, a[64:67] offset:57344
    ds_write_b128 v3, a[8:11] offset:7168
    ds_write_b128 v3, a[28:31] offset:17408
    ds_write_b128 v3, a[68:71] offset:58368
    ds_write_b128 v3, a[12:15] offset:8192
    ds_write_b128 v3, a[32:35] offset:18432
    ds_write_b128 v3, a[72:75] offset:59392
    s_mov_b32 exec_hi, 0
    ds_write_b128 v3, a[16:19] offset:9216
    s_not_b64 exec, exec
    ds_write_b128 v3, a[80:83] offset:9216
    s_mov_b64 exec, -1
    s_mov_b32 exec_hi, 0
    ds_write_b128 v3, a[36:39] offset:19456
    s_not_b64 exec, exec
    ds_write_b128 v3, a[84:87] offset:19456
    s_mov_b64 exec, -1
    s_mov_b32 exec_hi, 0
    ds_write_b128 v3, a[76:79] offset:60416
    s_not_b64 exec, exec
    ds_write_b128 v3, a[92:95] offset:60416
    s_mov_b64 exec, -1
    v_accvgpr_read_b32 v104, a40
    v_accvgpr_read_b32 v105, a41
    v_accvgpr_read_b32 v106, a42
    v_accvgpr_read_b32 v107, a43
    v_accvgpr_read_b32 v108, a44
    v_accvgpr_read_b32 v109, a45
    v_accvgpr_read_b32 v110, a46
    v_accvgpr_read_b32 v111, a47
    v_accvgpr_read_b32 v112, a48
    v_accvgpr_read_b32 v113, a49
    v_accvgpr_read_b32 v114, a50
    v_accvgpr_read_b32 v115, a51
    v_accvgpr_read_b32 v116, a52
    v_accvgpr_read_b32 v117, a53
    v_accvgpr_read_b32 v118, a54
    v_accvgpr_read_b32 v119, a55
    v_accvgpr_read_b32 v120, a56
    v_accvgpr_read_b32 v121, a57
    v_accvgpr_read_b32 v122, a58
    v_accvgpr_read_b32 v123, a59
    s_mov_b32 exec_lo, 0
    v_accvgpr_read_b32 v120, a88
    v_accvgpr_read_b32 v121, a89
    v_accvgpr_read_b32 v122, a90
    v_accvgpr_read_b32 v123, a91
    s_mov_b32 exec_lo, -1
g3_red2:
    s_cmp_lg_u32 s3, 3
    s_cbranch_scc1 g3_red3
    ds_write_b128 v3, a[0:3] offset:10240
    ds_write_b128 v3, a[20:23] offset:20480
    ds_write_b128 v3, a[40:43] offset:30720
    ds_write_b128 v3, a[4:7] offset:11264
    ds_write_b128 v3, a[24:27] offset:21504
    ds_write_b128 v3, a[44:47] offset:31744
    ds_write_b128 v3, a[8:11] offset:12288
    ds_write_b128 v3, a[28:31] offset:22528
    ds_write_b128 v3, a[48:51] offset:32768
    ds_write_b128 v3, a[12:15] offset:13312
    ds_write_b128 v3, a[32:35] offset:23552
    ds_write_b128 v3, a[52:55] offset:33792
    s_mov_b32 exec_hi, 0
    ds_write_b128 v3, a[16:19] offset:14336
    s_not_b64 exec, exec
    ds_write_b128 v3, a[80:83] offset:14336
    s_mov_b64 exec, -1
    s_mov_b32 exec_hi, 0
    ds_write_b128 v3, a[36:39] offset:24576
    s_not_b64 exec, exec
    ds_write_b128 v3, a[84:87] offset:24576
    s_mov_b64 exec, -1
    s_mov_b32 exec_hi, 0
    ds_write_b128 v3, a[56:59] offset:34816
    s_not_b64 exec, exec
    ds_write_b128 v3, a[88:91] offset:34816
    s_mov_b64 exec, -1
    v_accvgpr_read_b32 v104, a60
    v_accvgpr_read_b32 v105, a61
    v_accvgpr_read_b32 v106, a62
    v_accvgpr_read_b32 v107, a63
    v_accvgpr_read_b32 v108, a64
    v_accvgpr_read_b32 v109, a65
    v_accvgpr_read_b32 v110, a66
    v_accvgpr_read_b32 v111, a67
    v_accvgpr_read_b32 v112, a68
    v_accvgpr_read_b32 v113, a69
    v_accvgpr_read_b32 v114, a70
    v_accvgpr_read_b32 v115, a71
    v_accvgpr_read_b32 v116, a72
    v_accvgpr_read_b32 v117, a73
    v_accvgpr_read_b32 v118, a74
    v_accvgpr_read_b32 v119, a75
    v_accvgpr_read_b32 v120, a76
    v_accvgpr_read_b32 v121, a77
    v_accvgpr_read_b32 v122, a78
    v_accvgpr_read_b32 v123, a79
    s_mov_b32 exec_lo, 0
    v_accvgpr_read_b32 v120, a92
    v_accvgpr_read_b32 v121, a93
    v_accvgpr_read_b32 v122, a94
    v_accvgpr_read_b32 v123, a95
    s_mov_b32 exec_lo, -1
g3_red3:
    s_waitcnt lgkmcnt(0)
    s_barrier
    ds_read_b128 v[44:47], v14 offset:0
    ds_read_b128 v[48:51], v14 offset:1024
    ds_read_b128 v[64:67], v14 offset:5120
    ds_read_b128 v[68:71], v14 offset:6144
    ds_read_b128 v[84:87], v14 offset:10240
    ds_read_b128 v[88:91], v14 offset:11264
    ds_read_b128 v[52:55], v14 offset:2048
    ds_read_b128 v[56:59], v14 offset:3072
    ds_read_b128 v[72:75], v14 offset:7168
    ds_read_b128 v[76:79], v14 offset:8192
    ds_read_b128 v[92:95], v14 offset:12288
    ds_read_b128 v[96:99], v14 offset:13312
    ds_read_b128 v[60:63], v14 offset:4096
    ds_read_b128 v[80:83], v14 offset:9216
    ds_read_b128 v[100:103], v14 offset:14336
    s_waitcnt lgkmcnt(13)
    v_pk_add_f32 v[104:105], v[104:105], v[44:45]
    v_pk_add_f32 v[106:107], v[106:107], v[46:47]
    v_pk_add_f32 v[108:109], v[108:109], v[48:49]
    v_pk_add_f32 v[110:111], v[110:111], v[50:51]
    s_waitcnt lgkmcnt(11)
    v_pk_add_f32 v[104:105], v[104:105], v[64:65]
    v_pk_add_f32 v[106:107], v[106:107], v[66:67]
    v_pk_add_f32 v[108:109], v[108:109], v[68:69]
    v_pk_add_f32 v[110:111], v[110:111], v[70:71]
    s_waitcnt lgkmcnt(9)
    v_pk_add_f32 v[104:105], v[104:105], v[84:85]
    v_pk_add_f32 v[106:107], v[106:107], v[86:87]
    v_pk_add_f32 v[108:109], v[108:109], v[88:89]
    v_pk_add_f32 v[110:111], v[110:111], v[90:91]
    v_cvt_pk_bf16_f32 v16, v104, v105
    v_cvt_pk_bf16_f32 v17, v106, v107
    v_cvt_pk_bf16_f32 v18, v108, v109
    v_cvt_pk_bf16_f32 v19, v110, v111
    buffer_store_dwordx4 v[16:19], v12, s[28:31], 0 offen offset:0
    s_waitcnt lgkmcnt(7)
    v_pk_add_f32 v[112:113], v[112:113], v[52:53]
    v_pk_add_f32 v[114:115], v[114:115], v[54:55]
    v_pk_add_f32 v[116:117], v[116:117], v[56:57]
    v_pk_add_f32 v[118:119], v[118:119], v[58:59]
    s_waitcnt lgkmcnt(5)
    v_pk_add_f32 v[112:113], v[112:113], v[72:73]
    v_pk_add_f32 v[114:115], v[114:115], v[74:75]
    v_pk_add_f32 v[116:117], v[116:117], v[76:77]
    v_pk_add_f32 v[118:119], v[118:119], v[78:79]
    s_waitcnt lgkmcnt(3)
    v_pk_add_f32 v[112:113], v[112:113], v[92:93]
    v_pk_add_f32 v[114:115], v[114:115], v[94:95]
    v_pk_add_f32 v[116:117], v[116:117], v[96:97]
    v_pk_add_f32 v[118:119], v[118:119], v[98:99]
    v_cvt_pk_bf16_f32 v20, v112, v113
    v_cvt_pk_bf16_f32 v21, v114, v115
    v_cvt_pk_bf16_f32 v22, v116, v117
    v_cvt_pk_bf16_f32 v23, v118, v119
    buffer_store_dwordx4 v[20:23], v12, s[28:31], 0 offen offset:64
    s_waitcnt lgkmcnt(2)
    v_pk_add_f32 v[120:121], v[120:121], v[60:61]
    v_pk_add_f32 v[122:123], v[122:123], v[62:63]
    s_waitcnt lgkmcnt(1)
    v_pk_add_f32 v[120:121], v[120:121], v[80:81]
    v_pk_add_f32 v[122:123], v[122:123], v[82:83]
    s_waitcnt lgkmcnt(0)
    v_pk_add_f32 v[120:121], v[120:121], v[100:101]
    v_pk_add_f32 v[122:123], v[122:123], v[102:103]
    v_mov_b32 v44, v120
    v_mov_b32 v45, v121
    v_mov_b32 v46, v122
    v_mov_b32 v47, v123
    s_nop 1
    v_permlane32_swap_b32 v44, v120
    v_permlane32_swap_b32 v45, v121
    v_permlane32_swap_b32 v46, v122
    v_permlane32_swap_b32 v47, v123
    s_nop 1
    v_pk_add_f32 v[120:121], v[120:121], v[44:45]
    v_pk_add_f32 v[122:123], v[122:123], v[46:47]
    v_cvt_pk_bf16_f32 v24, v120, v121
    v_cvt_pk_bf16_f32 v25, v122, v123
    s_mov_b32 exec_hi, 0
    buffer_store_dwordx2 v[24:25], v13, s[28:31], 0 offen offset:128
g3_end:
    s_endpgm
.section .rodata,"a"
.p2align 6
.amdhsa_kernel g1_kernel
  .amdhsa_next_free_vgpr 256
  .amdhsa_next_free_sgpr 102
  .amdhsa_accum_offset 256
  .amdhsa_group_segment_fixed_size 0
  .amdhsa_kernarg_size 88
  .amdhsa_user_sgpr_count 2
  .amdhsa_user_sgpr_kernarg_segment_ptr 1
  .amdhsa_system_sgpr_workgroup_id_x 1
.end_amdhsa_kernel
.p2align 6
.amdhsa_kernel g2_kernel
  .amdhsa_next_free_vgpr 256
  .amdhsa_next_free_sgpr 102
  .amdhsa_accum_offset 256
  .amdhsa_group_segment_fixed_size 0
  .amdhsa_kernarg_size 88
  .amdhsa_user_sgpr_count 2
  .amdhsa_user_sgpr_kernarg_segment_ptr 1
  .amdhsa_system_sgpr_workgroup_id_x 1
.end_amdhsa_kernel
.p2align 6
.amdhsa_kernel g3_kernel
  .amdhsa_next_free_vgpr 340
  .amdhsa_next_free_sgpr 102
  .amdhsa_accum_offset 244
  .amdhsa_group_segment_fixed_size 0
  .amdhsa_kernarg_size 88
  .amdhsa_user_sgpr_count 2
  .amdhsa_user_sgpr_kernarg_segment_ptr 1
  .amdhsa_system_sgpr_workgroup_id_x 1
.end_amdhsa_kernel
```
